```python
import torch

def _softmax(x, axis=-1):
    return torch.softmax(x, dim=axis)
def _gelu(x):
    return torch.nn.functional.gelu(x, approximate="tanh")
def _silu(x):
    return torch.nn.functional.silu(x)
def _sigmoid(x):
    return torch.sigmoid(x)
def _layernorm(x, axis=-1, eps=1e-5):
    m = x.mean(dim=axis, keepdim=True)
    v = x.var(dim=axis, keepdim=True, unbiased=False)
    return (x - m) / torch.sqrt(v + eps)
def _scatter_add(tgt, idx, src, axis=0):
    return tgt.clone().index_add_(axis, idx, src)
def _segment_sum(src, seg, n):
    out = torch.zeros((n,) + src.shape[1:], dtype=src.dtype)
    return out.index_add_(0, seg, src)
def _pad(x, pw):
    flat = tuple(v for pair in reversed(pw) for v in pair)
    return torch.nn.functional.pad(x, flat)

kernel_name = 'interleave_layers__linear_attn_block__glu_gated_glu__prompt'

def setup_inputs():

    _w = (lambda a: (lambda t: t.to(torch.bfloat16) if t.is_floating_point() else t)(torch.as_tensor(a)))
    def _A_setup():
        B, S, D = 1, 2048, 448
        return {
            "x": _w((lambda *s: torch.randn(*s, dtype=torch.bfloat16) * 0.05)(B, S, D)),
            "wqkv": _w((lambda *s: torch.randn(*s, dtype=torch.bfloat16) * 0.1)(D, 3 * D)),
            "wo": _w((lambda *s: torch.randn(*s, dtype=torch.bfloat16) * 0.05)(D, D)),
        }
    _A_in = _A_setup()

    def _B_setup():
        B, S, D, F = 1, 2048, 448, 1792
        return {
            "x": _w((lambda *s: torch.randn(*s, dtype=torch.bfloat16) * 0.05)(B, S, D)),
            "w_gate": _w((lambda *s: torch.randn(*s, dtype=torch.bfloat16) * 0.05)(D, F)),
            "w_up": _w((lambda *s: torch.randn(*s, dtype=torch.bfloat16) * 0.05)(D, F)),
            "w_down": _w((lambda *s: torch.randn(*s, dtype=torch.bfloat16) * 0.05)(F, D)),
        }
    _B_in = _B_setup()

    return {
        "A_x": _A_in["x"],
        "A_wqkv": _A_in["wqkv"],
        "A_wo": _A_in["wo"],
        "B_x": _B_in["x"],
        "B_w_gate": _B_in["w_gate"],
        "B_w_up": _B_in["w_up"],
        "B_w_down": _B_in["w_down"],
    }

def reference(A_x, A_wqkv, A_wo, B_x, B_w_gate, B_w_up, B_w_down):
    def _A_ref(x, wqkv, wo):
        B, S, D = x.shape
        H = 16; Dh = D // H
        qkv = (lambda x, *d: x.permute(*d))((x @ wqkv).reshape(B, S, 3, H, Dh), 2, 0, 3, 1, 4)
        q, k, v = qkv[0], qkv[1], qkv[2]
        phi = lambda t: torch.where(t > 0, t + 1, torch.exp(t)) + 1e-6
        pq, pk = phi(q), phi(k)
        kv = torch.einsum("bhsd,bhse->bhde", pk, v)
        z = torch.einsum("bhsd->bhd", pk)
        num = torch.einsum("bhqd,bhde->bhqe", pq, kv)
        den = torch.einsum("bhqd,bhd->bhq", pq, z)[..., None] + 1e-6
        o = num / den
        return (lambda x, *d: x.permute(*d))(o, 0, 2, 1, 3).reshape(B, S, D) @ wo

    def _B_ref(x, w_gate, w_up, w_down):
        g = torch.einsum("bsd,df->bsf", x, w_gate)
        u = torch.einsum("bsd,df->bsf", x, w_up)
        h = _sigmoid(g) * u
        return torch.einsum("bsf,fd->bsd", h, w_down)

    x = A_x
    x = x + _A_ref(_layernorm(x, axis=-1), A_wqkv, A_wo)
    x = x + _B_ref(_layernorm(x, axis=-1), B_w_gate, B_w_up, B_w_down)
    x = x + _A_ref(_layernorm(x, axis=-1), A_wqkv, A_wo)
    x = x + _B_ref(_layernorm(x, axis=-1), B_w_gate, B_w_up, B_w_down)
    return x
```

```asm
; @launch grid=(256,1,1) block=(256,1,1) lds=163840
.amdgcn_target "amdgcn-amd-amdhsa--gfx950"
.text
.globl interleave_layers__linear_attn_block__glu_gated_glu__prompt_kernel
.p2align 8
.type interleave_layers__linear_attn_block__glu_gated_glu__prompt_kernel,@function
interleave_layers__linear_attn_block__glu_gated_glu__prompt_kernel:
  s_cmp_ge_u32 s2, 256
  s_cbranch_scc1 L_end
  s_load_dwordx16 s[84:99], s[0:1], 0
  s_load_dwordx4 s[80:83], s[0:1], 64
  v_lshrrev_b32 v250, 6, v0
  v_and_b32 v0, 63, v0
  v_readfirstlane_b32 s3, v250
  v_lshlrev_b32 v1, 4, v0
  s_and_b32 s4, s2, 7
  s_lshr_b32 s5, s2, 3
  s_getpc_b64 s[78:79]
  s_lshl_b32 s71, s5, 2
  s_add_u32 s71, s71, s3
  s_min_u32 s54, s71, (L_fast_end-interleave_layers__linear_attn_block__glu_gated_glu__prompt_kernel)/512-1
  s_lshl_b32 s54, s54, 9
  v_lshrrev_b32 v251, 1, v1
  v_add_u32 v251, s54, v251
  global_load_dword a240, v251, s[78:79]
  s_and_b32 s6, s5, 15
  s_lshr_b32 s56, s5, 4
  s_lshl_b32 s54, s4, 1
  s_add_u32 s56, s56, s54
  s_lshl_b32 s7, s56, 2
  s_add_u32 s7, s7, s3
  v_lshrrev_b32 v250, 2, v0
  v_and_b32 v251, 3, v0
  v_lshlrev_b32 v251, 4, v251
  s_movk_i32 s54, 2688
  v_mad_u32_u24 v5, v250, s54, v251
  s_movk_i32 s54, 896
  v_mad_u32_u24 v6, v250, s54, v251
  s_movk_i32 s55, 3584
  v_mad_u32_u24 v7, v250, s55, v251
  s_mul_i32 s63, s3, 7168
  s_mul_i32 s65, s6, 86016
  s_add_u32 s65, s65, s63
  s_mul_i32 s68, s3, 401408
  s_lshl_b32 s54, s5, 6
  s_add_u32 s68, s68, s54
  s_mul_i32 s64, s3, 12288
  s_add_u32 s64, s64, 114688
  s_mul_i32 s70, s3, 5120
  s_add_u32 s70, s70, 143360
  s_mul_i32 s74, s7, 28672
  s_add_u32 s75, s74, 7168
  s_add_u32 s52, s74, 14336
  s_add_u32 s53, s74, 21504
  v_lshrrev_b32 v136, 3, v0
  v_lshrrev_b32 v137, 4, v0
  v_xor_b32 v137, v137, v0
  v_and_b32 v137, 7, v137
  v_mul_u32_u24 v136, 896, v136
  v_lshl_add_u32 v136, v137, 4, v136
  v_xor_b32 v137, 64, v136
  s_mul_i32 s73, s4, 229376
  s_lshl_b32 s57, s2, 2
  s_add_u32 s57, s57, s3
  s_cmp_ge_u32 s2, 196
  s_cbranch_scc1 L_prep2
  s_mul_i32 s58, s57, 9363
  s_lshr_b32 s58, s58, 16
  s_mul_i32 s59, s58, 7
  s_sub_u32 s59, s57, s59
  s_mul_i32 s60, s58, 14336
  s_lshl_b32 s61, s59, 7
  s_add_u32 s60, s60, s61
  s_add_u32 s61, s60, 64
  s_mul_i32 s48, s59, 229376
  s_lshl_b32 s58, s58, 10
  s_add_u32 s48, s48, s58
  s_add_u32 s48, s48, 7340032
  s_add_u32 s49, s48, 114688
  v_mov_b32 v249, v6
  s_branch L_prep3
L_prep2:
  s_sub_u32 s61, s57, 784
  s_mul_i32 s58, s61, 2341
  s_lshr_b32 s58, s58, 16
  s_mul_i32 s59, s58, 28
  s_sub_u32 s59, s61, s59
  s_mul_i32 s48, s58, 57344
  s_lshl_b32 s49, s59, 10
  s_add_u32 s48, s48, s49
  s_add_u32 s48, s48, 524288
  s_cmp_ge_u32 s61, 224
  s_cselect_b32 s48, 0x40000000, s48
  s_add_u32 s49, s48, 28672
  s_mul_i32 s60, s59, 57344
  s_lshl_b32 s58, s58, 6
  s_add_u32 s60, s60, s58
  s_add_u32 s60, s60, 3072
  s_mov_b32 s61, s60
  v_mov_b32 v249, v7
L_prep3:
  s_mul_i32 s58, s57, 9363
  s_lshr_b32 s58, s58, 22
  s_mul_i32 s59, s58, 448
  s_sub_u32 s59, s57, s59
  s_lshr_b32 s59, s59, 4
  s_and_b32 s54, s57, 15
  s_mul_i32 s50, s54, 86016
  s_add_u32 s50, s50, 16777216
  s_mul_i32 s54, s54, 56
  s_add_u32 s69, s57, 128
  s_lshr_b32 s69, s69, 4
  s_lshl_b32 s51, s69, 10
  s_add_u32 s51, s51, s50
  s_add_u32 s51, s51, 57344
  s_cmp_ge_u32 s57, 320
  s_cselect_b32 s51, 0x40000000, s51
  s_mul_i32 s69, s69, 43008
  s_add_u32 s69, s69, s54
  s_mul_i32 s55, s58, 28672
  s_add_u32 s50, s50, s55
  s_lshl_b32 s55, s59, 10
  s_add_u32 s50, s50, s55
  s_add_u32 s58, s58, 1
  s_mul_i32 s55, s58, 896
  s_cmp_eq_u32 s58, 3
  s_cselect_b32 s55, 0, s55
  s_mul_i32 s62, s59, 43008
  s_add_u32 s62, s62, s54
  s_add_u32 s62, s62, s55
  s_waitcnt lgkmcnt(0)
  s_mov_b32 s12, s86
  s_mov_b32 s13, s87
  s_mov_b32 s14, 1204224
  s_mov_b32 s15, 0x20000
  buffer_load_dwordx4 v[176:179], v5, s[12:15], s62 offen
  s_mov_b32 s36, s82
  s_mov_b32 s37, s83
  s_mov_b32 s38, 268435456
  s_mov_b32 s39, 0x20000
  v_mov_b32 v253, 0
  buffer_load_dwordx4 v[180:183], v5, s[12:15], s69 offen
  buffer_load_dword v15, v253, s[36:39], 0 offen sc1
  s_mov_b32 s8, s84
  s_mov_b32 s9, s85
  s_mov_b32 s10, 1835008
  s_mov_b32 s11, 0x20000
  s_mul_i32 s78, s71, 1792
  s_add_u32 s78, s78, 0
  s_add_u32 s78, s78, s73
  v_lshlrev_b32 v252, 3, v1
  v_min_u32 v252, 1664, v252
  buffer_load_dword a240, v252, s[8:11], s78 offen
  s_cmp_ge_u32 s2, 196
  s_cselect_b32 s44, s92, s96
  s_cselect_b32 s45, s93, s97
  s_cselect_b32 s28, s94, s96
  s_cselect_b32 s29, s95, s97
  s_mov_b32 s46, 1605632
  s_mov_b32 s47, 0x20000
  s_mov_b32 s30, 1605632
  s_mov_b32 s31, 0x20000
  s_mov_b32 s20, s92
  s_mov_b32 s21, s93
  s_mov_b32 s22, 1605632
  s_mov_b32 s23, 0x20000
  s_mov_b32 s24, s94
  s_mov_b32 s25, s95
  s_mov_b32 s26, 1605632
  s_mov_b32 s27, 0x20000
  s_mov_b32 s16, s88
  s_mov_b32 s17, s89
  s_mov_b32 s18, 401408
  s_mov_b32 s19, 0x20000
  s_add_u32 m0, s63, 0
  s_nop 0
  buffer_load_dwordx4 v136, s[8:11], s74 offen offset:0 lds
  s_add_u32 m0, s63, 28672
  s_nop 0
  buffer_load_dwordx4 v137, s[8:11], s75 offen offset:0 lds
  s_add_u32 m0, s63, 57344
  s_nop 0
  buffer_load_dwordx4 v136, s[8:11], s52 offen offset:0 lds
  s_add_u32 m0, s63, 86016
  s_nop 0
  buffer_load_dwordx4 v137, s[8:11], s53 offen offset:0 lds
  s_add_u32 m0, s63, 896
  s_nop 0
  buffer_load_dwordx4 v136, s[8:11], s74 offen offset:128 lds
  s_add_u32 m0, s63, 29568
  s_nop 0
  buffer_load_dwordx4 v137, s[8:11], s75 offen offset:128 lds
  s_add_u32 m0, s63, 58240
  s_nop 0
  buffer_load_dwordx4 v136, s[8:11], s52 offen offset:128 lds
  s_add_u32 m0, s63, 86912
  s_nop 0
  buffer_load_dwordx4 v137, s[8:11], s53 offen offset:128 lds
  s_mul_i32 s54, s5, 9363
  s_lshr_b32 s54, s54, 16
  s_mul_i32 s55, s54, 7
  s_sub_u32 s55, s5, s55
  s_cmp_ge_u32 s5, 28
  s_cselect_b32 s54, s55, s54
  s_cselect_b32 s55, 0, s55
  s_cselect_b32 s42, 0, 268435456
  s_cselect_b32 s34, 0, 1835008
  s_mov_b32 s40, s36
  s_mov_b32 s41, s37
  s_mov_b32 s43, 0x20000
  s_mov_b32 s32, s98
  s_mov_b32 s33, s99
  s_mov_b32 s35, 0x20000
  s_lshl_b32 s78, s4, 2
  s_add_u32 s54, s54, s78
  s_lshr_b32 s78, s3, 1
  s_lshl_b32 s76, s54, 1
  s_add_u32 s76, s76, s78
  s_and_b32 s79, s3, 1
  s_lshl_b32 s77, s55, 1
  s_add_u32 s77, s77, s79
  v_and_b32 v250, 31, v0
  v_lshrrev_b32 v251, 5, v0
  v_mul_u32_u24 v9, 896, v250
  v_lshl_add_u32 v9, v251, 4, v9
  s_mul_i32 s80, s76, 28672
  s_lshl_b32 s81, s77, 6
  s_add_u32 s80, s80, s81
  v_add_u32 v9, s80, v9
  v_lshlrev_b32 v11, 4, v250
  v_lshl_add_u32 v11, v251, 2, v11
  v_add_u32 v10, 86016, v1
  v_and_b32 v12, 7, v0
  v_lshlrev_b32 v12, 2, v12
  v_min_u32 v13, 13, v250
  v_lshlrev_b32 v13, 2, v13
  v_cmp_eq_u32 vcc, 0, v0
  v_bfrev_b32 v4, 1
  s_nop 0
  v_cndmask_b32 v4, v4, 0, vcc
  v_bfe_u32 v252, v0, 2, 2
  v_lshl_add_u32 v252, v251, 3, v252
  v_and_b32 v253, 1, v0
  v_lshlrev_b32 v253, 4, v253
  v_bfe_u32 v254, v0, 1, 1
  v_lshl_add_u32 v253, v254, 3, v253
  v_bfe_u32 v254, v0, 4, 1
  v_lshl_add_u32 v255, v252, 6, v253
  v_lshl_add_u32 v8, v254, 5, v255
  v_lshl_add_u32 v255, v254, 10, v255
  v_add_u32 v14, 86016, v8
  s_getreg_b32 s85, hwreg(HW_REG_XCC_ID)
  s_and_b32 s85, s85, 7
  s_lshr_b32 s80, s7, 1
  s_lshl_b32 s72, s80, 7
  s_lshl_b32 s80, s6, 3
  s_add_u32 s72, s72, s80
  s_lshl_b32 s80, s79, 2
  s_add_u32 s72, s72, s80
  s_add_u32 s72, s72, 8192
  s_lshl_b32 s73, s54, 7
  s_lshl_b32 s80, s3, 5
  s_add_u32 s73, s73, s80
  s_mul_i32 s78, s3, 401408
  s_lshl_b32 s80, s5, 5
  s_add_u32 s78, s78, s80
  s_add_u32 s78, s78, 2048
  v_and_b32 v252, 0xffffffdf, v7
  v_add_u32 v252, s78, v252
  v_and_b32 v253, 2, v0
  v_cmp_ne_u32 vcc, 0, v253
  v_mov_b32 v2, s20
  v_mov_b32 v253, s24
  v_cndmask_b32 v2, v2, v253, vcc
  v_mov_b32 v3, s21
  v_mov_b32 v253, s25
  v_cndmask_b32 v3, v3, v253, vcc
  v_add_co_u32 v2, vcc, v2, v252
  s_nop 1
  v_addc_co_u32 v3, vcc, 0, v3, vcc
  s_mov_b32 s66, 57344
  s_mov_b32 s67, 0
  s_and_b32 s79, s5, 1
  s_xor_b32 s79, s79, 1
  s_lshl_b32 s79, s79, 2
  s_lshl_b32 s89, s4, 3
  s_add_u32 s89, s89, s79
  s_add_u32 s89, s89, s3
  v_accvgpr_write_b32 a224, 0
  v_accvgpr_write_b32 a225, 0
  v_accvgpr_write_b32 a226, 0
  v_accvgpr_write_b32 a227, 0
  v_accvgpr_write_b32 a228, 0
  v_accvgpr_write_b32 a229, 0
  v_accvgpr_write_b32 a230, 0
  v_accvgpr_write_b32 a231, 0
  v_accvgpr_write_b32 a232, 0
  v_accvgpr_write_b32 a233, 0
  v_accvgpr_write_b32 a234, 0
  v_accvgpr_write_b32 a235, 0
  v_mov_b32 v252, 0x3f803f80
  v_accvgpr_write_b32 a236, v252
  v_accvgpr_write_b32 a237, v252
  v_accvgpr_write_b32 a238, v252
  v_accvgpr_write_b32 a239, v252
  v_bfe_u32 v253, v0, 1, 3
  v_xor_b32 v253, v253, v251
  v_and_b32 v138, 7, v0
  v_lshlrev_b32 v138, 7, v138
  v_lshl_add_u32 v138, v253, 4, v138
  v_bfe_u32 v253, v0, 3, 2
  v_mul_u32_u24 v253, 28672, v253
  v_add3_u32 v138, v138, v253, s63
  v_xor_b32 v139, 32, v138
  v_xor_b32 v140, 64, v138
  v_xor_b32 v141, 96, v138
  v_mov_b32 v204, 0
  v_mov_b32 v205, 0
  v_mov_b32 v206, 0
  v_mov_b32 v207, 0
  v_add_u32 v250, s70, v8
  v_add_u32 v255, s70, v255
  s_cmp_ge_u32 s2, 196
  s_cselect_b64 vcc, -1, 0
  s_cselect_b32 s78, 32, 1024
  v_cndmask_b32 v255, v250, v255, vcc
  v_add_u32 v254, s78, v255
  s_mov_b32 s96, s48
  s_mov_b32 s90, s49
  s_mov_b32 s91, s50
  s_mov_b32 s99, s51
  s_mov_b32 s48, 0
  s_mov_b32 s49, -1
  s_mov_b32 s50, 0x10000000
  s_mov_b32 s51, 0x10000000
  s_mov_b32 s80, 0x88888888
  s_mov_b32 s81, 0x88888888
  s_waitcnt vmcnt(9)
  v_readfirstlane_b32 s101, v15
  s_nop 0
  s_mul_i32 s88, s101, 0x9e3779b1
  s_add_u32 s88, s88, 0x3c6ef373
  s_and_b32 s79, s88, 0xbfffbfff
  v_mov_b32 v5, s79
  v_cndmask_b32 v179, v179, v5, s[80:81]
  v_cndmask_b32 v183, v183, v5, s[80:81]
  buffer_store_dwordx4 v[176:179], v1, s[36:39], s91 offen sc1
  buffer_store_dwordx4 v[180:183], v1, s[36:39], s99 offen sc1
  s_add_u32 m0, s63, 1792
  s_nop 0
  buffer_load_dwordx4 v136, s[8:11], s74 offen offset:256 lds
  s_add_u32 m0, s63, 30464
  s_nop 0
  buffer_load_dwordx4 v137, s[8:11], s75 offen offset:256 lds
  s_add_u32 m0, s63, 59136
  s_nop 0
  buffer_load_dwordx4 v136, s[8:11], s52 offen offset:256 lds
  s_add_u32 m0, s63, 87808
  s_nop 0
  buffer_load_dwordx4 v137, s[8:11], s53 offen offset:256 lds
  s_add_u32 m0, s63, 2688
  s_nop 0
  buffer_load_dwordx4 v136, s[8:11], s74 offen offset:384 lds
  s_add_u32 m0, s63, 31360
  s_nop 0
  buffer_load_dwordx4 v137, s[8:11], s75 offen offset:384 lds
  s_add_u32 m0, s63, 60032
  s_nop 0
  buffer_load_dwordx4 v136, s[8:11], s52 offen offset:384 lds
  s_add_u32 m0, s63, 88704
  s_nop 0
  buffer_load_dwordx4 v137, s[8:11], s53 offen offset:384 lds
  s_add_u32 m0, s63, 3584
  s_nop 0
  buffer_load_dwordx4 v136, s[8:11], s74 offen offset:512 lds
  s_add_u32 m0, s63, 32256
  s_nop 0
  buffer_load_dwordx4 v137, s[8:11], s75 offen offset:512 lds
  s_add_u32 m0, s63, 60928
  s_nop 0
  buffer_load_dwordx4 v136, s[8:11], s52 offen offset:512 lds
  s_add_u32 m0, s63, 89600
  s_nop 0
  buffer_load_dwordx4 v137, s[8:11], s53 offen offset:512 lds
  s_add_u32 m0, s63, 4480
  s_nop 0
  buffer_load_dwordx4 v136, s[8:11], s74 offen offset:640 lds
  s_add_u32 m0, s63, 33152
  s_nop 0
  buffer_load_dwordx4 v137, s[8:11], s75 offen offset:640 lds
  s_add_u32 m0, s63, 61824
  s_nop 0
  buffer_load_dwordx4 v136, s[8:11], s52 offen offset:640 lds
  s_add_u32 m0, s63, 90496
  s_nop 0
  buffer_load_dwordx4 v137, s[8:11], s53 offen offset:640 lds
  s_add_u32 m0, s63, 5376
  s_nop 0
  buffer_load_dwordx4 v136, s[8:11], s74 offen offset:768 lds
  s_add_u32 m0, s63, 34048
  s_nop 0
  buffer_load_dwordx4 v137, s[8:11], s75 offen offset:768 lds
  s_add_u32 m0, s63, 62720
  s_nop 0
  buffer_load_dwordx4 v136, s[8:11], s52 offen offset:768 lds
  s_add_u32 m0, s63, 91392
  s_nop 0
  buffer_load_dwordx4 v137, s[8:11], s53 offen offset:768 lds
  s_sub_u32 s52, s88, 1
  s_mov_b32 s53, 0
  s_waitcnt vmcnt(26)
  ds_read_b128 v[24:27], v138 offset:0
  ds_read_b128 v[28:31], v139 offset:0
  ds_read_b128 v[32:35], v140 offset:0
  ds_read_b128 v[36:39], v141 offset:0
  s_waitcnt vmcnt(22)
  ds_read_b128 v[40:43], v138 offset:1024
  ds_read_b128 v[44:47], v139 offset:1024
  ds_read_b128 v[48:51], v140 offset:1024
  ds_read_b128 v[52:55], v141 offset:1024
  s_waitcnt lgkmcnt(7)
  v_dot2c_f32_bf16 v204, v24, v252
  v_dot2c_f32_bf16 v205, v24, v24
  v_dot2c_f32_bf16 v206, v25, v252
  v_dot2c_f32_bf16 v207, v25, v25
  v_dot2c_f32_bf16 v204, v26, v252
  v_dot2c_f32_bf16 v205, v26, v26
  v_dot2c_f32_bf16 v206, v27, v252
  v_dot2c_f32_bf16 v207, v27, v27
  s_waitcnt lgkmcnt(6)
  v_dot2c_f32_bf16 v204, v28, v252
  v_dot2c_f32_bf16 v205, v28, v28
  v_dot2c_f32_bf16 v206, v29, v252
  v_dot2c_f32_bf16 v207, v29, v29
  v_dot2c_f32_bf16 v204, v30, v252
  v_dot2c_f32_bf16 v205, v30, v30
  v_dot2c_f32_bf16 v206, v31, v252
  v_dot2c_f32_bf16 v207, v31, v31
  s_waitcnt lgkmcnt(5)
  v_dot2c_f32_bf16 v204, v32, v252
  v_dot2c_f32_bf16 v205, v32, v32
  v_dot2c_f32_bf16 v206, v33, v252
  v_dot2c_f32_bf16 v207, v33, v33
  v_dot2c_f32_bf16 v204, v34, v252
  v_dot2c_f32_bf16 v205, v34, v34
  v_dot2c_f32_bf16 v206, v35, v252
  v_dot2c_f32_bf16 v207, v35, v35
  s_waitcnt lgkmcnt(4)
  v_dot2c_f32_bf16 v204, v36, v252
  v_dot2c_f32_bf16 v205, v36, v36
  v_dot2c_f32_bf16 v206, v37, v252
  v_dot2c_f32_bf16 v207, v37, v37
  v_dot2c_f32_bf16 v204, v38, v252
  v_dot2c_f32_bf16 v205, v38, v38
  v_dot2c_f32_bf16 v206, v39, v252
  v_dot2c_f32_bf16 v207, v39, v39
  s_waitcnt vmcnt(16)
  ds_read_b128 v[56:59], v138 offset:2048
  ds_read_b128 v[60:63], v139 offset:2048
  ds_read_b128 v[64:67], v140 offset:2048
  ds_read_b128 v[68:71], v141 offset:2048
  s_waitcnt lgkmcnt(7)
  v_dot2c_f32_bf16 v204, v40, v252
  v_dot2c_f32_bf16 v205, v40, v40
  v_dot2c_f32_bf16 v206, v41, v252
  v_dot2c_f32_bf16 v207, v41, v41
  v_dot2c_f32_bf16 v204, v42, v252
  v_dot2c_f32_bf16 v205, v42, v42
  v_dot2c_f32_bf16 v206, v43, v252
  v_dot2c_f32_bf16 v207, v43, v43
  s_waitcnt lgkmcnt(6)
  v_dot2c_f32_bf16 v204, v44, v252
  v_dot2c_f32_bf16 v205, v44, v44
  v_dot2c_f32_bf16 v206, v45, v252
  v_dot2c_f32_bf16 v207, v45, v45
  v_dot2c_f32_bf16 v204, v46, v252
  v_dot2c_f32_bf16 v205, v46, v46
  v_dot2c_f32_bf16 v206, v47, v252
  v_dot2c_f32_bf16 v207, v47, v47
  s_waitcnt lgkmcnt(5)
  v_dot2c_f32_bf16 v204, v48, v252
  v_dot2c_f32_bf16 v205, v48, v48
  v_dot2c_f32_bf16 v206, v49, v252
  v_dot2c_f32_bf16 v207, v49, v49
  v_dot2c_f32_bf16 v204, v50, v252
  v_dot2c_f32_bf16 v205, v50, v50
  v_dot2c_f32_bf16 v206, v51, v252
  v_dot2c_f32_bf16 v207, v51, v51
  s_waitcnt lgkmcnt(4)
  v_dot2c_f32_bf16 v204, v52, v252
  v_dot2c_f32_bf16 v205, v52, v52
  v_dot2c_f32_bf16 v206, v53, v252
  v_dot2c_f32_bf16 v207, v53, v53
  v_dot2c_f32_bf16 v204, v54, v252
  v_dot2c_f32_bf16 v205, v54, v54
  v_dot2c_f32_bf16 v206, v55, v252
  v_dot2c_f32_bf16 v207, v55, v55
  s_add_u32 m0, s63, 114688
  s_add_u32 s97, s65, 16805888
  buffer_load_dwordx4 v1, s[36:39], s97 offen sc1 lds
  s_add_u32 m0, s63, 115712
  s_add_u32 s97, s65, 16806912
  buffer_load_dwordx4 v1, s[36:39], s97 offen sc1 lds
  s_add_u32 m0, s63, 116736
  s_add_u32 s97, s65, 16807936
  buffer_load_dwordx4 v1, s[36:39], s97 offen sc1 lds
  s_add_u32 m0, s63, 117760
  s_add_u32 s97, s65, 16808960
  buffer_load_dwordx4 v1, s[36:39], s97 offen sc1 lds
  s_add_u32 m0, s63, 118784
  s_add_u32 s97, s65, 16809984
  buffer_load_dwordx4 v1, s[36:39], s97 offen sc1 lds
  s_add_u32 m0, s63, 119808
  s_add_u32 s97, s65, 16811008
  buffer_load_dwordx4 v1, s[36:39], s97 offen sc1 lds
  s_add_u32 m0, s63, 120832
  s_add_u32 s97, s65, 16812032
  buffer_load_dwordx4 v1, s[36:39], s97 offen sc1 lds
  s_waitcnt vmcnt(19)
  ds_read_b128 v[72:75], v138 offset:3072
  ds_read_b128 v[76:79], v139 offset:3072
  ds_read_b128 v[80:83], v140 offset:3072
  ds_read_b128 v[84:87], v141 offset:3072
  s_waitcnt lgkmcnt(7)
  v_dot2c_f32_bf16 v204, v56, v252
  v_dot2c_f32_bf16 v205, v56, v56
  v_dot2c_f32_bf16 v206, v57, v252
  v_dot2c_f32_bf16 v207, v57, v57
  v_dot2c_f32_bf16 v204, v58, v252
  v_dot2c_f32_bf16 v205, v58, v58
  v_dot2c_f32_bf16 v206, v59, v252
  v_dot2c_f32_bf16 v207, v59, v59
  s_waitcnt lgkmcnt(6)
  v_dot2c_f32_bf16 v204, v60, v252
  v_dot2c_f32_bf16 v205, v60, v60
  v_dot2c_f32_bf16 v206, v61, v252
  v_dot2c_f32_bf16 v207, v61, v61
  v_dot2c_f32_bf16 v204, v62, v252
  v_dot2c_f32_bf16 v205, v62, v62
  v_dot2c_f32_bf16 v206, v63, v252
  v_dot2c_f32_bf16 v207, v63, v63
  s_waitcnt lgkmcnt(5)
  v_dot2c_f32_bf16 v204, v64, v252
  v_dot2c_f32_bf16 v205, v64, v64
  v_dot2c_f32_bf16 v206, v65, v252
  v_dot2c_f32_bf16 v207, v65, v65
  v_dot2c_f32_bf16 v204, v66, v252
  v_dot2c_f32_bf16 v205, v66, v66
  v_dot2c_f32_bf16 v206, v67, v252
  v_dot2c_f32_bf16 v207, v67, v67
  s_waitcnt lgkmcnt(4)
  v_dot2c_f32_bf16 v204, v68, v252
  v_dot2c_f32_bf16 v205, v68, v68
  v_dot2c_f32_bf16 v206, v69, v252
  v_dot2c_f32_bf16 v207, v69, v69
  v_dot2c_f32_bf16 v204, v70, v252
  v_dot2c_f32_bf16 v205, v70, v70
  v_dot2c_f32_bf16 v206, v71, v252
  v_dot2c_f32_bf16 v207, v71, v71
  s_waitcnt vmcnt(15)
  ds_read_b128 v[88:91], v138 offset:4096
  ds_read_b128 v[92:95], v139 offset:4096
  ds_read_b128 v[96:99], v140 offset:4096
  ds_read_b128 v[100:103], v141 offset:4096
  s_waitcnt lgkmcnt(7)
  v_dot2c_f32_bf16 v204, v72, v252
  v_dot2c_f32_bf16 v205, v72, v72
  v_dot2c_f32_bf16 v206, v73, v252
  v_dot2c_f32_bf16 v207, v73, v73
  v_dot2c_f32_bf16 v204, v74, v252
  v_dot2c_f32_bf16 v205, v74, v74
  v_dot2c_f32_bf16 v206, v75, v252
  v_dot2c_f32_bf16 v207, v75, v75
  s_waitcnt lgkmcnt(6)
  v_dot2c_f32_bf16 v204, v76, v252
  v_dot2c_f32_bf16 v205, v76, v76
  v_dot2c_f32_bf16 v206, v77, v252
  v_dot2c_f32_bf16 v207, v77, v77
  v_dot2c_f32_bf16 v204, v78, v252
  v_dot2c_f32_bf16 v205, v78, v78
  v_dot2c_f32_bf16 v206, v79, v252
  v_dot2c_f32_bf16 v207, v79, v79
  s_waitcnt lgkmcnt(5)
  v_dot2c_f32_bf16 v204, v80, v252
  v_dot2c_f32_bf16 v205, v80, v80
  v_dot2c_f32_bf16 v206, v81, v252
  v_dot2c_f32_bf16 v207, v81, v81
  v_dot2c_f32_bf16 v204, v82, v252
  v_dot2c_f32_bf16 v205, v82, v82
  v_dot2c_f32_bf16 v206, v83, v252
  v_dot2c_f32_bf16 v207, v83, v83
  s_waitcnt lgkmcnt(4)
  v_dot2c_f32_bf16 v204, v84, v252
  v_dot2c_f32_bf16 v205, v84, v84
  v_dot2c_f32_bf16 v206, v85, v252
  v_dot2c_f32_bf16 v207, v85, v85
  v_dot2c_f32_bf16 v204, v86, v252
  v_dot2c_f32_bf16 v205, v86, v86
  v_dot2c_f32_bf16 v206, v87, v252
  v_dot2c_f32_bf16 v207, v87, v87
  s_waitcnt vmcnt(11)
  ds_read_b128 v[104:107], v138 offset:5120
  ds_read_b128 v[108:111], v139 offset:5120
  ds_read_b128 v[112:115], v140 offset:5120
  ds_read_b128 v[116:119], v141 offset:5120
  s_waitcnt lgkmcnt(7)
  v_dot2c_f32_bf16 v204, v88, v252
  v_dot2c_f32_bf16 v205, v88, v88
  v_dot2c_f32_bf16 v206, v89, v252
  v_dot2c_f32_bf16 v207, v89, v89
  v_dot2c_f32_bf16 v204, v90, v252
  v_dot2c_f32_bf16 v205, v90, v90
  v_dot2c_f32_bf16 v206, v91, v252
  v_dot2c_f32_bf16 v207, v91, v91
  s_waitcnt lgkmcnt(6)
  v_dot2c_f32_bf16 v204, v92, v252
  v_dot2c_f32_bf16 v205, v92, v92
  v_dot2c_f32_bf16 v206, v93, v252
  v_dot2c_f32_bf16 v207, v93, v93
  v_dot2c_f32_bf16 v204, v94, v252
  v_dot2c_f32_bf16 v205, v94, v94
  v_dot2c_f32_bf16 v206, v95, v252
  v_dot2c_f32_bf16 v207, v95, v95
  s_waitcnt lgkmcnt(5)
  v_dot2c_f32_bf16 v204, v96, v252
  v_dot2c_f32_bf16 v205, v96, v96
  v_dot2c_f32_bf16 v206, v97, v252
  v_dot2c_f32_bf16 v207, v97, v97
  v_dot2c_f32_bf16 v204, v98, v252
  v_dot2c_f32_bf16 v205, v98, v98
  v_dot2c_f32_bf16 v206, v99, v252
  v_dot2c_f32_bf16 v207, v99, v99
  s_waitcnt lgkmcnt(4)
  v_dot2c_f32_bf16 v204, v100, v252
  v_dot2c_f32_bf16 v205, v100, v100
  v_dot2c_f32_bf16 v206, v101, v252
  v_dot2c_f32_bf16 v207, v101, v101
  v_dot2c_f32_bf16 v204, v102, v252
  v_dot2c_f32_bf16 v205, v102, v102
  v_dot2c_f32_bf16 v206, v103, v252
  v_dot2c_f32_bf16 v207, v103, v103
  s_waitcnt vmcnt(7)
  ds_read_b128 v[120:123], v138 offset:6144
  ds_read_b128 v[124:127], v139 offset:6144
  ds_read_b128 v[128:131], v140 offset:6144
  ds_read_b128 v[132:135], v141 offset:6144
  s_waitcnt lgkmcnt(0)
  s_add_u32 m0, s63, 86016
  s_add_u32 s97, s65, 16777216
  buffer_load_dwordx4 v1, s[36:39], s97 offen sc1 lds
  s_add_u32 m0, s63, 87040
  s_add_u32 s97, s65, 16778240
  buffer_load_dwordx4 v1, s[36:39], s97 offen sc1 lds
  s_add_u32 m0, s63, 88064
  s_add_u32 s97, s65, 16779264
  buffer_load_dwordx4 v1, s[36:39], s97 offen sc1 lds
  s_add_u32 m0, s63, 89088
  s_add_u32 s97, s65, 16780288
  buffer_load_dwordx4 v1, s[36:39], s97 offen sc1 lds
  s_add_u32 m0, s63, 90112
  s_add_u32 s97, s65, 16781312
  buffer_load_dwordx4 v1, s[36:39], s97 offen sc1 lds
  s_add_u32 m0, s63, 91136
  s_add_u32 s97, s65, 16782336
  buffer_load_dwordx4 v1, s[36:39], s97 offen sc1 lds
  s_add_u32 m0, s63, 92160
  s_add_u32 s97, s65, 16783360
  buffer_load_dwordx4 v1, s[36:39], s97 offen sc1 lds
  v_dot2c_f32_bf16 v204, v104, v252
  v_dot2c_f32_bf16 v205, v104, v104
  v_dot2c_f32_bf16 v206, v105, v252
  v_dot2c_f32_bf16 v207, v105, v105
  v_dot2c_f32_bf16 v204, v106, v252
  v_dot2c_f32_bf16 v205, v106, v106
  v_dot2c_f32_bf16 v206, v107, v252
  v_dot2c_f32_bf16 v207, v107, v107
  v_dot2c_f32_bf16 v204, v108, v252
  v_dot2c_f32_bf16 v205, v108, v108
  v_dot2c_f32_bf16 v206, v109, v252
  v_dot2c_f32_bf16 v207, v109, v109
  v_dot2c_f32_bf16 v204, v110, v252
  v_dot2c_f32_bf16 v205, v110, v110
  v_dot2c_f32_bf16 v206, v111, v252
  v_dot2c_f32_bf16 v207, v111, v111
  v_dot2c_f32_bf16 v204, v112, v252
  v_dot2c_f32_bf16 v205, v112, v112
  v_dot2c_f32_bf16 v206, v113, v252
  v_dot2c_f32_bf16 v207, v113, v113
  v_dot2c_f32_bf16 v204, v114, v252
  v_dot2c_f32_bf16 v205, v114, v114
  v_dot2c_f32_bf16 v206, v115, v252
  v_dot2c_f32_bf16 v207, v115, v115
  v_dot2c_f32_bf16 v204, v116, v252
  v_dot2c_f32_bf16 v205, v116, v116
  v_dot2c_f32_bf16 v206, v117, v252
  v_dot2c_f32_bf16 v207, v117, v117
  v_dot2c_f32_bf16 v204, v118, v252
  v_dot2c_f32_bf16 v205, v118, v118
  v_dot2c_f32_bf16 v206, v119, v252
  v_dot2c_f32_bf16 v207, v119, v119
  v_dot2c_f32_bf16 v204, v120, v252
  v_dot2c_f32_bf16 v205, v120, v120
  v_dot2c_f32_bf16 v206, v121, v252
  v_dot2c_f32_bf16 v207, v121, v121
  v_dot2c_f32_bf16 v204, v122, v252
  v_dot2c_f32_bf16 v205, v122, v122
  v_dot2c_f32_bf16 v206, v123, v252
  v_dot2c_f32_bf16 v207, v123, v123
  v_dot2c_f32_bf16 v204, v124, v252
  v_dot2c_f32_bf16 v205, v124, v124
  v_dot2c_f32_bf16 v206, v125, v252
  v_dot2c_f32_bf16 v207, v125, v125
  v_dot2c_f32_bf16 v204, v126, v252
  v_dot2c_f32_bf16 v205, v126, v126
  v_dot2c_f32_bf16 v206, v127, v252
  v_dot2c_f32_bf16 v207, v127, v127
  v_dot2c_f32_bf16 v204, v128, v252
  v_dot2c_f32_bf16 v205, v128, v128
  v_dot2c_f32_bf16 v206, v129, v252
  v_dot2c_f32_bf16 v207, v129, v129
  v_dot2c_f32_bf16 v204, v130, v252
  v_dot2c_f32_bf16 v205, v130, v130
  v_dot2c_f32_bf16 v206, v131, v252
  v_dot2c_f32_bf16 v207, v131, v131
  v_dot2c_f32_bf16 v204, v132, v252
  v_dot2c_f32_bf16 v205, v132, v132
  v_dot2c_f32_bf16 v206, v133, v252
  v_dot2c_f32_bf16 v207, v133, v133
  v_dot2c_f32_bf16 v204, v134, v252
  v_dot2c_f32_bf16 v205, v134, v134
  v_dot2c_f32_bf16 v206, v135, v252
  v_dot2c_f32_bf16 v207, v135, v135
  s_nop 1
  v_add_f32 v200, v204, v206
  v_add_f32 v201, v205, v207
  v_lshlrev_b32 v253, 3, v1
  v_min_u32 v253, 1536, v253
  s_mul_i32 s78, s57, 1664
  buffer_load_dword a240, v253, s[20:23], s78 offen
  buffer_load_dword a240, v253, s[24:27], s78 offen
  v_min_u32 v253, 384, v253
  s_lshl_b32 s78, s57, 9
  buffer_load_dword a240, v253, s[16:19], s78 offen
  s_mov_b32 m0, s70
  s_nop 0
  buffer_load_dwordx4 v249, s[44:47], s60 offen lds
  s_add_u32 m0, s70, 1024
  s_nop 0
  buffer_load_dwordx4 v249, s[28:31], s61 offen lds
  s_movk_i32 s57, 4096
  s_movk_i32 s58, 8192
  s_movk_i32 s59, 12288
  s_movk_i32 s60, 16384
  s_movk_i32 s61, 20480
  s_movk_i32 s62, 24576
  s_movk_i32 s98, 28672
  s_mul_i32 s69, s3, 100352
  s_lshl_b32 s80, s55, 7
  s_add_u32 s69, s69, s80
  s_add_u32 m0, s63, 0
  s_add_u32 s97, s68, 0
  buffer_load_dwordx4 v7, s[20:23], s97 offen  lds
  s_add_u32 m0, s63, 1024
  s_add_u32 s97, s68, 57344
  buffer_load_dwordx4 v7, s[20:23], s97 offen  lds
  s_mov_b32 s74, 0x3f317218
  s_mov_b32 s75, 0x3f803f80
  v_bfe_u32 v248, v1, 6, 3
  v_mul_u32_u24 v6, 896, v248
  v_and_b32 v248, 48, v1
  v_add_u32 v6, v6, v248
  s_and_b32 s79, s3, 1
  v_xor_b32 v248, s79, v251
  v_lshl_add_u32 v6, v248, 6, v6
  v_add_u32 v246, s63, v14
  v_lshlrev_b32 v247, 2, v1
  v_add_u32 v247, s63, v247
  v_add_u32 v247, 86076, v247
  s_waitcnt vmcnt(14)
Lvc_1:
  ds_read_b32 v248, v247 offset:28672
  ds_read_b32 v15, v247 offset:31744
  s_waitcnt lgkmcnt(0)
  v_xor_b32 v248, v248, v5
  v_bitop3_b32 v248, v248, v15, v5 bitop3:0xf6
  v_cmp_ne_u32 vcc, 0, v248
  s_cbranch_vccnz Lvr_2
Lvd_3:
  ds_read_b64_tr_b16 v[216:217], v246 offset:28672
  ds_read_b64_tr_b16 v[218:219], v246 offset:28928
  ds_read_b64_tr_b16 v[220:221], v246 offset:29696
  ds_read_b64_tr_b16 v[222:223], v246 offset:29952
  ds_read_b64_tr_b16 v[224:225], v246 offset:30720
  ds_read_b64_tr_b16 v[226:227], v246 offset:30976
  s_waitcnt lgkmcnt(4)
  v_mfma_f32_32x32x16_bf16 v[152:167], a[236:239], v[216:219], 0
  ds_read_b64_tr_b16 v[228:229], v246 offset:31744
  ds_read_b64_tr_b16 v[230:231], v246 offset:32000
  s_add_u32 m0, s63, 2048
  s_add_u32 s97, s68, 114688
  buffer_load_dwordx4 v7, s[20:23], s97 offen  lds
  s_waitcnt lgkmcnt(4)
  v_mfma_f32_32x32x16_bf16 v[152:167], a[236:239], v[220:223], v[152:167]
  ds_read_b64_tr_b16 v[232:233], v246 offset:32768
  ds_read_b64_tr_b16 v[234:235], v246 offset:33024
  s_waitcnt lgkmcnt(4)
  v_mfma_f32_32x32x16_bf16 v[152:167], a[236:239], v[224:227], v[152:167]
  ds_read_b64_tr_b16 v[236:237], v246 offset:33792
  ds_read_b64_tr_b16 v[238:239], v246 offset:34048
  s_waitcnt lgkmcnt(4)
  v_mfma_f32_32x32x16_bf16 v[152:167], a[236:239], v[228:231], v[152:167]
  ds_read_b64_tr_b16 v[216:217], v246 offset:34816
  ds_read_b64_tr_b16 v[218:219], v246 offset:35072
  s_waitcnt lgkmcnt(4)
  v_mfma_f32_32x32x16_bf16 v[152:167], a[236:239], v[232:235], v[152:167]
  s_waitcnt lgkmcnt(2)
  v_mfma_f32_32x32x16_bf16 v[152:167], a[236:239], v[236:239], v[152:167]
  s_waitcnt lgkmcnt(0)
  v_mfma_f32_32x32x16_bf16 v[152:167], a[236:239], v[216:219], v[152:167]
  s_add_u32 m0, s63, 3072
  s_add_u32 s97, s68, 172032
  buffer_load_dwordx4 v7, s[20:23], s97 offen  lds
  v_lshlrev_b32 v247, 2, v1
  v_add_u32 v247, s63, v247
  v_add_u32 v247, 86076, v247
  s_waitcnt vmcnt(9)
Lvc_4:
  ds_read_b32 v248, v247 offset:0
  ds_read_b32 v15, v247 offset:3072
  s_waitcnt lgkmcnt(0)
  v_xor_b32 v248, v248, v5
  v_bitop3_b32 v248, v248, v15, v5 bitop3:0xf6
  v_cmp_ne_u32 vcc, 0, v248
  s_cbranch_vccnz Lvr_5
Lvd_6:
  ds_read_b64_tr_b16 v[216:217], v246 offset:0
  ds_read_b64_tr_b16 v[218:219], v246 offset:256
  ds_read_b64_tr_b16 v[220:221], v246 offset:1024
  ds_read_b64_tr_b16 v[222:223], v246 offset:1280
  ds_read_b64_tr_b16 v[224:225], v246 offset:2048
  ds_read_b64_tr_b16 v[226:227], v246 offset:2304
  s_waitcnt lgkmcnt(4)
  v_mfma_f32_32x32x16_bf16 v[136:151], a[236:239], v[216:219], 0
  ds_read_b64_tr_b16 v[228:229], v246 offset:3072
  ds_read_b64_tr_b16 v[230:231], v246 offset:3328
  s_waitcnt lgkmcnt(4)
  v_mfma_f32_32x32x16_bf16 v[136:151], a[236:239], v[220:223], v[136:151]
  ds_read_b64_tr_b16 v[232:233], v246 offset:4096
  ds_read_b64_tr_b16 v[234:235], v246 offset:4352
  s_waitcnt lgkmcnt(4)
  v_mfma_f32_32x32x16_bf16 v[136:151], a[236:239], v[224:227], v[136:151]
  ds_read_b64_tr_b16 v[236:237], v246 offset:5120
  ds_read_b64_tr_b16 v[238:239], v246 offset:5376
  s_waitcnt lgkmcnt(4)
  v_mfma_f32_32x32x16_bf16 v[136:151], a[236:239], v[228:231], v[136:151]
  ds_read_b64_tr_b16 v[216:217], v246 offset:6144
  ds_read_b64_tr_b16 v[218:219], v246 offset:6400
  s_waitcnt lgkmcnt(4)
  v_mfma_f32_32x32x16_bf16 v[136:151], a[236:239], v[232:235], v[136:151]
  s_waitcnt lgkmcnt(2)
  v_mfma_f32_32x32x16_bf16 v[136:151], a[236:239], v[236:239], v[136:151]
  s_add_u32 m0, s63, 4096
  s_add_u32 s97, s68, 229376
  buffer_load_dwordx4 v7, s[20:23], s97 offen  lds
  s_waitcnt lgkmcnt(0)
  v_mfma_f32_32x32x16_bf16 v[136:151], a[236:239], v[216:219], v[136:151]
  v_lshrrev_b32 v248, 2, v1
  v_and_b32 v248, 0x7c, v248
  v_add_u32 v248, s70, v248
  s_nop 8
  ds_write_b32 v248, v136 offset:4608
  ds_write_b32 v248, v152 offset:4736
  s_waitcnt lgkmcnt(0)
  s_barrier
  ds_read_b64_tr_b16 v[216:217], v14 offset:0
  ds_read_b64_tr_b16 v[218:219], v14 offset:256
  ds_read_b64_tr_b16 v[220:221], v14 offset:28672
  ds_read_b64_tr_b16 v[222:223], v14 offset:28928
  ds_read_b64_tr_b16 v[224:225], v14 offset:1024
  ds_read_b64_tr_b16 v[226:227], v14 offset:1280
  ds_read_b64_tr_b16 v[228:229], v14 offset:29696
  ds_read_b64_tr_b16 v[230:231], v14 offset:29952
  s_waitcnt lgkmcnt(4)
  v_mfma_f32_32x32x16_bf16 v[136:151], v[24:27], v[216:219], 0
  ds_read_b64_tr_b16 v[232:233], v14 offset:2048
  ds_read_b64_tr_b16 v[234:235], v14 offset:2304
  v_lshrrev_b32 v248, 2, v1
  v_and_b32 v248, 0x7c, v248
  v_add_u32 v248, 143360, v248
  ds_read_b32 v184, v248 offset:4608
  v_mfma_f32_32x32x16_bf16 v[152:167], v[24:27], v[220:223], 0
  ds_read_b64_tr_b16 v[236:237], v14 offset:30720
  ds_read_b64_tr_b16 v[238:239], v14 offset:30976
  ds_read_b32 v185, v248 offset:9728
  ds_read_b32 v186, v248 offset:14848
  ds_read_b32 v187, v248 offset:19968
  s_waitcnt lgkmcnt(8)
  v_mfma_f32_32x32x16_bf16 v[136:151], v[28:31], v[224:227], v[136:151]
  ds_read_b64_tr_b16 v[216:217], v14 offset:3072
  ds_read_b64_tr_b16 v[218:219], v14 offset:3328
  ds_read_b32 v188, v248 offset:4736
  ds_read_b32 v189, v248 offset:9856
  ds_read_b32 v190, v248 offset:14976
  ds_read_b32 v191, v248 offset:20096
  v_mfma_f32_32x32x16_bf16 v[152:167], v[28:31], v[228:231], v[152:167]
  ds_read_b64_tr_b16 v[220:221], v14 offset:31744
  ds_read_b64_tr_b16 v[222:223], v14 offset:32000
  s_waitcnt lgkmcnt(11)
  v_mfma_f32_32x32x16_bf16 v[136:151], v[32:35], v[232:235], v[136:151]
  ds_read_b64_tr_b16 v[224:225], v14 offset:4096
  ds_read_b64_tr_b16 v[226:227], v14 offset:4352
  s_add_u32 m0, s63, 5120
  s_add_u32 s97, s68, 286720
  buffer_load_dwordx4 v7, s[20:23], s97 offen  lds
  v_mfma_f32_32x32x16_bf16 v[152:167], v[32:35], v[236:239], v[152:167]
  ds_read_b64_tr_b16 v[228:229], v14 offset:32768
  ds_read_b64_tr_b16 v[230:231], v14 offset:33024
  s_waitcnt lgkmcnt(6)
  v_add_f32 v184, v184, v185
  v_add_f32 v186, v186, v187
  s_waitcnt lgkmcnt(4)
  v_mfma_f32_32x32x16_bf16 v[136:151], v[36:39], v[216:219], v[136:151]
  ds_read_b64_tr_b16 v[232:233], v14 offset:5120
  ds_read_b64_tr_b16 v[234:235], v14 offset:5376
  v_add_f32 v188, v188, v189
  v_add_f32 v190, v190, v191
  v_add_f32 v184, v184, v186
  v_add_f32 v188, v188, v190
  v_mfma_f32_32x32x16_bf16 v[152:167], v[36:39], v[220:223], v[152:167]
  ds_read_b64_tr_b16 v[236:237], v14 offset:33792
  ds_read_b64_tr_b16 v[238:239], v14 offset:34048
  v_cvt_pk_bf16_f32 v185, v184, v184
  v_cvt_pk_bf16_f32 v189, v188, v188
  v_lshlrev_b32 v185, 16, v185
  s_waitcnt lgkmcnt(4)
  v_mfma_f32_32x32x16_bf16 v[136:151], v[40:43], v[224:227], v[136:151]
  ds_read_b64_tr_b16 v[216:217], v14 offset:6144
  ds_read_b64_tr_b16 v[218:219], v14 offset:6400
  v_lshlrev_b32 v189, 16, v189
  v_sub_f32 v185, v184, v185
  v_sub_f32 v189, v188, v189
  v_cvt_pk_bf16_f32 v184, v184, v185
  v_mfma_f32_32x32x16_bf16 v[152:167], v[40:43], v[228:231], v[152:167]
  ds_read_b64_tr_b16 v[220:221], v14 offset:34816
  ds_read_b64_tr_b16 v[222:223], v14 offset:35072
  v_cvt_pk_bf16_f32 v188, v188, v189
  v_accvgpr_write_b32 a225, v184
  v_accvgpr_write_b32 a227, v188
  s_waitcnt lgkmcnt(4)
  v_mfma_f32_32x32x16_bf16 v[136:151], v[44:47], v[232:235], v[136:151]
  ds_read_b64_tr_b16 v[224:225], v14 offset:7168
  ds_read_b64_tr_b16 v[226:227], v14 offset:7424
  s_add_u32 m0, s63, 6144
  s_add_u32 s97, s68, 344064
  buffer_load_dwordx4 v7, s[20:23], s97 offen  lds
  v_mov_b32 v240, 0
  v_mfma_f32_32x32x16_bf16 v[152:167], v[44:47], v[236:239], v[152:167]
  ds_read_b64_tr_b16 v[228:229], v14 offset:35840
  ds_read_b64_tr_b16 v[230:231], v14 offset:36096
  v_mov_b32 v242, 0
  v_mov_b32 v243, 0
  v_permlane32_swap_b32 v200, v201
  s_waitcnt lgkmcnt(4)
  v_mfma_f32_32x32x16_bf16 v[136:151], v[48:51], v[216:219], v[136:151]
  ds_read_b64_tr_b16 v[232:233], v14 offset:8192
  ds_read_b64_tr_b16 v[234:235], v14 offset:8448
  v_add_f32 v200, v200, v201
  v_mul_f32 v200, 0x3b124925, v200
  v_mov_b32 v201, v200
  s_nop 1
  v_permlane32_swap_b32 v200, v201
  v_mfma_f32_32x32x16_bf16 v[152:167], v[48:51], v[220:223], v[152:167]
  ds_read_b64_tr_b16 v[236:237], v14 offset:36864
  ds_read_b64_tr_b16 v[238:239], v14 offset:37120
  v_fma_f32 v201, -v200, v200, v201
  v_cvt_pk_bf16_f32 v200, -v200, -v200
  v_max_f32 v201, 0, v201
  s_waitcnt lgkmcnt(4)
  v_mfma_f32_32x32x16_bf16 v[136:151], v[52:55], v[224:227], v[136:151]
  ds_read_b64_tr_b16 v[216:217], v14 offset:9216
  ds_read_b64_tr_b16 v[218:219], v14 offset:9472
  v_cndmask_b32 v241, v200, 0, s[48:49]
  v_cvt_pk_bf16_f32 v201, v201, v201
  v_lshlrev_b32 v201, 16, v201
  v_add_f32 v201, 0x3727c5ac, v201
  v_mfma_f32_32x32x16_bf16 v[152:167], v[52:55], v[228:231], v[152:167]
  ds_read_b64_tr_b16 v[220:221], v14 offset:37888
  ds_read_b64_tr_b16 v[222:223], v14 offset:38144
  v_cvt_pk_bf16_f32 v201, v201, v201
  v_lshlrev_b32 v201, 16, v201
  s_waitcnt lgkmcnt(4)
  v_mfma_f32_32x32x16_bf16 v[136:151], v[56:59], v[232:235], v[136:151]
  ds_read_b64_tr_b16 v[224:225], v14 offset:10240
  ds_read_b64_tr_b16 v[226:227], v14 offset:10496
  s_add_u32 m0, s63, 28672
  s_add_u32 s97, s68, 0
  buffer_load_dwordx4 v7, s[24:27], s97 offen  lds
  v_mfma_f32_32x32x16_bf16 v[152:167], v[56:59], v[236:239], v[152:167]
  ds_read_b64_tr_b16 v[228:229], v14 offset:38912
  ds_read_b64_tr_b16 v[230:231], v14 offset:39168
  v_sqrt_f32 v201, v201
  s_nop 0
  v_cvt_pk_bf16_f32 v201, v201, v201
  s_waitcnt lgkmcnt(4)
  v_mfma_f32_32x32x16_bf16 v[136:151], v[60:63], v[216:219], v[136:151]
  ds_read_b64_tr_b16 v[232:233], v14 offset:11264
  ds_read_b64_tr_b16 v[234:235], v14 offset:11520
  v_lshlrev_b32 v245, 16, v201
  v_rcp_f32 v244, v245
  s_nop 0
  v_mul_f32 v244, 0x3fb8aa3b, v244
  v_mfma_f32_32x32x16_bf16 v[152:167], v[60:63], v[220:223], v[152:167]
  ds_read_b64_tr_b16 v[236:237], v14 offset:39936
  ds_read_b64_tr_b16 v[238:239], v14 offset:40192
  v_lshrrev_b32 v248, 2, v1
  v_and_b32 v248, 0x7c, v248
  v_add_u32 v248, s70, v248
  s_waitcnt lgkmcnt(4)
  v_mfma_f32_32x32x16_bf16 v[136:151], v[64:67], v[224:227], v[136:151]
  ds_read_b64_tr_b16 v[216:217], v14 offset:12288
  ds_read_b64_tr_b16 v[218:219], v14 offset:12544
  v_lshrrev_b32 v249, 5, v1
  v_and_b32 v249, 16, v249
  v_add_u32 v249, s70, v249
  ds_write_b32 v248, v244 offset:4096
  v_mfma_f32_32x32x16_bf16 v[152:167], v[64:67], v[228:231], v[152:167]
  ds_read_b64_tr_b16 v[220:221], v14 offset:40960
  ds_read_b64_tr_b16 v[222:223], v14 offset:41216
  ds_read_b128 v[200:203], v249 offset:4096
  ds_read_b128 v[204:207], v249 offset:4128
  ds_read_b128 v[208:211], v249 offset:4160
  s_waitcnt lgkmcnt(8)
  v_mfma_f32_32x32x16_bf16 v[136:151], v[68:71], v[232:235], v[136:151]
  ds_read_b64_tr_b16 v[224:225], v14 offset:13312
  ds_read_b64_tr_b16 v[226:227], v14 offset:13568
  s_add_u32 m0, s63, 29696
  s_add_u32 s97, s68, 57344
  buffer_load_dwordx4 v7, s[24:27], s97 offen  lds
  ds_read_b128 v[212:215], v249 offset:4192
  v_mfma_f32_32x32x16_bf16 v[152:167], v[68:71], v[236:239], v[152:167]
  ds_read_b64_tr_b16 v[228:229], v14 offset:41984
  ds_read_b64_tr_b16 v[230:231], v14 offset:42240
  s_waitcnt lgkmcnt(8)
  v_mfma_f32_32x32x16_bf16 v[136:151], v[72:75], v[216:219], v[136:151]
  ds_read_b64_tr_b16 v[232:233], v14 offset:14336
  ds_read_b64_tr_b16 v[234:235], v14 offset:14592
  v_mfma_f32_32x32x16_bf16 v[152:167], v[72:75], v[220:223], v[152:167]
  ds_read_b64_tr_b16 v[236:237], v14 offset:43008
  ds_read_b64_tr_b16 v[238:239], v14 offset:43264
  s_waitcnt lgkmcnt(4)
  v_mfma_f32_32x32x16_bf16 v[136:151], v[76:79], v[224:227], v[136:151]
  ds_read_b64_tr_b16 v[216:217], v14 offset:15360
  ds_read_b64_tr_b16 v[218:219], v14 offset:15616
  v_mfma_f32_32x32x16_bf16 v[152:167], v[76:79], v[228:231], v[152:167]
  ds_read_b64_tr_b16 v[220:221], v14 offset:44032
  ds_read_b64_tr_b16 v[222:223], v14 offset:44288
  s_waitcnt lgkmcnt(4)
  v_mfma_f32_32x32x16_bf16 v[136:151], v[80:83], v[232:235], v[136:151]
  ds_read_b64_tr_b16 v[224:225], v14 offset:16384
  ds_read_b64_tr_b16 v[226:227], v14 offset:16640
  s_add_u32 m0, s63, 30720
  s_add_u32 s97, s68, 114688
  buffer_load_dwordx4 v7, s[24:27], s97 offen  lds
  v_mfma_f32_32x32x16_bf16 v[152:167], v[80:83], v[236:239], v[152:167]
  ds_read_b64_tr_b16 v[228:229], v14 offset:45056
  ds_read_b64_tr_b16 v[230:231], v14 offset:45312
  s_waitcnt lgkmcnt(4)
  v_mfma_f32_32x32x16_bf16 v[136:151], v[84:87], v[216:219], v[136:151]
  ds_read_b64_tr_b16 v[232:233], v14 offset:17408
  ds_read_b64_tr_b16 v[234:235], v14 offset:17664
  v_mfma_f32_32x32x16_bf16 v[152:167], v[84:87], v[220:223], v[152:167]
  ds_read_b64_tr_b16 v[236:237], v14 offset:46080
  ds_read_b64_tr_b16 v[238:239], v14 offset:46336
  s_waitcnt lgkmcnt(4)
  v_mfma_f32_32x32x16_bf16 v[136:151], v[88:91], v[224:227], v[136:151]
  ds_read_b64_tr_b16 v[216:217], v14 offset:18432
  ds_read_b64_tr_b16 v[218:219], v14 offset:18688
  v_mfma_f32_32x32x16_bf16 v[152:167], v[88:91], v[228:231], v[152:167]
  ds_read_b64_tr_b16 v[220:221], v14 offset:47104
  ds_read_b64_tr_b16 v[222:223], v14 offset:47360
  s_waitcnt lgkmcnt(4)
  v_mfma_f32_32x32x16_bf16 v[136:151], v[92:95], v[232:235], v[136:151]
  ds_read_b64_tr_b16 v[224:225], v14 offset:19456
  ds_read_b64_tr_b16 v[226:227], v14 offset:19712
  s_add_u32 m0, s63, 31744
  s_add_u32 s97, s68, 172032
  buffer_load_dwordx4 v7, s[24:27], s97 offen  lds
  v_mfma_f32_32x32x16_bf16 v[152:167], v[92:95], v[236:239], v[152:167]
  ds_read_b64_tr_b16 v[228:229], v14 offset:48128
  ds_read_b64_tr_b16 v[230:231], v14 offset:48384
  s_waitcnt vmcnt(11)
  ds_read_b64_tr_b16 v[168:169], v255 offset:0
  ds_read_b64_tr_b16 v[170:171], v255 offset:256
  s_waitcnt lgkmcnt(6)
  v_mfma_f32_32x32x16_bf16 v[136:151], v[96:99], v[216:219], v[136:151]
  ds_read_b64_tr_b16 v[232:233], v14 offset:20480
  ds_read_b64_tr_b16 v[234:235], v14 offset:20736
  ds_read_b64_tr_b16 v[172:173], v254 offset:0
  ds_read_b64_tr_b16 v[174:175], v254 offset:256
  s_waitcnt lgkmcnt(0)
  buffer_store_dwordx4 v[168:171], v1, s[36:39], s96 offen sc1
  v_mfma_f32_32x32x16_bf16 v[152:167], v[96:99], v[220:223], v[152:167]
  ds_read_b64_tr_b16 v[236:237], v14 offset:49152
  ds_read_b64_tr_b16 v[238:239], v14 offset:49408
  buffer_store_dwordx4 v[172:175], v1, s[36:39], s90 offen sc1
  buffer_load_dwordx4 v[16:19], v9, s[8:11], 0 offen
  buffer_load_dwordx4 v[20:23], v9, s[8:11], 0 offen offset:32
  v_mfma_f32_32x32x16_bf16 v[136:151], v[100:103], v[224:227], v[136:151]
  ds_read_b64_tr_b16 v[216:217], v14 offset:21504
  ds_read_b64_tr_b16 v[218:219], v14 offset:21760
  v_add_u32 v248, s70, v1
  v_lshrrev_b32 v249, 3, v1
  v_and_b32 v249, 0x70, v249
  v_bfe_u32 v252, v1, 5, 1
  v_mfma_f32_32x32x16_bf16 v[152:167], v[100:103], v[228:231], v[152:167]
  ds_read_b64_tr_b16 v[220:221], v14 offset:50176
  ds_read_b64_tr_b16 v[222:223], v14 offset:50432
  v_lshl_add_u32 v249, v252, 9, v249
  v_bfe_u32 v252, v1, 6, 1
  v_lshl_add_u32 v249, v252, 11, v249
  s_waitcnt lgkmcnt(4)
  v_mfma_f32_32x32x16_bf16 v[136:151], v[104:107], v[232:235], v[136:151]
  ds_read_b64_tr_b16 v[224:225], v14 offset:22528
  ds_read_b64_tr_b16 v[226:227], v14 offset:22784
  s_add_u32 m0, s63, 32768
  s_add_u32 s97, s68, 229376
  buffer_load_dwordx4 v7, s[24:27], s97 offen  lds
  v_bfe_u32 v252, v1, 4, 1
  v_mfma_f32_32x32x16_bf16 v[152:167], v[104:107], v[236:239], v[152:167]
  ds_read_b64_tr_b16 v[228:229], v14 offset:51200
  ds_read_b64_tr_b16 v[230:231], v14 offset:51456
  v_lshl_add_u32 v249, v252, 10, v249
  s_lshl_b32 s78, s3, 7
  s_add_u32 s78, s78, 143360
  s_waitcnt lgkmcnt(4)
  v_mfma_f32_32x32x16_bf16 v[136:151], v[108:111], v[216:219], v[136:151]
  ds_read_b64_tr_b16 v[232:233], v14 offset:23552
  ds_read_b64_tr_b16 v[234:235], v14 offset:23808
  v_add_u32 v249, s78, v249
  v_mov_b32 v252, s75
  s_lshl_b32 s78, s6, 2
  s_add_u32 s78, s78, s3
  v_mfma_f32_32x32x16_bf16 v[152:167], v[108:111], v[220:223], v[152:167]
  ds_read_b64_tr_b16 v[236:237], v14 offset:52224
  ds_read_b64_tr_b16 v[238:239], v14 offset:52480
  s_lshl_b32 s78, s78, 13
  s_add_u32 s78, s78, 1048576
  s_lshl_b32 s79, s56, 9
  s_waitcnt lgkmcnt(4)
  v_mfma_f32_32x32x16_bf16 v[136:151], v[112:115], v[224:227], v[136:151]
  ds_read_b64_tr_b16 v[216:217], v14 offset:24576
  ds_read_b64_tr_b16 v[218:219], v14 offset:24832
  s_add_u32 s79, s79, s78
  v_mov_b32 v253, s88
  v_lshrrev_b32 v254, 1, v1
  s_mov_b32 s80, 0x80808080
  v_mfma_f32_32x32x16_bf16 v[152:167], v[112:115], v[228:231], v[152:167]
  ds_read_b64_tr_b16 v[220:221], v14 offset:53248
  ds_read_b64_tr_b16 v[222:223], v14 offset:53504
  s_mov_b32 s81, 0x80808080
  s_waitcnt lgkmcnt(4)
  v_mfma_f32_32x32x16_bf16 v[136:151], v[116:119], v[232:235], v[136:151]
  ds_read_b64_tr_b16 v[224:225], v14 offset:25600
  ds_read_b64_tr_b16 v[226:227], v14 offset:25856
  s_add_u32 m0, s63, 33792
  s_add_u32 s97, s68, 286720
  buffer_load_dwordx4 v7, s[24:27], s97 offen  lds
  v_mfma_f32_32x32x16_bf16 v[152:167], v[116:119], v[236:239], v[152:167]
  ds_read_b64_tr_b16 v[228:229], v14 offset:54272
  ds_read_b64_tr_b16 v[230:231], v14 offset:54528
  s_waitcnt lgkmcnt(4)
  v_mfma_f32_32x32x16_bf16 v[136:151], v[120:123], v[216:219], v[136:151]
  ds_read_b64_tr_b16 v[232:233], v14 offset:26624
  ds_read_b64_tr_b16 v[234:235], v14 offset:26880
  v_mfma_f32_32x32x16_bf16 v[152:167], v[120:123], v[220:223], v[152:167]
  ds_read_b64_tr_b16 v[236:237], v14 offset:55296
  ds_read_b64_tr_b16 v[238:239], v14 offset:55552
  s_waitcnt lgkmcnt(4)
  v_mfma_f32_32x32x16_bf16 v[136:151], v[124:127], v[224:227], v[136:151]
  ds_read_b64_tr_b16 v[216:217], v14 offset:27648
  ds_read_b64_tr_b16 v[218:219], v14 offset:27904
  v_mfma_f32_32x32x16_bf16 v[152:167], v[124:127], v[228:231], v[152:167]
  ds_read_b64_tr_b16 v[220:221], v14 offset:56320
  ds_read_b64_tr_b16 v[222:223], v14 offset:56576
  v_mfma_f32_32x32x16_bf16 v[136:151], v[240:243], a[224:227], v[136:151]
  s_add_u32 m0, s63, 34816
  s_add_u32 s97, s68, 344064
  buffer_load_dwordx4 v7, s[24:27], s97 offen  lds
  v_mfma_f32_32x32x16_bf16 v[152:167], v[240:243], a[226:229], v[152:167]
  s_waitcnt lgkmcnt(4)
  v_mfma_f32_32x32x16_bf16 v[136:151], v[128:131], v[232:235], v[136:151]
  v_mfma_f32_32x32x16_bf16 v[152:167], v[128:131], v[236:239], v[152:167]
  s_waitcnt lgkmcnt(0)
  v_mfma_f32_32x32x16_bf16 v[136:151], v[132:135], v[216:219], v[136:151]
  v_mfma_f32_32x32x16_bf16 v[152:167], v[132:135], v[220:223], v[152:167]
  v_add_u32 v246, s78, v1
  s_add_u32 m0, s63, 57344
  s_nop 0
  global_load_lds_dwordx4 v[2:3], off
  s_nop 0
  v_pk_mul_f32 v[136:137], v[136:137], v[200:201]
  v_pk_mul_f32 v[138:139], v[138:139], v[202:203]
  v_pk_mul_f32 v[140:141], v[140:141], v[204:205]
  v_pk_mul_f32 v[142:143], v[142:143], v[206:207]
  v_pk_mul_f32 v[144:145], v[144:145], v[208:209]
  v_pk_mul_f32 v[146:147], v[146:147], v[210:211]
  v_pk_mul_f32 v[148:149], v[148:149], v[212:213]
  v_pk_mul_f32 v[150:151], v[150:151], v[214:215]
  v_exp_f32_e64 v168, v136 clamp
  v_max_f32 v136, 0x35c1a2a0, v136
  v_exp_f32_e64 v169, v137 clamp
  v_max_f32 v137, 0x35c1a2a0, v137
  v_exp_f32_e64 v170, v138 clamp
  v_max_f32 v138, 0x35c1a2a0, v138
  v_exp_f32_e64 v171, v139 clamp
  v_max_f32 v139, 0x35c1a2a0, v139
  v_exp_f32_e64 v172, v140 clamp
  v_max_f32 v140, 0x35c1a2a0, v140
  v_exp_f32_e64 v173, v141 clamp
  v_max_f32 v141, 0x35c1a2a0, v141
  v_exp_f32_e64 v174, v142 clamp
  v_max_f32 v142, 0x35c1a2a0, v142
  v_exp_f32_e64 v175, v143 clamp
  v_max_f32 v143, 0x35c1a2a0, v143
  v_exp_f32_e64 v176, v144 clamp
  v_max_f32 v144, 0x35c1a2a0, v144
  v_exp_f32_e64 v177, v145 clamp
  v_max_f32 v145, 0x35c1a2a0, v145
  v_exp_f32_e64 v178, v146 clamp
  v_max_f32 v146, 0x35c1a2a0, v146
  v_exp_f32_e64 v179, v147 clamp
  v_max_f32 v147, 0x35c1a2a0, v147
  v_exp_f32_e64 v180, v148 clamp
  v_max_f32 v148, 0x35c1a2a0, v148
  v_exp_f32_e64 v181, v149 clamp
  v_max_f32 v149, 0x35c1a2a0, v149
  v_exp_f32_e64 v182, v150 clamp
  v_max_f32 v150, 0x35c1a2a0, v150
  v_exp_f32_e64 v183, v151 clamp
  v_max_f32 v151, 0x35c1a2a0, v151
  v_fmac_f32 v168, s74, v136
  v_fmac_f32 v169, s74, v137
  v_fmac_f32 v170, s74, v138
  v_fmac_f32 v171, s74, v139
  v_fmac_f32 v172, s74, v140
  v_fmac_f32 v173, s74, v141
  v_fmac_f32 v174, s74, v142
  v_fmac_f32 v175, s74, v143
  v_fmac_f32 v176, s74, v144
  v_fmac_f32 v177, s74, v145
  v_fmac_f32 v178, s74, v146
  v_fmac_f32 v179, s74, v147
  v_fmac_f32 v180, s74, v148
  v_fmac_f32 v181, s74, v149
  v_fmac_f32 v182, s74, v150
  v_fmac_f32 v183, s74, v151
  v_cvt_pk_bf16_f32 v136, v168, v169
  v_cvt_pk_bf16_f32 v137, v170, v171
  v_cvt_pk_bf16_f32 v138, v172, v173
  v_cvt_pk_bf16_f32 v139, v174, v175
  v_cvt_pk_bf16_f32 v140, v176, v177
  v_cvt_pk_bf16_f32 v141, v178, v179
  v_cvt_pk_bf16_f32 v142, v180, v181
  v_cvt_pk_bf16_f32 v143, v182, v183
  s_add_u32 m0, s63, 58368
  v_lshl_add_u64 v[2:3], v[2:3], 0, s[66:67]
  global_load_lds_dwordx4 v[2:3], off
  v_pk_mul_f32 v[152:153], v[152:153], v[200:201]
  v_pk_mul_f32 v[154:155], v[154:155], v[202:203]
  v_pk_mul_f32 v[156:157], v[156:157], v[204:205]
  v_pk_mul_f32 v[158:159], v[158:159], v[206:207]
  v_pk_mul_f32 v[160:161], v[160:161], v[208:209]
  v_pk_mul_f32 v[162:163], v[162:163], v[210:211]
  v_pk_mul_f32 v[164:165], v[164:165], v[212:213]
  v_pk_mul_f32 v[166:167], v[166:167], v[214:215]
  v_cvt_pk_bf16_f32 v152, v152, v153
  v_cvt_pk_bf16_f32 v153, v154, v155
  v_cvt_pk_bf16_f32 v154, v156, v157
  v_cvt_pk_bf16_f32 v155, v158, v159
  v_cvt_pk_bf16_f32 v156, v160, v161
  v_cvt_pk_bf16_f32 v157, v162, v163
  v_cvt_pk_bf16_f32 v158, v164, v165
  v_cvt_pk_bf16_f32 v159, v166, v167
  v_cndmask_b32 v152, v152, v252, s[50:51]
  v_cndmask_b32 v153, v153, v252, s[50:51]
  v_cndmask_b32 v154, v154, v252, s[50:51]
  v_cndmask_b32 v155, v155, v252, s[50:51]
  v_cndmask_b32 v156, v156, v252, s[50:51]
  v_cndmask_b32 v157, v157, v252, s[50:51]
  v_cndmask_b32 v158, v158, v252, s[50:51]
  v_cndmask_b32 v159, v159, v252, s[50:51]
  v_mfma_f32_32x32x16_bf16 v[184:199], v[136:139], v[152:155], 0
  s_nop 0
  v_mfma_f32_32x32x16_bf16 v[184:199], v[140:143], v[156:159], v[184:199]
  s_nop 11
  ds_write_b128 v248, v[184:187] offset:0
  ds_write_b128 v248, v[188:191] offset:1024
  ds_write_b128 v248, v[192:195] offset:2048
  ds_write_b128 v248, v[196:199] offset:3072
  s_waitcnt vmcnt(7) lgkmcnt(0)
  s_barrier
  ds_read_b128 v[152:155], v249 offset:0
  ds_read_b128 v[156:159], v249 offset:5120
  ds_read_b128 v[160:163], v249 offset:10240
  ds_read_b128 v[164:167], v249 offset:15360
  s_waitcnt lgkmcnt(2)
  v_pk_add_f32 v[152:153], v[152:153], v[156:157]
  v_pk_add_f32 v[154:155], v[154:155], v[158:159]
  s_waitcnt lgkmcnt(0)
  v_pk_add_f32 v[160:161], v[160:161], v[164:165]
  v_pk_add_f32 v[162:163], v[162:163], v[166:167]
  v_pk_add_f32 v[152:153], v[152:153], v[160:161]
  v_pk_add_f32 v[154:155], v[154:155], v[162:163]
  v_cvt_pk_bf16_f32 v152, v152, v153
  v_cvt_pk_bf16_f32 v153, v154, v155
  v_cndmask_b32 v153, v153, v253, s[80:81]
  buffer_store_dwordx2 v[152:153], v254, s[36:39], s79 offen sc1
  s_lshl_b32 s81, s4, 7
  s_lshl_b32 s82, s5, 2
  s_add_u32 s81, s81, s82
  s_add_u32 s81, s81, 4096
  s_cmp_lg_u32 s3, 0
  s_cselect_b32 s81, 0x40000000, s81
  s_add_u32 s85, s85, s88
  v_mov_b32 v253, s85
  buffer_store_dword v253, v4, s[36:39], s81 offen sc1
  s_add_u32 m0, s63, 86016
  s_add_u32 s97, s65, 16834560
  buffer_load_dwordx4 v1, s[36:39], s97 offen sc1 lds
  s_add_u32 m0, s63, 87040
  s_add_u32 s97, s65, 16835584
  buffer_load_dwordx4 v1, s[36:39], s97 offen sc1 lds
  s_add_u32 m0, s63, 88064
  s_add_u32 s97, s65, 16836608
  buffer_load_dwordx4 v1, s[36:39], s97 offen sc1 lds
  s_add_u32 m0, s63, 89088
  s_add_u32 s97, s65, 16837632
  buffer_load_dwordx4 v1, s[36:39], s97 offen sc1 lds
  s_add_u32 m0, s63, 90112
  s_add_u32 s97, s65, 16838656
  buffer_load_dwordx4 v1, s[36:39], s97 offen sc1 lds
  s_add_u32 m0, s63, 91136
  s_add_u32 s97, s65, 16839680
  buffer_load_dwordx4 v1, s[36:39], s97 offen sc1 lds
  s_add_u32 m0, s63, 92160
  s_add_u32 s97, s65, 16840704
  buffer_load_dwordx4 v1, s[36:39], s97 offen sc1 lds
  v_add_u32 v250, s63, v8
  v_add_u32 v251, s63, v1
  s_add_u32 m0, s63, 59392
  v_lshl_add_u64 v[2:3], v[2:3], 0, s[66:67]
  global_load_lds_dwordx4 v[2:3], off
  s_add_u32 m0, s63, 60416
  v_lshl_add_u64 v[2:3], v[2:3], 0, s[66:67]
  global_load_lds_dwordx4 v[2:3], off
  s_add_u32 m0, s63, 61440
  v_lshl_add_u64 v[2:3], v[2:3], 0, s[66:67]
  global_load_lds_dwordx4 v[2:3], off
  s_add_u32 m0, s63, 62464
  v_lshl_add_u64 v[2:3], v[2:3], 0, s[66:67]
  global_load_lds_dwordx4 v[2:3], off
  s_add_u32 m0, s63, 63488
  v_lshl_add_u64 v[2:3], v[2:3], 0, s[66:67]
  global_load_lds_dwordx4 v[2:3], off
  v_lshlrev_b32 v247, 2, v1
  v_add_u32 v247, s63, v247
  v_add_u32 v247, 86076, v247
  s_waitcnt vmcnt(5)
Lvc_7:
  ds_read_b32 v248, v247 offset:0
  ds_read_b32 v15, v247 offset:3072
  s_waitcnt lgkmcnt(0)
  v_xor_b32 v248, v248, v5
  v_bitop3_b32 v248, v248, v15, v5 bitop3:0xf6
  v_cmp_ne_u32 vcc, 0, v248
  s_cbranch_vccnz Lvr_8
Lvd_9:
  v_add_u32 v248, s63, v14
  ds_read_b64_tr_b16 v[216:217], v248 offset:0
  ds_read_b64_tr_b16 v[218:219], v248 offset:256
  ds_read_b64_tr_b16 v[220:221], v248 offset:1024
  ds_read_b64_tr_b16 v[222:223], v248 offset:1280
  ds_read_b64_tr_b16 v[224:225], v248 offset:2048
  ds_read_b64_tr_b16 v[226:227], v248 offset:2304
  s_waitcnt lgkmcnt(4)
  v_mfma_f32_32x32x16_bf16 v[200:215], a[236:239], v[216:219], 0
  ds_read_b64_tr_b16 v[228:229], v248 offset:3072
  ds_read_b64_tr_b16 v[230:231], v248 offset:3328
  s_add_u32 m0, s63, 114688
  s_add_u32 s97, s69, 0
  buffer_load_dwordx4 v6, s[16:19], s97 offen  lds
  s_waitcnt lgkmcnt(4)
  v_mfma_f32_32x32x16_bf16 v[200:215], a[236:239], v[220:223], v[200:215]
  ds_read_b64_tr_b16 v[232:233], v248 offset:4096
  ds_read_b64_tr_b16 v[234:235], v248 offset:4352
  s_waitcnt lgkmcnt(4)
  v_mfma_f32_32x32x16_bf16 v[200:215], a[236:239], v[224:227], v[200:215]
  ds_read_b64_tr_b16 v[236:237], v248 offset:5120
  ds_read_b64_tr_b16 v[238:239], v248 offset:5376
  s_waitcnt lgkmcnt(4)
  v_mfma_f32_32x32x16_bf16 v[200:215], a[236:239], v[228:231], v[200:215]
  ds_read_b64_tr_b16 v[216:217], v248 offset:6144
  ds_read_b64_tr_b16 v[218:219], v248 offset:6400
  s_add_u32 m0, s63, 115712
  s_add_u32 s97, s69, 7168
  buffer_load_dwordx4 v6, s[16:19], s97 offen  lds
  s_waitcnt lgkmcnt(4)
  v_mfma_f32_32x32x16_bf16 v[200:215], a[236:239], v[232:235], v[200:215]
  s_waitcnt lgkmcnt(2)
  v_mfma_f32_32x32x16_bf16 v[200:215], a[236:239], v[236:239], v[200:215]
  s_waitcnt lgkmcnt(0)
  v_mfma_f32_32x32x16_bf16 v[200:215], a[236:239], v[216:219], v[200:215]
  s_add_u32 m0, s63, 116736
  s_add_u32 s97, s69, 14336
  buffer_load_dwordx4 v6, s[16:19], s97 offen  lds
  v_lshrrev_b32 v253, 2, v1
  v_and_b32 v253, 0x7c, v253
  v_add_u32 v253, s70, v253
  s_nop 5
  ds_write_b32 v253, v200 offset:4608
  v_and_b32 v249, 0x1ff, v8
  s_add_u32 s78, s63, 86016
  v_add_u32 v249, s78, v249
  v_and_b32 v248, 0x200, v8
  v_lshl_add_u32 v248, v248, 1, v249
  s_waitcnt lgkmcnt(0)
  s_barrier
  ds_read_b64_tr_b16 v[216:217], v14 offset:0
  ds_read_b64_tr_b16 v[218:219], v14 offset:256
  ds_read_b64_tr_b16 v[220:221], v14 offset:1024
  ds_read_b64_tr_b16 v[222:223], v14 offset:1280
  ds_read_b64_tr_b16 v[224:225], v14 offset:2048
  ds_read_b64_tr_b16 v[226:227], v14 offset:2304
  ds_read_b64_tr_b16 v[228:229], v14 offset:3072
  ds_read_b64_tr_b16 v[230:231], v14 offset:3328
  s_waitcnt lgkmcnt(4)
  v_mfma_f32_32x32x16_bf16 v[168:183], v[216:219], v[24:27], 0
  ds_read_b64_tr_b16 v[232:233], v14 offset:4096
  ds_read_b64_tr_b16 v[234:235], v14 offset:4352
  v_lshrrev_b32 v253, 2, v1
  v_and_b32 v253, 0x7c, v253
  v_add_u32 v253, 143360, v253
  ds_read_b32 v140, v253 offset:4608
  v_mfma_f32_32x32x16_bf16 v[168:183], v[220:223], v[28:31], v[168:183]
  ds_read_b64_tr_b16 v[236:237], v14 offset:5120
  ds_read_b64_tr_b16 v[238:239], v14 offset:5376
  ds_read_b32 v141, v253 offset:9728
  ds_read_b32 v142, v253 offset:14848
  ds_read_b32 v143, v253 offset:19968
  s_waitcnt lgkmcnt(8)
  v_mfma_f32_32x32x16_bf16 v[168:183], v[224:227], v[32:35], v[168:183]
  ds_read_b64_tr_b16 v[216:217], v14 offset:6144
  ds_read_b64_tr_b16 v[218:219], v14 offset:6400
  s_add_u32 m0, s63, 117760
  s_add_u32 s97, s69, 21504
  buffer_load_dwordx4 v6, s[16:19], s97 offen  lds
  v_mfma_f32_32x32x16_bf16 v[168:183], v[228:231], v[36:39], v[168:183]
  ds_read_b64_tr_b16 v[220:221], v14 offset:7168
  ds_read_b64_tr_b16 v[222:223], v14 offset:7424
  s_waitcnt lgkmcnt(7)
  v_mfma_f32_32x32x16_bf16 v[168:183], v[232:235], v[40:43], v[168:183]
  ds_read_b64_tr_b16 v[224:225], v14 offset:8192
  ds_read_b64_tr_b16 v[226:227], v14 offset:8448
  v_mfma_f32_32x32x16_bf16 v[168:183], v[236:239], v[44:47], v[168:183]
  ds_read_b64_tr_b16 v[228:229], v14 offset:9216
  ds_read_b64_tr_b16 v[230:231], v14 offset:9472
  s_add_u32 m0, s63, 118784
  s_add_u32 s97, s69, 28672
  buffer_load_dwordx4 v6, s[16:19], s97 offen  lds
  s_waitcnt lgkmcnt(4)
  v_mfma_f32_32x32x16_bf16 v[168:183], v[216:219], v[48:51], v[168:183]
  ds_read_b64_tr_b16 v[232:233], v14 offset:10240
  ds_read_b64_tr_b16 v[234:235], v14 offset:10496
  v_add_f32 v140, v140, v141
  v_add_f32 v142, v142, v143
  v_add_f32 v140, v140, v142
  v_mfma_f32_32x32x16_bf16 v[168:183], v[220:223], v[52:55], v[168:183]
  ds_read_b64_tr_b16 v[236:237], v14 offset:11264
  ds_read_b64_tr_b16 v[238:239], v14 offset:11520
  v_cvt_pk_bf16_f32 v141, v140, v140
  v_lshlrev_b32 v141, 16, v141
  v_sub_f32 v141, v140, v141
  s_waitcnt lgkmcnt(4)
  v_mfma_f32_32x32x16_bf16 v[168:183], v[224:227], v[56:59], v[168:183]
  ds_read_b64_tr_b16 v[216:217], v14 offset:12288
  ds_read_b64_tr_b16 v[218:219], v14 offset:12544
  s_add_u32 m0, s63, 119808
  s_add_u32 s97, s69, 35840
  buffer_load_dwordx4 v6, s[16:19], s97 offen  lds
  v_cvt_pk_bf16_f32 v140, v140, v141
  v_mfma_f32_32x32x16_bf16 v[168:183], v[228:231], v[60:63], v[168:183]
  ds_read_b64_tr_b16 v[220:221], v14 offset:13312
  ds_read_b64_tr_b16 v[222:223], v14 offset:13568
  v_accvgpr_write_b32 a229, v140
  s_waitcnt lgkmcnt(4)
  v_mfma_f32_32x32x16_bf16 v[168:183], v[232:235], v[64:67], v[168:183]
  ds_read_b64_tr_b16 v[224:225], v14 offset:14336
  ds_read_b64_tr_b16 v[226:227], v14 offset:14592
  v_mfma_f32_32x32x16_bf16 v[168:183], v[236:239], v[68:71], v[168:183]
  ds_read_b64_tr_b16 v[228:229], v14 offset:15360
  ds_read_b64_tr_b16 v[230:231], v14 offset:15616
  s_add_u32 m0, s63, 120832
  s_add_u32 s97, s69, 43008
  buffer_load_dwordx4 v6, s[16:19], s97 offen  lds
  s_waitcnt lgkmcnt(4)
  v_mfma_f32_32x32x16_bf16 v[168:183], v[216:219], v[72:75], v[168:183]
  ds_read_b64_tr_b16 v[232:233], v14 offset:16384
  ds_read_b64_tr_b16 v[234:235], v14 offset:16640
  v_mfma_f32_32x32x16_bf16 v[168:183], v[220:223], v[76:79], v[168:183]
  ds_read_b64_tr_b16 v[236:237], v14 offset:17408
  ds_read_b64_tr_b16 v[238:239], v14 offset:17664
  s_waitcnt lgkmcnt(4)
  v_mfma_f32_32x32x16_bf16 v[168:183], v[224:227], v[80:83], v[168:183]
  ds_read_b64_tr_b16 v[216:217], v14 offset:18432
  ds_read_b64_tr_b16 v[218:219], v14 offset:18688
  v_mfma_f32_32x32x16_bf16 v[168:183], v[228:231], v[84:87], v[168:183]
  ds_read_b64_tr_b16 v[220:221], v14 offset:19456
  ds_read_b64_tr_b16 v[222:223], v14 offset:19712
  s_waitcnt lgkmcnt(4)
  v_mfma_f32_32x32x16_bf16 v[168:183], v[232:235], v[88:91], v[168:183]
  ds_read_b64_tr_b16 v[224:225], v14 offset:20480
  ds_read_b64_tr_b16 v[226:227], v14 offset:20736
  v_mfma_f32_32x32x16_bf16 v[168:183], v[236:239], v[92:95], v[168:183]
  ds_read_b64_tr_b16 v[228:229], v14 offset:21504
  ds_read_b64_tr_b16 v[230:231], v14 offset:21760
  buffer_load_dwordx4 v[32:35], v1, s[36:39], s57 offen sc1
  s_waitcnt lgkmcnt(4)
  v_mfma_f32_32x32x16_bf16 v[168:183], v[216:219], v[96:99], v[168:183]
  ds_read_b64_tr_b16 v[232:233], v14 offset:22528
  ds_read_b64_tr_b16 v[234:235], v14 offset:22784
  buffer_load_dwordx4 v[184:187], v246, s[36:39], 0 offen offset:0 sc1
  v_mfma_f32_32x32x16_bf16 v[168:183], v[220:223], v[100:103], v[168:183]
  ds_read_b64_tr_b16 v[236:237], v14 offset:23552
  ds_read_b64_tr_b16 v[238:239], v14 offset:23808
  buffer_load_dwordx4 v[188:191], v246, s[36:39], 0 offen offset:1024 sc1
  s_waitcnt lgkmcnt(4)
  v_mfma_f32_32x32x16_bf16 v[168:183], v[224:227], v[104:107], v[168:183]
  ds_read_b64_tr_b16 v[216:217], v14 offset:24576
  ds_read_b64_tr_b16 v[218:219], v14 offset:24832
  buffer_load_dwordx4 v[192:195], v246, s[36:39], 0 offen offset:2048 sc1
  v_mfma_f32_32x32x16_bf16 v[168:183], v[228:231], v[108:111], v[168:183]
  ds_read_b64_tr_b16 v[220:221], v14 offset:25600
  ds_read_b64_tr_b16 v[222:223], v14 offset:25856
  buffer_load_dwordx4 v[196:199], v246, s[36:39], 0 offen offset:3072 sc1
  s_waitcnt lgkmcnt(4)
  v_mfma_f32_32x32x16_bf16 v[168:183], v[232:235], v[112:115], v[168:183]
  ds_read_b64_tr_b16 v[224:225], v14 offset:26624
  ds_read_b64_tr_b16 v[226:227], v14 offset:26880
  buffer_load_dwordx4 v[200:203], v246, s[36:39], s57 offen offset:0 sc1
  v_mfma_f32_32x32x16_bf16 v[168:183], v[236:239], v[116:119], v[168:183]
  ds_read_b64_tr_b16 v[228:229], v14 offset:27648
  ds_read_b64_tr_b16 v[230:231], v14 offset:27904
  buffer_load_dwordx4 v[204:207], v246, s[36:39], s57 offen offset:1024 sc1
  s_waitcnt vmcnt(7)
  ds_read_b64_tr_b16 v[136:137], v248 offset:28672
  s_waitcnt lgkmcnt(5)
  v_mfma_f32_32x32x16_bf16 v[168:183], v[216:219], v[120:123], v[168:183]
  buffer_load_dwordx4 v[208:211], v246, s[36:39], s57 offen offset:2048 sc1
  ds_read_b64_tr_b16 v[138:139], v248 offset:28928
  ds_read_b64_tr_b16 v[140:141], v248 offset:29184
  ds_read_b64_tr_b16 v[142:143], v248 offset:29440
  ds_read_b64_tr_b16 v[144:145], v248 offset:30720
  ds_read_b64_tr_b16 v[146:147], v249 offset:30976
  v_mfma_f32_32x32x16_bf16 v[168:183], v[220:223], v[124:127], v[168:183]
  buffer_load_dwordx4 v[212:215], v246, s[36:39], s57 offen offset:3072 sc1
  ds_read_b64_tr_b16 v[148:149], v248 offset:31232
  ds_read_b64_tr_b16 v[150:151], v249 offset:31488
  ds_read_b64_tr_b16 v[152:153], v248 offset:32000
  ds_read_b64_tr_b16 v[154:155], v248 offset:32768
  v_mfma_f32_32x32x16_bf16 v[168:183], a[228:231], v[240:243], v[168:183]
  ds_read_b64_tr_b16 v[156:157], v248 offset:32512
  ds_read_b64_tr_b16 v[158:159], v248 offset:33280
  ds_read_b64_tr_b16 v[160:161], v248 offset:34048
  ds_read_b64_tr_b16 v[162:163], v249 offset:34816
  ds_read_b64_tr_b16 v[164:165], v248 offset:34560
  s_waitcnt lgkmcnt(15)
  v_mfma_f32_32x32x16_bf16 v[168:183], v[224:227], v[128:131], v[168:183]
  ds_read_b64_tr_b16 v[166:167], v249 offset:35328
  s_waitcnt lgkmcnt(0)
  v_mfma_f32_32x32x16_bf16 v[168:183], v[228:231], v[132:135], v[168:183]
  s_nop 11
  v_pk_mul_f32 v[168:169], v[168:169], v[244:245] op_sel_hi:[1,0]
  v_pk_mul_f32 v[170:171], v[170:171], v[244:245] op_sel_hi:[1,0]
  v_pk_mul_f32 v[172:173], v[172:173], v[244:245] op_sel_hi:[1,0]
  v_pk_mul_f32 v[174:175], v[174:175], v[244:245] op_sel_hi:[1,0]
  v_pk_mul_f32 v[176:177], v[176:177], v[244:245] op_sel_hi:[1,0]
  v_pk_mul_f32 v[178:179], v[178:179], v[244:245] op_sel_hi:[1,0]
  v_pk_mul_f32 v[180:181], v[180:181], v[244:245] op_sel_hi:[1,0]
  v_pk_mul_f32 v[182:183], v[182:183], v[244:245] op_sel_hi:[1,0]
  v_exp_f32_e64 v40, v168 clamp
  v_max_f32 v168, 0x35c1a2a0, v168
  v_exp_f32_e64 v41, v169 clamp
  v_max_f32 v169, 0x35c1a2a0, v169
  v_exp_f32_e64 v42, v170 clamp
  v_max_f32 v170, 0x35c1a2a0, v170
  v_exp_f32_e64 v43, v171 clamp
  v_max_f32 v171, 0x35c1a2a0, v171
  v_exp_f32_e64 v44, v172 clamp
  v_max_f32 v172, 0x35c1a2a0, v172
  v_exp_f32_e64 v45, v173 clamp
  v_max_f32 v173, 0x35c1a2a0, v173
  v_exp_f32_e64 v46, v174 clamp
  v_max_f32 v174, 0x35c1a2a0, v174
  v_exp_f32_e64 v47, v175 clamp
  v_max_f32 v175, 0x35c1a2a0, v175
  v_exp_f32_e64 v48, v176 clamp
  v_max_f32 v176, 0x35c1a2a0, v176
  v_exp_f32_e64 v49, v177 clamp
  v_max_f32 v177, 0x35c1a2a0, v177
  v_exp_f32_e64 v50, v178 clamp
  v_max_f32 v178, 0x35c1a2a0, v178
  v_exp_f32_e64 v51, v179 clamp
  v_max_f32 v179, 0x35c1a2a0, v179
  v_exp_f32_e64 v52, v180 clamp
  v_max_f32 v180, 0x35c1a2a0, v180
  v_exp_f32_e64 v53, v181 clamp
  v_max_f32 v181, 0x35c1a2a0, v181
  v_exp_f32_e64 v54, v182 clamp
  v_max_f32 v182, 0x35c1a2a0, v182
  v_exp_f32_e64 v55, v183 clamp
  v_max_f32 v183, 0x35c1a2a0, v183
  v_fmac_f32 v40, s74, v168
  v_fmac_f32 v41, s74, v169
  v_fmac_f32 v42, s74, v170
  v_fmac_f32 v43, s74, v171
  v_fmac_f32 v44, s74, v172
  v_fmac_f32 v45, s74, v173
  v_fmac_f32 v46, s74, v174
  v_fmac_f32 v47, s74, v175
  v_fmac_f32 v48, s74, v176
  v_fmac_f32 v49, s74, v177
  v_fmac_f32 v50, s74, v178
  v_fmac_f32 v51, s74, v179
  v_fmac_f32 v52, s74, v180
  v_fmac_f32 v53, s74, v181
  v_fmac_f32 v54, s74, v182
  v_fmac_f32 v55, s74, v183
  v_cvt_pk_bf16_f32 v168, v40, v41
  v_cvt_pk_bf16_f32 v169, v42, v43
  v_cvt_pk_bf16_f32 v170, v44, v45
  v_cvt_pk_bf16_f32 v171, v46, v47
  v_cvt_pk_bf16_f32 v172, v48, v49
  v_cvt_pk_bf16_f32 v173, v50, v51
  v_cvt_pk_bf16_f32 v174, v52, v53
  v_cvt_pk_bf16_f32 v175, v54, v55
  v_cndmask_b32 v174, v174, 0, s[48:49]
  v_cndmask_b32 v175, v175, 0, s[48:49]
  s_add_u32 m0, s63, 114688
  s_add_u32 s97, s69, 50176
  buffer_load_dwordx4 v6, s[16:19], s97 offen  lds
  s_add_u32 m0, s63, 115712
  s_add_u32 s97, s69, 57344
  buffer_load_dwordx4 v6, s[16:19], s97 offen  lds
  s_add_u32 m0, s63, 116736
  s_add_u32 s97, s69, 64512
  buffer_load_dwordx4 v6, s[16:19], s97 offen  lds
  s_add_u32 m0, s63, 117760
  s_add_u32 s97, s69, 71680
  buffer_load_dwordx4 v6, s[16:19], s97 offen  lds
  s_add_u32 m0, s63, 118784
  s_add_u32 s97, s69, 78848
  buffer_load_dwordx4 v6, s[16:19], s97 offen  lds
  s_add_u32 m0, s63, 119808
  s_add_u32 s97, s69, 86016
  buffer_load_dwordx4 v6, s[16:19], s97 offen  lds
  s_add_u32 m0, s63, 120832
  s_add_u32 s97, s69, 93184
  buffer_load_dwordx4 v6, s[16:19], s97 offen  lds
  s_mul_i32 s28, s77, 114688
  s_add_u32 s28, s28, 7340032
  v_add_u32 v7, s28, v1
  s_xor_b32 s28, s77, 1
  s_mul_i32 s28, s28, 114688
  s_add_u32 s28, s28, 7340032
  v_add_u32 v3, s28, v1
  s_bfe_u32 s28, s54, 0x10001
  s_lshl_b32 s28, s28, 10
  s_lshl_b32 s44, s3, 13
  s_add_u32 s44, s44, s28
  s_xor_b32 s45, s44, 1024
  s_lshl_b32 s46, s3, 12
  s_lshl_b32 s82, s4, 3
  s_mov_b64 s[80:81], 0xff
  s_lshl_b64 s[80:81], s[80:81], s82
  s_waitcnt vmcnt(15)
Lxc_11:
  v_subrev_u32 v252, s88, v32
  v_subrev_u32 v253, s88, v33
  v_subrev_u32 v254, s88, v34
  v_subrev_u32 v255, s88, v35
  v_or3_b32 v252, v252, v253, v254
  v_or_b32 v252, v252, v255
  v_cmp_le_u32 vcc, 8, v252
  s_cbranch_vccnz Lxi_10
Lxid_12:
  v_xor_b32 v252, s85, v32
  v_xor_b32 v253, s85, v33
  v_xor_b32 v254, s85, v34
  v_xor_b32 v255, s85, v35
  v_or3_b32 v252, v252, v253, v254
  v_or_b32 v252, v252, v255
  v_cmp_ne_u32 vcc, 0, v252
  s_nop 0
  s_and_b64 vcc, vcc, s[80:81]
  s_cbranch_scc1 L_slow
  s_lshl_b32 s28, s45, 1
  s_add_u32 s28, s28, 0
  buffer_load_dwordx4 a[0:3], v7, s[40:43], s28 offen offset:0 sc1
  buffer_load_dwordx4 a[4:7], v3, s[40:43], s28 offen offset:0 sc1
  s_lshl_b32 s28, s45, 1
  s_add_u32 s28, s28, 0
  buffer_load_dwordx4 a[8:11], v7, s[40:43], s28 offen offset:1024 sc1
  buffer_load_dwordx4 a[12:15], v3, s[40:43], s28 offen offset:1024 sc1
  s_lshl_b32 s28, s45, 1
  s_add_u32 s28, s28, 4096
  buffer_load_dwordx4 a[16:19], v7, s[40:43], s28 offen offset:0 sc1
  buffer_load_dwordx4 a[20:23], v3, s[40:43], s28 offen offset:0 sc1
  v_add_u32 v2, 57344, v8
  v_and_b32 v250, 0x1f0, v1
  v_lshrrev_b32 v251, 6, v1
  v_and_b32 v251, 8, v251
  v_add3_u32 v250, v250, v251, s70
  v_lshlrev_b32 v251, 1, v251
  v_bfe_u32 v252, v1, 4, 3
  v_lshl_add_u32 v251, v252, 6, v251
  v_bfe_u32 v252, v1, 7, 2
  v_mul_u32_u24 v252, 5120, v252
  v_add_u32 v252, 147456, v252
  v_add_u32 v251, v251, v252
  s_lshl_b32 s78, s7, 2
  s_lshr_b32 s79, s6, 2
  s_add_u32 s78, s78, s79
  s_mul_i32 s78, s78, 28672
  s_and_b32 s79, s6, 3
  s_lshl_b32 s79, s79, 11
  s_add_u32 s78, s78, s79
  s_add_u32 s78, s78, 59789312
  s_mov_b32 s79, 0x3fb8aa3b
  v_mov_b32 v254, 0x35c1a2a0
  v_mov_b32 v253, s88
  s_mov_b32 s80, 0x88888888
  s_mov_b32 s81, 0x88888888
  s_movk_i32 s82, 0x3f80
  s_mov_b32 s83, 0x3f800000
Lchk_13:
  s_waitcnt vmcnt(20)
  v_xor_b32 v252, v187, v253
  v_lshlrev_b32 v24, 16, v184
  v_and_b32 v25, 0xffff0000, v184
  v_lshlrev_b32 v26, 16, v185
  v_and_b32 v27, 0xffff0000, v185
  v_lshlrev_b32 v28, 16, v186
  v_and_b32 v29, 0xffff0000, v186
  v_lshlrev_b32 v30, 16, v187
  v_and_b32 v31, 0xffff0000, v187
  s_waitcnt vmcnt(19)
  v_bitop3_b32 v252, v252, v191, v253 bitop3:0xf6
  v_dot2c_f32_bf16 v24, s82, v188
  v_dot2c_f32_bf16 v25, s83, v188
  v_dot2c_f32_bf16 v26, s82, v189
  v_dot2c_f32_bf16 v27, s83, v189
  v_dot2c_f32_bf16 v28, s82, v190
  v_dot2c_f32_bf16 v29, s83, v190
  v_dot2c_f32_bf16 v30, s82, v191
  v_dot2c_f32_bf16 v31, s83, v191
  s_waitcnt vmcnt(18)
  v_bitop3_b32 v252, v252, v195, v253 bitop3:0xf6
  v_dot2c_f32_bf16 v24, s82, v192
  v_dot2c_f32_bf16 v25, s83, v192
  v_dot2c_f32_bf16 v26, s82, v193
  v_dot2c_f32_bf16 v27, s83, v193
  v_dot2c_f32_bf16 v28, s82, v194
  v_dot2c_f32_bf16 v29, s83, v194
  v_dot2c_f32_bf16 v30, s82, v195
  v_dot2c_f32_bf16 v31, s83, v195
  s_waitcnt vmcnt(17)
  v_bitop3_b32 v252, v252, v199, v253 bitop3:0xf6
  v_dot2c_f32_bf16 v24, s82, v196
  v_dot2c_f32_bf16 v25, s83, v196
  v_dot2c_f32_bf16 v26, s82, v197
  v_dot2c_f32_bf16 v27, s83, v197
  v_dot2c_f32_bf16 v28, s82, v198
  v_dot2c_f32_bf16 v29, s83, v198
  v_dot2c_f32_bf16 v30, s82, v199
  v_dot2c_f32_bf16 v31, s83, v199
  s_waitcnt vmcnt(16)
  v_bitop3_b32 v252, v252, v203, v253 bitop3:0xf6
  v_dot2c_f32_bf16 v24, s82, v200
  v_dot2c_f32_bf16 v25, s83, v200
  v_dot2c_f32_bf16 v26, s82, v201
  v_dot2c_f32_bf16 v27, s83, v201
  v_dot2c_f32_bf16 v28, s82, v202
  v_dot2c_f32_bf16 v29, s83, v202
  v_dot2c_f32_bf16 v30, s82, v203
  v_dot2c_f32_bf16 v31, s83, v203
  s_waitcnt vmcnt(15)
  v_bitop3_b32 v252, v252, v207, v253 bitop3:0xf6
  v_dot2c_f32_bf16 v24, s82, v204
  v_dot2c_f32_bf16 v25, s83, v204
  v_dot2c_f32_bf16 v26, s82, v205
  v_dot2c_f32_bf16 v27, s83, v205
  v_dot2c_f32_bf16 v28, s82, v206
  v_dot2c_f32_bf16 v29, s83, v206
  v_dot2c_f32_bf16 v30, s82, v207
  v_dot2c_f32_bf16 v31, s83, v207
  s_waitcnt vmcnt(14)
  v_bitop3_b32 v252, v252, v211, v253 bitop3:0xf6
  v_dot2c_f32_bf16 v24, s82, v208
  v_dot2c_f32_bf16 v25, s83, v208
  v_dot2c_f32_bf16 v26, s82, v209
  v_dot2c_f32_bf16 v27, s83, v209
  v_dot2c_f32_bf16 v28, s82, v210
  v_dot2c_f32_bf16 v29, s83, v210
  v_dot2c_f32_bf16 v30, s82, v211
  v_dot2c_f32_bf16 v31, s83, v211
  s_waitcnt vmcnt(13)
  v_bitop3_b32 v252, v252, v215, v253 bitop3:0xf6
  v_dot2c_f32_bf16 v24, s82, v212
  v_dot2c_f32_bf16 v25, s83, v212
  v_dot2c_f32_bf16 v26, s82, v213
  v_dot2c_f32_bf16 v27, s83, v213
  v_dot2c_f32_bf16 v28, s82, v214
  v_dot2c_f32_bf16 v29, s83, v214
  v_dot2c_f32_bf16 v30, s82, v215
  v_dot2c_f32_bf16 v31, s83, v215
  v_cmp_ne_u32 vcc, 0, v252
  s_nop 0
  s_and_b64 vcc, vcc, s[80:81]
  s_cbranch_scc1 Lre_14
Lgd_15:
  s_mov_b32 s80, 0
  v_permlane32_swap_b32 v24, v28
  v_permlane32_swap_b32 v25, v29
  v_permlane32_swap_b32 v26, v30
  v_permlane32_swap_b32 v27, v31
  v_pk_add_f32 v[24:25], v[24:25], v[28:29]
  v_pk_add_f32 v[26:27], v[26:27], v[30:31]
  v_cvt_pk_bf16_f32 v24, v24, v25
  v_cvt_pk_bf16_f32 v25, v26, v27
  v_cndmask_b32 v25, v25, 0, s[80:81]
  ds_write_b64 v250, v[24:25] offset:4096
  s_waitcnt lgkmcnt(0)
  s_barrier
  ds_read_b128 v[216:219], v251
  ds_read_b128 v[220:223], v251 offset:32
  s_waitcnt lgkmcnt(1)
  v_mfma_f32_32x32x16_bf16 v[184:199], v[216:219], v[168:171], 0
  s_waitcnt lgkmcnt(0)
  v_mfma_f32_32x32x16_bf16 v[184:199], v[220:223], v[172:175], v[184:199]
  s_nop 11
  v_mov_b32 v252, v196
  v_mov_b32 v253, v196
  s_nop 1
  v_permlane32_swap_b32 v253, v252
  v_fma_f32 v252, v252, s79, v254
  v_rcp_f32 v252, v252
  s_nop 0
  v_cndmask_b32 v254, v252, 0, s[48:49]
  v_pk_mul_f32 v[184:185], v[184:185], v[252:253] op_sel_hi:[1,0]
  v_pk_mul_f32 v[186:187], v[186:187], v[252:253] op_sel_hi:[1,0]
  v_pk_mul_f32 v[188:189], v[188:189], v[252:253] op_sel_hi:[1,0]
  v_pk_mul_f32 v[190:191], v[190:191], v[252:253] op_sel_hi:[1,0]
  v_pk_mul_f32 v[192:193], v[192:193], v[252:253] op_sel_hi:[1,0]
  v_pk_mul_f32 v[194:195], v[194:195], v[252:253] op_sel_hi:[1,0]
  v_pk_mul_f32 v[196:197], v[196:197], v[254:255] op_sel_hi:[1,0]
  v_pk_mul_f32 v[198:199], v[198:199], v[254:255] op_sel_hi:[1,0]
  v_cvt_pk_bf16_f32 v184, v184, v185
  v_cvt_pk_bf16_f32 v185, v186, v187
  v_cvt_pk_bf16_f32 v186, v188, v189
  v_cvt_pk_bf16_f32 v187, v190, v191
  buffer_store_dwordx4 v[184:187], v1, s[36:39], s78 offen sc1
  v_cvt_pk_bf16_f32 v188, v192, v193
  v_cvt_pk_bf16_f32 v189, v194, v195
  v_cvt_pk_bf16_f32 v190, v196, v197
  v_cvt_pk_bf16_f32 v191, v198, v199
  buffer_store_dwordx4 v[188:191], v1, s[36:39], s78 offen offset:1024 sc1
  s_lshr_b32 s99, s5, 1
  s_mul_i32 s99, s99, 28672
  s_add_u32 s99, s99, s63
  v_lshlrev_b32 v168, 16, v16
  v_and_b32 v169, 0xffff0000, v16
  v_lshlrev_b32 v170, 16, v17
  v_and_b32 v171, 0xffff0000, v17
  v_lshlrev_b32 v172, 16, v18
  v_and_b32 v173, 0xffff0000, v18
  v_lshlrev_b32 v174, 16, v19
  v_and_b32 v175, 0xffff0000, v19
  v_lshlrev_b32 v176, 16, v20
  v_and_b32 v177, 0xffff0000, v20
  v_lshlrev_b32 v178, 16, v21
  v_and_b32 v179, 0xffff0000, v21
  v_lshlrev_b32 v180, 16, v22
  v_and_b32 v181, 0xffff0000, v22
  v_lshlrev_b32 v182, 16, v23
  v_and_b32 v183, 0xffff0000, v23
  s_waitcnt vmcnt(8)
  ds_read_b64_tr_b16 v[88:89], v248 offset:28672
  ds_read_b64_tr_b16 v[90:91], v248 offset:28928
  ds_read_b64_tr_b16 v[92:93], v248 offset:29184
  ds_read_b64_tr_b16 v[94:95], v248 offset:29440
  ds_read_b64_tr_b16 v[96:97], v248 offset:30720
  ds_read_b64_tr_b16 v[98:99], v249 offset:30976
  ds_read_b64_tr_b16 v[100:101], v248 offset:31232
  ds_read_b64_tr_b16 v[102:103], v249 offset:31488
  ds_read_b64_tr_b16 v[104:105], v248 offset:32000
  ds_read_b64_tr_b16 v[106:107], v248 offset:32768
  ds_read_b64_tr_b16 v[108:109], v248 offset:32512
  ds_read_b64_tr_b16 v[110:111], v248 offset:33280
  ds_read_b64_tr_b16 v[112:113], v248 offset:34048
  ds_read_b64_tr_b16 v[114:115], v249 offset:34816
  ds_read_b64_tr_b16 v[116:117], v248 offset:34560
  ds_read_b64_tr_b16 v[118:119], v249 offset:35328
  s_waitcnt lgkmcnt(0)
  v_add_u32 v248, s63, v8
  v_add_u32 v249, s63, v1
  ds_read_b64_tr_b16 v[216:217], v248 offset:0
  ds_read_b64_tr_b16 v[218:219], v248 offset:256
  ds_read_b64_tr_b16 v[220:221], v248 offset:1024
  ds_read_b64_tr_b16 v[222:223], v248 offset:1280
  ds_read_b64_tr_b16 v[224:225], v248 offset:2048
  ds_read_b64_tr_b16 v[226:227], v248 offset:2304
  s_waitcnt lgkmcnt(4)
  v_mfma_f32_32x32x16_bf16 v[56:71], a[236:239], v[216:219], 0
  ds_read_b64_tr_b16 v[228:229], v248 offset:3072
  ds_read_b64_tr_b16 v[230:231], v248 offset:3328
  s_waitcnt lgkmcnt(4)
  v_mfma_f32_32x32x16_bf16 v[56:71], a[236:239], v[220:223], v[56:71]
  ds_read_b64_tr_b16 v[232:233], v248 offset:4096
  ds_read_b64_tr_b16 v[234:235], v248 offset:4352
  s_waitcnt lgkmcnt(4)
  v_mfma_f32_32x32x16_bf16 v[56:71], a[236:239], v[224:227], v[56:71]
  ds_read_b64_tr_b16 v[236:237], v248 offset:5120
  ds_read_b64_tr_b16 v[238:239], v248 offset:5376
  s_waitcnt lgkmcnt(4)
  v_mfma_f32_32x32x16_bf16 v[56:71], a[236:239], v[228:231], v[56:71]
  ds_read_b64_tr_b16 v[216:217], v248 offset:6144
  ds_read_b64_tr_b16 v[218:219], v248 offset:6400
  s_waitcnt lgkmcnt(4)
  v_mfma_f32_32x32x16_bf16 v[56:71], a[236:239], v[232:235], v[56:71]
  ds_read_b64_tr_b16 v[220:221], v248 offset:28672
  ds_read_b64_tr_b16 v[222:223], v248 offset:28928
  s_waitcnt lgkmcnt(4)
  v_mfma_f32_32x32x16_bf16 v[56:71], a[236:239], v[236:239], v[56:71]
  ds_read_b64_tr_b16 v[224:225], v248 offset:29696
  ds_read_b64_tr_b16 v[226:227], v248 offset:29952
  s_waitcnt lgkmcnt(4)
  v_mfma_f32_32x32x16_bf16 v[56:71], a[236:239], v[216:219], v[56:71]
  ds_read_b64_tr_b16 v[228:229], v248 offset:30720
  ds_read_b64_tr_b16 v[230:231], v248 offset:30976
  s_waitcnt lgkmcnt(4)
  v_mfma_f32_32x32x16_bf16 v[200:215], a[236:239], v[220:223], 0
  ds_read_b64_tr_b16 v[232:233], v248 offset:31744
  ds_read_b64_tr_b16 v[234:235], v248 offset:32000
  s_waitcnt lgkmcnt(4)
  v_mfma_f32_32x32x16_bf16 v[200:215], a[236:239], v[224:227], v[200:215]
  ds_read_b64_tr_b16 v[236:237], v248 offset:32768
  ds_read_b64_tr_b16 v[238:239], v248 offset:33024
  s_waitcnt lgkmcnt(4)
  v_mfma_f32_32x32x16_bf16 v[200:215], a[236:239], v[228:231], v[200:215]
  ds_read_b64_tr_b16 v[216:217], v248 offset:33792
  ds_read_b64_tr_b16 v[218:219], v248 offset:34048
  s_waitcnt lgkmcnt(4)
  v_mfma_f32_32x32x16_bf16 v[200:215], a[236:239], v[232:235], v[200:215]
  ds_read_b64_tr_b16 v[220:221], v248 offset:34816
  ds_read_b64_tr_b16 v[222:223], v248 offset:35072
  s_waitcnt lgkmcnt(4)
  v_mfma_f32_32x32x16_bf16 v[200:215], a[236:239], v[236:239], v[200:215]
  ds_read_b64_tr_b16 v[224:225], v248 offset:57344
  ds_read_b64_tr_b16 v[226:227], v248 offset:57600
  s_waitcnt lgkmcnt(4)
  v_mfma_f32_32x32x16_bf16 v[200:215], a[236:239], v[216:219], v[200:215]
  ds_read_b64_tr_b16 v[228:229], v248 offset:58368
  ds_read_b64_tr_b16 v[230:231], v248 offset:58624
  s_waitcnt lgkmcnt(4)
  v_mfma_f32_32x32x16_bf16 v[200:215], a[236:239], v[220:223], v[200:215]
  ds_read_b64_tr_b16 v[232:233], v248 offset:59392
  ds_read_b64_tr_b16 v[234:235], v248 offset:59648
  s_waitcnt lgkmcnt(4)
  v_mfma_f32_32x32x16_bf16 v[120:135], a[236:239], v[224:227], 0
  ds_read_b64_tr_b16 v[236:237], v248 offset:60416
  ds_read_b64_tr_b16 v[238:239], v248 offset:60672
  s_waitcnt lgkmcnt(4)
  v_mfma_f32_32x32x16_bf16 v[120:135], a[236:239], v[228:231], v[120:135]
  ds_read_b64_tr_b16 v[216:217], v248 offset:61440
  ds_read_b64_tr_b16 v[218:219], v248 offset:61696
  s_waitcnt lgkmcnt(4)
  v_mfma_f32_32x32x16_bf16 v[120:135], a[236:239], v[232:235], v[120:135]
  ds_read_b64_tr_b16 v[220:221], v248 offset:62464
  ds_read_b64_tr_b16 v[222:223], v248 offset:62720
  s_waitcnt lgkmcnt(4)
  v_mfma_f32_32x32x16_bf16 v[120:135], a[236:239], v[236:239], v[120:135]
  ds_read_b64_tr_b16 v[224:225], v248 offset:63488
  ds_read_b64_tr_b16 v[226:227], v248 offset:63744
  s_waitcnt lgkmcnt(4)
  v_mfma_f32_32x32x16_bf16 v[120:135], a[236:239], v[216:219], v[120:135]
  s_waitcnt lgkmcnt(2)
  v_mfma_f32_32x32x16_bf16 v[120:135], a[236:239], v[220:223], v[120:135]
  s_waitcnt lgkmcnt(0)
  v_mfma_f32_32x32x16_bf16 v[120:135], a[236:239], v[224:227], v[120:135]
  s_waitcnt vmcnt(0)
  s_add_u32 s79, s52, 1
  v_mov_b32 v252, s79
  buffer_store_dword v252, v4, s[36:39], s72 offen
  s_lshl_b32 s83, s4, 18
  s_mul_i32 s97, s7, 114688
  s_lshl_b32 s84, s6, 11
  s_add_u32 s97, s97, s84
  s_add_u32 s97, s97, 59768832
  v_lshlrev_b32 v255, 3, v1
  v_min_u32 v255, 1920, v255
  s_mul_i32 s97, s71, 2048
  s_add_u32 s97, s97, 5242880
  s_add_u32 s97, s97, s83
  v_lshlrev_b32 v255, 3, v1
  v_min_u32 v255, 1920, v255
  buffer_load_dword a240, v255, s[36:39], s97 offen
  s_add_u32 m0, s63, 86016
  s_add_u32 s97, s99, 524288
  buffer_load_dwordx4 v1, s[36:39], s97 offen sc1 lds
  s_add_u32 m0, s63, 87040
  s_add_u32 s97, s99, 525312
  buffer_load_dwordx4 v1, s[36:39], s97 offen sc1 lds
  s_add_u32 m0, s63, 88064
  s_add_u32 s97, s99, 526336
  buffer_load_dwordx4 v1, s[36:39], s97 offen sc1 lds
  s_add_u32 m0, s63, 89088
  s_add_u32 s97, s99, 527360
  buffer_load_dwordx4 v1, s[36:39], s97 offen sc1 lds
  s_add_u32 m0, s63, 90112
  s_add_u32 s97, s99, 528384
  buffer_load_dwordx4 v1, s[36:39], s97 offen sc1 lds
  s_add_u32 m0, s63, 91136
  s_add_u32 s97, s99, 529408
  buffer_load_dwordx4 v1, s[36:39], s97 offen sc1 lds
  s_add_u32 m0, s63, 92160
  s_add_u32 s97, s99, 530432
  buffer_load_dwordx4 v1, s[36:39], s97 offen sc1 lds
  v_lshrrev_b32 v253, 2, v1
  v_and_b32 v253, 0x7c, v253
  v_add_u32 v253, s70, v253
  ds_write_b32 v253, v56 offset:0
  ds_write_b32 v253, v200 offset:128
  ds_write_b32 v253, v120 offset:256
  s_waitcnt lgkmcnt(0)
  s_barrier
  s_xor_b32 s78, s76, 0
  s_mul_i32 s78, s78, 114688
  s_mul_i32 s79, s3, 28672
  s_add_u32 s78, s78, s79
  s_add_u32 s78, s78, 59789312
  v_add_u32 v246, s78, v1
  s_xor_b32 s78, s76, 1
  s_mul_i32 s78, s78, 114688
  s_mul_i32 s79, s3, 28672
  s_add_u32 s78, s78, s79
  s_add_u32 s78, s78, 59789312
  v_add_u32 v247, s78, v1
  v_add_u32 v250, s64, v1
  s_xor_b32 s82, s3, 1
  s_mul_i32 s82, s82, 12288
  s_add_u32 s82, s82, 114688
  v_add_u32 v251, s82, v1
  s_xor_b32 s82, s3, 2
  s_mul_i32 s82, s82, 12288
  s_add_u32 s82, s82, 118784
  v_add_u32 v252, s82, v1
  s_xor_b32 s82, s3, 3
  s_mul_i32 s82, s82, 12288
  s_add_u32 s82, s82, 122880
  v_add_u32 v253, s82, v1
  s_lshl_b32 s80, s76, 15
  s_add_u32 s80, s80, 5242880
  s_lshl_b32 s79, s77, 11
  s_add_u32 s78, s80, s79
  s_lshl_b32 s79, s55, 9
  s_add_u32 s79, s79, s80
  s_and_b32 s80, s3, 1
  s_lshl_b32 s80, s80, 3
  s_add_u32 s79, s79, s80
  s_add_u32 s79, s79, 28672
  s_lshl_b32 s80, s76, 7
  s_lshl_b32 s82, s77, 2
  s_add_u32 s80, s80, s82
  s_add_u32 s80, s80, 24576
  s_add_u32 s81, s73, 8192
  s_add_u32 s84, s52, 1
Lpoll_16:
  buffer_load_dword v15, v12, s[36:39], s81 offen sc1
  s_add_u32 s53, s53, 1
  s_cmp_gt_u32 s53, 0x20000
  s_cbranch_scc1 Lpd_17
  s_waitcnt vmcnt(0)
  v_subrev_u32 v15, s84, v15
  v_cmp_le_u32 vcc, 16, v15
  s_cbranch_vccnz Lpoll_16
Lpd_17:
  buffer_load_dwordx4 v[28:31], v247, s[40:43], 0 offen offset:0 sc1
  buffer_load_dwordx4 v[36:39], v247, s[40:43], 0 offen offset:1024 sc1
  buffer_load_dwordx4 v[44:47], v247, s[40:43], 0 offen offset:2048 sc1
  buffer_load_dwordx4 v[52:55], v247, s[40:43], 0 offen offset:3072 sc1
  buffer_load_dwordx4 v[60:63], v247, s[40:43], s57 offen offset:0 sc1
  buffer_load_dwordx4 v[68:71], v247, s[40:43], s57 offen offset:1024 sc1
  buffer_load_dwordx4 v[76:79], v247, s[40:43], s57 offen offset:2048 sc1
  s_waitcnt vmcnt(6)
  v_mfma_f32_32x32x16_bf16 v[200:215], v[136:139], v[28:31], 0
  buffer_load_dwordx4 v[84:87], v247, s[40:43], s57 offen offset:3072 sc1
  v_lshrrev_b32 v248, 2, v1
  v_and_b32 v248, 0x7c, v248
  v_add_u32 v248, 143360, v248
  ds_read_b32 v120, v248 offset:0
  v_mfma_f32_32x32x16_bf16 v[216:231], v[140:143], v[28:31], 0
  ds_read_b32 v121, v248 offset:5120
  ds_read_b32 v122, v248 offset:10240
  ds_read_b32 v123, v248 offset:15360
  ds_read_b32 v124, v248 offset:128
  ds_read_b32 v125, v248 offset:5248
  s_waitcnt vmcnt(6)
  v_mfma_f32_32x32x16_bf16 v[200:215], v[144:147], v[36:39], v[200:215]
  buffer_load_dwordx4 v[24:27], v246, s[40:43], 0 offen offset:0 sc1
  ds_read_b32 v126, v248 offset:10368
  ds_read_b32 v127, v248 offset:15488
  ds_read_b32 v128, v248 offset:256
  ds_read_b32 v129, v248 offset:5376
  v_mfma_f32_32x32x16_bf16 v[216:231], v[148:151], v[36:39], v[216:231]
  ds_read_b32 v130, v248 offset:10496
  ds_read_b32 v131, v248 offset:15616
  s_waitcnt vmcnt(6)
  v_mfma_f32_32x32x16_bf16 v[200:215], v[152:155], v[44:47], v[200:215]
  buffer_load_dwordx4 v[32:35], v246, s[40:43], 0 offen offset:1024 sc1
  v_mfma_f32_32x32x16_bf16 v[216:231], v[156:159], v[44:47], v[216:231]
  s_waitcnt lgkmcnt(0)
  v_add_f32 v120, v120, v121
  v_add_f32 v122, v122, v123
  v_add_f32 v124, v124, v125
  v_add_f32 v126, v126, v127
  s_waitcnt vmcnt(6)
  v_mfma_f32_32x32x16_bf16 v[200:215], v[160:163], v[52:55], v[200:215]
  buffer_load_dwordx4 v[40:43], v246, s[40:43], 0 offen offset:2048 sc1
  v_add_f32 v128, v128, v129
  v_add_f32 v130, v130, v131
  v_add_f32 v120, v120, v122
  v_add_f32 v124, v124, v126
  v_mfma_f32_32x32x16_bf16 v[216:231], v[164:167], v[52:55], v[216:231]
  v_add_f32 v128, v128, v130
  v_cvt_pk_bf16_f32 v121, v120, v120
  v_cvt_pk_bf16_f32 v125, v124, v124
  v_cvt_pk_bf16_f32 v129, v128, v128
  v_lshlrev_b32 v121, 16, v121
  s_waitcnt vmcnt(6)
  v_mfma_f32_32x32x16_bf16 v[200:215], v[88:91], v[60:63], v[200:215]
  buffer_load_dwordx4 v[48:51], v246, s[40:43], 0 offen offset:3072 sc1
  v_lshlrev_b32 v125, 16, v125
  v_lshlrev_b32 v129, 16, v129
  v_sub_f32 v121, v120, v121
  v_sub_f32 v125, v124, v125
  v_mfma_f32_32x32x16_bf16 v[216:231], v[92:95], v[60:63], v[216:231]
  v_sub_f32 v129, v128, v129
  v_cvt_pk_bf16_f32 v120, v120, v121
  v_cvt_pk_bf16_f32 v124, v124, v125
  v_cvt_pk_bf16_f32 v128, v128, v129
  v_accvgpr_write_b32 a224, v120
  s_waitcnt vmcnt(6)
  v_mfma_f32_32x32x16_bf16 v[200:215], v[96:99], v[68:71], v[200:215]
  buffer_load_dwordx4 v[56:59], v246, s[40:43], s57 offen offset:0 sc1
  v_accvgpr_write_b32 a226, v124
  v_accvgpr_write_b32 a228, v128
  v_mfma_f32_32x32x16_bf16 v[216:231], v[100:103], v[68:71], v[216:231]
  s_waitcnt vmcnt(6)
  v_mfma_f32_32x32x16_bf16 v[200:215], v[104:107], v[76:79], v[200:215]
  buffer_load_dwordx4 v[64:67], v246, s[40:43], s57 offen offset:1024 sc1
  v_mfma_f32_32x32x16_bf16 v[216:231], v[108:111], v[76:79], v[216:231]
  s_waitcnt vmcnt(6)
  v_mfma_f32_32x32x16_bf16 v[200:215], v[112:115], v[84:87], v[200:215]
  buffer_load_dwordx4 v[72:75], v246, s[40:43], s57 offen offset:2048 sc1
  v_mfma_f32_32x32x16_bf16 v[216:231], v[116:119], v[84:87], v[216:231]
  s_waitcnt vmcnt(6)
  v_mfma_f32_32x32x16_bf16 v[168:183], v[136:139], v[24:27], v[168:183]
  buffer_load_dwordx4 v[80:83], v246, s[40:43], s57 offen offset:3072 sc1
  s_barrier
  v_mfma_f32_32x32x16_bf16 v[184:199], v[140:143], v[24:27], 0
  s_waitcnt vmcnt(6)
  v_mfma_f32_32x32x16_bf16 v[168:183], v[144:147], v[32:35], v[168:183]
  s_lshl_b32 s28, s45, 1
  s_add_u32 s28, s28, 4096
  buffer_load_dwordx4 a[24:27], v7, s[40:43], s28 offen offset:1024 sc1
  ds_write_b128 v250, v[200:203] offset:4096
  v_mfma_f32_32x32x16_bf16 v[184:199], v[148:151], v[32:35], v[184:199]
  buffer_load_dwordx4 a[28:31], v3, s[40:43], s28 offen offset:1024 sc1
  ds_write_b128 v250, v[204:207] offset:5120
  s_waitcnt vmcnt(7)
  v_mfma_f32_32x32x16_bf16 v[168:183], v[152:155], v[40:43], v[168:183]
  s_lshl_b32 s28, s45, 1
  s_add_u32 s28, s28, 8192
  buffer_load_dwordx4 a[32:35], v7, s[40:43], s28 offen offset:0 sc1
  ds_write_b128 v250, v[208:211] offset:6144
  v_mfma_f32_32x32x16_bf16 v[184:199], v[156:159], v[40:43], v[184:199]
  buffer_load_dwordx4 a[36:39], v3, s[40:43], s28 offen offset:0 sc1
  ds_write_b128 v250, v[212:215] offset:7168
  s_waitcnt vmcnt(8)
  v_mfma_f32_32x32x16_bf16 v[168:183], v[160:163], v[48:51], v[168:183]
  s_lshl_b32 s28, s45, 1
  s_add_u32 s28, s28, 8192
  buffer_load_dwordx4 a[40:43], v7, s[40:43], s28 offen offset:1024 sc1
  v_mfma_f32_32x32x16_bf16 v[184:199], v[164:167], v[48:51], v[184:199]
  buffer_load_dwordx4 a[44:47], v3, s[40:43], s28 offen offset:1024 sc1
  s_waitcnt vmcnt(9)
  v_mfma_f32_32x32x16_bf16 v[168:183], v[88:91], v[56:59], v[168:183]
  s_lshl_b32 s28, s45, 1
  s_add_u32 s28, s28, 12288
  buffer_load_dwordx4 a[48:51], v7, s[40:43], s28 offen offset:0 sc1
  ds_write_b128 v250, v[216:219] offset:8192
  v_mfma_f32_32x32x16_bf16 v[184:199], v[92:95], v[56:59], v[184:199]
  buffer_load_dwordx4 a[52:55], v3, s[40:43], s28 offen offset:0 sc1
  ds_write_b128 v250, v[220:223] offset:9216
  s_waitcnt vmcnt(10)
  v_mfma_f32_32x32x16_bf16 v[184:199], v[100:103], v[64:67], v[184:199]
  ds_write_b128 v250, v[224:227] offset:10240
  s_waitcnt vmcnt(9)
  v_mfma_f32_32x32x16_bf16 v[184:199], v[108:111], v[72:75], v[184:199]
  ds_write_b128 v250, v[228:231] offset:11264
  s_waitcnt vmcnt(8)
  v_mfma_f32_32x32x16_bf16 v[184:199], v[116:119], v[80:83], v[184:199]
  v_mfma_f32_32x32x16_bf16 v[168:183], v[96:99], v[64:67], v[168:183]
  v_mfma_f32_32x32x16_bf16 v[168:183], v[104:107], v[72:75], v[168:183]
  ds_write_b128 v250, v[184:187] offset:0
  v_mfma_f32_32x32x16_bf16 v[168:183], v[112:115], v[80:83], v[168:183]
  ds_write_b128 v250, v[188:191] offset:1024
  ds_write_b128 v250, v[192:195] offset:2048
  ds_write_b128 v250, v[196:199] offset:3072
  s_waitcnt lgkmcnt(0)
  s_barrier
  ds_read_b128 v[184:187], v251 offset:0
  ds_read_b128 v[200:203], v252 offset:0
  ds_read_b128 v[216:219], v253 offset:0
  ds_read_b128 v[188:191], v251 offset:1024
  ds_read_b128 v[204:207], v252 offset:1024
  ds_read_b128 v[220:223], v253 offset:1024
  ds_read_b128 v[192:195], v251 offset:2048
  ds_read_b128 v[208:211], v252 offset:2048
  ds_read_b128 v[224:227], v253 offset:2048
  ds_read_b128 v[196:199], v251 offset:3072
  ds_read_b128 v[212:215], v252 offset:3072
  ds_read_b128 v[228:231], v253 offset:3072
  v_mov_b32 v254, 0
  v_mov_b32 v255, 0
  s_waitcnt lgkmcnt(9)
  v_pk_add_f32 v[168:169], v[168:169], v[184:185]
  v_pk_add_f32 v[200:201], v[200:201], v[216:217]
  v_pk_add_f32 v[170:171], v[170:171], v[186:187]
  v_pk_add_f32 v[202:203], v[202:203], v[218:219]
  v_pk_add_f32 v[168:169], v[168:169], v[200:201]
  v_pk_add_f32 v[170:171], v[170:171], v[202:203]
  v_cvt_pk_bf16_f32 v16, v168, v169
  v_cvt_pk_bf16_f32 v17, v170, v171
  v_dot2c_f32_bf16 v254, s75, v16
  v_dot2c_f32_bf16 v255, v16, v16
  v_dot2c_f32_bf16 v254, s75, v17
  v_dot2c_f32_bf16 v255, v17, v17
  s_waitcnt lgkmcnt(6)
  v_pk_add_f32 v[172:173], v[172:173], v[188:189]
  v_pk_add_f32 v[204:205], v[204:205], v[220:221]
  v_pk_add_f32 v[174:175], v[174:175], v[190:191]
  v_pk_add_f32 v[206:207], v[206:207], v[222:223]
  v_pk_add_f32 v[172:173], v[172:173], v[204:205]
  v_pk_add_f32 v[174:175], v[174:175], v[206:207]
  v_cvt_pk_bf16_f32 v18, v172, v173
  v_cvt_pk_bf16_f32 v19, v174, v175
  buffer_store_dwordx4 v[16:19], v1, s[40:43], s78 offen offset:0
  v_dot2c_f32_bf16 v254, s75, v18
  v_dot2c_f32_bf16 v255, v18, v18
  v_dot2c_f32_bf16 v254, s75, v19
  v_dot2c_f32_bf16 v255, v19, v19
  s_waitcnt lgkmcnt(3)
  v_pk_add_f32 v[176:177], v[176:177], v[192:193]
  v_pk_add_f32 v[208:209], v[208:209], v[224:225]
  v_pk_add_f32 v[178:179], v[178:179], v[194:195]
  v_pk_add_f32 v[210:211], v[210:211], v[226:227]
  v_pk_add_f32 v[176:177], v[176:177], v[208:209]
  v_pk_add_f32 v[178:179], v[178:179], v[210:211]
  v_cvt_pk_bf16_f32 v20, v176, v177
  v_cvt_pk_bf16_f32 v21, v178, v179
  v_dot2c_f32_bf16 v254, s75, v20
  v_dot2c_f32_bf16 v255, v20, v20
  v_dot2c_f32_bf16 v254, s75, v21
  v_dot2c_f32_bf16 v255, v21, v21
  s_waitcnt lgkmcnt(0)
  v_pk_add_f32 v[180:181], v[180:181], v[196:197]
  v_pk_add_f32 v[212:213], v[212:213], v[228:229]
  v_pk_add_f32 v[182:183], v[182:183], v[198:199]
  v_pk_add_f32 v[214:215], v[214:215], v[230:231]
  v_pk_add_f32 v[180:181], v[180:181], v[212:213]
  v_pk_add_f32 v[182:183], v[182:183], v[214:215]
  v_cvt_pk_bf16_f32 v22, v180, v181
  v_cvt_pk_bf16_f32 v23, v182, v183
  buffer_store_dwordx4 v[20:23], v1, s[40:43], s78 offen offset:1024
  v_dot2c_f32_bf16 v254, s75, v22
  v_dot2c_f32_bf16 v255, v22, v22
  v_dot2c_f32_bf16 v254, s75, v23
  v_dot2c_f32_bf16 v255, v23, v23
  s_nop 2
  v_permlane32_swap_b32 v254, v255
  v_add_f32 v254, v254, v255
  buffer_store_dword v254, v11, s[40:43], s79 offen
  s_waitcnt vmcnt(0)
  s_add_u32 s81, s52, 1
  v_mov_b32 v255, s81
  buffer_store_dword v255, v4, s[40:43], s80 offen
  v_add_u32 v248, s63, v10
  ds_read_b128 v[216:219], v248 offset:0
  ds_read_b128 v[220:223], v248 offset:1024
  ds_read_b128 v[224:227], v248 offset:2048
  s_waitcnt lgkmcnt(2)
  v_mfma_f32_32x32x16_bf16 v[184:199], a[236:239], v[216:219], 0
  ds_read_b128 v[228:231], v248 offset:3072
  s_waitcnt lgkmcnt(2)
  v_mfma_f32_32x32x16_bf16 v[184:199], a[236:239], v[220:223], v[184:199]
  ds_read_b128 v[232:235], v248 offset:4096
  s_waitcnt lgkmcnt(2)
  v_mfma_f32_32x32x16_bf16 v[184:199], a[236:239], v[224:227], v[184:199]
  ds_read_b128 v[236:239], v248 offset:5120
  s_waitcnt lgkmcnt(2)
  v_mfma_f32_32x32x16_bf16 v[184:199], a[236:239], v[228:231], v[184:199]
  ds_read_b128 v[216:219], v248 offset:6144
  s_waitcnt lgkmcnt(2)
  v_mfma_f32_32x32x16_bf16 v[184:199], a[236:239], v[232:235], v[184:199]
  s_waitcnt lgkmcnt(1)
  v_mfma_f32_32x32x16_bf16 v[184:199], a[236:239], v[236:239], v[184:199]
  s_waitcnt lgkmcnt(0)
  v_mfma_f32_32x32x16_bf16 v[184:199], a[236:239], v[216:219], v[184:199]
  s_lshr_b32 s78, s5, 3
  s_mul_i32 s78, s78, 28672
  s_bfe_u32 s79, s5, 0x20001
  s_lshl_b32 s80, s79, 11
  s_add_u32 s78, s78, s80
  s_add_u32 s78, s78, 9437184
  s_mul_i32 s90, s89, 114688
  s_add_u32 s90, s90, s78
  s_xor_b32 s81, s89, 4
  s_mul_i32 s91, s81, 114688
  s_add_u32 s91, s91, s78
  s_add_u32 s91, s91, 12288
  s_lshl_b32 s80, s79, 10
  s_sub_u32 s96, s90, s80
  s_add_u32 s96, s96, 8192
  s_lshr_b32 s78, s5, 3
  s_lshl_b32 s78, s78, 6
  s_lshl_b32 s80, s79, 3
  s_add_u32 s78, s78, s80
  s_and_b32 s80, s3, 1
  s_lshl_b32 s80, s80, 2
  s_add_u32 s78, s78, s80
  s_add_u32 s78, s78, 16384
  s_lshr_b32 s80, s89, 1
  s_lshl_b32 s80, s80, 8
  s_add_u32 s92, s78, s80
  s_xor_b32 s80, s80, 512
  s_add_u32 s93, s78, s80
  s_add_u32 s93, s93, 32
  s_lshl_b32 s94, s73, 1
  s_add_u32 s94, s94, 16384
  s_add_u32 s95, s94, 32
  s_lshr_b32 s99, s5, 1
  s_mul_i32 s99, s99, 28672
  s_add_u32 s99, s99, s63
  ds_read_b64_tr_b16 v[216:217], v8 offset:0
  ds_read_b64_tr_b16 v[218:219], v8 offset:256
  ds_read_b64_tr_b16 v[220:221], v8 offset:28672
  ds_read_b64_tr_b16 v[222:223], v8 offset:28928
  ds_read_b64_tr_b16 v[224:225], v2 offset:0
  ds_read_b64_tr_b16 v[226:227], v2 offset:256
  ds_read_b64_tr_b16 v[228:229], v8 offset:1024
  ds_read_b64_tr_b16 v[230:231], v8 offset:1280
  s_andn2_b32 s78, s89, 4
  s_lshl_b32 s78, s78, 7
  v_and_b32 v248, 0x200, v1
  v_add_u32 v248, v248, v13
  s_add_u32 s78, s78, 24576
  s_lshl_b32 s80, s89, 15
  s_add_u32 s80, s80, 5242880
  v_add_u32 v246, s80, v1
  v_xor_b32 v247, 131072, v246
  s_add_u32 s84, s52, 1
Lpoll_18:
  buffer_load_dword v15, v248, s[36:39], s78 offen sc1
  s_add_u32 s53, s53, 1
  s_cmp_gt_u32 s53, 0x20000
  s_cbranch_scc1 Lpd_19
  s_waitcnt vmcnt(0)
  v_subrev_u32 v15, s84, v15
  v_cmp_le_u32 vcc, 16, v15
  s_cbranch_vccnz Lpoll_18
Lpd_19:
  buffer_load_dwordx4 v[24:27], v246, s[36:39], 0 offen offset:0 sc1
  buffer_load_dwordx4 v[28:31], v246, s[36:39], 0 offen offset:1024 sc1
  buffer_load_dwordx4 v[32:35], v246, s[36:39], 0 offen offset:2048 sc1
  buffer_load_dwordx4 v[36:39], v246, s[36:39], 0 offen offset:3072 sc1
  buffer_load_dwordx4 v[40:43], v246, s[36:39], s57 offen offset:0 sc1
  buffer_load_dwordx4 v[44:47], v246, s[36:39], s57 offen offset:1024 sc1
  s_barrier
  v_lshrrev_b32 v248, 2, v1
  v_and_b32 v248, 0x7c, v248
  v_add_u32 v248, s70, v248
  ds_write_b32 v248, v184 offset:512
  s_waitcnt vmcnt(5) lgkmcnt(5)
  v_mfma_f32_32x32x16_bf16 v[136:151], v[216:219], v[24:27], 0
  ds_read_b64_tr_b16 v[232:233], v8 offset:29696
  ds_read_b64_tr_b16 v[234:235], v8 offset:29952
  buffer_load_dwordx4 v[48:51], v246, s[36:39], s57 offen offset:2048 sc1
  v_mfma_f32_32x32x16_bf16 v[152:167], v[220:223], v[24:27], 0
  ds_read_b64_tr_b16 v[236:237], v2 offset:1024
  ds_read_b64_tr_b16 v[238:239], v2 offset:1280
  s_waitcnt lgkmcnt(5)
  v_mfma_f32_32x32x16_bf16 v[200:215], v[224:227], v[24:27], 0
  ds_read_b64_tr_b16 v[216:217], v8 offset:2048
  ds_read_b64_tr_b16 v[218:219], v8 offset:2304
  buffer_load_dwordx4 v[52:55], v246, s[36:39], s57 offen offset:3072 sc1
  s_waitcnt vmcnt(6)
  v_mfma_f32_32x32x16_bf16 v[136:151], v[228:231], v[28:31], v[136:151]
  ds_read_b64_tr_b16 v[220:221], v8 offset:30720
  ds_read_b64_tr_b16 v[222:223], v8 offset:30976
  s_waitcnt lgkmcnt(4)
  v_mfma_f32_32x32x16_bf16 v[152:167], v[232:235], v[28:31], v[152:167]
  ds_read_b64_tr_b16 v[224:225], v2 offset:2048
  ds_read_b64_tr_b16 v[226:227], v2 offset:2304
  buffer_load_dwordx4 v[56:59], v246, s[36:39], s58 offen offset:0 sc1
  v_mfma_f32_32x32x16_bf16 v[200:215], v[236:239], v[28:31], v[200:215]
  ds_read_b64_tr_b16 v[228:229], v8 offset:3072
  ds_read_b64_tr_b16 v[230:231], v8 offset:3328
  s_waitcnt vmcnt(6) lgkmcnt(4)
  v_mfma_f32_32x32x16_bf16 v[136:151], v[216:219], v[32:35], v[136:151]
  ds_read_b64_tr_b16 v[232:233], v8 offset:31744
  ds_read_b64_tr_b16 v[234:235], v8 offset:32000
  buffer_load_dwordx4 v[60:63], v246, s[36:39], s58 offen offset:1024 sc1
  v_mfma_f32_32x32x16_bf16 v[152:167], v[220:223], v[32:35], v[152:167]
  ds_read_b64_tr_b16 v[236:237], v2 offset:3072
  ds_read_b64_tr_b16 v[238:239], v2 offset:3328
  s_waitcnt lgkmcnt(4)
  v_mfma_f32_32x32x16_bf16 v[200:215], v[224:227], v[32:35], v[200:215]
  ds_read_b64_tr_b16 v[216:217], v8 offset:4096
  ds_read_b64_tr_b16 v[218:219], v8 offset:4352
  buffer_load_dwordx4 v[64:67], v246, s[36:39], s58 offen offset:2048 sc1
  s_waitcnt vmcnt(7)
  v_mfma_f32_32x32x16_bf16 v[136:151], v[228:231], v[36:39], v[136:151]
  ds_read_b64_tr_b16 v[220:221], v8 offset:32768
  ds_read_b64_tr_b16 v[222:223], v8 offset:33024
  s_waitcnt lgkmcnt(4)
  v_mfma_f32_32x32x16_bf16 v[152:167], v[232:235], v[36:39], v[152:167]
  ds_read_b64_tr_b16 v[224:225], v2 offset:4096
  ds_read_b64_tr_b16 v[226:227], v2 offset:4352
  buffer_load_dwordx4 v[68:71], v246, s[36:39], s58 offen offset:3072 sc1
  v_mfma_f32_32x32x16_bf16 v[200:215], v[236:239], v[36:39], v[200:215]
  ds_read_b64_tr_b16 v[228:229], v8 offset:5120
  ds_read_b64_tr_b16 v[230:231], v8 offset:5376
  s_waitcnt vmcnt(7) lgkmcnt(4)
  v_mfma_f32_32x32x16_bf16 v[136:151], v[216:219], v[40:43], v[136:151]
  ds_read_b64_tr_b16 v[232:233], v8 offset:33792
  ds_read_b64_tr_b16 v[234:235], v8 offset:34048
  buffer_load_dwordx4 v[72:75], v246, s[36:39], s59 offen offset:0 sc1
  v_mfma_f32_32x32x16_bf16 v[152:167], v[220:223], v[40:43], v[152:167]
  ds_read_b64_tr_b16 v[236:237], v2 offset:5120
  ds_read_b64_tr_b16 v[238:239], v2 offset:5376
  s_waitcnt lgkmcnt(4)
  v_mfma_f32_32x32x16_bf16 v[200:215], v[224:227], v[40:43], v[200:215]
  s_barrier
  ds_read_b64_tr_b16 v[216:217], v8 offset:6144
  ds_read_b64_tr_b16 v[218:219], v8 offset:6400
  buffer_load_dwordx4 v[76:79], v246, s[36:39], s59 offen offset:1024 sc1
  v_lshrrev_b32 v248, 2, v1
  s_waitcnt vmcnt(8)
  v_mfma_f32_32x32x16_bf16 v[136:151], v[228:231], v[44:47], v[136:151]
  ds_read_b64_tr_b16 v[220:221], v8 offset:34816
  ds_read_b64_tr_b16 v[222:223], v8 offset:35072
  v_and_b32 v248, 0x7c, v248
  v_add_u32 v248, 143360, v248
  ds_read_b32 v188, v248 offset:512
  s_waitcnt lgkmcnt(5)
  v_mfma_f32_32x32x16_bf16 v[152:167], v[232:235], v[44:47], v[152:167]
  ds_read_b64_tr_b16 v[224:225], v2 offset:6144
  ds_read_b64_tr_b16 v[226:227], v2 offset:6400
  buffer_load_dwordx4 v[168:171], v246, s[36:39], s98 offen offset:0 sc1
  ds_read_b32 v189, v248 offset:5632
  ds_read_b32 v190, v248 offset:10752
  ds_read_b32 v191, v248 offset:15872
  v_mfma_f32_32x32x16_bf16 v[200:215], v[236:239], v[44:47], v[200:215]
  ds_read_b64_tr_b16 v[228:229], v8 offset:7168
  ds_read_b64_tr_b16 v[230:231], v8 offset:7424
  s_waitcnt vmcnt(8) lgkmcnt(8)
  v_mfma_f32_32x32x16_bf16 v[136:151], v[216:219], v[48:51], v[136:151]
  ds_read_b64_tr_b16 v[232:233], v8 offset:35840
  ds_read_b64_tr_b16 v[234:235], v8 offset:36096
  buffer_load_dwordx4 v[172:175], v246, s[36:39], s98 offen offset:1024 sc1
  v_mfma_f32_32x32x16_bf16 v[152:167], v[220:223], v[48:51], v[152:167]
  ds_read_b64_tr_b16 v[236:237], v2 offset:7168
  ds_read_b64_tr_b16 v[238:239], v2 offset:7424
  s_waitcnt lgkmcnt(4)
  v_mfma_f32_32x32x16_bf16 v[200:215], v[224:227], v[48:51], v[200:215]
  ds_read_b64_tr_b16 v[216:217], v8 offset:8192
  ds_read_b64_tr_b16 v[218:219], v8 offset:8448
  buffer_load_dwordx4 v[176:179], v246, s[36:39], s98 offen offset:2048 sc1
  v_add_f32 v188, v188, v189
  s_waitcnt vmcnt(9)
  v_mfma_f32_32x32x16_bf16 v[136:151], v[228:231], v[52:55], v[136:151]
  ds_read_b64_tr_b16 v[220:221], v8 offset:36864
  ds_read_b64_tr_b16 v[222:223], v8 offset:37120
  v_add_f32 v190, v190, v191
  v_add_f32 v188, v188, v190
  v_cvt_pk_bf16_f32 v189, v188, v188
  s_waitcnt lgkmcnt(4)
  v_mfma_f32_32x32x16_bf16 v[152:167], v[232:235], v[52:55], v[152:167]
  ds_read_b64_tr_b16 v[224:225], v2 offset:8192
  ds_read_b64_tr_b16 v[226:227], v2 offset:8448
  buffer_load_dwordx4 v[180:183], v246, s[36:39], s98 offen offset:3072 sc1
  v_lshlrev_b32 v189, 16, v189
  v_sub_f32 v189, v188, v189
  v_cvt_pk_bf16_f32 v188, v188, v189
  v_mfma_f32_32x32x16_bf16 v[200:215], v[236:239], v[52:55], v[200:215]
  ds_read_b64_tr_b16 v[228:229], v8 offset:9216
  ds_read_b64_tr_b16 v[230:231], v8 offset:9472
  v_accvgpr_write_b32 a230, v188
  s_waitcnt vmcnt(9) lgkmcnt(4)
  v_mfma_f32_32x32x16_bf16 v[136:151], v[216:219], v[56:59], v[136:151]
  ds_read_b64_tr_b16 v[232:233], v8 offset:37888
  ds_read_b64_tr_b16 v[234:235], v8 offset:38144
  buffer_load_dwordx4 v[80:83], v246, s[36:39], s59 offen offset:2048 sc1
  v_mfma_f32_32x32x16_bf16 v[152:167], v[220:223], v[56:59], v[152:167]
  ds_read_b64_tr_b16 v[236:237], v2 offset:9216
  ds_read_b64_tr_b16 v[238:239], v2 offset:9472
  s_waitcnt lgkmcnt(4)
  v_mfma_f32_32x32x16_bf16 v[200:215], v[224:227], v[56:59], v[200:215]
  ds_read_b64_tr_b16 v[216:217], v8 offset:10240
  ds_read_b64_tr_b16 v[218:219], v8 offset:10496
  buffer_load_dwordx4 v[84:87], v246, s[36:39], s59 offen offset:3072 sc1
  s_waitcnt vmcnt(10)
  v_mfma_f32_32x32x16_bf16 v[136:151], v[228:231], v[60:63], v[136:151]
  ds_read_b64_tr_b16 v[220:221], v8 offset:38912
  ds_read_b64_tr_b16 v[222:223], v8 offset:39168
  s_waitcnt lgkmcnt(4)
  v_mfma_f32_32x32x16_bf16 v[152:167], v[232:235], v[60:63], v[152:167]
  ds_read_b64_tr_b16 v[224:225], v2 offset:10240
  ds_read_b64_tr_b16 v[226:227], v2 offset:10496
  buffer_load_dwordx4 v[88:91], v246, s[36:39], s60 offen offset:0 sc1
  v_mfma_f32_32x32x16_bf16 v[200:215], v[236:239], v[60:63], v[200:215]
  ds_read_b64_tr_b16 v[228:229], v8 offset:11264
  ds_read_b64_tr_b16 v[230:231], v8 offset:11520
  s_waitcnt vmcnt(10) lgkmcnt(4)
  v_mfma_f32_32x32x16_bf16 v[136:151], v[216:219], v[64:67], v[136:151]
  ds_read_b64_tr_b16 v[232:233], v8 offset:39936
  ds_read_b64_tr_b16 v[234:235], v8 offset:40192
  buffer_load_dwordx4 v[92:95], v246, s[36:39], s60 offen offset:1024 sc1
  v_mfma_f32_32x32x16_bf16 v[152:167], v[220:223], v[64:67], v[152:167]
  ds_read_b64_tr_b16 v[236:237], v2 offset:11264
  ds_read_b64_tr_b16 v[238:239], v2 offset:11520
  s_waitcnt lgkmcnt(4)
  v_mfma_f32_32x32x16_bf16 v[200:215], v[224:227], v[64:67], v[200:215]
  ds_read_b64_tr_b16 v[216:217], v8 offset:12288
  ds_read_b64_tr_b16 v[218:219], v8 offset:12544
  buffer_load_dwordx4 v[96:99], v246, s[36:39], s60 offen offset:2048 sc1
  s_waitcnt vmcnt(11)
  v_mfma_f32_32x32x16_bf16 v[136:151], v[228:231], v[68:71], v[136:151]
  ds_read_b64_tr_b16 v[220:221], v8 offset:40960
  ds_read_b64_tr_b16 v[222:223], v8 offset:41216
  s_waitcnt lgkmcnt(4)
  v_mfma_f32_32x32x16_bf16 v[152:167], v[232:235], v[68:71], v[152:167]
  ds_read_b64_tr_b16 v[224:225], v2 offset:12288
  ds_read_b64_tr_b16 v[226:227], v2 offset:12544
  buffer_load_dwordx4 v[100:103], v246, s[36:39], s60 offen offset:3072 sc1
  v_mfma_f32_32x32x16_bf16 v[200:215], v[236:239], v[68:71], v[200:215]
  ds_read_b64_tr_b16 v[228:229], v8 offset:13312
  ds_read_b64_tr_b16 v[230:231], v8 offset:13568
  s_waitcnt vmcnt(11) lgkmcnt(4)
  v_mfma_f32_32x32x16_bf16 v[136:151], v[216:219], v[72:75], v[136:151]
  ds_read_b64_tr_b16 v[232:233], v8 offset:41984
  ds_read_b64_tr_b16 v[234:235], v8 offset:42240
  buffer_load_dwordx4 v[104:107], v246, s[36:39], s61 offen offset:0 sc1
  v_mfma_f32_32x32x16_bf16 v[152:167], v[220:223], v[72:75], v[152:167]
  ds_read_b64_tr_b16 v[236:237], v2 offset:13312
  ds_read_b64_tr_b16 v[238:239], v2 offset:13568
  s_waitcnt lgkmcnt(4)
  v_mfma_f32_32x32x16_bf16 v[200:215], v[224:227], v[72:75], v[200:215]
  ds_read_b64_tr_b16 v[216:217], v8 offset:14336
  ds_read_b64_tr_b16 v[218:219], v8 offset:14592
  buffer_load_dwordx4 v[108:111], v246, s[36:39], s61 offen offset:1024 sc1
  s_waitcnt vmcnt(12)
  v_mfma_f32_32x32x16_bf16 v[136:151], v[228:231], v[76:79], v[136:151]
  ds_read_b64_tr_b16 v[220:221], v8 offset:43008
  ds_read_b64_tr_b16 v[222:223], v8 offset:43264
  s_waitcnt vmcnt(8)
  v_add_f32 v180, v180, v182
  v_add_f32 v181, v181, v183
  s_waitcnt lgkmcnt(4)
  v_mfma_f32_32x32x16_bf16 v[152:167], v[232:235], v[76:79], v[152:167]
  ds_read_b64_tr_b16 v[224:225], v2 offset:14336
  ds_read_b64_tr_b16 v[226:227], v2 offset:14592
  buffer_load_dwordx4 v[184:187], v247, s[36:39], s98 offen offset:0 sc1
  v_add_f32 v168, v168, v170
  v_add_f32 v169, v169, v171
  v_add_f32 v172, v172, v174
  v_mfma_f32_32x32x16_bf16 v[200:215], v[236:239], v[76:79], v[200:215]
  ds_read_b64_tr_b16 v[228:229], v8 offset:15360
  ds_read_b64_tr_b16 v[230:231], v8 offset:15616
  v_add_f32 v173, v173, v175
  v_add_f32 v176, v176, v178
  v_add_f32 v177, v177, v179
  s_waitcnt vmcnt(8) lgkmcnt(4)
  v_mfma_f32_32x32x16_bf16 v[136:151], v[216:219], v[80:83], v[136:151]
  ds_read_b64_tr_b16 v[232:233], v8 offset:44032
  ds_read_b64_tr_b16 v[234:235], v8 offset:44288
  buffer_load_dwordx4 v[188:191], v247, s[36:39], s98 offen offset:1024 sc1
  v_cndmask_b32 v180, v180, 0, s[48:49]
  v_cndmask_b32 v181, v181, 0, s[48:49]
  v_add_f32 v168, v168, v172
  v_mfma_f32_32x32x16_bf16 v[152:167], v[220:223], v[80:83], v[152:167]
  ds_read_b64_tr_b16 v[236:237], v2 offset:15360
  ds_read_b64_tr_b16 v[238:239], v2 offset:15616
  v_add_f32 v169, v169, v173
  v_add_f32 v176, v176, v180
  v_add_f32 v177, v177, v181
  s_waitcnt lgkmcnt(4)
  v_mfma_f32_32x32x16_bf16 v[200:215], v[224:227], v[80:83], v[200:215]
  ds_read_b64_tr_b16 v[216:217], v8 offset:16384
  ds_read_b64_tr_b16 v[218:219], v8 offset:16640
  buffer_load_dwordx4 v[192:195], v247, s[36:39], s98 offen offset:2048 sc1
  v_add_f32 v168, v168, v176
  v_add_f32 v169, v169, v177
  s_waitcnt vmcnt(9)
  v_mfma_f32_32x32x16_bf16 v[136:151], v[228:231], v[84:87], v[136:151]
  ds_read_b64_tr_b16 v[220:221], v8 offset:45056
  ds_read_b64_tr_b16 v[222:223], v8 offset:45312
  v_mov_b32 v241, 0
  v_mov_b32 v242, 0
  v_mov_b32 v243, 0
  s_waitcnt lgkmcnt(4)
  v_mfma_f32_32x32x16_bf16 v[152:167], v[232:235], v[84:87], v[152:167]
  ds_read_b64_tr_b16 v[224:225], v2 offset:16384
  ds_read_b64_tr_b16 v[226:227], v2 offset:16640
  buffer_load_dwordx4 v[196:199], v247, s[36:39], s98 offen offset:3072 sc1
  v_permlane32_swap_b32 v168, v169
  v_add_f32 v168, v168, v169
  v_mul_f32 v168, 0x3b124925, v168
  v_mfma_f32_32x32x16_bf16 v[200:215], v[236:239], v[84:87], v[200:215]
  ds_read_b64_tr_b16 v[228:229], v8 offset:17408
  ds_read_b64_tr_b16 v[230:231], v8 offset:17664
  v_mov_b32 v169, v168
  s_nop 1
  v_permlane32_swap_b32 v168, v169
  s_waitcnt vmcnt(9) lgkmcnt(4)
  v_mfma_f32_32x32x16_bf16 v[136:151], v[216:219], v[88:91], v[136:151]
  ds_read_b64_tr_b16 v[232:233], v8 offset:46080
  ds_read_b64_tr_b16 v[234:235], v8 offset:46336
  buffer_load_dwordx4 v[112:115], v246, s[36:39], s61 offen offset:2048 sc1
  v_fma_f32 v169, -v168, v168, v169
  v_cvt_pk_bf16_f32 v168, -v168, -v168
  v_max_f32 v169, 0, v169
  v_mfma_f32_32x32x16_bf16 v[152:167], v[220:223], v[88:91], v[152:167]
  ds_read_b64_tr_b16 v[236:237], v2 offset:17408
  ds_read_b64_tr_b16 v[238:239], v2 offset:17664
  v_cndmask_b32 v240, v168, 0, s[48:49]
  v_cvt_pk_bf16_f32 v169, v169, v169
  v_lshlrev_b32 v169, 16, v169
  s_waitcnt lgkmcnt(4)
  v_mfma_f32_32x32x16_bf16 v[200:215], v[224:227], v[88:91], v[200:215]
  ds_read_b64_tr_b16 v[216:217], v8 offset:18432
  ds_read_b64_tr_b16 v[218:219], v8 offset:18688
  buffer_load_dwordx4 v[116:119], v246, s[36:39], s61 offen offset:3072 sc1
  v_add_f32 v169, 0x3727c5ac, v169
  v_cvt_pk_bf16_f32 v169, v169, v169
  s_waitcnt vmcnt(10)
  v_mfma_f32_32x32x16_bf16 v[136:151], v[228:231], v[92:95], v[136:151]
  ds_read_b64_tr_b16 v[220:221], v8 offset:47104
  ds_read_b64_tr_b16 v[222:223], v8 offset:47360
  v_lshlrev_b32 v169, 16, v169
  v_sqrt_f32 v169, v169
  s_waitcnt lgkmcnt(4)
  v_mfma_f32_32x32x16_bf16 v[152:167], v[232:235], v[92:95], v[152:167]
  ds_read_b64_tr_b16 v[224:225], v2 offset:18432
  ds_read_b64_tr_b16 v[226:227], v2 offset:18688
  buffer_load_dwordx4 v[120:123], v246, s[36:39], s62 offen offset:0 sc1
  v_cvt_pk_bf16_f32 v169, v169, v169
  v_lshlrev_b32 v245, 16, v169
  v_mfma_f32_32x32x16_bf16 v[200:215], v[236:239], v[92:95], v[200:215]
  ds_read_b64_tr_b16 v[228:229], v8 offset:19456
  ds_read_b64_tr_b16 v[230:231], v8 offset:19712
  v_rcp_f32 v244, v245
  s_nop 0
  v_mul_f32 v244, 0xbfb8aa3b, v244
  s_waitcnt vmcnt(10) lgkmcnt(4)
  v_mfma_f32_32x32x16_bf16 v[136:151], v[216:219], v[96:99], v[136:151]
  ds_read_b64_tr_b16 v[232:233], v8 offset:48128
  ds_read_b64_tr_b16 v[234:235], v8 offset:48384
  buffer_load_dwordx4 v[124:127], v246, s[36:39], s62 offen offset:1024 sc1
  v_mfma_f32_32x32x16_bf16 v[152:167], v[220:223], v[96:99], v[152:167]
  ds_read_b64_tr_b16 v[236:237], v2 offset:19456
  ds_read_b64_tr_b16 v[238:239], v2 offset:19712
  s_waitcnt lgkmcnt(4)
  v_mfma_f32_32x32x16_bf16 v[200:215], v[224:227], v[96:99], v[200:215]
  ds_read_b64_tr_b16 v[216:217], v8 offset:20480
  ds_read_b64_tr_b16 v[218:219], v8 offset:20736
  buffer_load_dwordx4 v[128:131], v246, s[36:39], s62 offen offset:2048 sc1
  s_waitcnt vmcnt(11)
  v_mfma_f32_32x32x16_bf16 v[136:151], v[228:231], v[100:103], v[136:151]
  ds_read_b64_tr_b16 v[220:221], v8 offset:49152
  ds_read_b64_tr_b16 v[222:223], v8 offset:49408
  s_waitcnt lgkmcnt(4)
  v_mfma_f32_32x32x16_bf16 v[152:167], v[232:235], v[100:103], v[152:167]
  ds_read_b64_tr_b16 v[224:225], v2 offset:20480
  ds_read_b64_tr_b16 v[226:227], v2 offset:20736
  buffer_load_dwordx4 v[132:135], v246, s[36:39], s62 offen offset:3072 sc1
  v_mfma_f32_32x32x16_bf16 v[200:215], v[236:239], v[100:103], v[200:215]
  ds_read_b64_tr_b16 v[228:229], v8 offset:21504
  ds_read_b64_tr_b16 v[230:231], v8 offset:21760
  s_waitcnt vmcnt(11) lgkmcnt(4)
  v_mfma_f32_32x32x16_bf16 v[136:151], v[216:219], v[104:107], v[136:151]
  ds_read_b64_tr_b16 v[232:233], v8 offset:50176
  ds_read_b64_tr_b16 v[234:235], v8 offset:50432
  buffer_load_dwordx4 v[24:27], v247, s[36:39], 0 offen offset:0 sc1
  v_mfma_f32_32x32x16_bf16 v[152:167], v[220:223], v[104:107], v[152:167]
  ds_read_b64_tr_b16 v[236:237], v2 offset:21504
  ds_read_b64_tr_b16 v[238:239], v2 offset:21760
  s_waitcnt lgkmcnt(4)
  v_mfma_f32_32x32x16_bf16 v[200:215], v[224:227], v[104:107], v[200:215]
  ds_read_b64_tr_b16 v[216:217], v8 offset:22528
  ds_read_b64_tr_b16 v[218:219], v8 offset:22784
  buffer_load_dwordx4 v[28:31], v247, s[36:39], 0 offen offset:1024 sc1
  s_waitcnt vmcnt(12)
  v_mfma_f32_32x32x16_bf16 v[136:151], v[228:231], v[108:111], v[136:151]
  ds_read_b64_tr_b16 v[220:221], v8 offset:51200
  ds_read_b64_tr_b16 v[222:223], v8 offset:51456
  s_waitcnt lgkmcnt(4)
  v_mfma_f32_32x32x16_bf16 v[152:167], v[232:235], v[108:111], v[152:167]
  ds_read_b64_tr_b16 v[224:225], v2 offset:22528
  ds_read_b64_tr_b16 v[226:227], v2 offset:22784
  buffer_load_dwordx4 v[32:35], v247, s[36:39], 0 offen offset:2048 sc1
  v_mfma_f32_32x32x16_bf16 v[200:215], v[236:239], v[108:111], v[200:215]
  ds_read_b64_tr_b16 v[228:229], v8 offset:23552
  ds_read_b64_tr_b16 v[230:231], v8 offset:23808
  s_waitcnt vmcnt(9)
  v_add_f32 v196, v196, v198
  v_add_f32 v197, v197, v199
  s_waitcnt vmcnt(8) lgkmcnt(4)
  v_mfma_f32_32x32x16_bf16 v[136:151], v[216:219], v[112:115], v[136:151]
  ds_read_b64_tr_b16 v[232:233], v8 offset:52224
  ds_read_b64_tr_b16 v[234:235], v8 offset:52480
  buffer_load_dwordx4 v[36:39], v247, s[36:39], 0 offen offset:3072 sc1
  v_add_f32 v184, v184, v186
  v_add_f32 v185, v185, v187
  v_add_f32 v188, v188, v190
  v_mfma_f32_32x32x16_bf16 v[152:167], v[220:223], v[112:115], v[152:167]
  ds_read_b64_tr_b16 v[236:237], v2 offset:23552
  ds_read_b64_tr_b16 v[238:239], v2 offset:23808
  v_add_f32 v189, v189, v191
  v_add_f32 v192, v192, v194
  v_add_f32 v193, v193, v195
  s_waitcnt lgkmcnt(4)
  v_mfma_f32_32x32x16_bf16 v[200:215], v[224:227], v[112:115], v[200:215]
  ds_read_b64_tr_b16 v[216:217], v8 offset:24576
  ds_read_b64_tr_b16 v[218:219], v8 offset:24832
  buffer_load_dwordx4 v[40:43], v247, s[36:39], s57 offen offset:0 sc1
  v_cndmask_b32 v196, v196, 0, s[48:49]
  v_cndmask_b32 v197, v197, 0, s[48:49]
  s_waitcnt vmcnt(9)
  v_mfma_f32_32x32x16_bf16 v[136:151], v[228:231], v[116:119], v[136:151]
  ds_read_b64_tr_b16 v[220:221], v8 offset:53248
  ds_read_b64_tr_b16 v[222:223], v8 offset:53504
  v_add_f32 v184, v184, v188
  v_add_f32 v185, v185, v189
  v_add_f32 v192, v192, v196
  s_waitcnt lgkmcnt(4)
  v_mfma_f32_32x32x16_bf16 v[152:167], v[232:235], v[116:119], v[152:167]
  ds_read_b64_tr_b16 v[224:225], v2 offset:24576
  ds_read_b64_tr_b16 v[226:227], v2 offset:24832
  buffer_load_dwordx4 v[44:47], v247, s[36:39], s57 offen offset:1024 sc1
  v_add_f32 v193, v193, v197
  v_add_f32 v184, v184, v192
  v_add_f32 v185, v185, v193
  v_mfma_f32_32x32x16_bf16 v[200:215], v[236:239], v[116:119], v[200:215]
  ds_read_b64_tr_b16 v[228:229], v8 offset:25600
  ds_read_b64_tr_b16 v[230:231], v8 offset:25856
  v_permlane32_swap_b32 v184, v185
  v_add_f32 v184, v184, v185
  v_mul_f32 v184, 0x3b124925, v184
  s_waitcnt vmcnt(9) lgkmcnt(4)
  v_mfma_f32_32x32x16_bf16 v[136:151], v[216:219], v[120:123], v[136:151]
  ds_read_b64_tr_b16 v[232:233], v8 offset:54272
  ds_read_b64_tr_b16 v[234:235], v8 offset:54528
  buffer_load_dwordx4 v[48:51], v247, s[36:39], s57 offen offset:2048 sc1
  v_mov_b32 v185, v184
  s_nop 1
  v_permlane32_swap_b32 v184, v185
  v_mfma_f32_32x32x16_bf16 v[152:167], v[220:223], v[120:123], v[152:167]
  ds_read_b64_tr_b16 v[236:237], v2 offset:25600
  ds_read_b64_tr_b16 v[238:239], v2 offset:25856
  v_fma_f32 v185, -v184, v184, v185
  v_cvt_pk_bf16_f32 v184, -v184, -v184
  v_max_f32 v185, 0, v185
  s_waitcnt lgkmcnt(4)
  v_mfma_f32_32x32x16_bf16 v[200:215], v[224:227], v[120:123], v[200:215]
  ds_read_b64_tr_b16 v[216:217], v8 offset:26624
  ds_read_b64_tr_b16 v[218:219], v8 offset:26880
  buffer_load_dwordx4 v[52:55], v247, s[36:39], s57 offen offset:3072 sc1
  v_cndmask_b32 v250, v184, 0, s[48:49]
  v_cvt_pk_bf16_f32 v185, v185, v185
  s_waitcnt vmcnt(10)
  v_mfma_f32_32x32x16_bf16 v[136:151], v[228:231], v[124:127], v[136:151]
  ds_read_b64_tr_b16 v[220:221], v8 offset:55296
  ds_read_b64_tr_b16 v[222:223], v8 offset:55552
  v_lshlrev_b32 v185, 16, v185
  v_add_f32 v185, 0x3727c5ac, v185
  v_cvt_pk_bf16_f32 v185, v185, v185
  s_waitcnt lgkmcnt(4)
  v_mfma_f32_32x32x16_bf16 v[152:167], v[232:235], v[124:127], v[152:167]
  ds_read_b64_tr_b16 v[224:225], v2 offset:26624
  ds_read_b64_tr_b16 v[226:227], v2 offset:26880
  buffer_load_dwordx4 v[56:59], v247, s[36:39], s58 offen offset:0 sc1
  v_lshlrev_b32 v185, 16, v185
  v_sqrt_f32 v185, v185
  v_mfma_f32_32x32x16_bf16 v[200:215], v[236:239], v[124:127], v[200:215]
  ds_read_b64_tr_b16 v[228:229], v8 offset:27648
  ds_read_b64_tr_b16 v[230:231], v8 offset:27904
  v_cvt_pk_bf16_f32 v185, v185, v185
  v_lshlrev_b32 v252, 16, v185
  v_rcp_f32 v251, v252
  s_nop 0
  v_mul_f32 v251, 0xbfb8aa3b, v251
  v_mfma_f32_32x32x16_bf16 v[136:151], a[224:227], v[240:243], v[136:151]
  v_mfma_f32_32x32x16_bf16 v[152:167], a[226:229], v[240:243], v[152:167]
  v_mfma_f32_32x32x16_bf16 v[200:215], a[228:231], v[240:243], v[200:215]
  v_mov_b32 v240, v250
  s_waitcnt vmcnt(10) lgkmcnt(4)
  v_mfma_f32_32x32x16_bf16 v[136:151], v[216:219], v[128:131], v[136:151]
  ds_read_b64_tr_b16 v[232:233], v8 offset:56320
  ds_read_b64_tr_b16 v[234:235], v8 offset:56576
  buffer_load_dwordx4 v[60:63], v247, s[36:39], s58 offen offset:1024 sc1
  v_mfma_f32_32x32x16_bf16 v[152:167], v[220:223], v[128:131], v[152:167]
  ds_read_b64_tr_b16 v[236:237], v2 offset:27648
  ds_read_b64_tr_b16 v[238:239], v2 offset:27904
  s_waitcnt lgkmcnt(4)
  v_mfma_f32_32x32x16_bf16 v[200:215], v[224:227], v[128:131], v[200:215]
  ds_read_b64_tr_b16 v[216:217], v8 offset:0
  ds_read_b64_tr_b16 v[218:219], v8 offset:256
  buffer_load_dwordx4 v[64:67], v247, s[36:39], s58 offen offset:2048 sc1
  s_waitcnt vmcnt(11)
  v_mfma_f32_32x32x16_bf16 v[136:151], v[228:231], v[132:135], v[136:151]
  ds_read_b64_tr_b16 v[220:221], v8 offset:28672
  ds_read_b64_tr_b16 v[222:223], v8 offset:28928
  s_waitcnt lgkmcnt(4)
  v_mfma_f32_32x32x16_bf16 v[152:167], v[232:235], v[132:135], v[152:167]
  ds_read_b64_tr_b16 v[224:225], v8 offset:1024
  ds_read_b64_tr_b16 v[226:227], v8 offset:1280
  buffer_load_dwordx4 v[68:71], v247, s[36:39], s58 offen offset:3072 sc1
  v_mfma_f32_32x32x16_bf16 v[200:215], v[236:239], v[132:135], v[200:215]
  ds_read_b64_tr_b16 v[228:229], v8 offset:29696
  ds_read_b64_tr_b16 v[230:231], v8 offset:29952
  s_waitcnt vmcnt(11) lgkmcnt(4)
  v_mfma_f32_32x32x16_bf16 v[168:183], v[216:219], v[24:27], 0
  ds_read_b64_tr_b16 v[232:233], v8 offset:2048
  ds_read_b64_tr_b16 v[234:235], v8 offset:2304
  s_lshl_b32 s28, s45, 1
  s_add_u32 s28, s28, 12288
  buffer_load_dwordx4 a[56:59], v7, s[40:43], s28 offen offset:1024 sc1
  v_mfma_f32_32x32x16_bf16 v[184:199], v[220:223], v[24:27], 0
  ds_read_b64_tr_b16 v[236:237], v8 offset:30720
  ds_read_b64_tr_b16 v[238:239], v8 offset:30976
  buffer_load_dwordx4 v[72:75], v247, s[36:39], s59 offen offset:0 sc1
  s_waitcnt vmcnt(12) lgkmcnt(4)
  v_mfma_f32_32x32x16_bf16 v[168:183], v[224:227], v[28:31], v[168:183]
  ds_read_b64_tr_b16 v[216:217], v8 offset:3072
  ds_read_b64_tr_b16 v[218:219], v8 offset:3328
  v_mul_f32 v136, v244, v136
  v_mul_f32 v137, v244, v137
  v_mul_f32 v138, v244, v138
  v_mul_f32 v139, v244, v139
  v_mfma_f32_32x32x16_bf16 v[184:199], v[228:231], v[28:31], v[184:199]
  ds_read_b64_tr_b16 v[220:221], v8 offset:31744
  ds_read_b64_tr_b16 v[222:223], v8 offset:32000
  buffer_load_dwordx4 v[76:79], v247, s[36:39], s59 offen offset:1024 sc1
  buffer_load_dwordx4 a[60:63], v3, s[40:43], s28 offen offset:1024 sc1
  s_waitcnt vmcnt(13) lgkmcnt(4)
  v_mfma_f32_32x32x16_bf16 v[168:183], v[232:235], v[32:35], v[168:183]
  ds_read_b64_tr_b16 v[224:225], v8 offset:4096
  ds_read_b64_tr_b16 v[226:227], v8 offset:4352
  v_exp_f32 v136, v136
  v_exp_f32 v137, v137
  v_mfma_f32_32x32x16_bf16 v[184:199], v[236:239], v[32:35], v[184:199]
  ds_read_b64_tr_b16 v[228:229], v8 offset:32768
  ds_read_b64_tr_b16 v[230:231], v8 offset:33024
  buffer_load_dwordx4 v[80:83], v247, s[36:39], s59 offen offset:2048 sc1
  v_exp_f32 v138, v138
  s_waitcnt vmcnt(13) lgkmcnt(4)
  v_mfma_f32_32x32x16_bf16 v[168:183], v[216:219], v[36:39], v[168:183]
  ds_read_b64_tr_b16 v[232:233], v8 offset:5120
  ds_read_b64_tr_b16 v[234:235], v8 offset:5376
  s_add_u32 s28, s45, 65536
  buffer_load_dwordx4 a[64:67], v7, s[40:43], s28 offen offset:0 sc1
  v_exp_f32 v139, v139
  v_mfma_f32_32x32x16_bf16 v[184:199], v[220:223], v[36:39], v[184:199]
  ds_read_b64_tr_b16 v[236:237], v8 offset:33792
  ds_read_b64_tr_b16 v[238:239], v8 offset:34048
  buffer_load_dwordx4 v[84:87], v247, s[36:39], s59 offen offset:3072 sc1
  v_fma_f32 v136, v136, v245, v245
  v_fma_f32 v137, v137, v245, v245
  s_waitcnt vmcnt(14) lgkmcnt(4)
  v_mfma_f32_32x32x16_bf16 v[168:183], v[224:227], v[40:43], v[168:183]
  ds_read_b64_tr_b16 v[216:217], v8 offset:6144
  ds_read_b64_tr_b16 v[218:219], v8 offset:6400
  v_fma_f32 v138, v138, v245, v245
  v_fma_f32 v139, v139, v245, v245
  v_rcp_f32 v136, v136
  v_mfma_f32_32x32x16_bf16 v[184:199], v[228:231], v[40:43], v[184:199]
  ds_read_b64_tr_b16 v[220:221], v8 offset:34816
  ds_read_b64_tr_b16 v[222:223], v8 offset:35072
  buffer_load_dwordx4 v[88:91], v247, s[36:39], s60 offen offset:0 sc1
  buffer_load_dwordx4 a[68:71], v3, s[40:43], s28 offen offset:0 sc1
  s_waitcnt vmcnt(15) lgkmcnt(4)
  v_mfma_f32_32x32x16_bf16 v[168:183], v[232:235], v[44:47], v[168:183]
  ds_read_b64_tr_b16 v[224:225], v8 offset:7168
  ds_read_b64_tr_b16 v[226:227], v8 offset:7424
  v_rcp_f32 v137, v137
  v_rcp_f32 v138, v138
  v_mfma_f32_32x32x16_bf16 v[184:199], v[236:239], v[44:47], v[184:199]
  ds_read_b64_tr_b16 v[228:229], v8 offset:35840
  ds_read_b64_tr_b16 v[230:231], v8 offset:36096
  buffer_load_dwordx4 v[92:95], v247, s[36:39], s60 offen offset:1024 sc1
  v_rcp_f32 v139, v139
  s_waitcnt vmcnt(15) lgkmcnt(4)
  v_mfma_f32_32x32x16_bf16 v[168:183], v[216:219], v[48:51], v[168:183]
  ds_read_b64_tr_b16 v[232:233], v8 offset:8192
  ds_read_b64_tr_b16 v[234:235], v8 offset:8448
  s_add_u32 s28, s45, 67584
  buffer_load_dwordx4 a[72:75], v7, s[40:43], s28 offen offset:0 sc1
  v_mul_f32 v152, v152, v136
  v_mul_f32 v153, v153, v137
  v_mfma_f32_32x32x16_bf16 v[184:199], v[220:223], v[48:51], v[184:199]
  ds_read_b64_tr_b16 v[236:237], v8 offset:36864
  ds_read_b64_tr_b16 v[238:239], v8 offset:37120
  buffer_load_dwordx4 v[96:99], v247, s[36:39], s60 offen offset:2048 sc1
  v_mul_f32 v154, v154, v138
  v_mul_f32 v155, v155, v139
  s_waitcnt vmcnt(16) lgkmcnt(4)
  v_mfma_f32_32x32x16_bf16 v[168:183], v[224:227], v[52:55], v[168:183]
  ds_read_b64_tr_b16 v[216:217], v8 offset:9216
  ds_read_b64_tr_b16 v[218:219], v8 offset:9472
  v_cvt_pk_bf16_f32 v136, v152, v153
  v_cvt_pk_bf16_f32 v137, v154, v155
  v_mul_f32 v140, v244, v140
  v_mul_f32 v141, v244, v141
  v_mfma_f32_32x32x16_bf16 v[184:199], v[228:231], v[52:55], v[184:199]
  ds_read_b64_tr_b16 v[220:221], v8 offset:37888
  ds_read_b64_tr_b16 v[222:223], v8 offset:38144
  buffer_load_dwordx4 v[100:103], v247, s[36:39], s60 offen offset:3072 sc1
  buffer_load_dwordx4 a[76:79], v3, s[40:43], s28 offen offset:0 sc1
  v_mul_f32 v142, v244, v142
  s_waitcnt vmcnt(17) lgkmcnt(4)
  v_mfma_f32_32x32x16_bf16 v[168:183], v[232:235], v[56:59], v[168:183]
  ds_read_b64_tr_b16 v[224:225], v8 offset:10240
  ds_read_b64_tr_b16 v[226:227], v8 offset:10496
  v_mul_f32 v143, v244, v143
  v_exp_f32 v140, v140
  v_mfma_f32_32x32x16_bf16 v[184:199], v[236:239], v[56:59], v[184:199]
  ds_read_b64_tr_b16 v[228:229], v8 offset:38912
  ds_read_b64_tr_b16 v[230:231], v8 offset:39168
  buffer_load_dwordx4 v[104:107], v247, s[36:39], s61 offen offset:0 sc1
  v_exp_f32 v141, v141
  s_waitcnt vmcnt(17) lgkmcnt(4)
  v_mfma_f32_32x32x16_bf16 v[168:183], v[216:219], v[60:63], v[168:183]
  ds_read_b64_tr_b16 v[232:233], v8 offset:11264
  ds_read_b64_tr_b16 v[234:235], v8 offset:11520
  s_add_u32 s28, s45, 69632
  buffer_load_dwordx4 a[80:83], v7, s[40:43], s28 offen offset:0 sc1
  v_exp_f32 v142, v142
  v_mfma_f32_32x32x16_bf16 v[184:199], v[220:223], v[60:63], v[184:199]
  ds_read_b64_tr_b16 v[236:237], v8 offset:39936
  ds_read_b64_tr_b16 v[238:239], v8 offset:40192
  buffer_load_dwordx4 v[108:111], v247, s[36:39], s61 offen offset:1024 sc1
  v_exp_f32 v143, v143
  s_waitcnt vmcnt(18) lgkmcnt(4)
  v_mfma_f32_32x32x16_bf16 v[168:183], v[224:227], v[64:67], v[168:183]
  ds_read_b64_tr_b16 v[216:217], v8 offset:12288
  ds_read_b64_tr_b16 v[218:219], v8 offset:12544
  v_fma_f32 v140, v140, v245, v245
  v_fma_f32 v141, v141, v245, v245
  v_fma_f32 v142, v142, v245, v245
  v_fma_f32 v143, v143, v245, v245
  v_mfma_f32_32x32x16_bf16 v[184:199], v[228:231], v[64:67], v[184:199]
  ds_read_b64_tr_b16 v[220:221], v8 offset:40960
  ds_read_b64_tr_b16 v[222:223], v8 offset:41216
  buffer_load_dwordx4 v[112:115], v247, s[36:39], s61 offen offset:2048 sc1
  buffer_load_dwordx4 a[84:87], v3, s[40:43], s28 offen offset:0 sc1
  s_waitcnt vmcnt(19) lgkmcnt(4)
  v_mfma_f32_32x32x16_bf16 v[168:183], v[232:235], v[68:71], v[168:183]
  ds_read_b64_tr_b16 v[224:225], v8 offset:13312
  ds_read_b64_tr_b16 v[226:227], v8 offset:13568
  v_rcp_f32 v140, v140
  v_rcp_f32 v141, v141
  v_mfma_f32_32x32x16_bf16 v[184:199], v[236:239], v[68:71], v[184:199]
  ds_read_b64_tr_b16 v[228:229], v8 offset:41984
  ds_read_b64_tr_b16 v[230:231], v8 offset:42240
  buffer_load_dwordx4 v[116:119], v247, s[36:39], s61 offen offset:3072 sc1
  v_rcp_f32 v142, v142
  s_waitcnt vmcnt(18) lgkmcnt(4)
  v_mfma_f32_32x32x16_bf16 v[168:183], v[216:219], v[72:75], v[168:183]
  ds_read_b64_tr_b16 v[232:233], v8 offset:14336
  ds_read_b64_tr_b16 v[234:235], v8 offset:14592
  s_add_u32 s28, s45, 71680
  buffer_load_dwordx4 a[88:91], v7, s[40:43], s28 offen offset:0 sc1
  v_rcp_f32 v143, v143
  v_mfma_f32_32x32x16_bf16 v[184:199], v[220:223], v[72:75], v[184:199]
  ds_read_b64_tr_b16 v[236:237], v8 offset:43008
  ds_read_b64_tr_b16 v[238:239], v8 offset:43264
  buffer_load_dwordx4 v[120:123], v247, s[36:39], s62 offen offset:0 sc1
  v_mul_f32 v156, v156, v140
  v_mul_f32 v157, v157, v141
  s_waitcnt vmcnt(19) lgkmcnt(4)
  v_mfma_f32_32x32x16_bf16 v[168:183], v[224:227], v[76:79], v[168:183]
  ds_read_b64_tr_b16 v[216:217], v8 offset:15360
  ds_read_b64_tr_b16 v[218:219], v8 offset:15616
  v_mul_f32 v158, v158, v142
  v_mul_f32 v159, v159, v143
  v_cvt_pk_bf16_f32 v138, v156, v157
  v_cvt_pk_bf16_f32 v139, v158, v159
  v_mfma_f32_32x32x16_bf16 v[184:199], v[228:231], v[76:79], v[184:199]
  ds_read_b64_tr_b16 v[220:221], v8 offset:44032
  ds_read_b64_tr_b16 v[222:223], v8 offset:44288
  buffer_load_dwordx4 v[124:127], v247, s[36:39], s62 offen offset:1024 sc1
  buffer_load_dwordx4 a[92:95], v3, s[40:43], s28 offen offset:0 sc1
  buffer_store_dwordx4 v[136:139], v1, s[36:39], s90 offen offset:0 sc1
  s_waitcnt vmcnt(20) lgkmcnt(4)
  v_mfma_f32_32x32x16_bf16 v[168:183], v[232:235], v[80:83], v[168:183]
  ds_read_b64_tr_b16 v[224:225], v8 offset:16384
  ds_read_b64_tr_b16 v[226:227], v8 offset:16640
  v_mul_f32 v144, v244, v144
  v_mul_f32 v145, v244, v145
  v_mul_f32 v146, v244, v146
  v_mul_f32 v147, v244, v147
  v_mfma_f32_32x32x16_bf16 v[184:199], v[236:239], v[80:83], v[184:199]
  ds_read_b64_tr_b16 v[228:229], v8 offset:45056
  ds_read_b64_tr_b16 v[230:231], v8 offset:45312
  buffer_load_dwordx4 v[128:131], v247, s[36:39], s62 offen offset:2048 sc1
  v_exp_f32 v144, v144
  s_waitcnt vmcnt(19) lgkmcnt(4)
  v_mfma_f32_32x32x16_bf16 v[168:183], v[216:219], v[84:87], v[168:183]
  ds_read_b64_tr_b16 v[232:233], v8 offset:17408
  ds_read_b64_tr_b16 v[234:235], v8 offset:17664
  s_lshl_b32 s28, s44, 1
  s_add_u32 s28, s28, 0
  buffer_load_dwordx4 a[96:99], v7, s[40:43], s28 offen offset:0 sc1
  v_mfma_f32_32x32x16_bf16 v[184:199], v[220:223], v[84:87], v[184:199]
  ds_read_b64_tr_b16 v[236:237], v8 offset:46080
  ds_read_b64_tr_b16 v[238:239], v8 offset:46336
  buffer_load_dwordx4 v[132:135], v247, s[36:39], s62 offen offset:3072 sc1
  v_exp_f32 v145, v145
  s_waitcnt vmcnt(20) lgkmcnt(4)
  v_mfma_f32_32x32x16_bf16 v[168:183], v[224:227], v[88:91], v[168:183]
  ds_read_b64_tr_b16 v[216:217], v8 offset:18432
  ds_read_b64_tr_b16 v[218:219], v8 offset:18688
  v_exp_f32 v146, v146
  v_exp_f32 v147, v147
  v_mfma_f32_32x32x16_bf16 v[184:199], v[228:231], v[88:91], v[184:199]
  ds_read_b64_tr_b16 v[220:221], v8 offset:47104
  ds_read_b64_tr_b16 v[222:223], v8 offset:47360
  buffer_load_dwordx4 a[100:103], v3, s[40:43], s28 offen offset:0 sc1
  v_fma_f32 v144, v144, v245, v245
  v_fma_f32 v145, v145, v245, v245
  s_waitcnt vmcnt(19) lgkmcnt(4)
  v_mfma_f32_32x32x16_bf16 v[168:183], v[232:235], v[92:95], v[168:183]
  ds_read_b64_tr_b16 v[224:225], v8 offset:19456
  ds_read_b64_tr_b16 v[226:227], v8 offset:19712
  v_fma_f32 v146, v146, v245, v245
  v_fma_f32 v147, v147, v245, v245
  v_rcp_f32 v144, v144
  v_mfma_f32_32x32x16_bf16 v[184:199], v[236:239], v[92:95], v[184:199]
  ds_read_b64_tr_b16 v[228:229], v8 offset:48128
  ds_read_b64_tr_b16 v[230:231], v8 offset:48384
  v_rcp_f32 v145, v145
  s_waitcnt vmcnt(17) lgkmcnt(4)
  v_mfma_f32_32x32x16_bf16 v[168:183], v[216:219], v[96:99], v[168:183]
  ds_read_b64_tr_b16 v[232:233], v8 offset:20480
  ds_read_b64_tr_b16 v[234:235], v8 offset:20736
  s_lshl_b32 s28, s44, 1
  s_add_u32 s28, s28, 0
  buffer_load_dwordx4 a[104:107], v7, s[40:43], s28 offen offset:1024 sc1
  v_mfma_f32_32x32x16_bf16 v[184:199], v[220:223], v[96:99], v[184:199]
  ds_read_b64_tr_b16 v[236:237], v8 offset:49152
  ds_read_b64_tr_b16 v[238:239], v8 offset:49408
  v_rcp_f32 v146, v146
  s_waitcnt vmcnt(17) lgkmcnt(4)
  v_mfma_f32_32x32x16_bf16 v[168:183], v[224:227], v[100:103], v[168:183]
  ds_read_b64_tr_b16 v[216:217], v8 offset:21504
  ds_read_b64_tr_b16 v[218:219], v8 offset:21760
  v_rcp_f32 v147, v147
  v_mul_f32 v160, v160, v144
  v_mul_f32 v161, v161, v145
  v_mfma_f32_32x32x16_bf16 v[184:199], v[228:231], v[100:103], v[184:199]
  ds_read_b64_tr_b16 v[220:221], v8 offset:50176
  ds_read_b64_tr_b16 v[222:223], v8 offset:50432
  buffer_load_dwordx4 a[108:111], v3, s[40:43], s28 offen offset:1024 sc1
  v_mul_f32 v162, v162, v146
  v_mul_f32 v163, v163, v147
  s_waitcnt vmcnt(16) lgkmcnt(4)
  v_mfma_f32_32x32x16_bf16 v[168:183], v[232:235], v[104:107], v[168:183]
  ds_read_b64_tr_b16 v[224:225], v8 offset:22528
  ds_read_b64_tr_b16 v[226:227], v8 offset:22784
  v_cvt_pk_bf16_f32 v140, v160, v161
  v_cvt_pk_bf16_f32 v141, v162, v163
  v_mul_f32 v148, v244, v148
  v_mul_f32 v149, v244, v149
  v_mfma_f32_32x32x16_bf16 v[184:199], v[236:239], v[104:107], v[184:199]
  ds_read_b64_tr_b16 v[228:229], v8 offset:51200
  ds_read_b64_tr_b16 v[230:231], v8 offset:51456
  v_mul_f32 v150, v244, v150
  v_mul_f32 v151, v244, v151
  s_waitcnt vmcnt(14) lgkmcnt(4)
  v_mfma_f32_32x32x16_bf16 v[168:183], v[216:219], v[108:111], v[168:183]
  ds_read_b64_tr_b16 v[232:233], v8 offset:23552
  ds_read_b64_tr_b16 v[234:235], v8 offset:23808
  s_lshl_b32 s28, s44, 1
  s_add_u32 s28, s28, 4096
  buffer_load_dwordx4 a[112:115], v7, s[40:43], s28 offen offset:0 sc1
  v_mfma_f32_32x32x16_bf16 v[184:199], v[220:223], v[108:111], v[184:199]
  ds_read_b64_tr_b16 v[236:237], v8 offset:52224
  ds_read_b64_tr_b16 v[238:239], v8 offset:52480
  v_exp_f32 v148, v148
  s_waitcnt vmcnt(14) lgkmcnt(4)
  v_mfma_f32_32x32x16_bf16 v[168:183], v[224:227], v[112:115], v[168:183]
  ds_read_b64_tr_b16 v[216:217], v8 offset:24576
  ds_read_b64_tr_b16 v[218:219], v8 offset:24832
  v_exp_f32 v149, v149
  v_exp_f32 v150, v150
  v_mfma_f32_32x32x16_bf16 v[184:199], v[228:231], v[112:115], v[184:199]
  ds_read_b64_tr_b16 v[220:221], v8 offset:53248
  ds_read_b64_tr_b16 v[222:223], v8 offset:53504
  buffer_load_dwordx4 a[116:119], v3, s[40:43], s28 offen offset:0 sc1
  v_exp_f32 v151, v151
  s_waitcnt vmcnt(13) lgkmcnt(4)
  v_mfma_f32_32x32x16_bf16 v[168:183], v[232:235], v[116:119], v[168:183]
  ds_read_b64_tr_b16 v[224:225], v8 offset:25600
  ds_read_b64_tr_b16 v[226:227], v8 offset:25856
  v_fma_f32 v148, v148, v245, v245
  v_fma_f32 v149, v149, v245, v245
  v_fma_f32 v150, v150, v245, v245
  v_fma_f32 v151, v151, v245, v245
  v_mfma_f32_32x32x16_bf16 v[184:199], v[236:239], v[116:119], v[184:199]
  ds_read_b64_tr_b16 v[228:229], v8 offset:54272
  ds_read_b64_tr_b16 v[230:231], v8 offset:54528
  v_rcp_f32 v148, v148
  s_waitcnt vmcnt(11) lgkmcnt(4)
  v_mfma_f32_32x32x16_bf16 v[168:183], v[216:219], v[120:123], v[168:183]
  ds_read_b64_tr_b16 v[232:233], v8 offset:26624
  ds_read_b64_tr_b16 v[234:235], v8 offset:26880
  s_lshl_b32 s28, s44, 1
  s_add_u32 s28, s28, 4096
  buffer_load_dwordx4 a[120:123], v7, s[40:43], s28 offen offset:1024 sc1
  v_mfma_f32_32x32x16_bf16 v[184:199], v[220:223], v[120:123], v[184:199]
  ds_read_b64_tr_b16 v[236:237], v8 offset:55296
  ds_read_b64_tr_b16 v[238:239], v8 offset:55552
  v_rcp_f32 v149, v149
  s_waitcnt vmcnt(11) lgkmcnt(4)
  v_mfma_f32_32x32x16_bf16 v[168:183], v[224:227], v[124:127], v[168:183]
  ds_read_b64_tr_b16 v[216:217], v8 offset:27648
  ds_read_b64_tr_b16 v[218:219], v8 offset:27904
  v_rcp_f32 v150, v150
  v_rcp_f32 v151, v151
  v_mfma_f32_32x32x16_bf16 v[184:199], v[228:231], v[124:127], v[184:199]
  ds_read_b64_tr_b16 v[220:221], v8 offset:56320
  ds_read_b64_tr_b16 v[222:223], v8 offset:56576
  buffer_load_dwordx4 a[124:127], v3, s[40:43], s28 offen offset:1024 sc1
  v_mul_f32 v164, v164, v148
  v_mul_f32 v165, v165, v149
  v_mfma_f32_32x32x16_bf16 v[168:183], a[224:227], v[240:243], v[168:183]
  v_mul_f32 v166, v166, v150
  v_mul_f32 v167, v167, v151
  v_cvt_pk_bf16_f32 v142, v164, v165
  v_cvt_pk_bf16_f32 v143, v166, v167
  buffer_store_dwordx4 v[140:143], v1, s[36:39], s90 offen offset:1024 sc1
  v_mul_f32 v200, v244, v200
  v_mfma_f32_32x32x16_bf16 v[184:199], a[226:229], v[240:243], v[184:199]
  v_mul_f32 v201, v244, v201
  v_mul_f32 v202, v244, v202
  v_mul_f32 v203, v244, v203
  v_exp_f32 v200, v200
  s_waitcnt vmcnt(10) lgkmcnt(4)
  v_mfma_f32_32x32x16_bf16 v[168:183], v[232:235], v[128:131], v[168:183]
  ds_read_b64_tr_b16 v[224:225], v2 offset:0
  ds_read_b64_tr_b16 v[226:227], v2 offset:256
  s_lshl_b32 s28, s44, 1
  s_add_u32 s28, s28, 8192
  buffer_load_dwordx4 a[128:131], v7, s[40:43], s28 offen offset:0 sc1
  v_mfma_f32_32x32x16_bf16 v[184:199], v[236:239], v[128:131], v[184:199]
  ds_read_b64_tr_b16 v[228:229], v2 offset:1024
  ds_read_b64_tr_b16 v[230:231], v2 offset:1280
  v_exp_f32 v201, v201
  s_waitcnt vmcnt(9) lgkmcnt(4)
  v_mfma_f32_32x32x16_bf16 v[168:183], v[216:219], v[132:135], v[168:183]
  ds_read_b64_tr_b16 v[232:233], v2 offset:2048
  ds_read_b64_tr_b16 v[234:235], v2 offset:2304
  v_exp_f32 v202, v202
  v_exp_f32 v203, v203
  v_mfma_f32_32x32x16_bf16 v[184:199], v[220:223], v[132:135], v[184:199]
  ds_read_b64_tr_b16 v[236:237], v2 offset:3072
  ds_read_b64_tr_b16 v[238:239], v2 offset:3328
  buffer_load_dwordx4 a[132:135], v3, s[40:43], s28 offen offset:0 sc1
  v_fma_f32 v200, v200, v245, v245
  v_fma_f32 v201, v201, v245, v245
  v_fma_f32 v202, v202, v245, v245
  v_fma_f32 v203, v203, v245, v245
  v_rcp_f32 v200, v200
  v_rcp_f32 v201, v201
  v_rcp_f32 v202, v202
  v_rcp_f32 v203, v203
  v_mul_f32 v208, v208, v200
  v_mul_f32 v209, v209, v201
  v_mul_f32 v210, v210, v202
  v_mul_f32 v211, v211, v203
  v_cvt_pk_bf16_f32 v200, v208, v209
  v_cvt_pk_bf16_f32 v201, v210, v211
  v_mul_f32 v204, v244, v204
  v_mul_f32 v205, v244, v205
  v_mul_f32 v206, v244, v206
  v_mul_f32 v207, v244, v207
  v_exp_f32 v204, v204
  v_exp_f32 v205, v205
  v_exp_f32 v206, v206
  v_exp_f32 v207, v207
  v_fma_f32 v204, v204, v245, v245
  v_fma_f32 v205, v205, v245, v245
  v_fma_f32 v206, v206, v245, v245
  v_fma_f32 v207, v207, v245, v245
  v_rcp_f32 v204, v204
  v_rcp_f32 v205, v205
  v_rcp_f32 v206, v206
  v_rcp_f32 v207, v207
  v_mul_f32 v212, v212, v204
  v_mul_f32 v213, v213, v205
  v_mul_f32 v214, v214, v206
  v_mul_f32 v215, v215, v207
  v_cvt_pk_bf16_f32 v202, v212, v213
  v_cvt_pk_bf16_f32 v203, v214, v215
  buffer_store_dwordx4 v[200:203], v1, s[36:39], s96 offen offset:0 sc1
  s_waitcnt lgkmcnt(4)
  v_mfma_f32_32x32x16_bf16 v[136:151], v[224:227], v[24:27], 0
  ds_read_b64_tr_b16 v[216:217], v2 offset:4096
  ds_read_b64_tr_b16 v[218:219], v2 offset:4352
  s_mul_i32 s79, s3, 28672
  s_add_u32 s79, s79, 9437184
  s_xor_b32 s78, s76, 0
  s_mul_i32 s78, s78, 114688
  v_mfma_f32_32x32x16_bf16 v[136:151], v[228:231], v[28:31], v[136:151]
  ds_read_b64_tr_b16 v[220:221], v2 offset:5120
  ds_read_b64_tr_b16 v[222:223], v2 offset:5376
  s_add_u32 s78, s78, s79
  v_add_u32 v246, s78, v1
  s_xor_b32 s78, s76, 1
  s_waitcnt lgkmcnt(4)
  v_mfma_f32_32x32x16_bf16 v[136:151], v[232:235], v[32:35], v[136:151]
  ds_read_b64_tr_b16 v[224:225], v2 offset:6144
  ds_read_b64_tr_b16 v[226:227], v2 offset:6400
  s_lshl_b32 s28, s44, 1
  s_add_u32 s28, s28, 8192
  buffer_load_dwordx4 a[136:139], v7, s[40:43], s28 offen offset:1024 sc1
  s_mul_i32 s78, s78, 114688
  v_mfma_f32_32x32x16_bf16 v[136:151], v[236:239], v[36:39], v[136:151]
  ds_read_b64_tr_b16 v[228:229], v2 offset:7168
  ds_read_b64_tr_b16 v[230:231], v2 offset:7424
  s_add_u32 s78, s78, s79
  v_add_u32 v247, s78, v1
  v_mul_f32 v168, v251, v168
  s_waitcnt lgkmcnt(4)
  v_mfma_f32_32x32x16_bf16 v[136:151], v[216:219], v[40:43], v[136:151]
  ds_read_b64_tr_b16 v[232:233], v2 offset:8192
  ds_read_b64_tr_b16 v[234:235], v2 offset:8448
  v_mul_f32 v169, v251, v169
  v_mul_f32 v170, v251, v170
  v_mul_f32 v171, v251, v171
  v_mfma_f32_32x32x16_bf16 v[136:151], v[220:223], v[44:47], v[136:151]
  ds_read_b64_tr_b16 v[236:237], v2 offset:9216
  ds_read_b64_tr_b16 v[238:239], v2 offset:9472
  buffer_load_dwordx4 a[140:143], v3, s[40:43], s28 offen offset:1024 sc1
  v_exp_f32 v168, v168
  s_waitcnt lgkmcnt(4)
  v_mfma_f32_32x32x16_bf16 v[136:151], v[224:227], v[48:51], v[136:151]
  ds_read_b64_tr_b16 v[216:217], v2 offset:10240
  ds_read_b64_tr_b16 v[218:219], v2 offset:10496
  v_exp_f32 v169, v169
  v_exp_f32 v170, v170
  v_mfma_f32_32x32x16_bf16 v[136:151], v[228:231], v[52:55], v[136:151]
  ds_read_b64_tr_b16 v[220:221], v2 offset:11264
  ds_read_b64_tr_b16 v[222:223], v2 offset:11520
  v_exp_f32 v171, v171
  v_fma_f32 v168, v168, v252, v252
  s_waitcnt lgkmcnt(4)
  v_mfma_f32_32x32x16_bf16 v[136:151], v[232:235], v[56:59], v[136:151]
  ds_read_b64_tr_b16 v[224:225], v2 offset:12288
  ds_read_b64_tr_b16 v[226:227], v2 offset:12544
  s_lshl_b32 s28, s44, 1
  s_add_u32 s28, s28, 12288
  buffer_load_dwordx4 a[144:147], v7, s[40:43], s28 offen offset:0 sc1
  v_fma_f32 v169, v169, v252, v252
  v_mfma_f32_32x32x16_bf16 v[136:151], v[236:239], v[60:63], v[136:151]
  ds_read_b64_tr_b16 v[228:229], v2 offset:13312
  ds_read_b64_tr_b16 v[230:231], v2 offset:13568
  v_fma_f32 v170, v170, v252, v252
  v_fma_f32 v171, v171, v252, v252
  s_waitcnt lgkmcnt(4)
  v_mfma_f32_32x32x16_bf16 v[136:151], v[216:219], v[64:67], v[136:151]
  ds_read_b64_tr_b16 v[232:233], v2 offset:14336
  ds_read_b64_tr_b16 v[234:235], v2 offset:14592
  v_rcp_f32 v168, v168
  v_rcp_f32 v169, v169
  v_mfma_f32_32x32x16_bf16 v[136:151], v[220:223], v[68:71], v[136:151]
  ds_read_b64_tr_b16 v[236:237], v2 offset:15360
  ds_read_b64_tr_b16 v[238:239], v2 offset:15616
  buffer_load_dwordx4 a[148:151], v3, s[40:43], s28 offen offset:0 sc1
  v_rcp_f32 v170, v170
  s_waitcnt lgkmcnt(4)
  v_mfma_f32_32x32x16_bf16 v[136:151], v[224:227], v[72:75], v[136:151]
  ds_read_b64_tr_b16 v[216:217], v2 offset:16384
  ds_read_b64_tr_b16 v[218:219], v2 offset:16640
  v_rcp_f32 v171, v171
  v_mul_f32 v184, v184, v168
  v_mul_f32 v185, v185, v169
  v_mfma_f32_32x32x16_bf16 v[136:151], v[228:231], v[76:79], v[136:151]
  ds_read_b64_tr_b16 v[220:221], v2 offset:17408
  ds_read_b64_tr_b16 v[222:223], v2 offset:17664
  v_mul_f32 v186, v186, v170
  v_mul_f32 v187, v187, v171
  v_cvt_pk_bf16_f32 v168, v184, v185
  s_waitcnt lgkmcnt(4)
  v_mfma_f32_32x32x16_bf16 v[136:151], v[232:235], v[80:83], v[136:151]
  ds_read_b64_tr_b16 v[224:225], v2 offset:18432
  ds_read_b64_tr_b16 v[226:227], v2 offset:18688
  s_lshl_b32 s28, s44, 1
  s_add_u32 s28, s28, 12288
  buffer_load_dwordx4 a[152:155], v7, s[40:43], s28 offen offset:1024 sc1
  v_cvt_pk_bf16_f32 v169, v186, v187
  v_mfma_f32_32x32x16_bf16 v[136:151], v[236:239], v[84:87], v[136:151]
  ds_read_b64_tr_b16 v[228:229], v2 offset:19456
  ds_read_b64_tr_b16 v[230:231], v2 offset:19712
  v_mul_f32 v172, v251, v172
  v_mul_f32 v173, v251, v173
  v_mul_f32 v174, v251, v174
  s_waitcnt lgkmcnt(4)
  v_mfma_f32_32x32x16_bf16 v[136:151], v[216:219], v[88:91], v[136:151]
  ds_read_b64_tr_b16 v[232:233], v2 offset:20480
  ds_read_b64_tr_b16 v[234:235], v2 offset:20736
  v_mul_f32 v175, v251, v175
  v_exp_f32 v172, v172
  v_mfma_f32_32x32x16_bf16 v[136:151], v[220:223], v[92:95], v[136:151]
  ds_read_b64_tr_b16 v[236:237], v2 offset:21504
  ds_read_b64_tr_b16 v[238:239], v2 offset:21760
  buffer_load_dwordx4 a[156:159], v3, s[40:43], s28 offen offset:1024 sc1
  v_exp_f32 v173, v173
  s_waitcnt lgkmcnt(4)
  v_mfma_f32_32x32x16_bf16 v[136:151], v[224:227], v[96:99], v[136:151]
  ds_read_b64_tr_b16 v[216:217], v2 offset:22528
  ds_read_b64_tr_b16 v[218:219], v2 offset:22784
  v_exp_f32 v174, v174
  v_exp_f32 v175, v175
  v_mfma_f32_32x32x16_bf16 v[136:151], v[228:231], v[100:103], v[136:151]
  ds_read_b64_tr_b16 v[220:221], v2 offset:23552
  ds_read_b64_tr_b16 v[222:223], v2 offset:23808
  v_fma_f32 v172, v172, v252, v252
  v_fma_f32 v173, v173, v252, v252
  v_fma_f32 v174, v174, v252, v252
  s_waitcnt lgkmcnt(4)
  v_mfma_f32_32x32x16_bf16 v[136:151], v[232:235], v[104:107], v[136:151]
  ds_read_b64_tr_b16 v[224:225], v2 offset:24576
  ds_read_b64_tr_b16 v[226:227], v2 offset:24832
  s_add_u32 s28, s44, 65536
  buffer_load_dwordx4 a[160:163], v7, s[40:43], s28 offen offset:0 sc1
  v_fma_f32 v175, v175, v252, v252
  v_mfma_f32_32x32x16_bf16 v[136:151], v[236:239], v[108:111], v[136:151]
  ds_read_b64_tr_b16 v[228:229], v2 offset:25600
  ds_read_b64_tr_b16 v[230:231], v2 offset:25856
  v_rcp_f32 v172, v172
  s_waitcnt lgkmcnt(4)
  v_mfma_f32_32x32x16_bf16 v[136:151], v[216:219], v[112:115], v[136:151]
  ds_read_b64_tr_b16 v[232:233], v2 offset:26624
  ds_read_b64_tr_b16 v[234:235], v2 offset:26880
  v_rcp_f32 v173, v173
  v_rcp_f32 v174, v174
  v_rcp_f32 v175, v175
  v_mul_f32 v188, v188, v172
  v_mul_f32 v189, v189, v173
  v_mul_f32 v190, v190, v174
  v_mul_f32 v191, v191, v175
  v_cvt_pk_bf16_f32 v170, v188, v189
  v_cvt_pk_bf16_f32 v171, v190, v191
  buffer_store_dwordx4 v[168:171], v1, s[36:39], s91 offen offset:0 sc1
  s_waitcnt vmcnt(8)
  s_add_u32 s83, s52, 2
  v_mov_b32 v255, s83
  buffer_store_dword v255, v4, s[36:39], s92 offen
  buffer_load_dword v15, v12, s[36:39], s94 offen sc1
  v_mfma_f32_32x32x16_bf16 v[136:151], v[220:223], v[116:119], v[136:151]
  ds_read_b64_tr_b16 v[236:237], v2 offset:27648
  ds_read_b64_tr_b16 v[238:239], v2 offset:27904
  buffer_load_dwordx4 a[164:167], v3, s[40:43], s28 offen offset:0 sc1
  v_mul_f32 v176, v251, v176
  v_mul_f32 v177, v251, v177
  s_waitcnt lgkmcnt(4)
  v_mfma_f32_32x32x16_bf16 v[136:151], v[224:227], v[120:123], v[136:151]
  ds_read_b128 v[216:219], v10 offset:0
  v_mul_f32 v178, v251, v178
  v_mul_f32 v179, v251, v179
  v_exp_f32 v176, v176
  v_mfma_f32_32x32x16_bf16 v[136:151], v[228:231], v[124:127], v[136:151]
  ds_read_b128 v[220:223], v10 offset:1024
  v_exp_f32 v177, v177
  v_exp_f32 v178, v178
  v_mfma_f32_32x32x16_bf16 v[136:151], a[228:231], v[240:243], v[136:151]
  s_add_u32 s28, s46, 98304
  buffer_load_dwordx4 a[168:171], v7, s[40:43], s28 offen offset:0 sc1
  v_exp_f32 v179, v179
  v_fma_f32 v176, v176, v252, v252
  s_waitcnt lgkmcnt(2)
  v_mfma_f32_32x32x16_bf16 v[136:151], v[232:235], v[128:131], v[136:151]
  ds_read_b128 v[224:227], v10 offset:2048
  v_fma_f32 v177, v177, v252, v252
  v_fma_f32 v178, v178, v252, v252
  v_fma_f32 v179, v179, v252, v252
  v_rcp_f32 v176, v176
  v_mfma_f32_32x32x16_bf16 v[136:151], v[236:239], v[132:135], v[136:151]
  ds_read_b128 v[228:231], v10 offset:3072
  v_rcp_f32 v177, v177
  v_rcp_f32 v178, v178
  s_waitcnt lgkmcnt(2)
  v_mfma_f32_32x32x16_bf16 v[152:167], v[216:219], v[24:27], 0
  ds_read_b128 v[232:235], v10 offset:4096
  buffer_load_dwordx4 a[172:175], v3, s[40:43], s28 offen offset:0 sc1
  v_rcp_f32 v179, v179
  v_mul_f32 v192, v192, v176
  v_mul_f32 v193, v193, v177
  v_mfma_f32_32x32x16_bf16 v[152:167], v[220:223], v[28:31], v[152:167]
  ds_read_b128 v[236:239], v10 offset:5120
  v_mul_f32 v194, v194, v178
  v_mul_f32 v195, v195, v179
  v_cvt_pk_bf16_f32 v172, v192, v193
  v_cvt_pk_bf16_f32 v173, v194, v195
  s_waitcnt lgkmcnt(2)
  v_mfma_f32_32x32x16_bf16 v[152:167], v[224:227], v[32:35], v[152:167]
  ds_read_b128 v[216:219], v10 offset:6144
  v_mul_f32 v180, v251, v180
  v_mul_f32 v181, v251, v181
  v_mul_f32 v182, v251, v182
  v_mul_f32 v183, v251, v183
  v_mfma_f32_32x32x16_bf16 v[152:167], v[228:231], v[36:39], v[152:167]
  ds_read_b128 v[220:223], v10 offset:7168
  s_add_u32 s28, s44, 67584
  buffer_load_dwordx4 a[176:179], v7, s[40:43], s28 offen offset:0 sc1
  v_exp_f32 v180, v180
  s_waitcnt lgkmcnt(2)
  v_mfma_f32_32x32x16_bf16 v[152:167], v[232:235], v[40:43], v[152:167]
  ds_read_b128 v[224:227], v10 offset:8192
  v_exp_f32 v181, v181
  v_exp_f32 v182, v182
  v_mfma_f32_32x32x16_bf16 v[152:167], v[236:239], v[44:47], v[152:167]
  ds_read_b128 v[228:231], v10 offset:9216
  v_exp_f32 v183, v183
  v_fma_f32 v180, v180, v252, v252
  v_fma_f32 v181, v181, v252, v252
  s_waitcnt lgkmcnt(2)
  v_mfma_f32_32x32x16_bf16 v[152:167], v[216:219], v[48:51], v[152:167]
  ds_read_b128 v[232:235], v10 offset:10240
  buffer_load_dwordx4 a[180:183], v3, s[40:43], s28 offen offset:0 sc1
  v_fma_f32 v182, v182, v252, v252
  v_fma_f32 v183, v183, v252, v252
  v_rcp_f32 v180, v180
  v_mfma_f32_32x32x16_bf16 v[152:167], v[220:223], v[52:55], v[152:167]
  ds_read_b128 v[236:239], v10 offset:11264
  s_add_u32 s84, s52, 2
  s_waitcnt vmcnt(5)
  v_subrev_u32 v15, s84, v15
  v_cmp_le_u32 vcc, 16, v15
  s_cbranch_vccnz Lslow_20
Lback_21:
  s_waitcnt lgkmcnt(2)
  v_mfma_f32_32x32x16_bf16 v[152:167], v[224:227], v[56:59], v[152:167]
  ds_read_b128 v[216:219], v10 offset:12288
  buffer_load_dwordx4 v[24:27], v246, s[40:43], 0 offen offset:0 sc1
  v_rcp_f32 v181, v181
  v_rcp_f32 v182, v182
  v_mfma_f32_32x32x16_bf16 v[152:167], v[228:231], v[60:63], v[152:167]
  ds_read_b128 v[220:223], v10 offset:13312
  s_add_u32 s28, s46, 99328
  buffer_load_dwordx4 a[184:187], v7, s[40:43], s28 offen offset:0 sc1
  v_rcp_f32 v183, v183
  s_waitcnt lgkmcnt(2)
  v_mfma_f32_32x32x16_bf16 v[152:167], v[232:235], v[64:67], v[152:167]
  ds_read_b128 v[224:227], v10 offset:14336
  buffer_load_dwordx4 v[28:31], v247, s[40:43], 0 offen offset:0 sc1
  v_mul_f32 v196, v196, v180
  v_mul_f32 v197, v197, v181
  v_mul_f32 v198, v198, v182
  v_mul_f32 v199, v199, v183
  v_mfma_f32_32x32x16_bf16 v[152:167], v[236:239], v[68:71], v[152:167]
  ds_read_b128 v[228:231], v10 offset:15360
  v_cvt_pk_bf16_f32 v174, v196, v197
  v_cvt_pk_bf16_f32 v175, v198, v199
  buffer_store_dwordx4 v[172:175], v1, s[36:39], s91 offen offset:1024 sc1
  v_lshlrev_b32 v168, 16, v16
  s_waitcnt lgkmcnt(2)
  v_mfma_f32_32x32x16_bf16 v[152:167], v[216:219], v[72:75], v[152:167]
  ds_read_b128 v[232:235], v10 offset:16384
  buffer_load_dwordx4 v[32:35], v246, s[40:43], 0 offen offset:1024 sc1
  buffer_load_dwordx4 a[188:191], v3, s[40:43], s28 offen offset:0 sc1
  v_and_b32 v169, 0xffff0000, v16
  v_lshlrev_b32 v170, 16, v17
  v_and_b32 v171, 0xffff0000, v17
  v_mfma_f32_32x32x16_bf16 v[152:167], v[220:223], v[76:79], v[152:167]
  ds_read_b128 v[236:239], v10 offset:17408
  v_lshlrev_b32 v172, 16, v18
  v_and_b32 v173, 0xffff0000, v18
  v_lshlrev_b32 v174, 16, v19
  v_and_b32 v175, 0xffff0000, v19
  s_waitcnt lgkmcnt(2)
  v_mfma_f32_32x32x16_bf16 v[152:167], v[224:227], v[80:83], v[152:167]
  ds_read_b128 v[216:219], v10 offset:18432
  buffer_load_dwordx4 v[36:39], v247, s[40:43], 0 offen offset:1024 sc1
  v_lshlrev_b32 v176, 16, v20
  v_and_b32 v177, 0xffff0000, v20
  v_lshlrev_b32 v178, 16, v21
  v_and_b32 v179, 0xffff0000, v21
  v_mfma_f32_32x32x16_bf16 v[152:167], v[228:231], v[84:87], v[152:167]
  ds_read_b128 v[220:223], v10 offset:19456
  s_add_u32 s28, s44, 69632
  buffer_load_dwordx4 a[192:195], v7, s[40:43], s28 offen offset:0 sc1
  v_lshlrev_b32 v180, 16, v22
  v_and_b32 v181, 0xffff0000, v22
  s_waitcnt lgkmcnt(2)
  v_mfma_f32_32x32x16_bf16 v[152:167], v[232:235], v[88:91], v[152:167]
  ds_read_b128 v[224:227], v10 offset:20480
  buffer_load_dwordx4 v[40:43], v246, s[40:43], 0 offen offset:2048 sc1
  v_lshlrev_b32 v182, 16, v23
  v_and_b32 v183, 0xffff0000, v23
  s_add_u32 s91, s91, 8192
  v_lshrrev_b32 v249, 2, v1
  v_mfma_f32_32x32x16_bf16 v[152:167], v[236:239], v[92:95], v[152:167]
  ds_read_b128 v[228:231], v10 offset:21504
  v_and_b32 v249, 0x3c, v249
  v_mul_f32 v136, v251, v136
  v_mul_f32 v137, v251, v137
  v_mul_f32 v138, v251, v138
  s_waitcnt lgkmcnt(2)
  v_mfma_f32_32x32x16_bf16 v[152:167], v[216:219], v[96:99], v[152:167]
  ds_read_b128 v[232:235], v10 offset:22528
  buffer_load_dwordx4 v[44:47], v247, s[40:43], 0 offen offset:2048 sc1
  buffer_load_dwordx4 a[196:199], v3, s[40:43], s28 offen offset:0 sc1
  v_mul_f32 v139, v251, v139
  v_exp_f32 v136, v136
  v_mfma_f32_32x32x16_bf16 v[152:167], v[220:223], v[100:103], v[152:167]
  ds_read_b128 v[236:239], v10 offset:23552
  v_exp_f32 v137, v137
  v_exp_f32 v138, v138
  s_waitcnt lgkmcnt(2)
  v_mfma_f32_32x32x16_bf16 v[152:167], v[224:227], v[104:107], v[152:167]
  ds_read_b128 v[216:219], v10 offset:24576
  buffer_load_dwordx4 v[48:51], v246, s[40:43], 0 offen offset:3072 sc1
  v_exp_f32 v139, v139
  v_fma_f32 v136, v136, v252, v252
  v_fma_f32 v137, v137, v252, v252
  v_mfma_f32_32x32x16_bf16 v[152:167], v[228:231], v[108:111], v[152:167]
  ds_read_b128 v[220:223], v10 offset:25600
  s_add_u32 s28, s46, 100352
  buffer_load_dwordx4 a[200:203], v7, s[40:43], s28 offen offset:0 sc1
  v_fma_f32 v138, v138, v252, v252
  v_fma_f32 v139, v139, v252, v252
  s_waitcnt lgkmcnt(2)
  v_mfma_f32_32x32x16_bf16 v[152:167], v[232:235], v[112:115], v[152:167]
  ds_read_b128 v[224:227], v10 offset:26624
  buffer_load_dwordx4 v[52:55], v247, s[40:43], 0 offen offset:3072 sc1
  v_rcp_f32 v136, v136
  v_rcp_f32 v137, v137
  v_mfma_f32_32x32x16_bf16 v[152:167], v[236:239], v[116:119], v[152:167]
  ds_read_b128 v[228:231], v10 offset:27648
  v_rcp_f32 v138, v138
  v_rcp_f32 v139, v139
  s_waitcnt lgkmcnt(2)
  v_mfma_f32_32x32x16_bf16 v[152:167], v[216:219], v[120:123], v[152:167]
  buffer_load_dwordx4 v[56:59], v246, s[40:43], s57 offen offset:0 sc1
  buffer_load_dwordx4 a[204:207], v3, s[40:43], s28 offen offset:0 sc1
  v_mul_f32 v144, v144, v136
  v_mul_f32 v145, v145, v137
  v_mul_f32 v146, v146, v138
  v_mul_f32 v147, v147, v139
  v_mfma_f32_32x32x16_bf16 v[152:167], v[220:223], v[124:127], v[152:167]
  v_cvt_pk_bf16_f32 v136, v144, v145
  v_cvt_pk_bf16_f32 v137, v146, v147
  v_mul_f32 v140, v251, v140
  v_mul_f32 v141, v251, v141
  v_mul_f32 v142, v251, v142
  v_mfma_f32_32x32x16_bf16 v[152:167], a[230:233], v[240:243], v[152:167]
  v_mul_f32 v143, v251, v143
  v_exp_f32 v140, v140
  v_exp_f32 v141, v141
  s_waitcnt lgkmcnt(0)
  v_mfma_f32_32x32x16_bf16 v[152:167], v[224:227], v[128:131], v[152:167]
  buffer_load_dwordx4 v[60:63], v247, s[40:43], s57 offen offset:0 sc1
  s_add_u32 s28, s44, 71680
  buffer_load_dwordx4 a[208:211], v7, s[40:43], s28 offen offset:0 sc1
  v_exp_f32 v142, v142
  v_mfma_f32_32x32x16_bf16 v[152:167], v[228:231], v[132:135], v[152:167]
  v_exp_f32 v143, v143
  v_fma_f32 v140, v140, v252, v252
  v_fma_f32 v141, v141, v252, v252
  v_fma_f32 v142, v142, v252, v252
  v_fma_f32 v143, v143, v252, v252
  s_barrier
  s_waitcnt vmcnt(17)
  v_mfma_f32_32x32x16_bf16 v[168:183], a[0:3], v[24:27], v[168:183]
  v_rcp_f32 v140, v140
  v_rcp_f32 v141, v141
  v_rcp_f32 v142, v142
  v_mfma_f32_32x32x16_bf16 v[184:199], a[4:7], v[24:27], 0
  buffer_load_dwordx4 v[64:67], v246, s[40:43], s57 offen offset:1024 sc1
  buffer_load_dwordx4 a[212:215], v3, s[40:43], s28 offen offset:0 sc1
  v_rcp_f32 v143, v143
  v_mul_f32 v148, v148, v140
  s_waitcnt vmcnt(17)
  v_mfma_f32_32x32x16_bf16 v[200:215], a[0:3], v[28:31], 0
  v_mul_f32 v149, v149, v141
  v_mul_f32 v150, v150, v142
  v_mul_f32 v151, v151, v143
  v_cvt_pk_bf16_f32 v138, v148, v149
  v_cvt_pk_bf16_f32 v139, v150, v151
  buffer_store_dwordx4 v[136:139], v1, s[36:39], s91 offen offset:0 sc1
  v_mfma_f32_32x32x16_bf16 v[216:231], a[4:7], v[28:31], 0
  buffer_load_dwordx4 v[68:71], v247, s[40:43], s57 offen offset:1024 sc1
  s_add_u32 s28, s46, 101376
  buffer_load_dwordx4 a[216:219], v7, s[40:43], s28 offen offset:0 sc1
  s_waitcnt vmcnt(19)
  s_waitcnt vmcnt(18)
  v_mfma_f32_32x32x16_bf16 v[168:183], a[8:11], v[32:35], v[168:183]
  s_add_u32 s83, s52, 2
  v_mov_b32 v255, s83
  buffer_store_dword v255, v4, s[36:39], s93 offen
  v_mul_f32 v152, v251, v152
  v_mul_f32 v153, v251, v153
  v_mul_f32 v154, v251, v154
  v_mfma_f32_32x32x16_bf16 v[184:199], a[12:15], v[32:35], v[184:199]
  buffer_load_dwordx4 v[72:75], v246, s[40:43], s57 offen offset:2048 sc1
  buffer_load_dwordx4 a[220:223], v3, s[40:43], s28 offen offset:0 sc1
  v_mul_f32 v155, v251, v155
  v_exp_f32 v152, v152
  s_waitcnt vmcnt(19)
  v_mfma_f32_32x32x16_bf16 v[200:215], a[8:11], v[36:39], v[200:215]
  v_exp_f32 v153, v153
  v_exp_f32 v154, v154
  v_exp_f32 v155, v155
  v_mfma_f32_32x32x16_bf16 v[216:231], a[12:15], v[36:39], v[216:231]
  buffer_load_dwordx4 v[76:79], v247, s[40:43], s57 offen offset:2048 sc1
  v_fma_f32 v152, v152, v252, v252
  v_fma_f32 v153, v153, v252, v252
  v_fma_f32 v154, v154, v252, v252
  v_fma_f32 v155, v155, v252, v252
  s_waitcnt vmcnt(18)
  v_mfma_f32_32x32x16_bf16 v[168:183], a[16:19], v[40:43], v[168:183]
  v_rcp_f32 v152, v152
  v_rcp_f32 v153, v153
  v_rcp_f32 v154, v154
  v_mfma_f32_32x32x16_bf16 v[184:199], a[20:23], v[40:43], v[184:199]
  buffer_load_dwordx4 v[80:83], v246, s[40:43], s57 offen offset:3072 sc1
  v_rcp_f32 v155, v155
  v_mul_f32 v160, v160, v152
  v_mul_f32 v161, v161, v153
  s_waitcnt vmcnt(18)
  v_mfma_f32_32x32x16_bf16 v[200:215], a[16:19], v[44:47], v[200:215]
  v_mul_f32 v162, v162, v154
  v_mul_f32 v163, v163, v155
  v_cvt_pk_bf16_f32 v152, v160, v161
  v_cvt_pk_bf16_f32 v153, v162, v163
  v_mul_f32 v156, v251, v156
  v_mul_f32 v157, v251, v157
  v_mfma_f32_32x32x16_bf16 v[216:231], a[20:23], v[44:47], v[216:231]
  buffer_load_dwordx4 v[84:87], v247, s[40:43], s57 offen offset:3072 sc1
  v_mul_f32 v158, v251, v158
  v_mul_f32 v159, v251, v159
  v_exp_f32 v156, v156
  s_waitcnt vmcnt(17)
  v_mfma_f32_32x32x16_bf16 v[168:183], a[24:27], v[48:51], v[168:183]
  v_exp_f32 v157, v157
  v_exp_f32 v158, v158
  v_exp_f32 v159, v159
  v_mfma_f32_32x32x16_bf16 v[184:199], a[28:31], v[48:51], v[184:199]
  buffer_load_dword v15, v12, s[36:39], s95 offen sc1
  buffer_load_dwordx4 v[88:91], v246, s[40:43], s58 offen offset:0 sc1
  v_fma_f32 v156, v156, v252, v252
  v_fma_f32 v157, v157, v252, v252
  v_fma_f32 v158, v158, v252, v252
  s_waitcnt vmcnt(17)
  v_mfma_f32_32x32x16_bf16 v[200:215], a[24:27], v[52:55], v[200:215]
  v_fma_f32 v159, v159, v252, v252
  v_rcp_f32 v156, v156
  v_rcp_f32 v157, v157
  v_mfma_f32_32x32x16_bf16 v[216:231], a[28:31], v[52:55], v[216:231]
  buffer_load_dwordx4 v[92:95], v247, s[40:43], s58 offen offset:0 sc1
  v_rcp_f32 v158, v158
  v_rcp_f32 v159, v159
  s_waitcnt vmcnt(17)
  v_mfma_f32_32x32x16_bf16 v[168:183], a[32:35], v[56:59], v[168:183]
  v_mul_f32 v164, v164, v156
  v_mul_f32 v165, v165, v157
  v_mul_f32 v166, v166, v158
  v_mul_f32 v167, v167, v159
  v_cvt_pk_bf16_f32 v154, v164, v165
  v_cvt_pk_bf16_f32 v155, v166, v167
  v_mfma_f32_32x32x16_bf16 v[184:199], a[36:39], v[56:59], v[184:199]
  buffer_load_dwordx4 v[96:99], v246, s[40:43], s58 offen offset:1024 sc1
  buffer_store_dwordx4 v[152:155], v1, s[36:39], s91 offen offset:1024 sc1
  s_waitcnt vmcnt(17)
  v_mfma_f32_32x32x16_bf16 v[200:215], a[32:35], v[60:63], v[200:215]
  v_mfma_f32_32x32x16_bf16 v[216:231], a[36:39], v[60:63], v[216:231]
  buffer_load_dwordx4 v[100:103], v247, s[40:43], s58 offen offset:1024 sc1
  s_waitcnt vmcnt(16)
  v_mfma_f32_32x32x16_bf16 v[168:183], a[40:43], v[64:67], v[168:183]
  v_mfma_f32_32x32x16_bf16 v[184:199], a[44:47], v[64:67], v[184:199]
  buffer_load_dwordx4 v[104:107], v246, s[40:43], s58 offen offset:2048 sc1
  s_waitcnt vmcnt(14)
  v_mfma_f32_32x32x16_bf16 v[200:215], a[40:43], v[68:71], v[200:215]
  v_mfma_f32_32x32x16_bf16 v[216:231], a[44:47], v[68:71], v[216:231]
  buffer_load_dwordx4 v[108:111], v247, s[40:43], s58 offen offset:2048 sc1
  s_waitcnt vmcnt(12)
  v_mfma_f32_32x32x16_bf16 v[168:183], a[48:51], v[72:75], v[168:183]
  v_mfma_f32_32x32x16_bf16 v[184:199], a[52:55], v[72:75], v[184:199]
  buffer_load_dwordx4 v[112:115], v246, s[40:43], s58 offen offset:3072 sc1
  s_waitcnt vmcnt(11)
  v_mfma_f32_32x32x16_bf16 v[200:215], a[48:51], v[76:79], v[200:215]
  v_mfma_f32_32x32x16_bf16 v[216:231], a[52:55], v[76:79], v[216:231]
  buffer_load_dwordx4 v[116:119], v247, s[40:43], s58 offen offset:3072 sc1
  s_waitcnt vmcnt(11)
  v_mfma_f32_32x32x16_bf16 v[168:183], a[56:59], v[80:83], v[168:183]
  v_mfma_f32_32x32x16_bf16 v[184:199], a[60:63], v[80:83], v[184:199]
  s_add_u32 s84, s52, 2
  s_waitcnt vmcnt(9)
  v_subrev_u32 v15, s84, v15
  v_cmp_le_u32 vcc, 16, v15
  s_cbranch_vccnz Lslow_22
Lback_23:
  buffer_load_dwordx4 v[120:123], v246, s[40:43], s59 offen offset:0 sc1
  v_mfma_f32_32x32x16_bf16 v[200:215], a[56:59], v[84:87], v[200:215]
  v_mfma_f32_32x32x16_bf16 v[216:231], a[60:63], v[84:87], v[216:231]
  buffer_load_dwordx4 v[124:127], v247, s[40:43], s59 offen offset:0 sc1
  s_waitcnt vmcnt(10)
  v_mfma_f32_32x32x16_bf16 v[168:183], a[64:67], v[88:91], v[168:183]
  v_mfma_f32_32x32x16_bf16 v[184:199], a[68:71], v[88:91], v[184:199]
  buffer_load_dwordx4 v[128:131], v246, s[40:43], s59 offen offset:1024 sc1
  s_waitcnt vmcnt(10)
  v_mfma_f32_32x32x16_bf16 v[200:215], a[64:67], v[92:95], v[200:215]
  v_mfma_f32_32x32x16_bf16 v[216:231], a[68:71], v[92:95], v[216:231]
  buffer_load_dwordx4 v[132:135], v247, s[40:43], s59 offen offset:1024 sc1
  s_waitcnt vmcnt(10)
  v_mfma_f32_32x32x16_bf16 v[168:183], a[72:75], v[96:99], v[168:183]
  v_mfma_f32_32x32x16_bf16 v[184:199], a[76:79], v[96:99], v[184:199]
  buffer_load_dwordx4 v[24:27], v246, s[40:43], s59 offen offset:2048 sc1
  s_waitcnt vmcnt(9)
  v_mfma_f32_32x32x16_bf16 v[200:215], a[72:75], v[100:103], v[200:215]
  v_mfma_f32_32x32x16_bf16 v[216:231], a[76:79], v[100:103], v[216:231]
  buffer_load_dwordx4 v[28:31], v247, s[40:43], s59 offen offset:2048 sc1
  s_waitcnt vmcnt(9)
  v_mfma_f32_32x32x16_bf16 v[168:183], a[80:83], v[104:107], v[168:183]
  v_mfma_f32_32x32x16_bf16 v[184:199], a[84:87], v[104:107], v[184:199]
  buffer_load_dwordx4 v[32:35], v246, s[40:43], s59 offen offset:3072 sc1
  s_waitcnt vmcnt(9)
  v_mfma_f32_32x32x16_bf16 v[200:215], a[80:83], v[108:111], v[200:215]
  v_mfma_f32_32x32x16_bf16 v[216:231], a[84:87], v[108:111], v[216:231]
  buffer_load_dwordx4 v[36:39], v247, s[40:43], s59 offen offset:3072 sc1
  s_waitcnt vmcnt(9)
  v_mfma_f32_32x32x16_bf16 v[168:183], a[88:91], v[112:115], v[168:183]
  v_mfma_f32_32x32x16_bf16 v[184:199], a[92:95], v[112:115], v[184:199]
  buffer_load_dwordx4 v[40:43], v246, s[40:43], s60 offen offset:0 sc1
  s_add_u32 s83, s52, 3
  v_mov_b32 v255, s83
  buffer_store_dword v255, v4, s[36:39], s93 offen
  s_waitcnt vmcnt(10)
  v_mfma_f32_32x32x16_bf16 v[200:215], a[88:91], v[116:119], v[200:215]
  v_mfma_f32_32x32x16_bf16 v[216:231], a[92:95], v[116:119], v[216:231]
  buffer_load_dwordx4 v[44:47], v247, s[40:43], s60 offen offset:0 sc1
  s_waitcnt vmcnt(10)
  v_mfma_f32_32x32x16_bf16 v[168:183], a[96:99], v[120:123], v[168:183]
  v_mfma_f32_32x32x16_bf16 v[184:199], a[100:103], v[120:123], v[184:199]
  buffer_load_dwordx4 v[48:51], v246, s[40:43], s60 offen offset:1024 sc1
  s_waitcnt vmcnt(10)
  v_mfma_f32_32x32x16_bf16 v[200:215], a[96:99], v[124:127], v[200:215]
  v_mfma_f32_32x32x16_bf16 v[216:231], a[100:103], v[124:127], v[216:231]
  buffer_load_dword v15, v12, s[36:39], s95 offen sc1
  buffer_load_dwordx4 v[52:55], v247, s[40:43], s60 offen offset:1024 sc1
  s_waitcnt vmcnt(11)
  v_mfma_f32_32x32x16_bf16 v[168:183], a[104:107], v[128:131], v[168:183]
  v_mfma_f32_32x32x16_bf16 v[184:199], a[108:111], v[128:131], v[184:199]
  buffer_load_dwordx4 v[56:59], v246, s[40:43], s60 offen offset:2048 sc1
  s_waitcnt vmcnt(11)
  v_mfma_f32_32x32x16_bf16 v[200:215], a[104:107], v[132:135], v[200:215]
  v_mfma_f32_32x32x16_bf16 v[216:231], a[108:111], v[132:135], v[216:231]
  buffer_load_dwordx4 v[60:63], v247, s[40:43], s60 offen offset:2048 sc1
  s_waitcnt vmcnt(11)
  v_mfma_f32_32x32x16_bf16 v[168:183], a[112:115], v[24:27], v[168:183]
  v_mfma_f32_32x32x16_bf16 v[184:199], a[116:119], v[24:27], v[184:199]
  buffer_load_dwordx4 v[64:67], v246, s[40:43], s60 offen offset:3072 sc1
  s_waitcnt vmcnt(11)
  v_mfma_f32_32x32x16_bf16 v[200:215], a[112:115], v[28:31], v[200:215]
  v_mfma_f32_32x32x16_bf16 v[216:231], a[116:119], v[28:31], v[216:231]
  buffer_load_dwordx4 v[68:71], v247, s[40:43], s60 offen offset:3072 sc1
  v_add_u32 v250, s64, v1
  s_xor_b32 s82, s3, 1
  s_mul_i32 s82, s82, 12288
  s_waitcnt vmcnt(11)
  v_mfma_f32_32x32x16_bf16 v[168:183], a[120:123], v[32:35], v[168:183]
  s_add_u32 m0, s63, 86016
  s_add_u32 s97, s65, 16777216
  buffer_load_dwordx4 v1, s[36:39], s97 offen sc1 lds
  s_add_u32 s82, s82, 114688
  v_add_u32 v251, s82, v1
  s_xor_b32 s82, s3, 2
  v_mfma_f32_32x32x16_bf16 v[184:199], a[124:127], v[32:35], v[184:199]
  s_mul_i32 s82, s82, 12288
  s_add_u32 s82, s82, 118784
  v_add_u32 v252, s82, v1
  s_xor_b32 s82, s3, 3
  s_mul_i32 s82, s82, 12288
  s_waitcnt vmcnt(11)
  v_mfma_f32_32x32x16_bf16 v[200:215], a[120:123], v[36:39], v[200:215]
  s_add_u32 s82, s82, 122880
  v_add_u32 v253, s82, v1
  s_lshl_b32 s80, s76, 15
  s_add_u32 s80, s80, 5242880
  s_lshl_b32 s79, s77, 11
  s_add_u32 s78, s80, s79
  v_mfma_f32_32x32x16_bf16 v[216:231], a[124:127], v[36:39], v[216:231]
  s_add_u32 m0, s63, 87040
  s_add_u32 s97, s65, 16778240
  buffer_load_dwordx4 v1, s[36:39], s97 offen sc1 lds
  s_lshl_b32 s79, s55, 9
  s_add_u32 s79, s79, s80
  s_waitcnt vmcnt(11)
  v_mfma_f32_32x32x16_bf16 v[168:183], a[128:131], v[40:43], v[168:183]
  s_and_b32 s80, s3, 1
  s_lshl_b32 s80, s80, 3
  s_add_u32 s79, s79, s80
  s_add_u32 s79, s79, 28672
  s_lshl_b32 s80, s76, 7
  s_lshl_b32 s82, s77, 2
  v_mfma_f32_32x32x16_bf16 v[184:199], a[132:135], v[40:43], v[184:199]
  s_add_u32 s80, s80, s82
  s_add_u32 s80, s80, 24576
  s_waitcnt vmcnt(9)
  v_mfma_f32_32x32x16_bf16 v[200:215], a[128:131], v[44:47], v[200:215]
  s_add_u32 m0, s63, 88064
  s_add_u32 s97, s65, 16779264
  buffer_load_dwordx4 v1, s[36:39], s97 offen sc1 lds
  v_mfma_f32_32x32x16_bf16 v[216:231], a[132:135], v[44:47], v[216:231]
  s_add_u32 s84, s52, 3
  s_waitcnt vmcnt(8)
  v_subrev_u32 v15, s84, v15
  v_cmp_le_u32 vcc, 16, v15
  s_cbranch_vccnz Lslow_24
Lback_25:
  buffer_load_dwordx4 v[72:75], v246, s[40:43], s61 offen offset:0 sc1
  buffer_load_dwordx4 v[76:79], v247, s[40:43], s61 offen offset:0 sc1
  v_mfma_f32_32x32x16_bf16 v[168:183], a[136:139], v[48:51], v[168:183]
  v_mfma_f32_32x32x16_bf16 v[184:199], a[140:143], v[48:51], v[184:199]
  buffer_load_dwordx4 v[80:83], v246, s[40:43], s61 offen offset:1024 sc1
  buffer_load_dwordx4 v[84:87], v247, s[40:43], s61 offen offset:1024 sc1
  s_add_u32 m0, s63, 89088
  s_add_u32 s97, s65, 16780288
  buffer_load_dwordx4 v1, s[36:39], s97 offen sc1 lds
  s_waitcnt vmcnt(12)
  v_mfma_f32_32x32x16_bf16 v[200:215], a[136:139], v[52:55], v[200:215]
  v_mfma_f32_32x32x16_bf16 v[216:231], a[140:143], v[52:55], v[216:231]
  buffer_load_dwordx4 v[92:95], v247, s[40:43], s61 offen offset:2048 sc1
  buffer_load_dwordx4 v[100:103], v247, s[40:43], s61 offen offset:3072 sc1
  s_waitcnt vmcnt(13)
  v_mfma_f32_32x32x16_bf16 v[168:183], a[144:147], v[56:59], v[168:183]
  s_add_u32 m0, s63, 90112
  s_add_u32 s97, s65, 16781312
  buffer_load_dwordx4 v1, s[36:39], s97 offen sc1 lds
  v_mfma_f32_32x32x16_bf16 v[184:199], a[148:151], v[56:59], v[184:199]
  buffer_load_dwordx4 v[108:111], v247, s[40:43], s62 offen offset:0 sc1
  buffer_load_dwordx4 v[116:119], v247, s[40:43], s62 offen offset:1024 sc1
  s_waitcnt vmcnt(15)
  v_mfma_f32_32x32x16_bf16 v[200:215], a[144:147], v[60:63], v[200:215]
  v_mfma_f32_32x32x16_bf16 v[216:231], a[148:151], v[60:63], v[216:231]
  buffer_load_dwordx4 v[124:127], v247, s[40:43], s62 offen offset:2048 sc1
  buffer_load_dwordx4 v[132:135], v247, s[40:43], s62 offen offset:3072 sc1
  s_add_u32 m0, s63, 91136
  s_add_u32 s97, s65, 16782336
  buffer_load_dwordx4 v1, s[36:39], s97 offen sc1 lds
  s_waitcnt vmcnt(17)
  v_mfma_f32_32x32x16_bf16 v[168:183], a[152:155], v[64:67], v[168:183]
  v_mfma_f32_32x32x16_bf16 v[184:199], a[156:159], v[64:67], v[184:199]
  buffer_load_dwordx4 v[88:91], v246, s[40:43], s61 offen offset:2048 sc1
  buffer_load_dwordx4 v[96:99], v246, s[40:43], s61 offen offset:3072 sc1
  s_waitcnt vmcnt(18)
  v_mfma_f32_32x32x16_bf16 v[200:215], a[152:155], v[68:71], v[200:215]
  s_add_u32 m0, s63, 92160
  s_add_u32 s97, s65, 16783360
  buffer_load_dwordx4 v1, s[36:39], s97 offen sc1 lds
  v_mfma_f32_32x32x16_bf16 v[216:231], a[156:159], v[68:71], v[216:231]
  buffer_load_dwordx4 v[104:107], v246, s[40:43], s62 offen offset:0 sc1
  buffer_load_dwordx4 v[112:115], v246, s[40:43], s62 offen offset:1024 sc1
  s_waitcnt vmcnt(17)
  v_mfma_f32_32x32x16_bf16 v[168:183], a[160:163], v[72:75], v[168:183]
  v_mfma_f32_32x32x16_bf16 v[184:199], a[164:167], v[72:75], v[184:199]
  buffer_load_dwordx4 v[120:123], v246, s[40:43], s62 offen offset:2048 sc1
  s_waitcnt vmcnt(17)
  v_mfma_f32_32x32x16_bf16 v[200:215], a[160:163], v[76:79], v[200:215]
  v_mfma_f32_32x32x16_bf16 v[216:231], a[164:167], v[76:79], v[216:231]
  buffer_load_dwordx4 v[128:131], v246, s[40:43], s62 offen offset:3072 sc1
  s_waitcnt vmcnt(17)
  v_mfma_f32_32x32x16_bf16 v[168:183], a[168:171], v[80:83], v[168:183]
  v_mfma_f32_32x32x16_bf16 v[184:199], a[172:175], v[80:83], v[184:199]
  s_waitcnt vmcnt(16)
  v_mfma_f32_32x32x16_bf16 v[200:215], a[168:171], v[84:87], v[200:215]
  v_mfma_f32_32x32x16_bf16 v[216:231], a[172:175], v[84:87], v[216:231]
  s_waitcnt vmcnt(14)
  v_mfma_f32_32x32x16_bf16 v[216:231], a[180:183], v[92:95], v[216:231]
  s_waitcnt vmcnt(13)
  v_mfma_f32_32x32x16_bf16 v[216:231], a[188:191], v[100:103], v[216:231]
  s_waitcnt vmcnt(11)
  v_mfma_f32_32x32x16_bf16 v[216:231], a[196:199], v[108:111], v[216:231]
  s_waitcnt vmcnt(10)
  v_mfma_f32_32x32x16_bf16 v[216:231], a[204:207], v[116:119], v[216:231]
  s_waitcnt vmcnt(9)
  v_mfma_f32_32x32x16_bf16 v[216:231], a[212:215], v[124:127], v[216:231]
  s_waitcnt vmcnt(8)
  v_mfma_f32_32x32x16_bf16 v[216:231], a[220:223], v[132:135], v[216:231]
  s_lshr_b32 s83, s71, 3
  s_mul_i32 s83, s83, 86016
  s_and_b32 s97, s71, 7
  s_mul_i32 s97, s97, 7168
  s_add_u32 s83, s83, s97
  s_add_u32 s83, s83, 16805888
  v_lshlrev_b32 v248, 3, v1
  v_min_u32 v248, 7040, v248
  buffer_load_dword a240, v248, s[36:39], s83 offen sc1
  v_mfma_f32_32x32x16_bf16 v[200:215], a[176:179], v[92:95], v[200:215]
  v_mfma_f32_32x32x16_bf16 v[200:215], a[184:187], v[100:103], v[200:215]
  ds_write_b128 v250, v[216:219] offset:8192
  v_mfma_f32_32x32x16_bf16 v[200:215], a[192:195], v[108:111], v[200:215]
  ds_write_b128 v250, v[220:223] offset:9216
  v_mfma_f32_32x32x16_bf16 v[200:215], a[200:203], v[116:119], v[200:215]
  ds_write_b128 v250, v[224:227] offset:10240
  v_mfma_f32_32x32x16_bf16 v[200:215], a[208:211], v[124:127], v[200:215]
  ds_write_b128 v250, v[228:231] offset:11264
  v_mfma_f32_32x32x16_bf16 v[200:215], a[216:219], v[132:135], v[200:215]
  s_waitcnt vmcnt(7)
  v_mfma_f32_32x32x16_bf16 v[184:199], a[180:183], v[88:91], v[184:199]
  s_waitcnt vmcnt(6)
  v_mfma_f32_32x32x16_bf16 v[184:199], a[188:191], v[96:99], v[184:199]
  ds_write_b128 v250, v[200:203] offset:4096
  s_waitcnt vmcnt(4)
  v_mfma_f32_32x32x16_bf16 v[184:199], a[196:199], v[104:107], v[184:199]
  ds_write_b128 v250, v[204:207] offset:5120
  s_waitcnt vmcnt(3)
  v_mfma_f32_32x32x16_bf16 v[184:199], a[204:207], v[112:115], v[184:199]
  ds_write_b128 v250, v[208:211] offset:6144
  s_waitcnt vmcnt(2)
  v_mfma_f32_32x32x16_bf16 v[184:199], a[212:215], v[120:123], v[184:199]
  ds_write_b128 v250, v[212:215] offset:7168
  s_waitcnt vmcnt(1)
  v_mfma_f32_32x32x16_bf16 v[184:199], a[220:223], v[128:131], v[184:199]
  v_mfma_f32_32x32x16_bf16 v[168:183], a[176:179], v[88:91], v[168:183]
  v_mfma_f32_32x32x16_bf16 v[168:183], a[184:187], v[96:99], v[168:183]
  ds_write_b128 v250, v[184:187] offset:0
  v_mfma_f32_32x32x16_bf16 v[168:183], a[192:195], v[104:107], v[168:183]
  ds_write_b128 v250, v[188:191] offset:1024
  v_mfma_f32_32x32x16_bf16 v[168:183], a[200:203], v[112:115], v[168:183]
  ds_write_b128 v250, v[192:195] offset:2048
  v_mfma_f32_32x32x16_bf16 v[168:183], a[208:211], v[120:123], v[168:183]
  ds_write_b128 v250, v[196:199] offset:3072
  v_mfma_f32_32x32x16_bf16 v[168:183], a[216:219], v[128:131], v[168:183]
  s_waitcnt lgkmcnt(0)
  s_barrier
  ds_read_b128 v[184:187], v251 offset:0
  ds_read_b128 v[200:203], v252 offset:0
  ds_read_b128 v[216:219], v253 offset:0
  ds_read_b128 v[188:191], v251 offset:1024
  ds_read_b128 v[204:207], v252 offset:1024
  ds_read_b128 v[220:223], v253 offset:1024
  ds_read_b128 v[192:195], v251 offset:2048
  ds_read_b128 v[208:211], v252 offset:2048
  ds_read_b128 v[224:227], v253 offset:2048
  ds_read_b128 v[196:199], v251 offset:3072
  ds_read_b128 v[212:215], v252 offset:3072
  ds_read_b128 v[228:231], v253 offset:3072
  v_mov_b32 v254, 0
  v_mov_b32 v255, 0
  s_waitcnt lgkmcnt(9)
  v_pk_add_f32 v[168:169], v[168:169], v[184:185]
  v_pk_add_f32 v[200:201], v[200:201], v[216:217]
  v_pk_add_f32 v[170:171], v[170:171], v[186:187]
  v_pk_add_f32 v[202:203], v[202:203], v[218:219]
  v_pk_add_f32 v[168:169], v[168:169], v[200:201]
  v_pk_add_f32 v[170:171], v[170:171], v[202:203]
  v_cvt_pk_bf16_f32 v16, v168, v169
  v_cvt_pk_bf16_f32 v17, v170, v171
  v_dot2c_f32_bf16 v254, s75, v16
  v_dot2c_f32_bf16 v255, v16, v16
  v_dot2c_f32_bf16 v254, s75, v17
  v_dot2c_f32_bf16 v255, v17, v17
  s_waitcnt lgkmcnt(6)
  v_pk_add_f32 v[172:173], v[172:173], v[188:189]
  v_pk_add_f32 v[204:205], v[204:205], v[220:221]
  v_pk_add_f32 v[174:175], v[174:175], v[190:191]
  v_pk_add_f32 v[206:207], v[206:207], v[222:223]
  v_pk_add_f32 v[172:173], v[172:173], v[204:205]
  v_pk_add_f32 v[174:175], v[174:175], v[206:207]
  v_cvt_pk_bf16_f32 v18, v172, v173
  v_cvt_pk_bf16_f32 v19, v174, v175
  buffer_store_dwordx4 v[16:19], v1, s[40:43], s78 offen offset:0
  v_dot2c_f32_bf16 v254, s75, v18
  v_dot2c_f32_bf16 v255, v18, v18
  v_dot2c_f32_bf16 v254, s75, v19
  v_dot2c_f32_bf16 v255, v19, v19
  s_waitcnt lgkmcnt(3)
  v_pk_add_f32 v[176:177], v[176:177], v[192:193]
  v_pk_add_f32 v[208:209], v[208:209], v[224:225]
  v_pk_add_f32 v[178:179], v[178:179], v[194:195]
  v_pk_add_f32 v[210:211], v[210:211], v[226:227]
  v_pk_add_f32 v[176:177], v[176:177], v[208:209]
  v_pk_add_f32 v[178:179], v[178:179], v[210:211]
  v_cvt_pk_bf16_f32 v20, v176, v177
  v_cvt_pk_bf16_f32 v21, v178, v179
  v_dot2c_f32_bf16 v254, s75, v20
  v_dot2c_f32_bf16 v255, v20, v20
  v_dot2c_f32_bf16 v254, s75, v21
  v_dot2c_f32_bf16 v255, v21, v21
  s_waitcnt lgkmcnt(0)
  v_pk_add_f32 v[180:181], v[180:181], v[196:197]
  v_pk_add_f32 v[212:213], v[212:213], v[228:229]
  v_pk_add_f32 v[182:183], v[182:183], v[198:199]
  v_pk_add_f32 v[214:215], v[214:215], v[230:231]
  v_pk_add_f32 v[180:181], v[180:181], v[212:213]
  v_pk_add_f32 v[182:183], v[182:183], v[214:215]
  v_cvt_pk_bf16_f32 v22, v180, v181
  v_cvt_pk_bf16_f32 v23, v182, v183
  buffer_store_dwordx4 v[20:23], v1, s[40:43], s78 offen offset:1024
  v_dot2c_f32_bf16 v254, s75, v22
  v_dot2c_f32_bf16 v255, v22, v22
  v_dot2c_f32_bf16 v254, s75, v23
  v_dot2c_f32_bf16 v255, v23, v23
  s_nop 2
  v_permlane32_swap_b32 v254, v255
  v_add_f32 v254, v254, v255
  buffer_store_dword v254, v11, s[40:43], s79 offen
  s_barrier
  s_add_u32 m0, s63, 114688
  s_add_u32 s97, s65, 16805888
  buffer_load_dwordx4 v1, s[36:39], s97 offen sc1 lds
  s_add_u32 m0, s63, 115712
  s_add_u32 s97, s65, 16806912
  buffer_load_dwordx4 v1, s[36:39], s97 offen sc1 lds
  s_add_u32 m0, s63, 116736
  s_add_u32 s97, s65, 16807936
  buffer_load_dwordx4 v1, s[36:39], s97 offen sc1 lds
  s_add_u32 m0, s63, 117760
  s_add_u32 s97, s65, 16808960
  buffer_load_dwordx4 v1, s[36:39], s97 offen sc1 lds
  s_add_u32 m0, s63, 118784
  s_add_u32 s97, s65, 16809984
  buffer_load_dwordx4 v1, s[36:39], s97 offen sc1 lds
  s_add_u32 m0, s63, 119808
  s_add_u32 s97, s65, 16811008
  buffer_load_dwordx4 v1, s[36:39], s97 offen sc1 lds
  s_add_u32 m0, s63, 120832
  s_add_u32 s97, s65, 16812032
  buffer_load_dwordx4 v1, s[36:39], s97 offen sc1 lds
  s_waitcnt vmcnt(7)
  s_add_u32 s81, s52, 2
  v_mov_b32 v255, s81
  buffer_store_dword v255, v4, s[40:43], s80 offen
  s_waitcnt vmcnt(1)
  s_barrier
  ds_read_b64_tr_b16 v[216:217], v14 offset:0
  ds_read_b64_tr_b16 v[218:219], v14 offset:256
  ds_read_b64_tr_b16 v[220:221], v14 offset:28672
  ds_read_b64_tr_b16 v[222:223], v14 offset:28928
  ds_read_b64_tr_b16 v[224:225], v14 offset:1024
  ds_read_b64_tr_b16 v[226:227], v14 offset:1280
  ds_read_b64_tr_b16 v[228:229], v14 offset:29696
  ds_read_b64_tr_b16 v[230:231], v14 offset:29952
  s_lshl_b32 s78, s7, 7
  s_add_u32 s78, s78, 24576
  s_lshl_b32 s80, s7, 15
  s_add_u32 s80, s80, 5242880
  v_add_u32 v246, s80, v1
  s_add_u32 s84, s52, 2
Lpoll_26:
  buffer_load_dword v15, v13, s[36:39], s78 offen sc1
  s_add_u32 s53, s53, 1
  s_cmp_gt_u32 s53, 0x20000
  s_cbranch_scc1 Lpd_27
  s_waitcnt vmcnt(0)
  v_subrev_u32 v15, s84, v15
  v_cmp_le_u32 vcc, 16, v15
  s_cbranch_vccnz Lpoll_26
Lpd_27:
  buffer_load_dwordx4 v[24:27], v246, s[36:39], 0 offen offset:0 sc1
  buffer_load_dwordx4 v[28:31], v246, s[36:39], 0 offen offset:1024 sc1
  buffer_load_dwordx4 v[32:35], v246, s[36:39], 0 offen offset:2048 sc1
  buffer_load_dwordx4 v[36:39], v246, s[36:39], 0 offen offset:3072 sc1
  buffer_load_dwordx4 v[40:43], v246, s[36:39], s57 offen offset:0 sc1
  buffer_load_dwordx4 v[44:47], v246, s[36:39], s57 offen offset:1024 sc1
  buffer_load_dwordx4 v[48:51], v246, s[36:39], s57 offen offset:2048 sc1
  buffer_load_dwordx4 v[52:55], v246, s[36:39], s57 offen offset:3072 sc1
  s_waitcnt vmcnt(7) lgkmcnt(4)
  v_mfma_f32_32x32x16_bf16 v[136:151], v[24:27], v[216:219], 0
  ds_read_b64_tr_b16 v[232:233], v14 offset:2048
  ds_read_b64_tr_b16 v[234:235], v14 offset:2304
  buffer_load_dwordx4 v[56:59], v246, s[36:39], s58 offen offset:0 sc1
  v_mfma_f32_32x32x16_bf16 v[152:167], v[24:27], v[220:223], 0
  ds_read_b64_tr_b16 v[236:237], v14 offset:30720
  ds_read_b64_tr_b16 v[238:239], v14 offset:30976
  buffer_load_dwordx4 v[60:63], v246, s[36:39], s58 offen offset:1024 sc1
  s_waitcnt vmcnt(8) lgkmcnt(4)
  v_mfma_f32_32x32x16_bf16 v[136:151], v[28:31], v[224:227], v[136:151]
  ds_read_b64_tr_b16 v[216:217], v14 offset:3072
  ds_read_b64_tr_b16 v[218:219], v14 offset:3328
  buffer_load_dwordx4 v[200:203], v246, s[36:39], s98 offen offset:0 sc1
  v_mfma_f32_32x32x16_bf16 v[152:167], v[28:31], v[228:231], v[152:167]
  ds_read_b64_tr_b16 v[220:221], v14 offset:31744
  ds_read_b64_tr_b16 v[222:223], v14 offset:32000
  buffer_load_dwordx4 v[204:207], v246, s[36:39], s98 offen offset:1024 sc1
  s_waitcnt vmcnt(9) lgkmcnt(4)
  v_mfma_f32_32x32x16_bf16 v[136:151], v[32:35], v[232:235], v[136:151]
  ds_read_b64_tr_b16 v[224:225], v14 offset:4096
  ds_read_b64_tr_b16 v[226:227], v14 offset:4352
  v_mfma_f32_32x32x16_bf16 v[152:167], v[32:35], v[236:239], v[152:167]
  ds_read_b64_tr_b16 v[228:229], v14 offset:32768
  ds_read_b64_tr_b16 v[230:231], v14 offset:33024
  buffer_load_dwordx4 v[208:211], v246, s[36:39], s98 offen offset:2048 sc1
  s_waitcnt vmcnt(9) lgkmcnt(4)
  v_mfma_f32_32x32x16_bf16 v[136:151], v[36:39], v[216:219], v[136:151]
  ds_read_b64_tr_b16 v[232:233], v14 offset:5120
  ds_read_b64_tr_b16 v[234:235], v14 offset:5376
  buffer_load_dwordx4 v[212:215], v246, s[36:39], s98 offen offset:3072 sc1
  v_mfma_f32_32x32x16_bf16 v[152:167], v[36:39], v[220:223], v[152:167]
  ds_read_b64_tr_b16 v[236:237], v14 offset:33792
  ds_read_b64_tr_b16 v[238:239], v14 offset:34048
  buffer_load_dwordx4 v[64:67], v246, s[36:39], s58 offen offset:2048 sc1
  s_waitcnt vmcnt(10) lgkmcnt(4)
  v_mfma_f32_32x32x16_bf16 v[136:151], v[40:43], v[224:227], v[136:151]
  ds_read_b64_tr_b16 v[216:217], v14 offset:6144
  ds_read_b64_tr_b16 v[218:219], v14 offset:6400
  buffer_load_dwordx4 v[68:71], v246, s[36:39], s58 offen offset:3072 sc1
  v_mfma_f32_32x32x16_bf16 v[152:167], v[40:43], v[228:231], v[152:167]
  ds_read_b64_tr_b16 v[220:221], v14 offset:34816
  ds_read_b64_tr_b16 v[222:223], v14 offset:35072
  s_waitcnt vmcnt(10) lgkmcnt(4)
  v_mfma_f32_32x32x16_bf16 v[136:151], v[44:47], v[232:235], v[136:151]
  ds_read_b64_tr_b16 v[224:225], v14 offset:7168
  ds_read_b64_tr_b16 v[226:227], v14 offset:7424
  buffer_load_dwordx4 v[72:75], v246, s[36:39], s59 offen offset:0 sc1
  v_mfma_f32_32x32x16_bf16 v[152:167], v[44:47], v[236:239], v[152:167]
  ds_read_b64_tr_b16 v[228:229], v14 offset:35840
  ds_read_b64_tr_b16 v[230:231], v14 offset:36096
  buffer_load_dwordx4 v[76:79], v246, s[36:39], s59 offen offset:1024 sc1
  s_waitcnt vmcnt(11) lgkmcnt(4)
  v_mfma_f32_32x32x16_bf16 v[136:151], v[48:51], v[216:219], v[136:151]
  ds_read_b64_tr_b16 v[232:233], v14 offset:8192
  ds_read_b64_tr_b16 v[234:235], v14 offset:8448
  buffer_load_dwordx4 v[80:83], v246, s[36:39], s59 offen offset:2048 sc1
  v_mfma_f32_32x32x16_bf16 v[152:167], v[48:51], v[220:223], v[152:167]
  ds_read_b64_tr_b16 v[236:237], v14 offset:36864
  ds_read_b64_tr_b16 v[238:239], v14 offset:37120
  buffer_load_dwordx4 v[84:87], v246, s[36:39], s59 offen offset:3072 sc1
  s_waitcnt vmcnt(12) lgkmcnt(4)
  v_mfma_f32_32x32x16_bf16 v[136:151], v[52:55], v[224:227], v[136:151]
  ds_read_b64_tr_b16 v[216:217], v14 offset:9216
  ds_read_b64_tr_b16 v[218:219], v14 offset:9472
  v_mfma_f32_32x32x16_bf16 v[152:167], v[52:55], v[228:231], v[152:167]
  ds_read_b64_tr_b16 v[220:221], v14 offset:37888
  ds_read_b64_tr_b16 v[222:223], v14 offset:38144
  buffer_load_dwordx4 v[88:91], v246, s[36:39], s60 offen offset:0 sc1
  s_waitcnt vmcnt(12) lgkmcnt(4)
  v_mfma_f32_32x32x16_bf16 v[136:151], v[56:59], v[232:235], v[136:151]
  ds_read_b64_tr_b16 v[224:225], v14 offset:10240
  ds_read_b64_tr_b16 v[226:227], v14 offset:10496
  buffer_load_dwordx4 v[92:95], v246, s[36:39], s60 offen offset:1024 sc1
  v_mfma_f32_32x32x16_bf16 v[152:167], v[56:59], v[236:239], v[152:167]
  ds_read_b64_tr_b16 v[228:229], v14 offset:38912
  ds_read_b64_tr_b16 v[230:231], v14 offset:39168
  buffer_load_dwordx4 v[96:99], v246, s[36:39], s60 offen offset:2048 sc1
  s_waitcnt vmcnt(13) lgkmcnt(4)
  v_mfma_f32_32x32x16_bf16 v[136:151], v[60:63], v[216:219], v[136:151]
  ds_read_b64_tr_b16 v[232:233], v14 offset:11264
  ds_read_b64_tr_b16 v[234:235], v14 offset:11520
  buffer_load_dwordx4 v[100:103], v246, s[36:39], s60 offen offset:3072 sc1
  v_mfma_f32_32x32x16_bf16 v[152:167], v[60:63], v[220:223], v[152:167]
  ds_read_b64_tr_b16 v[236:237], v14 offset:39936
  ds_read_b64_tr_b16 v[238:239], v14 offset:40192
  s_waitcnt vmcnt(9) lgkmcnt(4)
  v_mfma_f32_32x32x16_bf16 v[136:151], v[64:67], v[224:227], v[136:151]
  ds_read_b64_tr_b16 v[216:217], v14 offset:12288
  ds_read_b64_tr_b16 v[218:219], v14 offset:12544
  buffer_load_dwordx4 v[104:107], v246, s[36:39], s61 offen offset:0 sc1
  v_mfma_f32_32x32x16_bf16 v[152:167], v[64:67], v[228:231], v[152:167]
  ds_read_b64_tr_b16 v[220:221], v14 offset:40960
  ds_read_b64_tr_b16 v[222:223], v14 offset:41216
  buffer_load_dwordx4 v[108:111], v246, s[36:39], s61 offen offset:1024 sc1
  v_add_f32 v212, v212, v214
  s_waitcnt vmcnt(10) lgkmcnt(4)
  v_mfma_f32_32x32x16_bf16 v[136:151], v[68:71], v[232:235], v[136:151]
  ds_read_b64_tr_b16 v[224:225], v14 offset:13312
  ds_read_b64_tr_b16 v[226:227], v14 offset:13568
  buffer_load_dwordx4 v[112:115], v246, s[36:39], s61 offen offset:2048 sc1
  v_add_f32 v213, v213, v215
  v_add_f32 v200, v200, v202
  v_add_f32 v201, v201, v203
  v_mfma_f32_32x32x16_bf16 v[152:167], v[68:71], v[236:239], v[152:167]
  ds_read_b64_tr_b16 v[228:229], v14 offset:41984
  ds_read_b64_tr_b16 v[230:231], v14 offset:42240
  buffer_load_dwordx4 v[116:119], v246, s[36:39], s61 offen offset:3072 sc1
  v_add_f32 v204, v204, v206
  v_add_f32 v205, v205, v207
  s_waitcnt vmcnt(11) lgkmcnt(4)
  v_mfma_f32_32x32x16_bf16 v[136:151], v[72:75], v[216:219], v[136:151]
  ds_read_b64_tr_b16 v[232:233], v14 offset:14336
  ds_read_b64_tr_b16 v[234:235], v14 offset:14592
  v_add_f32 v208, v208, v210
  v_add_f32 v209, v209, v211
  v_cndmask_b32 v212, v212, 0, s[48:49]
  v_cndmask_b32 v213, v213, 0, s[48:49]
  v_mfma_f32_32x32x16_bf16 v[152:167], v[72:75], v[220:223], v[152:167]
  ds_read_b64_tr_b16 v[236:237], v14 offset:43008
  ds_read_b64_tr_b16 v[238:239], v14 offset:43264
  buffer_load_dwordx4 v[120:123], v246, s[36:39], s62 offen offset:0 sc1
  v_add_f32 v200, v200, v204
  v_add_f32 v201, v201, v205
  s_waitcnt vmcnt(11) lgkmcnt(4)
  v_mfma_f32_32x32x16_bf16 v[136:151], v[76:79], v[224:227], v[136:151]
  ds_read_b64_tr_b16 v[216:217], v14 offset:15360
  ds_read_b64_tr_b16 v[218:219], v14 offset:15616
  buffer_load_dwordx4 v[124:127], v246, s[36:39], s62 offen offset:1024 sc1
  v_add_f32 v208, v208, v212
  v_add_f32 v209, v209, v213
  v_add_f32 v200, v200, v208
  v_mfma_f32_32x32x16_bf16 v[152:167], v[76:79], v[228:231], v[152:167]
  ds_read_b64_tr_b16 v[220:221], v14 offset:44032
  ds_read_b64_tr_b16 v[222:223], v14 offset:44288
  buffer_load_dwordx4 v[128:131], v246, s[36:39], s62 offen offset:2048 sc1
  v_add_f32 v201, v201, v209
  v_mov_b32 v240, 0
  s_waitcnt vmcnt(12) lgkmcnt(4)
  v_mfma_f32_32x32x16_bf16 v[136:151], v[80:83], v[232:235], v[136:151]
  ds_read_b64_tr_b16 v[224:225], v14 offset:16384
  ds_read_b64_tr_b16 v[226:227], v14 offset:16640
  buffer_load_dwordx4 v[132:135], v246, s[36:39], s62 offen offset:3072 sc1
  v_mov_b32 v242, 0
  v_mov_b32 v243, 0
  v_permlane32_swap_b32 v200, v201
  v_mfma_f32_32x32x16_bf16 v[152:167], v[80:83], v[236:239], v[152:167]
  ds_read_b64_tr_b16 v[228:229], v14 offset:45056
  ds_read_b64_tr_b16 v[230:231], v14 offset:45312
  v_add_f32 v200, v200, v201
  v_mul_f32 v200, 0x3b124925, v200
  v_mov_b32 v201, v200
  s_waitcnt vmcnt(12) lgkmcnt(4)
  v_mfma_f32_32x32x16_bf16 v[136:151], v[84:87], v[216:219], v[136:151]
  ds_read_b64_tr_b16 v[232:233], v14 offset:17408
  ds_read_b64_tr_b16 v[234:235], v14 offset:17664
  v_permlane32_swap_b32 v200, v201
  v_fma_f32 v201, -v200, v200, v201
  v_cvt_pk_bf16_f32 v200, -v200, -v200
  v_max_f32 v201, 0, v201
  v_mfma_f32_32x32x16_bf16 v[152:167], v[84:87], v[220:223], v[152:167]
  ds_read_b64_tr_b16 v[236:237], v14 offset:46080
  ds_read_b64_tr_b16 v[238:239], v14 offset:46336
  v_cndmask_b32 v241, v200, 0, s[48:49]
  v_cvt_pk_bf16_f32 v201, v201, v201
  v_lshlrev_b32 v201, 16, v201
  s_waitcnt vmcnt(11) lgkmcnt(4)
  v_mfma_f32_32x32x16_bf16 v[136:151], v[88:91], v[224:227], v[136:151]
  ds_read_b64_tr_b16 v[216:217], v14 offset:18432
  ds_read_b64_tr_b16 v[218:219], v14 offset:18688
  v_add_f32 v201, 0x3727c5ac, v201
  v_cvt_pk_bf16_f32 v201, v201, v201
  v_lshlrev_b32 v201, 16, v201
  v_mfma_f32_32x32x16_bf16 v[152:167], v[88:91], v[228:231], v[152:167]
  ds_read_b64_tr_b16 v[220:221], v14 offset:47104
  ds_read_b64_tr_b16 v[222:223], v14 offset:47360
  v_sqrt_f32 v201, v201
  s_nop 0
  v_cvt_pk_bf16_f32 v201, v201, v201
  s_waitcnt vmcnt(10) lgkmcnt(4)
  v_mfma_f32_32x32x16_bf16 v[136:151], v[92:95], v[232:235], v[136:151]
  ds_read_b64_tr_b16 v[224:225], v14 offset:19456
  ds_read_b64_tr_b16 v[226:227], v14 offset:19712
  v_lshlrev_b32 v245, 16, v201
  v_rcp_f32 v244, v245
  s_nop 0
  v_mul_f32 v244, 0x3fb8aa3b, v244
  v_mfma_f32_32x32x16_bf16 v[152:167], v[92:95], v[236:239], v[152:167]
  ds_read_b64_tr_b16 v[228:229], v14 offset:48128
  ds_read_b64_tr_b16 v[230:231], v14 offset:48384
  v_lshrrev_b32 v248, 2, v1
  v_and_b32 v248, 0x7c, v248
  v_add_u32 v248, s70, v248
  s_waitcnt vmcnt(9) lgkmcnt(4)
  v_mfma_f32_32x32x16_bf16 v[136:151], v[96:99], v[216:219], v[136:151]
  ds_read_b64_tr_b16 v[232:233], v14 offset:20480
  ds_read_b64_tr_b16 v[234:235], v14 offset:20736
  v_lshrrev_b32 v249, 5, v1
  v_and_b32 v249, 16, v249
  v_add_u32 v249, s70, v249
  ds_write_b32 v248, v244 offset:4096
  v_mfma_f32_32x32x16_bf16 v[152:167], v[96:99], v[220:223], v[152:167]
  ds_read_b64_tr_b16 v[236:237], v14 offset:49152
  ds_read_b64_tr_b16 v[238:239], v14 offset:49408
  ds_read_b128 v[200:203], v249 offset:4096
  ds_read_b128 v[204:207], v249 offset:4128
  ds_read_b128 v[208:211], v249 offset:4160
  s_waitcnt vmcnt(8) lgkmcnt(8)
  v_mfma_f32_32x32x16_bf16 v[136:151], v[100:103], v[224:227], v[136:151]
  ds_read_b64_tr_b16 v[216:217], v14 offset:21504
  ds_read_b64_tr_b16 v[218:219], v14 offset:21760
  ds_read_b128 v[212:215], v249 offset:4192
  v_add_u32 v248, s70, v1
  v_lshrrev_b32 v249, 3, v1
  v_and_b32 v249, 0x70, v249
  v_mfma_f32_32x32x16_bf16 v[152:167], v[100:103], v[228:231], v[152:167]
  ds_read_b64_tr_b16 v[220:221], v14 offset:50176
  ds_read_b64_tr_b16 v[222:223], v14 offset:50432
  v_bfe_u32 v252, v1, 5, 1
  v_lshl_add_u32 v249, v252, 9, v249
  v_bfe_u32 v252, v1, 6, 1
  s_waitcnt vmcnt(7) lgkmcnt(8)
  v_mfma_f32_32x32x16_bf16 v[136:151], v[104:107], v[232:235], v[136:151]
  ds_read_b64_tr_b16 v[224:225], v14 offset:22528
  ds_read_b64_tr_b16 v[226:227], v14 offset:22784
  v_lshl_add_u32 v249, v252, 11, v249
  v_bfe_u32 v252, v1, 4, 1
  v_lshl_add_u32 v249, v252, 10, v249
  s_lshl_b32 s78, s3, 7
  v_mfma_f32_32x32x16_bf16 v[152:167], v[104:107], v[236:239], v[152:167]
  ds_read_b64_tr_b16 v[228:229], v14 offset:51200
  ds_read_b64_tr_b16 v[230:231], v14 offset:51456
  s_barrier
  s_mul_i32 s44, s3, 4096
  s_sub_u32 s45, s65, s63
  s_add_u32 s45, s45, s44
  s_waitcnt vmcnt(6) lgkmcnt(4)
  v_mfma_f32_32x32x16_bf16 v[136:151], v[108:111], v[216:219], v[136:151]
  ds_read_b64_tr_b16 v[232:233], v14 offset:23552
  ds_read_b64_tr_b16 v[234:235], v14 offset:23808
  s_add_u32 m0, s44, 86016
  s_add_u32 s97, s45, 16834560
  buffer_load_dwordx4 v1, s[36:39], s97 offen sc1 lds
  s_add_u32 s78, s78, 143360
  v_mfma_f32_32x32x16_bf16 v[152:167], v[108:111], v[220:223], v[152:167]
  ds_read_b64_tr_b16 v[236:237], v14 offset:52224
  ds_read_b64_tr_b16 v[238:239], v14 offset:52480
  v_add_u32 v249, s78, v249
  v_mov_b32 v252, s75
  s_lshl_b32 s78, s6, 2
  s_waitcnt vmcnt(6) lgkmcnt(4)
  v_mfma_f32_32x32x16_bf16 v[136:151], v[112:115], v[224:227], v[136:151]
  ds_read_b64_tr_b16 v[216:217], v14 offset:24576
  ds_read_b64_tr_b16 v[218:219], v14 offset:24832
  s_add_u32 m0, s44, 87040
  s_add_u32 s97, s45, 16835584
  buffer_load_dwordx4 v1, s[36:39], s97 offen sc1 lds
  s_add_u32 s78, s78, s3
  v_mfma_f32_32x32x16_bf16 v[152:167], v[112:115], v[228:231], v[152:167]
  ds_read_b64_tr_b16 v[220:221], v14 offset:53248
  ds_read_b64_tr_b16 v[222:223], v14 offset:53504
  s_lshl_b32 s78, s78, 13
  s_add_u32 s78, s78, 1572864
  s_lshl_b32 s79, s56, 9
  s_waitcnt vmcnt(6) lgkmcnt(4)
  v_mfma_f32_32x32x16_bf16 v[136:151], v[116:119], v[232:235], v[136:151]
  ds_read_b64_tr_b16 v[224:225], v14 offset:25600
  ds_read_b64_tr_b16 v[226:227], v14 offset:25856
  s_add_u32 m0, s44, 88064
  s_add_u32 s97, s45, 16836608
  buffer_load_dwordx4 v1, s[36:39], s97 offen sc1 lds
  s_add_u32 s79, s79, s78
  v_mfma_f32_32x32x16_bf16 v[152:167], v[116:119], v[236:239], v[152:167]
  ds_read_b64_tr_b16 v[228:229], v14 offset:54272
  ds_read_b64_tr_b16 v[230:231], v14 offset:54528
  v_mov_b32 v253, s88
  v_lshrrev_b32 v254, 1, v1
  s_mov_b32 s80, 0x80808080
  s_waitcnt vmcnt(6) lgkmcnt(4)
  v_mfma_f32_32x32x16_bf16 v[136:151], v[120:123], v[216:219], v[136:151]
  ds_read_b64_tr_b16 v[232:233], v14 offset:26624
  ds_read_b64_tr_b16 v[234:235], v14 offset:26880
  s_add_u32 m0, s44, 89088
  s_add_u32 s97, s45, 16837632
  buffer_load_dwordx4 v1, s[36:39], s97 offen sc1 lds
  s_mov_b32 s81, 0x80808080
  v_mfma_f32_32x32x16_bf16 v[152:167], v[120:123], v[220:223], v[152:167]
  ds_read_b64_tr_b16 v[236:237], v14 offset:55296
  ds_read_b64_tr_b16 v[238:239], v14 offset:55552
  s_mul_i32 s83, s71, 3200
  s_add_u32 s83, s83, 0
  v_lshlrev_b32 v255, 3, v1
  v_min_u32 v255, 3072, v255
  buffer_load_dword a240, v255, s[16:19], s83 offen
  s_waitcnt vmcnt(7) lgkmcnt(4)
  v_mfma_f32_32x32x16_bf16 v[136:151], v[124:127], v[224:227], v[136:151]
  ds_read_b64_tr_b16 v[216:217], v14 offset:27648
  ds_read_b64_tr_b16 v[218:219], v14 offset:27904
  v_mfma_f32_32x32x16_bf16 v[152:167], v[124:127], v[228:231], v[152:167]
  ds_read_b64_tr_b16 v[220:221], v14 offset:56320
  ds_read_b64_tr_b16 v[222:223], v14 offset:56576
  s_mul_i32 s83, s71, 3584
  s_add_u32 s83, s83, 524288
  v_lshlrev_b32 v255, 3, v1
  v_min_u32 v255, 3456, v255
  buffer_load_dword a240, v255, s[36:39], s83 offen sc1
  v_mfma_f32_32x32x16_bf16 v[136:151], v[240:243], a[224:227], v[136:151]
  v_mfma_f32_32x32x16_bf16 v[152:167], v[240:243], a[226:229], v[152:167]
  s_waitcnt vmcnt(7) lgkmcnt(4)
  v_mfma_f32_32x32x16_bf16 v[136:151], v[128:131], v[232:235], v[136:151]
  v_mfma_f32_32x32x16_bf16 v[152:167], v[128:131], v[236:239], v[152:167]
  s_waitcnt vmcnt(6) lgkmcnt(0)
  v_mfma_f32_32x32x16_bf16 v[136:151], v[132:135], v[216:219], v[136:151]
  v_mfma_f32_32x32x16_bf16 v[152:167], v[132:135], v[220:223], v[152:167]
  v_add_u32 v246, s78, v1
  s_nop 3
  v_pk_mul_f32 v[136:137], v[136:137], v[200:201]
  v_pk_mul_f32 v[138:139], v[138:139], v[202:203]
  v_pk_mul_f32 v[140:141], v[140:141], v[204:205]
  v_pk_mul_f32 v[142:143], v[142:143], v[206:207]
  v_pk_mul_f32 v[144:145], v[144:145], v[208:209]
  v_pk_mul_f32 v[146:147], v[146:147], v[210:211]
  v_pk_mul_f32 v[148:149], v[148:149], v[212:213]
  v_pk_mul_f32 v[150:151], v[150:151], v[214:215]
  v_exp_f32_e64 v168, v136 clamp
  v_max_f32 v136, 0x35c1a2a0, v136
  v_exp_f32_e64 v169, v137 clamp
  v_max_f32 v137, 0x35c1a2a0, v137
  v_exp_f32_e64 v170, v138 clamp
  v_max_f32 v138, 0x35c1a2a0, v138
  v_exp_f32_e64 v171, v139 clamp
  v_max_f32 v139, 0x35c1a2a0, v139
  v_exp_f32_e64 v172, v140 clamp
  v_max_f32 v140, 0x35c1a2a0, v140
  v_exp_f32_e64 v173, v141 clamp
  v_max_f32 v141, 0x35c1a2a0, v141
  v_exp_f32_e64 v174, v142 clamp
  v_max_f32 v142, 0x35c1a2a0, v142
  v_exp_f32_e64 v175, v143 clamp
  v_max_f32 v143, 0x35c1a2a0, v143
  v_exp_f32_e64 v176, v144 clamp
  v_max_f32 v144, 0x35c1a2a0, v144
  v_exp_f32_e64 v177, v145 clamp
  v_max_f32 v145, 0x35c1a2a0, v145
  v_exp_f32_e64 v178, v146 clamp
  v_max_f32 v146, 0x35c1a2a0, v146
  v_exp_f32_e64 v179, v147 clamp
  v_max_f32 v147, 0x35c1a2a0, v147
  v_exp_f32_e64 v180, v148 clamp
  v_max_f32 v148, 0x35c1a2a0, v148
  v_exp_f32_e64 v181, v149 clamp
  v_max_f32 v149, 0x35c1a2a0, v149
  v_exp_f32_e64 v182, v150 clamp
  v_max_f32 v150, 0x35c1a2a0, v150
  v_exp_f32_e64 v183, v151 clamp
  v_max_f32 v151, 0x35c1a2a0, v151
  v_fmac_f32 v168, s74, v136
  v_fmac_f32 v169, s74, v137
  v_fmac_f32 v170, s74, v138
  v_fmac_f32 v171, s74, v139
  v_fmac_f32 v172, s74, v140
  v_fmac_f32 v173, s74, v141
  v_fmac_f32 v174, s74, v142
  v_fmac_f32 v175, s74, v143
  v_fmac_f32 v176, s74, v144
  v_fmac_f32 v177, s74, v145
  v_fmac_f32 v178, s74, v146
  v_fmac_f32 v179, s74, v147
  v_fmac_f32 v180, s74, v148
  v_fmac_f32 v181, s74, v149
  v_fmac_f32 v182, s74, v150
  v_fmac_f32 v183, s74, v151
  v_cvt_pk_bf16_f32 v136, v168, v169
  v_cvt_pk_bf16_f32 v137, v170, v171
  v_cvt_pk_bf16_f32 v138, v172, v173
  v_cvt_pk_bf16_f32 v139, v174, v175
  v_cvt_pk_bf16_f32 v140, v176, v177
  v_cvt_pk_bf16_f32 v141, v178, v179
  v_cvt_pk_bf16_f32 v142, v180, v181
  v_cvt_pk_bf16_f32 v143, v182, v183
  v_pk_mul_f32 v[152:153], v[152:153], v[200:201]
  v_pk_mul_f32 v[154:155], v[154:155], v[202:203]
  v_pk_mul_f32 v[156:157], v[156:157], v[204:205]
  v_pk_mul_f32 v[158:159], v[158:159], v[206:207]
  v_pk_mul_f32 v[160:161], v[160:161], v[208:209]
  v_pk_mul_f32 v[162:163], v[162:163], v[210:211]
  v_pk_mul_f32 v[164:165], v[164:165], v[212:213]
  v_pk_mul_f32 v[166:167], v[166:167], v[214:215]
  v_cvt_pk_bf16_f32 v152, v152, v153
  v_cvt_pk_bf16_f32 v153, v154, v155
  v_cvt_pk_bf16_f32 v154, v156, v157
  v_cvt_pk_bf16_f32 v155, v158, v159
  v_cvt_pk_bf16_f32 v156, v160, v161
  v_cvt_pk_bf16_f32 v157, v162, v163
  v_cvt_pk_bf16_f32 v158, v164, v165
  v_cvt_pk_bf16_f32 v159, v166, v167
  v_cndmask_b32 v152, v152, v252, s[50:51]
  v_cndmask_b32 v153, v153, v252, s[50:51]
  v_cndmask_b32 v154, v154, v252, s[50:51]
  v_cndmask_b32 v155, v155, v252, s[50:51]
  v_cndmask_b32 v156, v156, v252, s[50:51]
  v_cndmask_b32 v157, v157, v252, s[50:51]
  v_cndmask_b32 v158, v158, v252, s[50:51]
  v_cndmask_b32 v159, v159, v252, s[50:51]
  v_mfma_f32_32x32x16_bf16 v[184:199], v[136:139], v[152:155], 0
  s_nop 0
  v_mfma_f32_32x32x16_bf16 v[184:199], v[140:143], v[156:159], v[184:199]
  s_nop 11
  ds_write_b128 v248, v[184:187] offset:0
  ds_write_b128 v248, v[188:191] offset:1024
  ds_write_b128 v248, v[192:195] offset:2048
  ds_write_b128 v248, v[196:199] offset:3072
  s_waitcnt vmcnt(2) lgkmcnt(0)
  s_barrier
  ds_read_b128 v[152:155], v249 offset:0
  ds_read_b128 v[156:159], v249 offset:5120
  ds_read_b128 v[160:163], v249 offset:10240
  ds_read_b128 v[164:167], v249 offset:15360
  s_waitcnt lgkmcnt(2)
  v_pk_add_f32 v[152:153], v[152:153], v[156:157]
  v_pk_add_f32 v[154:155], v[154:155], v[158:159]
  s_waitcnt lgkmcnt(0)
  v_pk_add_f32 v[160:161], v[160:161], v[164:165]
  v_pk_add_f32 v[162:163], v[162:163], v[166:167]
  v_pk_add_f32 v[152:153], v[152:153], v[160:161]
  v_pk_add_f32 v[154:155], v[154:155], v[162:163]
  v_cvt_pk_bf16_f32 v152, v152, v153
  v_cvt_pk_bf16_f32 v153, v154, v155
  v_cndmask_b32 v153, v153, v253, s[80:81]
  buffer_store_dwordx2 v[152:153], v254, s[36:39], s79 offen sc1
  s_mul_i32 s44, s3, 3072
  s_sub_u32 s45, s65, s63
  s_add_u32 s45, s45, s44
  s_add_u32 m0, s44, 102400
  s_add_u32 s97, s45, 16850944
  buffer_load_dwordx4 v1, s[36:39], s97 offen sc1 lds
  s_add_u32 m0, s44, 103424
  s_add_u32 s97, s45, 16851968
  buffer_load_dwordx4 v1, s[36:39], s97 offen sc1 lds
  s_add_u32 m0, s44, 104448
  s_add_u32 s97, s45, 16852992
  buffer_load_dwordx4 v1, s[36:39], s97 offen sc1 lds
  v_and_b32 v249, 0x1ff, v8
  s_add_u32 s78, s63, 86016
  v_add_u32 v249, s78, v249
  v_and_b32 v248, 0x200, v8
  v_lshl_add_u32 v248, v248, 1, v249
  ds_read_b64_tr_b16 v[216:217], v14 offset:0
  ds_read_b64_tr_b16 v[218:219], v14 offset:256
  ds_read_b64_tr_b16 v[220:221], v14 offset:1024
  ds_read_b64_tr_b16 v[222:223], v14 offset:1280
  ds_read_b64_tr_b16 v[224:225], v14 offset:2048
  ds_read_b64_tr_b16 v[226:227], v14 offset:2304
  ds_read_b64_tr_b16 v[228:229], v14 offset:3072
  ds_read_b64_tr_b16 v[230:231], v14 offset:3328
  s_waitcnt lgkmcnt(4)
  v_mfma_f32_32x32x16_bf16 v[168:183], v[216:219], v[24:27], 0
  ds_read_b64_tr_b16 v[232:233], v14 offset:4096
  ds_read_b64_tr_b16 v[234:235], v14 offset:4352
  s_add_u32 m0, s63, 114688
  s_add_u32 s97, s69, 0
  buffer_load_dwordx4 v6, s[16:19], s97 offen  lds
  v_mfma_f32_32x32x16_bf16 v[168:183], v[220:223], v[28:31], v[168:183]
  ds_read_b64_tr_b16 v[236:237], v14 offset:5120
  ds_read_b64_tr_b16 v[238:239], v14 offset:5376
  s_add_u32 m0, s63, 115712
  s_add_u32 s97, s69, 7168
  buffer_load_dwordx4 v6, s[16:19], s97 offen  lds
  s_waitcnt lgkmcnt(4)
  v_mfma_f32_32x32x16_bf16 v[168:183], v[224:227], v[32:35], v[168:183]
  ds_read_b64_tr_b16 v[216:217], v14 offset:6144
  ds_read_b64_tr_b16 v[218:219], v14 offset:6400
  s_add_u32 m0, s63, 116736
  s_add_u32 s97, s69, 14336
  buffer_load_dwordx4 v6, s[16:19], s97 offen  lds
  v_mfma_f32_32x32x16_bf16 v[168:183], v[228:231], v[36:39], v[168:183]
  ds_read_b64_tr_b16 v[220:221], v14 offset:7168
  ds_read_b64_tr_b16 v[222:223], v14 offset:7424
  s_add_u32 m0, s63, 117760
  s_add_u32 s97, s69, 21504
  buffer_load_dwordx4 v6, s[16:19], s97 offen  lds
  s_waitcnt lgkmcnt(4)
  v_mfma_f32_32x32x16_bf16 v[168:183], v[232:235], v[40:43], v[168:183]
  ds_read_b64_tr_b16 v[224:225], v14 offset:8192
  ds_read_b64_tr_b16 v[226:227], v14 offset:8448
  s_add_u32 m0, s63, 118784
  s_add_u32 s97, s69, 28672
  buffer_load_dwordx4 v6, s[16:19], s97 offen  lds
  v_mfma_f32_32x32x16_bf16 v[168:183], v[236:239], v[44:47], v[168:183]
  ds_read_b64_tr_b16 v[228:229], v14 offset:9216
  ds_read_b64_tr_b16 v[230:231], v14 offset:9472
  s_add_u32 m0, s63, 119808
  s_add_u32 s97, s69, 35840
  buffer_load_dwordx4 v6, s[16:19], s97 offen  lds
  s_waitcnt lgkmcnt(4)
  v_mfma_f32_32x32x16_bf16 v[168:183], v[216:219], v[48:51], v[168:183]
  ds_read_b64_tr_b16 v[232:233], v14 offset:10240
  ds_read_b64_tr_b16 v[234:235], v14 offset:10496
  s_add_u32 m0, s63, 120832
  s_add_u32 s97, s69, 43008
  buffer_load_dwordx4 v6, s[16:19], s97 offen  lds
  v_mfma_f32_32x32x16_bf16 v[168:183], v[220:223], v[52:55], v[168:183]
  ds_read_b64_tr_b16 v[236:237], v14 offset:11264
  ds_read_b64_tr_b16 v[238:239], v14 offset:11520
  s_waitcnt lgkmcnt(4)
  v_mfma_f32_32x32x16_bf16 v[168:183], v[224:227], v[56:59], v[168:183]
  ds_read_b64_tr_b16 v[216:217], v14 offset:12288
  ds_read_b64_tr_b16 v[218:219], v14 offset:12544
  v_mfma_f32_32x32x16_bf16 v[168:183], v[228:231], v[60:63], v[168:183]
  ds_read_b64_tr_b16 v[220:221], v14 offset:13312
  ds_read_b64_tr_b16 v[222:223], v14 offset:13568
  s_waitcnt lgkmcnt(4)
  v_mfma_f32_32x32x16_bf16 v[168:183], v[232:235], v[64:67], v[168:183]
  ds_read_b64_tr_b16 v[224:225], v14 offset:14336
  ds_read_b64_tr_b16 v[226:227], v14 offset:14592
  v_mfma_f32_32x32x16_bf16 v[168:183], v[236:239], v[68:71], v[168:183]
  ds_read_b64_tr_b16 v[228:229], v14 offset:15360
  ds_read_b64_tr_b16 v[230:231], v14 offset:15616
  s_waitcnt lgkmcnt(4)
  v_mfma_f32_32x32x16_bf16 v[168:183], v[216:219], v[72:75], v[168:183]
  s_waitcnt vmcnt(7)
  s_barrier
  ds_read_b64_tr_b16 v[232:233], v14 offset:16384
  ds_read_b64_tr_b16 v[234:235], v14 offset:16640
  buffer_load_dwordx4 v[184:187], v246, s[36:39], 0 offen offset:0 sc1
  v_mfma_f32_32x32x16_bf16 v[168:183], v[220:223], v[76:79], v[168:183]
  ds_read_b64_tr_b16 v[236:237], v14 offset:17408
  ds_read_b64_tr_b16 v[238:239], v14 offset:17664
  buffer_load_dwordx4 v[188:191], v246, s[36:39], 0 offen offset:1024 sc1
  s_waitcnt lgkmcnt(4)
  v_mfma_f32_32x32x16_bf16 v[168:183], v[224:227], v[80:83], v[168:183]
  ds_read_b64_tr_b16 v[216:217], v14 offset:18432
  ds_read_b64_tr_b16 v[218:219], v14 offset:18688
  buffer_load_dwordx4 v[192:195], v246, s[36:39], 0 offen offset:2048 sc1
  v_mfma_f32_32x32x16_bf16 v[168:183], v[228:231], v[84:87], v[168:183]
  ds_read_b64_tr_b16 v[220:221], v14 offset:19456
  ds_read_b64_tr_b16 v[222:223], v14 offset:19712
  buffer_load_dwordx4 v[196:199], v246, s[36:39], 0 offen offset:3072 sc1
  s_waitcnt lgkmcnt(4)
  v_mfma_f32_32x32x16_bf16 v[168:183], v[232:235], v[88:91], v[168:183]
  ds_read_b64_tr_b16 v[224:225], v14 offset:20480
  ds_read_b64_tr_b16 v[226:227], v14 offset:20736
  buffer_load_dwordx4 v[200:203], v246, s[36:39], s57 offen offset:0 sc1
  v_mfma_f32_32x32x16_bf16 v[168:183], v[236:239], v[92:95], v[168:183]
  ds_read_b64_tr_b16 v[228:229], v14 offset:21504
  ds_read_b64_tr_b16 v[230:231], v14 offset:21760
  buffer_load_dwordx4 v[204:207], v246, s[36:39], s57 offen offset:1024 sc1
  s_waitcnt lgkmcnt(4)
  v_mfma_f32_32x32x16_bf16 v[168:183], v[216:219], v[96:99], v[168:183]
  ds_read_b64_tr_b16 v[232:233], v14 offset:22528
  ds_read_b64_tr_b16 v[234:235], v14 offset:22784
  buffer_load_dwordx4 v[208:211], v246, s[36:39], s57 offen offset:2048 sc1
  v_mfma_f32_32x32x16_bf16 v[168:183], v[220:223], v[100:103], v[168:183]
  ds_read_b64_tr_b16 v[236:237], v14 offset:23552
  ds_read_b64_tr_b16 v[238:239], v14 offset:23808
  buffer_load_dwordx4 v[212:215], v246, s[36:39], s57 offen offset:3072 sc1
  s_waitcnt lgkmcnt(4)
  v_mfma_f32_32x32x16_bf16 v[168:183], v[224:227], v[104:107], v[168:183]
  ds_read_b64_tr_b16 v[216:217], v14 offset:24576
  ds_read_b64_tr_b16 v[218:219], v14 offset:24832
  v_mfma_f32_32x32x16_bf16 v[168:183], v[228:231], v[108:111], v[168:183]
  ds_read_b64_tr_b16 v[220:221], v14 offset:25600
  ds_read_b64_tr_b16 v[222:223], v14 offset:25856
  s_waitcnt lgkmcnt(4)
  v_mfma_f32_32x32x16_bf16 v[168:183], v[232:235], v[112:115], v[168:183]
  ds_read_b64_tr_b16 v[224:225], v14 offset:26624
  ds_read_b64_tr_b16 v[226:227], v14 offset:26880
  v_mfma_f32_32x32x16_bf16 v[168:183], v[236:239], v[116:119], v[168:183]
  ds_read_b64_tr_b16 v[228:229], v14 offset:27648
  ds_read_b64_tr_b16 v[230:231], v14 offset:27904
  s_waitcnt vmcnt(8)
  ds_read_b64_tr_b16 v[136:137], v248 offset:28672
  ds_read_b64_tr_b16 v[138:139], v248 offset:28928
  s_waitcnt lgkmcnt(6)
  v_mfma_f32_32x32x16_bf16 v[168:183], v[216:219], v[120:123], v[168:183]
  ds_read_b64_tr_b16 v[140:141], v248 offset:29184
  ds_read_b64_tr_b16 v[142:143], v248 offset:29440
  ds_read_b64_tr_b16 v[144:145], v248 offset:30720
  ds_read_b64_tr_b16 v[146:147], v249 offset:30976
  ds_read_b64_tr_b16 v[148:149], v248 offset:31232
  ds_read_b64_tr_b16 v[150:151], v249 offset:31488
  v_mfma_f32_32x32x16_bf16 v[168:183], v[220:223], v[124:127], v[168:183]
  ds_read_b64_tr_b16 v[152:153], v248 offset:32000
  ds_read_b64_tr_b16 v[154:155], v248 offset:32768
  ds_read_b64_tr_b16 v[156:157], v248 offset:32512
  ds_read_b64_tr_b16 v[158:159], v248 offset:33280
  ds_read_b64_tr_b16 v[160:161], v248 offset:34048
  v_mfma_f32_32x32x16_bf16 v[168:183], a[228:231], v[240:243], v[168:183]
  ds_read_b64_tr_b16 v[162:163], v249 offset:34816
  ds_read_b64_tr_b16 v[164:165], v248 offset:34560
  ds_read_b64_tr_b16 v[166:167], v249 offset:35328
  s_waitcnt lgkmcnt(0)
  v_mfma_f32_32x32x16_bf16 v[168:183], v[224:227], v[128:131], v[168:183]
  v_mfma_f32_32x32x16_bf16 v[168:183], v[228:231], v[132:135], v[168:183]
  s_nop 11
  v_pk_mul_f32 v[168:169], v[168:169], v[244:245] op_sel_hi:[1,0]
  v_pk_mul_f32 v[170:171], v[170:171], v[244:245] op_sel_hi:[1,0]
  v_pk_mul_f32 v[172:173], v[172:173], v[244:245] op_sel_hi:[1,0]
  v_pk_mul_f32 v[174:175], v[174:175], v[244:245] op_sel_hi:[1,0]
  v_pk_mul_f32 v[176:177], v[176:177], v[244:245] op_sel_hi:[1,0]
  v_pk_mul_f32 v[178:179], v[178:179], v[244:245] op_sel_hi:[1,0]
  v_pk_mul_f32 v[180:181], v[180:181], v[244:245] op_sel_hi:[1,0]
  v_pk_mul_f32 v[182:183], v[182:183], v[244:245] op_sel_hi:[1,0]
  v_exp_f32_e64 v40, v168 clamp
  v_max_f32 v168, 0x35c1a2a0, v168
  v_exp_f32_e64 v41, v169 clamp
  v_max_f32 v169, 0x35c1a2a0, v169
  v_exp_f32_e64 v42, v170 clamp
  v_max_f32 v170, 0x35c1a2a0, v170
  v_exp_f32_e64 v43, v171 clamp
  v_max_f32 v171, 0x35c1a2a0, v171
  v_exp_f32_e64 v44, v172 clamp
  v_max_f32 v172, 0x35c1a2a0, v172
  v_exp_f32_e64 v45, v173 clamp
  v_max_f32 v173, 0x35c1a2a0, v173
  v_exp_f32_e64 v46, v174 clamp
  v_max_f32 v174, 0x35c1a2a0, v174
  v_exp_f32_e64 v47, v175 clamp
  v_max_f32 v175, 0x35c1a2a0, v175
  v_exp_f32_e64 v48, v176 clamp
  v_max_f32 v176, 0x35c1a2a0, v176
  v_exp_f32_e64 v49, v177 clamp
  v_max_f32 v177, 0x35c1a2a0, v177
  v_exp_f32_e64 v50, v178 clamp
  v_max_f32 v178, 0x35c1a2a0, v178
  v_exp_f32_e64 v51, v179 clamp
  v_max_f32 v179, 0x35c1a2a0, v179
  v_exp_f32_e64 v52, v180 clamp
  v_max_f32 v180, 0x35c1a2a0, v180
  v_exp_f32_e64 v53, v181 clamp
  v_max_f32 v181, 0x35c1a2a0, v181
  v_exp_f32_e64 v54, v182 clamp
  v_max_f32 v182, 0x35c1a2a0, v182
  v_exp_f32_e64 v55, v183 clamp
  v_max_f32 v183, 0x35c1a2a0, v183
  v_fmac_f32 v40, s74, v168
  v_fmac_f32 v41, s74, v169
  v_fmac_f32 v42, s74, v170
  v_fmac_f32 v43, s74, v171
  v_fmac_f32 v44, s74, v172
  v_fmac_f32 v45, s74, v173
  v_fmac_f32 v46, s74, v174
  v_fmac_f32 v47, s74, v175
  v_fmac_f32 v48, s74, v176
  v_fmac_f32 v49, s74, v177
  v_fmac_f32 v50, s74, v178
  v_fmac_f32 v51, s74, v179
  v_fmac_f32 v52, s74, v180
  v_fmac_f32 v53, s74, v181
  v_fmac_f32 v54, s74, v182
  v_fmac_f32 v55, s74, v183
  v_cvt_pk_bf16_f32 v168, v40, v41
  v_cvt_pk_bf16_f32 v169, v42, v43
  v_cvt_pk_bf16_f32 v170, v44, v45
  v_cvt_pk_bf16_f32 v171, v46, v47
  v_cvt_pk_bf16_f32 v172, v48, v49
  v_cvt_pk_bf16_f32 v173, v50, v51
  v_cvt_pk_bf16_f32 v174, v52, v53
  v_cvt_pk_bf16_f32 v175, v54, v55
  v_cndmask_b32 v174, v174, 0, s[48:49]
  v_cndmask_b32 v175, v175, 0, s[48:49]
  s_add_u32 m0, s63, 114688
  s_add_u32 s97, s69, 50176
  buffer_load_dwordx4 v6, s[16:19], s97 offen  lds
  s_add_u32 m0, s63, 115712
  s_add_u32 s97, s69, 57344
  buffer_load_dwordx4 v6, s[16:19], s97 offen  lds
  s_add_u32 m0, s63, 116736
  s_add_u32 s97, s69, 64512
  buffer_load_dwordx4 v6, s[16:19], s97 offen  lds
  s_add_u32 m0, s63, 117760
  s_add_u32 s97, s69, 71680
  buffer_load_dwordx4 v6, s[16:19], s97 offen  lds
  s_add_u32 m0, s63, 118784
  s_add_u32 s97, s69, 78848
  buffer_load_dwordx4 v6, s[16:19], s97 offen  lds
  s_add_u32 m0, s63, 119808
  s_add_u32 s97, s69, 86016
  buffer_load_dwordx4 v6, s[16:19], s97 offen  lds
  s_add_u32 m0, s63, 120832
  s_add_u32 s97, s69, 93184
  buffer_load_dwordx4 v6, s[16:19], s97 offen  lds
  v_and_b32 v250, 0x1f0, v1
  v_lshrrev_b32 v251, 6, v1
  v_and_b32 v251, 8, v251
  v_add3_u32 v250, v250, v251, s70
  v_lshlrev_b32 v251, 1, v251
  v_bfe_u32 v252, v1, 4, 3
  v_lshl_add_u32 v251, v252, 6, v251
  v_bfe_u32 v252, v1, 7, 2
  v_mul_u32_u24 v252, 5120, v252
  v_add_u32 v252, 147456, v252
  v_add_u32 v251, v251, v252
  s_lshl_b32 s78, s7, 2
  s_lshr_b32 s79, s6, 2
  s_add_u32 s78, s78, s79
  s_mul_i32 s78, s78, 28672
  s_and_b32 s79, s6, 3
  s_lshl_b32 s79, s79, 11
  s_add_u32 s78, s78, s79
  s_add_u32 s78, s78, 9457664
  s_mov_b32 s79, 0x3fb8aa3b
  v_mov_b32 v254, 0x35c1a2a0
  v_mov_b32 v253, s88
  s_mov_b32 s80, 0x88888888
  s_mov_b32 s81, 0x88888888
  s_movk_i32 s82, 0x3f80
  s_mov_b32 s83, 0x3f800000
Lchk_28:
  s_waitcnt vmcnt(14)
  v_xor_b32 v252, v187, v253
  v_lshlrev_b32 v24, 16, v184
  v_and_b32 v25, 0xffff0000, v184
  v_lshlrev_b32 v26, 16, v185
  v_and_b32 v27, 0xffff0000, v185
  v_lshlrev_b32 v28, 16, v186
  v_and_b32 v29, 0xffff0000, v186
  v_lshlrev_b32 v30, 16, v187
  v_and_b32 v31, 0xffff0000, v187
  s_waitcnt vmcnt(13)
  v_bitop3_b32 v252, v252, v191, v253 bitop3:0xf6
  v_dot2c_f32_bf16 v24, s82, v188
  v_dot2c_f32_bf16 v25, s83, v188
  v_dot2c_f32_bf16 v26, s82, v189
  v_dot2c_f32_bf16 v27, s83, v189
  v_dot2c_f32_bf16 v28, s82, v190
  v_dot2c_f32_bf16 v29, s83, v190
  v_dot2c_f32_bf16 v30, s82, v191
  v_dot2c_f32_bf16 v31, s83, v191
  s_waitcnt vmcnt(12)
  v_bitop3_b32 v252, v252, v195, v253 bitop3:0xf6
  v_dot2c_f32_bf16 v24, s82, v192
  v_dot2c_f32_bf16 v25, s83, v192
  v_dot2c_f32_bf16 v26, s82, v193
  v_dot2c_f32_bf16 v27, s83, v193
  v_dot2c_f32_bf16 v28, s82, v194
  v_dot2c_f32_bf16 v29, s83, v194
  v_dot2c_f32_bf16 v30, s82, v195
  v_dot2c_f32_bf16 v31, s83, v195
  s_waitcnt vmcnt(11)
  v_bitop3_b32 v252, v252, v199, v253 bitop3:0xf6
  v_dot2c_f32_bf16 v24, s82, v196
  v_dot2c_f32_bf16 v25, s83, v196
  v_dot2c_f32_bf16 v26, s82, v197
  v_dot2c_f32_bf16 v27, s83, v197
  v_dot2c_f32_bf16 v28, s82, v198
  v_dot2c_f32_bf16 v29, s83, v198
  v_dot2c_f32_bf16 v30, s82, v199
  v_dot2c_f32_bf16 v31, s83, v199
  s_waitcnt vmcnt(10)
  v_bitop3_b32 v252, v252, v203, v253 bitop3:0xf6
  v_dot2c_f32_bf16 v24, s82, v200
  v_dot2c_f32_bf16 v25, s83, v200
  v_dot2c_f32_bf16 v26, s82, v201
  v_dot2c_f32_bf16 v27, s83, v201
  v_dot2c_f32_bf16 v28, s82, v202
  v_dot2c_f32_bf16 v29, s83, v202
  v_dot2c_f32_bf16 v30, s82, v203
  v_dot2c_f32_bf16 v31, s83, v203
  s_waitcnt vmcnt(9)
  v_bitop3_b32 v252, v252, v207, v253 bitop3:0xf6
  v_dot2c_f32_bf16 v24, s82, v204
  v_dot2c_f32_bf16 v25, s83, v204
  v_dot2c_f32_bf16 v26, s82, v205
  v_dot2c_f32_bf16 v27, s83, v205
  v_dot2c_f32_bf16 v28, s82, v206
  v_dot2c_f32_bf16 v29, s83, v206
  v_dot2c_f32_bf16 v30, s82, v207
  v_dot2c_f32_bf16 v31, s83, v207
  s_waitcnt vmcnt(8)
  v_bitop3_b32 v252, v252, v211, v253 bitop3:0xf6
  v_dot2c_f32_bf16 v24, s82, v208
  v_dot2c_f32_bf16 v25, s83, v208
  v_dot2c_f32_bf16 v26, s82, v209
  v_dot2c_f32_bf16 v27, s83, v209
  v_dot2c_f32_bf16 v28, s82, v210
  v_dot2c_f32_bf16 v29, s83, v210
  v_dot2c_f32_bf16 v30, s82, v211
  v_dot2c_f32_bf16 v31, s83, v211
  s_waitcnt vmcnt(7)
  v_bitop3_b32 v252, v252, v215, v253 bitop3:0xf6
  v_dot2c_f32_bf16 v24, s82, v212
  v_dot2c_f32_bf16 v25, s83, v212
  v_dot2c_f32_bf16 v26, s82, v213
  v_dot2c_f32_bf16 v27, s83, v213
  v_dot2c_f32_bf16 v28, s82, v214
  v_dot2c_f32_bf16 v29, s83, v214
  v_dot2c_f32_bf16 v30, s82, v215
  v_dot2c_f32_bf16 v31, s83, v215
  v_cmp_ne_u32 vcc, 0, v252
  s_nop 0
  s_and_b64 vcc, vcc, s[80:81]
  s_cbranch_scc1 Lre_29
Lgd_30:
  s_mov_b32 s80, 0
  v_permlane32_swap_b32 v24, v28
  v_permlane32_swap_b32 v25, v29
  v_permlane32_swap_b32 v26, v30
  v_permlane32_swap_b32 v27, v31
  v_pk_add_f32 v[24:25], v[24:25], v[28:29]
  v_pk_add_f32 v[26:27], v[26:27], v[30:31]
  v_cvt_pk_bf16_f32 v24, v24, v25
  v_cvt_pk_bf16_f32 v25, v26, v27
  v_cndmask_b32 v25, v25, 0, s[80:81]
  ds_write_b64 v250, v[24:25] offset:4096
  s_waitcnt lgkmcnt(0)
  s_barrier
  ds_read_b128 v[216:219], v251
  ds_read_b128 v[220:223], v251 offset:32
  s_waitcnt lgkmcnt(1)
  v_mfma_f32_32x32x16_bf16 v[184:199], v[216:219], v[168:171], 0
  s_waitcnt lgkmcnt(0)
  v_mfma_f32_32x32x16_bf16 v[184:199], v[220:223], v[172:175], v[184:199]
  s_nop 11
  v_mov_b32 v252, v196
  v_mov_b32 v253, v196
  s_nop 1
  v_permlane32_swap_b32 v253, v252
  v_fma_f32 v252, v252, s79, v254
  v_rcp_f32 v252, v252
  s_nop 0
  v_cndmask_b32 v254, v252, 0, s[48:49]
  v_pk_mul_f32 v[184:185], v[184:185], v[252:253] op_sel_hi:[1,0]
  v_pk_mul_f32 v[186:187], v[186:187], v[252:253] op_sel_hi:[1,0]
  v_pk_mul_f32 v[188:189], v[188:189], v[252:253] op_sel_hi:[1,0]
  v_pk_mul_f32 v[190:191], v[190:191], v[252:253] op_sel_hi:[1,0]
  v_pk_mul_f32 v[192:193], v[192:193], v[252:253] op_sel_hi:[1,0]
  v_pk_mul_f32 v[194:195], v[194:195], v[252:253] op_sel_hi:[1,0]
  v_pk_mul_f32 v[196:197], v[196:197], v[254:255] op_sel_hi:[1,0]
  v_pk_mul_f32 v[198:199], v[198:199], v[254:255] op_sel_hi:[1,0]
  v_cvt_pk_bf16_f32 v184, v184, v185
  v_cvt_pk_bf16_f32 v185, v186, v187
  v_cvt_pk_bf16_f32 v186, v188, v189
  v_cvt_pk_bf16_f32 v187, v190, v191
  buffer_store_dwordx4 v[184:187], v1, s[36:39], s78 offen
  v_cvt_pk_bf16_f32 v188, v192, v193
  v_cvt_pk_bf16_f32 v189, v194, v195
  v_cvt_pk_bf16_f32 v190, v196, v197
  v_cvt_pk_bf16_f32 v191, v198, v199
  buffer_store_dwordx4 v[188:191], v1, s[36:39], s78 offen offset:1024
  v_lshlrev_b32 v168, 16, v16
  v_and_b32 v169, 0xffff0000, v16
  v_lshlrev_b32 v170, 16, v17
  v_and_b32 v171, 0xffff0000, v17
  v_lshlrev_b32 v172, 16, v18
  v_and_b32 v173, 0xffff0000, v18
  v_lshlrev_b32 v174, 16, v19
  v_and_b32 v175, 0xffff0000, v19
  v_lshlrev_b32 v176, 16, v20
  v_and_b32 v177, 0xffff0000, v20
  v_lshlrev_b32 v178, 16, v21
  v_and_b32 v179, 0xffff0000, v21
  v_lshlrev_b32 v180, 16, v22
  v_and_b32 v181, 0xffff0000, v22
  v_lshlrev_b32 v182, 16, v23
  v_and_b32 v183, 0xffff0000, v23
  s_waitcnt vmcnt(2)
  ds_read_b64_tr_b16 v[88:89], v248 offset:28672
  ds_read_b64_tr_b16 v[90:91], v248 offset:28928
  ds_read_b64_tr_b16 v[92:93], v248 offset:29184
  ds_read_b64_tr_b16 v[94:95], v248 offset:29440
  ds_read_b64_tr_b16 v[96:97], v248 offset:30720
  ds_read_b64_tr_b16 v[98:99], v249 offset:30976
  ds_read_b64_tr_b16 v[100:101], v248 offset:31232
  ds_read_b64_tr_b16 v[102:103], v249 offset:31488
  ds_read_b64_tr_b16 v[104:105], v248 offset:32000
  ds_read_b64_tr_b16 v[106:107], v248 offset:32768
  ds_read_b64_tr_b16 v[108:109], v248 offset:32512
  ds_read_b64_tr_b16 v[110:111], v248 offset:33280
  ds_read_b64_tr_b16 v[112:113], v248 offset:34048
  ds_read_b64_tr_b16 v[114:115], v249 offset:34816
  ds_read_b64_tr_b16 v[116:117], v248 offset:34560
  ds_read_b64_tr_b16 v[118:119], v249 offset:35328
  s_waitcnt vmcnt(0)
  s_add_u32 s79, s52, 2
  v_mov_b32 v252, s79
  buffer_store_dword v252, v4, s[36:39], s72 offen
  s_waitcnt lgkmcnt(0)
  s_barrier
  s_xor_b32 s78, s76, 0
  s_mul_i32 s78, s78, 114688
  s_mul_i32 s79, s3, 28672
  s_add_u32 s78, s78, s79
  s_add_u32 s78, s78, 9457664
  v_add_u32 v246, s78, v1
  s_xor_b32 s78, s76, 1
  s_mul_i32 s78, s78, 114688
  s_mul_i32 s79, s3, 28672
  s_add_u32 s78, s78, s79
  s_add_u32 s78, s78, 9457664
  v_add_u32 v247, s78, v1
  v_add_u32 v250, s64, v1
  s_xor_b32 s82, s3, 1
  s_mul_i32 s82, s82, 12288
  s_add_u32 s82, s82, 114688
  v_add_u32 v251, s82, v1
  s_xor_b32 s82, s3, 2
  s_mul_i32 s82, s82, 12288
  s_add_u32 s82, s82, 118784
  v_add_u32 v252, s82, v1
  s_xor_b32 s82, s3, 3
  s_mul_i32 s82, s82, 12288
  s_add_u32 s82, s82, 122880
  v_add_u32 v253, s82, v1
  s_lshl_b32 s80, s76, 15
  s_add_u32 s80, s80, 5242880
  s_lshl_b32 s79, s77, 11
  s_add_u32 s78, s80, s79
  s_lshl_b32 s79, s55, 9
  s_add_u32 s79, s79, s80
  s_and_b32 s80, s3, 1
  s_lshl_b32 s80, s80, 3
  s_add_u32 s79, s79, s80
  s_add_u32 s79, s79, 28672
  s_lshl_b32 s80, s76, 7
  s_lshl_b32 s82, s77, 2
  s_add_u32 s80, s80, s82
  s_add_u32 s80, s80, 24576
  s_add_u32 s81, s73, 8192
  s_add_u32 s84, s52, 2
Lpoll_31:
  buffer_load_dword v15, v12, s[36:39], s81 offen sc1
  s_add_u32 s53, s53, 1
  s_cmp_gt_u32 s53, 0x20000
  s_cbranch_scc1 Lpd_32
  s_waitcnt vmcnt(0)
  v_subrev_u32 v15, s84, v15
  v_cmp_le_u32 vcc, 16, v15
  s_cbranch_vccnz Lpoll_31
Lpd_32:
  buffer_load_dwordx4 v[28:31], v247, s[40:43], 0 offen offset:0 sc1
  buffer_load_dwordx4 v[36:39], v247, s[40:43], 0 offen offset:1024 sc1
  buffer_load_dwordx4 v[44:47], v247, s[40:43], 0 offen offset:2048 sc1
  buffer_load_dwordx4 v[52:55], v247, s[40:43], 0 offen offset:3072 sc1
  buffer_load_dwordx4 v[60:63], v247, s[40:43], s57 offen offset:0 sc1
  buffer_load_dwordx4 v[68:71], v247, s[40:43], s57 offen offset:1024 sc1
  buffer_load_dwordx4 v[76:79], v247, s[40:43], s57 offen offset:2048 sc1
  s_waitcnt vmcnt(6)
  v_mfma_f32_32x32x16_bf16 v[200:215], v[136:139], v[28:31], 0
  buffer_load_dwordx4 v[84:87], v247, s[40:43], s57 offen offset:3072 sc1
  v_mfma_f32_32x32x16_bf16 v[216:231], v[140:143], v[28:31], 0
  s_waitcnt vmcnt(6)
  v_mfma_f32_32x32x16_bf16 v[200:215], v[144:147], v[36:39], v[200:215]
  buffer_load_dwordx4 v[24:27], v246, s[40:43], 0 offen offset:0 sc1
  v_mfma_f32_32x32x16_bf16 v[216:231], v[148:151], v[36:39], v[216:231]
  s_waitcnt vmcnt(6)
  v_mfma_f32_32x32x16_bf16 v[200:215], v[152:155], v[44:47], v[200:215]
  buffer_load_dwordx4 v[32:35], v246, s[40:43], 0 offen offset:1024 sc1
  v_mfma_f32_32x32x16_bf16 v[216:231], v[156:159], v[44:47], v[216:231]
  s_waitcnt vmcnt(6)
  v_mfma_f32_32x32x16_bf16 v[200:215], v[160:163], v[52:55], v[200:215]
  buffer_load_dwordx4 v[40:43], v246, s[40:43], 0 offen offset:2048 sc1
  v_mfma_f32_32x32x16_bf16 v[216:231], v[164:167], v[52:55], v[216:231]
  s_waitcnt vmcnt(6)
  v_mfma_f32_32x32x16_bf16 v[200:215], v[88:91], v[60:63], v[200:215]
  buffer_load_dwordx4 v[48:51], v246, s[40:43], 0 offen offset:3072 sc1
  v_mfma_f32_32x32x16_bf16 v[216:231], v[92:95], v[60:63], v[216:231]
  s_waitcnt vmcnt(6)
  v_mfma_f32_32x32x16_bf16 v[200:215], v[96:99], v[68:71], v[200:215]
  buffer_load_dwordx4 v[56:59], v246, s[40:43], s57 offen offset:0 sc1
  v_mfma_f32_32x32x16_bf16 v[216:231], v[100:103], v[68:71], v[216:231]
  s_waitcnt vmcnt(6)
  v_mfma_f32_32x32x16_bf16 v[200:215], v[104:107], v[76:79], v[200:215]
  buffer_load_dwordx4 v[64:67], v246, s[40:43], s57 offen offset:1024 sc1
  v_mfma_f32_32x32x16_bf16 v[216:231], v[108:111], v[76:79], v[216:231]
  s_waitcnt vmcnt(6)
  v_mfma_f32_32x32x16_bf16 v[200:215], v[112:115], v[84:87], v[200:215]
  buffer_load_dwordx4 v[72:75], v246, s[40:43], s57 offen offset:2048 sc1
  v_mfma_f32_32x32x16_bf16 v[216:231], v[116:119], v[84:87], v[216:231]
  s_waitcnt vmcnt(6)
  v_mfma_f32_32x32x16_bf16 v[168:183], v[136:139], v[24:27], v[168:183]
  buffer_load_dwordx4 v[80:83], v246, s[40:43], s57 offen offset:3072 sc1
  v_mfma_f32_32x32x16_bf16 v[184:199], v[140:143], v[24:27], 0
  s_waitcnt vmcnt(6)
  v_mfma_f32_32x32x16_bf16 v[168:183], v[144:147], v[32:35], v[168:183]
  ds_write_b128 v250, v[200:203] offset:4096
  v_mfma_f32_32x32x16_bf16 v[184:199], v[148:151], v[32:35], v[184:199]
  ds_write_b128 v250, v[204:207] offset:5120
  s_waitcnt vmcnt(5)
  v_mfma_f32_32x32x16_bf16 v[168:183], v[152:155], v[40:43], v[168:183]
  ds_write_b128 v250, v[208:211] offset:6144
  v_mfma_f32_32x32x16_bf16 v[184:199], v[156:159], v[40:43], v[184:199]
  ds_write_b128 v250, v[212:215] offset:7168
  s_waitcnt vmcnt(4)
  v_mfma_f32_32x32x16_bf16 v[168:183], v[160:163], v[48:51], v[168:183]
  v_mfma_f32_32x32x16_bf16 v[184:199], v[164:167], v[48:51], v[184:199]
  s_waitcnt vmcnt(3)
  v_mfma_f32_32x32x16_bf16 v[168:183], v[88:91], v[56:59], v[168:183]
  ds_write_b128 v250, v[216:219] offset:8192
  v_mfma_f32_32x32x16_bf16 v[184:199], v[92:95], v[56:59], v[184:199]
  ds_write_b128 v250, v[220:223] offset:9216
  s_waitcnt vmcnt(2)
  v_mfma_f32_32x32x16_bf16 v[184:199], v[100:103], v[64:67], v[184:199]
  ds_write_b128 v250, v[224:227] offset:10240
  s_waitcnt vmcnt(1)
  v_mfma_f32_32x32x16_bf16 v[184:199], v[108:111], v[72:75], v[184:199]
  ds_write_b128 v250, v[228:231] offset:11264
  s_waitcnt vmcnt(0)
  v_mfma_f32_32x32x16_bf16 v[184:199], v[116:119], v[80:83], v[184:199]
  v_mfma_f32_32x32x16_bf16 v[168:183], v[96:99], v[64:67], v[168:183]
  v_mfma_f32_32x32x16_bf16 v[168:183], v[104:107], v[72:75], v[168:183]
  ds_write_b128 v250, v[184:187] offset:0
  v_mfma_f32_32x32x16_bf16 v[168:183], v[112:115], v[80:83], v[168:183]
  ds_write_b128 v250, v[188:191] offset:1024
  ds_write_b128 v250, v[192:195] offset:2048
  ds_write_b128 v250, v[196:199] offset:3072
  s_waitcnt lgkmcnt(0)
  s_barrier
  ds_read_b128 v[184:187], v251 offset:0
  ds_read_b128 v[200:203], v252 offset:0
  ds_read_b128 v[216:219], v253 offset:0
  ds_read_b128 v[188:191], v251 offset:1024
  ds_read_b128 v[204:207], v252 offset:1024
  ds_read_b128 v[220:223], v253 offset:1024
  ds_read_b128 v[192:195], v251 offset:2048
  ds_read_b128 v[208:211], v252 offset:2048
  ds_read_b128 v[224:227], v253 offset:2048
  ds_read_b128 v[196:199], v251 offset:3072
  ds_read_b128 v[212:215], v252 offset:3072
  ds_read_b128 v[228:231], v253 offset:3072
  v_mov_b32 v254, 0
  v_mov_b32 v255, 0
  s_waitcnt lgkmcnt(9)
  v_pk_add_f32 v[168:169], v[168:169], v[184:185]
  v_pk_add_f32 v[200:201], v[200:201], v[216:217]
  v_pk_add_f32 v[170:171], v[170:171], v[186:187]
  v_pk_add_f32 v[202:203], v[202:203], v[218:219]
  v_pk_add_f32 v[168:169], v[168:169], v[200:201]
  v_pk_add_f32 v[170:171], v[170:171], v[202:203]
  v_cvt_pk_bf16_f32 v16, v168, v169
  v_cvt_pk_bf16_f32 v17, v170, v171
  v_dot2c_f32_bf16 v254, s75, v16
  v_dot2c_f32_bf16 v255, v16, v16
  v_dot2c_f32_bf16 v254, s75, v17
  v_dot2c_f32_bf16 v255, v17, v17
  s_waitcnt lgkmcnt(6)
  v_pk_add_f32 v[172:173], v[172:173], v[188:189]
  v_pk_add_f32 v[204:205], v[204:205], v[220:221]
  v_pk_add_f32 v[174:175], v[174:175], v[190:191]
  v_pk_add_f32 v[206:207], v[206:207], v[222:223]
  v_pk_add_f32 v[172:173], v[172:173], v[204:205]
  v_pk_add_f32 v[174:175], v[174:175], v[206:207]
  v_cvt_pk_bf16_f32 v18, v172, v173
  v_cvt_pk_bf16_f32 v19, v174, v175
  buffer_store_dwordx4 v[16:19], v1, s[40:43], s78 offen offset:0
  v_dot2c_f32_bf16 v254, s75, v18
  v_dot2c_f32_bf16 v255, v18, v18
  v_dot2c_f32_bf16 v254, s75, v19
  v_dot2c_f32_bf16 v255, v19, v19
  s_waitcnt lgkmcnt(3)
  v_pk_add_f32 v[176:177], v[176:177], v[192:193]
  v_pk_add_f32 v[208:209], v[208:209], v[224:225]
  v_pk_add_f32 v[178:179], v[178:179], v[194:195]
  v_pk_add_f32 v[210:211], v[210:211], v[226:227]
  v_pk_add_f32 v[176:177], v[176:177], v[208:209]
  v_pk_add_f32 v[178:179], v[178:179], v[210:211]
  v_cvt_pk_bf16_f32 v20, v176, v177
  v_cvt_pk_bf16_f32 v21, v178, v179
  v_dot2c_f32_bf16 v254, s75, v20
  v_dot2c_f32_bf16 v255, v20, v20
  v_dot2c_f32_bf16 v254, s75, v21
  v_dot2c_f32_bf16 v255, v21, v21
  s_waitcnt lgkmcnt(0)
  v_pk_add_f32 v[180:181], v[180:181], v[196:197]
  v_pk_add_f32 v[212:213], v[212:213], v[228:229]
  v_pk_add_f32 v[182:183], v[182:183], v[198:199]
  v_pk_add_f32 v[214:215], v[214:215], v[230:231]
  v_pk_add_f32 v[180:181], v[180:181], v[212:213]
  v_pk_add_f32 v[182:183], v[182:183], v[214:215]
  v_cvt_pk_bf16_f32 v22, v180, v181
  v_cvt_pk_bf16_f32 v23, v182, v183
  buffer_store_dwordx4 v[20:23], v1, s[40:43], s78 offen offset:1024
  v_dot2c_f32_bf16 v254, s75, v22
  v_dot2c_f32_bf16 v255, v22, v22
  v_dot2c_f32_bf16 v254, s75, v23
  v_dot2c_f32_bf16 v255, v23, v23
  s_nop 2
  v_permlane32_swap_b32 v254, v255
  v_add_f32 v254, v254, v255
  buffer_store_dword v254, v11, s[40:43], s79 offen
  s_waitcnt vmcnt(0)
  s_add_u32 s81, s52, 3
  v_mov_b32 v255, s81
  buffer_store_dword v255, v4, s[40:43], s80 offen
  s_lshr_b32 s78, s5, 3
  s_mul_i32 s78, s78, 28672
  s_bfe_u32 s79, s5, 0x20001
  s_lshl_b32 s80, s79, 11
  s_add_u32 s78, s78, s80
  s_add_u32 s78, s78, 9437184
  s_mul_i32 s90, s89, 114688
  s_add_u32 s90, s90, s78
  s_xor_b32 s81, s89, 4
  s_mul_i32 s91, s81, 114688
  s_add_u32 s91, s91, s78
  s_add_u32 s91, s91, 12288
  s_lshl_b32 s80, s79, 10
  s_sub_u32 s96, s90, s80
  s_add_u32 s96, s96, 8192
  s_lshr_b32 s78, s5, 3
  s_lshl_b32 s78, s78, 6
  s_lshl_b32 s80, s79, 3
  s_add_u32 s78, s78, s80
  s_and_b32 s80, s3, 1
  s_lshl_b32 s80, s80, 2
  s_add_u32 s78, s78, s80
  s_add_u32 s78, s78, 16384
  s_lshr_b32 s80, s89, 1
  s_lshl_b32 s80, s80, 8
  s_add_u32 s92, s78, s80
  s_xor_b32 s80, s80, 512
  s_add_u32 s93, s78, s80
  s_add_u32 s93, s93, 32
  s_lshl_b32 s94, s73, 1
  s_add_u32 s94, s94, 16384
  s_add_u32 s95, s94, 32
  s_lshr_b32 s99, s5, 1
  s_mul_i32 s99, s99, 28672
  s_add_u32 s99, s99, s63
  ds_read_b64_tr_b16 v[216:217], v8 offset:0
  ds_read_b64_tr_b16 v[218:219], v8 offset:256
  ds_read_b64_tr_b16 v[220:221], v8 offset:28672
  ds_read_b64_tr_b16 v[222:223], v8 offset:28928
  ds_read_b64_tr_b16 v[224:225], v2 offset:0
  ds_read_b64_tr_b16 v[226:227], v2 offset:256
  ds_read_b64_tr_b16 v[228:229], v8 offset:1024
  ds_read_b64_tr_b16 v[230:231], v8 offset:1280
  s_andn2_b32 s78, s89, 4
  s_lshl_b32 s78, s78, 7
  v_and_b32 v248, 0x200, v1
  v_add_u32 v248, v248, v13
  s_add_u32 s78, s78, 24576
  s_lshl_b32 s80, s89, 15
  s_add_u32 s80, s80, 5242880
  v_add_u32 v246, s80, v1
  v_xor_b32 v247, 131072, v246
  s_add_u32 s84, s52, 3
Lpoll_33:
  buffer_load_dword v15, v248, s[36:39], s78 offen sc1
  s_add_u32 s53, s53, 1
  s_cmp_gt_u32 s53, 0x20000
  s_cbranch_scc1 Lpd_34
  s_waitcnt vmcnt(0)
  v_subrev_u32 v15, s84, v15
  v_cmp_le_u32 vcc, 16, v15
  s_cbranch_vccnz Lpoll_33
Lpd_34:
  buffer_load_dwordx4 v[24:27], v246, s[36:39], 0 offen offset:0 sc1
  buffer_load_dwordx4 v[28:31], v246, s[36:39], 0 offen offset:1024 sc1
  buffer_load_dwordx4 v[32:35], v246, s[36:39], 0 offen offset:2048 sc1
  buffer_load_dwordx4 v[36:39], v246, s[36:39], 0 offen offset:3072 sc1
  buffer_load_dwordx4 v[40:43], v246, s[36:39], s57 offen offset:0 sc1
  buffer_load_dwordx4 v[44:47], v246, s[36:39], s57 offen offset:1024 sc1
  s_waitcnt vmcnt(5) lgkmcnt(4)
  v_mfma_f32_32x32x16_bf16 v[136:151], v[216:219], v[24:27], 0
  ds_read_b64_tr_b16 v[232:233], v8 offset:29696
  ds_read_b64_tr_b16 v[234:235], v8 offset:29952
  buffer_load_dwordx4 v[48:51], v246, s[36:39], s57 offen offset:2048 sc1
  v_mfma_f32_32x32x16_bf16 v[152:167], v[220:223], v[24:27], 0
  ds_read_b64_tr_b16 v[236:237], v2 offset:1024
  ds_read_b64_tr_b16 v[238:239], v2 offset:1280
  s_waitcnt lgkmcnt(4)
  v_mfma_f32_32x32x16_bf16 v[200:215], v[224:227], v[24:27], 0
  ds_read_b64_tr_b16 v[216:217], v8 offset:2048
  ds_read_b64_tr_b16 v[218:219], v8 offset:2304
  buffer_load_dwordx4 v[52:55], v246, s[36:39], s57 offen offset:3072 sc1
  s_waitcnt vmcnt(6)
  v_mfma_f32_32x32x16_bf16 v[136:151], v[228:231], v[28:31], v[136:151]
  ds_read_b64_tr_b16 v[220:221], v8 offset:30720
  ds_read_b64_tr_b16 v[222:223], v8 offset:30976
  s_waitcnt lgkmcnt(4)
  v_mfma_f32_32x32x16_bf16 v[152:167], v[232:235], v[28:31], v[152:167]
  ds_read_b64_tr_b16 v[224:225], v2 offset:2048
  ds_read_b64_tr_b16 v[226:227], v2 offset:2304
  buffer_load_dwordx4 v[56:59], v246, s[36:39], s58 offen offset:0 sc1
  v_mfma_f32_32x32x16_bf16 v[200:215], v[236:239], v[28:31], v[200:215]
  ds_read_b64_tr_b16 v[228:229], v8 offset:3072
  ds_read_b64_tr_b16 v[230:231], v8 offset:3328
  s_waitcnt vmcnt(6) lgkmcnt(4)
  v_mfma_f32_32x32x16_bf16 v[136:151], v[216:219], v[32:35], v[136:151]
  ds_read_b64_tr_b16 v[232:233], v8 offset:31744
  ds_read_b64_tr_b16 v[234:235], v8 offset:32000
  buffer_load_dwordx4 v[60:63], v246, s[36:39], s58 offen offset:1024 sc1
  v_mfma_f32_32x32x16_bf16 v[152:167], v[220:223], v[32:35], v[152:167]
  ds_read_b64_tr_b16 v[236:237], v2 offset:3072
  ds_read_b64_tr_b16 v[238:239], v2 offset:3328
  s_waitcnt lgkmcnt(4)
  v_mfma_f32_32x32x16_bf16 v[200:215], v[224:227], v[32:35], v[200:215]
  ds_read_b64_tr_b16 v[216:217], v8 offset:4096
  ds_read_b64_tr_b16 v[218:219], v8 offset:4352
  buffer_load_dwordx4 v[64:67], v246, s[36:39], s58 offen offset:2048 sc1
  s_waitcnt vmcnt(7)
  v_mfma_f32_32x32x16_bf16 v[136:151], v[228:231], v[36:39], v[136:151]
  ds_read_b64_tr_b16 v[220:221], v8 offset:32768
  ds_read_b64_tr_b16 v[222:223], v8 offset:33024
  s_waitcnt lgkmcnt(4)
  v_mfma_f32_32x32x16_bf16 v[152:167], v[232:235], v[36:39], v[152:167]
  ds_read_b64_tr_b16 v[224:225], v2 offset:4096
  ds_read_b64_tr_b16 v[226:227], v2 offset:4352
  buffer_load_dwordx4 v[68:71], v246, s[36:39], s58 offen offset:3072 sc1
  v_mfma_f32_32x32x16_bf16 v[200:215], v[236:239], v[36:39], v[200:215]
  ds_read_b64_tr_b16 v[228:229], v8 offset:5120
  ds_read_b64_tr_b16 v[230:231], v8 offset:5376
  s_waitcnt vmcnt(7) lgkmcnt(4)
  v_mfma_f32_32x32x16_bf16 v[136:151], v[216:219], v[40:43], v[136:151]
  ds_read_b64_tr_b16 v[232:233], v8 offset:33792
  ds_read_b64_tr_b16 v[234:235], v8 offset:34048
  buffer_load_dwordx4 v[72:75], v246, s[36:39], s59 offen offset:0 sc1
  v_mfma_f32_32x32x16_bf16 v[152:167], v[220:223], v[40:43], v[152:167]
  ds_read_b64_tr_b16 v[236:237], v2 offset:5120
  ds_read_b64_tr_b16 v[238:239], v2 offset:5376
  s_waitcnt lgkmcnt(4)
  v_mfma_f32_32x32x16_bf16 v[200:215], v[224:227], v[40:43], v[200:215]
  ds_read_b64_tr_b16 v[216:217], v8 offset:6144
  ds_read_b64_tr_b16 v[218:219], v8 offset:6400
  buffer_load_dwordx4 v[76:79], v246, s[36:39], s59 offen offset:1024 sc1
  s_waitcnt vmcnt(8)
  v_mfma_f32_32x32x16_bf16 v[136:151], v[228:231], v[44:47], v[136:151]
  ds_read_b64_tr_b16 v[220:221], v8 offset:34816
  ds_read_b64_tr_b16 v[222:223], v8 offset:35072
  s_waitcnt lgkmcnt(4)
  v_mfma_f32_32x32x16_bf16 v[152:167], v[232:235], v[44:47], v[152:167]
  ds_read_b64_tr_b16 v[224:225], v2 offset:6144
  ds_read_b64_tr_b16 v[226:227], v2 offset:6400
  buffer_load_dwordx4 v[168:171], v246, s[36:39], s98 offen offset:0 sc1
  v_mfma_f32_32x32x16_bf16 v[200:215], v[236:239], v[44:47], v[200:215]
  ds_read_b64_tr_b16 v[228:229], v8 offset:7168
  ds_read_b64_tr_b16 v[230:231], v8 offset:7424
  s_waitcnt vmcnt(8) lgkmcnt(4)
  v_mfma_f32_32x32x16_bf16 v[136:151], v[216:219], v[48:51], v[136:151]
  ds_read_b64_tr_b16 v[232:233], v8 offset:35840
  ds_read_b64_tr_b16 v[234:235], v8 offset:36096
  buffer_load_dwordx4 v[172:175], v246, s[36:39], s98 offen offset:1024 sc1
  v_mfma_f32_32x32x16_bf16 v[152:167], v[220:223], v[48:51], v[152:167]
  ds_read_b64_tr_b16 v[236:237], v2 offset:7168
  ds_read_b64_tr_b16 v[238:239], v2 offset:7424
  s_waitcnt lgkmcnt(4)
  v_mfma_f32_32x32x16_bf16 v[200:215], v[224:227], v[48:51], v[200:215]
  ds_read_b64_tr_b16 v[216:217], v8 offset:8192
  ds_read_b64_tr_b16 v[218:219], v8 offset:8448
  buffer_load_dwordx4 v[176:179], v246, s[36:39], s98 offen offset:2048 sc1
  s_waitcnt vmcnt(9)
  v_mfma_f32_32x32x16_bf16 v[136:151], v[228:231], v[52:55], v[136:151]
  ds_read_b64_tr_b16 v[220:221], v8 offset:36864
  ds_read_b64_tr_b16 v[222:223], v8 offset:37120
  s_waitcnt lgkmcnt(4)
  v_mfma_f32_32x32x16_bf16 v[152:167], v[232:235], v[52:55], v[152:167]
  ds_read_b64_tr_b16 v[224:225], v2 offset:8192
  ds_read_b64_tr_b16 v[226:227], v2 offset:8448
  buffer_load_dwordx4 v[180:183], v246, s[36:39], s98 offen offset:3072 sc1
  v_mfma_f32_32x32x16_bf16 v[200:215], v[236:239], v[52:55], v[200:215]
  ds_read_b64_tr_b16 v[228:229], v8 offset:9216
  ds_read_b64_tr_b16 v[230:231], v8 offset:9472
  s_waitcnt vmcnt(9) lgkmcnt(4)
  v_mfma_f32_32x32x16_bf16 v[136:151], v[216:219], v[56:59], v[136:151]
  ds_read_b64_tr_b16 v[232:233], v8 offset:37888
  ds_read_b64_tr_b16 v[234:235], v8 offset:38144
  buffer_load_dwordx4 v[80:83], v246, s[36:39], s59 offen offset:2048 sc1
  v_mfma_f32_32x32x16_bf16 v[152:167], v[220:223], v[56:59], v[152:167]
  ds_read_b64_tr_b16 v[236:237], v2 offset:9216
  ds_read_b64_tr_b16 v[238:239], v2 offset:9472
  s_waitcnt lgkmcnt(4)
  v_mfma_f32_32x32x16_bf16 v[200:215], v[224:227], v[56:59], v[200:215]
  ds_read_b64_tr_b16 v[216:217], v8 offset:10240
  ds_read_b64_tr_b16 v[218:219], v8 offset:10496
  buffer_load_dwordx4 v[84:87], v246, s[36:39], s59 offen offset:3072 sc1
  s_waitcnt vmcnt(10)
  v_mfma_f32_32x32x16_bf16 v[136:151], v[228:231], v[60:63], v[136:151]
  ds_read_b64_tr_b16 v[220:221], v8 offset:38912
  ds_read_b64_tr_b16 v[222:223], v8 offset:39168
  s_waitcnt lgkmcnt(4)
  v_mfma_f32_32x32x16_bf16 v[152:167], v[232:235], v[60:63], v[152:167]
  ds_read_b64_tr_b16 v[224:225], v2 offset:10240
  ds_read_b64_tr_b16 v[226:227], v2 offset:10496
  buffer_load_dwordx4 v[88:91], v246, s[36:39], s60 offen offset:0 sc1
  v_mfma_f32_32x32x16_bf16 v[200:215], v[236:239], v[60:63], v[200:215]
  ds_read_b64_tr_b16 v[228:229], v8 offset:11264
  ds_read_b64_tr_b16 v[230:231], v8 offset:11520
  s_waitcnt vmcnt(10) lgkmcnt(4)
  v_mfma_f32_32x32x16_bf16 v[136:151], v[216:219], v[64:67], v[136:151]
  ds_read_b64_tr_b16 v[232:233], v8 offset:39936
  ds_read_b64_tr_b16 v[234:235], v8 offset:40192
  buffer_load_dwordx4 v[92:95], v246, s[36:39], s60 offen offset:1024 sc1
  v_mfma_f32_32x32x16_bf16 v[152:167], v[220:223], v[64:67], v[152:167]
  ds_read_b64_tr_b16 v[236:237], v2 offset:11264
  ds_read_b64_tr_b16 v[238:239], v2 offset:11520
  s_waitcnt lgkmcnt(4)
  v_mfma_f32_32x32x16_bf16 v[200:215], v[224:227], v[64:67], v[200:215]
  ds_read_b64_tr_b16 v[216:217], v8 offset:12288
  ds_read_b64_tr_b16 v[218:219], v8 offset:12544
  buffer_load_dwordx4 v[96:99], v246, s[36:39], s60 offen offset:2048 sc1
  s_waitcnt vmcnt(11)
  v_mfma_f32_32x32x16_bf16 v[136:151], v[228:231], v[68:71], v[136:151]
  ds_read_b64_tr_b16 v[220:221], v8 offset:40960
  ds_read_b64_tr_b16 v[222:223], v8 offset:41216
  s_waitcnt lgkmcnt(4)
  v_mfma_f32_32x32x16_bf16 v[152:167], v[232:235], v[68:71], v[152:167]
  ds_read_b64_tr_b16 v[224:225], v2 offset:12288
  ds_read_b64_tr_b16 v[226:227], v2 offset:12544
  buffer_load_dwordx4 v[100:103], v246, s[36:39], s60 offen offset:3072 sc1
  v_mfma_f32_32x32x16_bf16 v[200:215], v[236:239], v[68:71], v[200:215]
  ds_read_b64_tr_b16 v[228:229], v8 offset:13312
  ds_read_b64_tr_b16 v[230:231], v8 offset:13568
  s_waitcnt vmcnt(11) lgkmcnt(4)
  v_mfma_f32_32x32x16_bf16 v[136:151], v[216:219], v[72:75], v[136:151]
  ds_read_b64_tr_b16 v[232:233], v8 offset:41984
  ds_read_b64_tr_b16 v[234:235], v8 offset:42240
  buffer_load_dwordx4 v[104:107], v246, s[36:39], s61 offen offset:0 sc1
  v_mfma_f32_32x32x16_bf16 v[152:167], v[220:223], v[72:75], v[152:167]
  ds_read_b64_tr_b16 v[236:237], v2 offset:13312
  ds_read_b64_tr_b16 v[238:239], v2 offset:13568
  s_waitcnt lgkmcnt(4)
  v_mfma_f32_32x32x16_bf16 v[200:215], v[224:227], v[72:75], v[200:215]
  ds_read_b64_tr_b16 v[216:217], v8 offset:14336
  ds_read_b64_tr_b16 v[218:219], v8 offset:14592
  buffer_load_dwordx4 v[108:111], v246, s[36:39], s61 offen offset:1024 sc1
  s_waitcnt vmcnt(12)
  v_mfma_f32_32x32x16_bf16 v[136:151], v[228:231], v[76:79], v[136:151]
  ds_read_b64_tr_b16 v[220:221], v8 offset:43008
  ds_read_b64_tr_b16 v[222:223], v8 offset:43264
  s_waitcnt vmcnt(8)
  v_add_f32 v180, v180, v182
  v_add_f32 v181, v181, v183
  s_waitcnt lgkmcnt(4)
  v_mfma_f32_32x32x16_bf16 v[152:167], v[232:235], v[76:79], v[152:167]
  ds_read_b64_tr_b16 v[224:225], v2 offset:14336
  ds_read_b64_tr_b16 v[226:227], v2 offset:14592
  buffer_load_dwordx4 v[184:187], v247, s[36:39], s98 offen offset:0 sc1
  v_add_f32 v168, v168, v170
  v_add_f32 v169, v169, v171
  v_add_f32 v172, v172, v174
  v_mfma_f32_32x32x16_bf16 v[200:215], v[236:239], v[76:79], v[200:215]
  ds_read_b64_tr_b16 v[228:229], v8 offset:15360
  ds_read_b64_tr_b16 v[230:231], v8 offset:15616
  v_add_f32 v173, v173, v175
  v_add_f32 v176, v176, v178
  v_add_f32 v177, v177, v179
  s_waitcnt vmcnt(8) lgkmcnt(4)
  v_mfma_f32_32x32x16_bf16 v[136:151], v[216:219], v[80:83], v[136:151]
  ds_read_b64_tr_b16 v[232:233], v8 offset:44032
  ds_read_b64_tr_b16 v[234:235], v8 offset:44288
  buffer_load_dwordx4 v[188:191], v247, s[36:39], s98 offen offset:1024 sc1
  v_cndmask_b32 v180, v180, 0, s[48:49]
  v_cndmask_b32 v181, v181, 0, s[48:49]
  v_add_f32 v168, v168, v172
  v_mfma_f32_32x32x16_bf16 v[152:167], v[220:223], v[80:83], v[152:167]
  ds_read_b64_tr_b16 v[236:237], v2 offset:15360
  ds_read_b64_tr_b16 v[238:239], v2 offset:15616
  v_add_f32 v169, v169, v173
  v_add_f32 v176, v176, v180
  v_add_f32 v177, v177, v181
  s_waitcnt lgkmcnt(4)
  v_mfma_f32_32x32x16_bf16 v[200:215], v[224:227], v[80:83], v[200:215]
  ds_read_b64_tr_b16 v[216:217], v8 offset:16384
  ds_read_b64_tr_b16 v[218:219], v8 offset:16640
  buffer_load_dwordx4 v[192:195], v247, s[36:39], s98 offen offset:2048 sc1
  v_add_f32 v168, v168, v176
  v_add_f32 v169, v169, v177
  s_waitcnt vmcnt(9)
  v_mfma_f32_32x32x16_bf16 v[136:151], v[228:231], v[84:87], v[136:151]
  ds_read_b64_tr_b16 v[220:221], v8 offset:45056
  ds_read_b64_tr_b16 v[222:223], v8 offset:45312
  v_mov_b32 v241, 0
  v_mov_b32 v242, 0
  v_mov_b32 v243, 0
  s_waitcnt lgkmcnt(4)
  v_mfma_f32_32x32x16_bf16 v[152:167], v[232:235], v[84:87], v[152:167]
  ds_read_b64_tr_b16 v[224:225], v2 offset:16384
  ds_read_b64_tr_b16 v[226:227], v2 offset:16640
  buffer_load_dwordx4 v[196:199], v247, s[36:39], s98 offen offset:3072 sc1
  v_permlane32_swap_b32 v168, v169
  v_add_f32 v168, v168, v169
  v_mul_f32 v168, 0x3b124925, v168
  v_mfma_f32_32x32x16_bf16 v[200:215], v[236:239], v[84:87], v[200:215]
  ds_read_b64_tr_b16 v[228:229], v8 offset:17408
  ds_read_b64_tr_b16 v[230:231], v8 offset:17664
  v_mov_b32 v169, v168
  s_nop 1
  v_permlane32_swap_b32 v168, v169
  s_waitcnt vmcnt(9) lgkmcnt(4)
  v_mfma_f32_32x32x16_bf16 v[136:151], v[216:219], v[88:91], v[136:151]
  ds_read_b64_tr_b16 v[232:233], v8 offset:46080
  ds_read_b64_tr_b16 v[234:235], v8 offset:46336
  buffer_load_dwordx4 v[112:115], v246, s[36:39], s61 offen offset:2048 sc1
  v_fma_f32 v169, -v168, v168, v169
  v_cvt_pk_bf16_f32 v168, -v168, -v168
  v_max_f32 v169, 0, v169
  v_mfma_f32_32x32x16_bf16 v[152:167], v[220:223], v[88:91], v[152:167]
  ds_read_b64_tr_b16 v[236:237], v2 offset:17408
  ds_read_b64_tr_b16 v[238:239], v2 offset:17664
  v_cndmask_b32 v240, v168, 0, s[48:49]
  v_cvt_pk_bf16_f32 v169, v169, v169
  v_lshlrev_b32 v169, 16, v169
  s_waitcnt lgkmcnt(4)
  v_mfma_f32_32x32x16_bf16 v[200:215], v[224:227], v[88:91], v[200:215]
  ds_read_b64_tr_b16 v[216:217], v8 offset:18432
  ds_read_b64_tr_b16 v[218:219], v8 offset:18688
  buffer_load_dwordx4 v[116:119], v246, s[36:39], s61 offen offset:3072 sc1
  v_add_f32 v169, 0x3727c5ac, v169
  v_cvt_pk_bf16_f32 v169, v169, v169
  s_waitcnt vmcnt(10)
  v_mfma_f32_32x32x16_bf16 v[136:151], v[228:231], v[92:95], v[136:151]
  ds_read_b64_tr_b16 v[220:221], v8 offset:47104
  ds_read_b64_tr_b16 v[222:223], v8 offset:47360
  v_lshlrev_b32 v169, 16, v169
  v_sqrt_f32 v169, v169
  s_waitcnt lgkmcnt(4)
  v_mfma_f32_32x32x16_bf16 v[152:167], v[232:235], v[92:95], v[152:167]
  ds_read_b64_tr_b16 v[224:225], v2 offset:18432
  ds_read_b64_tr_b16 v[226:227], v2 offset:18688
  buffer_load_dwordx4 v[120:123], v246, s[36:39], s62 offen offset:0 sc1
  v_cvt_pk_bf16_f32 v169, v169, v169
  v_lshlrev_b32 v245, 16, v169
  v_mfma_f32_32x32x16_bf16 v[200:215], v[236:239], v[92:95], v[200:215]
  ds_read_b64_tr_b16 v[228:229], v8 offset:19456
  ds_read_b64_tr_b16 v[230:231], v8 offset:19712
  v_rcp_f32 v244, v245
  s_nop 0
  v_mul_f32 v244, 0xbfb8aa3b, v244
  s_waitcnt vmcnt(10) lgkmcnt(4)
  v_mfma_f32_32x32x16_bf16 v[136:151], v[216:219], v[96:99], v[136:151]
  ds_read_b64_tr_b16 v[232:233], v8 offset:48128
  ds_read_b64_tr_b16 v[234:235], v8 offset:48384
  buffer_load_dwordx4 v[124:127], v246, s[36:39], s62 offen offset:1024 sc1
  v_mfma_f32_32x32x16_bf16 v[152:167], v[220:223], v[96:99], v[152:167]
  ds_read_b64_tr_b16 v[236:237], v2 offset:19456
  ds_read_b64_tr_b16 v[238:239], v2 offset:19712
  s_waitcnt lgkmcnt(4)
  v_mfma_f32_32x32x16_bf16 v[200:215], v[224:227], v[96:99], v[200:215]
  ds_read_b64_tr_b16 v[216:217], v8 offset:20480
  ds_read_b64_tr_b16 v[218:219], v8 offset:20736
  buffer_load_dwordx4 v[128:131], v246, s[36:39], s62 offen offset:2048 sc1
  s_waitcnt vmcnt(11)
  v_mfma_f32_32x32x16_bf16 v[136:151], v[228:231], v[100:103], v[136:151]
  ds_read_b64_tr_b16 v[220:221], v8 offset:49152
  ds_read_b64_tr_b16 v[222:223], v8 offset:49408
  s_waitcnt lgkmcnt(4)
  v_mfma_f32_32x32x16_bf16 v[152:167], v[232:235], v[100:103], v[152:167]
  ds_read_b64_tr_b16 v[224:225], v2 offset:20480
  ds_read_b64_tr_b16 v[226:227], v2 offset:20736
  buffer_load_dwordx4 v[132:135], v246, s[36:39], s62 offen offset:3072 sc1
  v_mfma_f32_32x32x16_bf16 v[200:215], v[236:239], v[100:103], v[200:215]
  ds_read_b64_tr_b16 v[228:229], v8 offset:21504
  ds_read_b64_tr_b16 v[230:231], v8 offset:21760
  s_waitcnt vmcnt(11) lgkmcnt(4)
  v_mfma_f32_32x32x16_bf16 v[136:151], v[216:219], v[104:107], v[136:151]
  ds_read_b64_tr_b16 v[232:233], v8 offset:50176
  ds_read_b64_tr_b16 v[234:235], v8 offset:50432
  buffer_load_dwordx4 v[24:27], v247, s[36:39], 0 offen offset:0 sc1
  v_mfma_f32_32x32x16_bf16 v[152:167], v[220:223], v[104:107], v[152:167]
  ds_read_b64_tr_b16 v[236:237], v2 offset:21504
  ds_read_b64_tr_b16 v[238:239], v2 offset:21760
  s_waitcnt lgkmcnt(4)
  v_mfma_f32_32x32x16_bf16 v[200:215], v[224:227], v[104:107], v[200:215]
  ds_read_b64_tr_b16 v[216:217], v8 offset:22528
  ds_read_b64_tr_b16 v[218:219], v8 offset:22784
  buffer_load_dwordx4 v[28:31], v247, s[36:39], 0 offen offset:1024 sc1
  s_waitcnt vmcnt(12)
  v_mfma_f32_32x32x16_bf16 v[136:151], v[228:231], v[108:111], v[136:151]
  ds_read_b64_tr_b16 v[220:221], v8 offset:51200
  ds_read_b64_tr_b16 v[222:223], v8 offset:51456
  s_waitcnt lgkmcnt(4)
  v_mfma_f32_32x32x16_bf16 v[152:167], v[232:235], v[108:111], v[152:167]
  ds_read_b64_tr_b16 v[224:225], v2 offset:22528
  ds_read_b64_tr_b16 v[226:227], v2 offset:22784
  buffer_load_dwordx4 v[32:35], v247, s[36:39], 0 offen offset:2048 sc1
  v_mfma_f32_32x32x16_bf16 v[200:215], v[236:239], v[108:111], v[200:215]
  ds_read_b64_tr_b16 v[228:229], v8 offset:23552
  ds_read_b64_tr_b16 v[230:231], v8 offset:23808
  s_waitcnt vmcnt(9)
  v_add_f32 v196, v196, v198
  v_add_f32 v197, v197, v199
  s_waitcnt vmcnt(8) lgkmcnt(4)
  v_mfma_f32_32x32x16_bf16 v[136:151], v[216:219], v[112:115], v[136:151]
  ds_read_b64_tr_b16 v[232:233], v8 offset:52224
  ds_read_b64_tr_b16 v[234:235], v8 offset:52480
  buffer_load_dwordx4 v[36:39], v247, s[36:39], 0 offen offset:3072 sc1
  v_add_f32 v184, v184, v186
  v_add_f32 v185, v185, v187
  v_add_f32 v188, v188, v190
  v_mfma_f32_32x32x16_bf16 v[152:167], v[220:223], v[112:115], v[152:167]
  ds_read_b64_tr_b16 v[236:237], v2 offset:23552
  ds_read_b64_tr_b16 v[238:239], v2 offset:23808
  v_add_f32 v189, v189, v191
  v_add_f32 v192, v192, v194
  v_add_f32 v193, v193, v195
  s_waitcnt lgkmcnt(4)
  v_mfma_f32_32x32x16_bf16 v[200:215], v[224:227], v[112:115], v[200:215]
  ds_read_b64_tr_b16 v[216:217], v8 offset:24576
  ds_read_b64_tr_b16 v[218:219], v8 offset:24832
  buffer_load_dwordx4 v[40:43], v247, s[36:39], s57 offen offset:0 sc1
  v_cndmask_b32 v196, v196, 0, s[48:49]
  v_cndmask_b32 v197, v197, 0, s[48:49]
  s_waitcnt vmcnt(9)
  v_mfma_f32_32x32x16_bf16 v[136:151], v[228:231], v[116:119], v[136:151]
  ds_read_b64_tr_b16 v[220:221], v8 offset:53248
  ds_read_b64_tr_b16 v[222:223], v8 offset:53504
  v_add_f32 v184, v184, v188
  v_add_f32 v185, v185, v189
  v_add_f32 v192, v192, v196
  s_waitcnt lgkmcnt(4)
  v_mfma_f32_32x32x16_bf16 v[152:167], v[232:235], v[116:119], v[152:167]
  ds_read_b64_tr_b16 v[224:225], v2 offset:24576
  ds_read_b64_tr_b16 v[226:227], v2 offset:24832
  buffer_load_dwordx4 v[44:47], v247, s[36:39], s57 offen offset:1024 sc1
  v_add_f32 v193, v193, v197
  v_add_f32 v184, v184, v192
  v_add_f32 v185, v185, v193
  v_mfma_f32_32x32x16_bf16 v[200:215], v[236:239], v[116:119], v[200:215]
  ds_read_b64_tr_b16 v[228:229], v8 offset:25600
  ds_read_b64_tr_b16 v[230:231], v8 offset:25856
  v_permlane32_swap_b32 v184, v185
  v_add_f32 v184, v184, v185
  v_mul_f32 v184, 0x3b124925, v184
  s_waitcnt vmcnt(9) lgkmcnt(4)
  v_mfma_f32_32x32x16_bf16 v[136:151], v[216:219], v[120:123], v[136:151]
  ds_read_b64_tr_b16 v[232:233], v8 offset:54272
  ds_read_b64_tr_b16 v[234:235], v8 offset:54528
  buffer_load_dwordx4 v[48:51], v247, s[36:39], s57 offen offset:2048 sc1
  v_mov_b32 v185, v184
  s_nop 1
  v_permlane32_swap_b32 v184, v185
  v_mfma_f32_32x32x16_bf16 v[152:167], v[220:223], v[120:123], v[152:167]
  ds_read_b64_tr_b16 v[236:237], v2 offset:25600
  ds_read_b64_tr_b16 v[238:239], v2 offset:25856
  v_fma_f32 v185, -v184, v184, v185
  v_cvt_pk_bf16_f32 v184, -v184, -v184
  v_max_f32 v185, 0, v185
  s_waitcnt lgkmcnt(4)
  v_mfma_f32_32x32x16_bf16 v[200:215], v[224:227], v[120:123], v[200:215]
  ds_read_b64_tr_b16 v[216:217], v8 offset:26624
  ds_read_b64_tr_b16 v[218:219], v8 offset:26880
  buffer_load_dwordx4 v[52:55], v247, s[36:39], s57 offen offset:3072 sc1
  v_cndmask_b32 v250, v184, 0, s[48:49]
  v_cvt_pk_bf16_f32 v185, v185, v185
  s_waitcnt vmcnt(10)
  v_mfma_f32_32x32x16_bf16 v[136:151], v[228:231], v[124:127], v[136:151]
  ds_read_b64_tr_b16 v[220:221], v8 offset:55296
  ds_read_b64_tr_b16 v[222:223], v8 offset:55552
  v_lshlrev_b32 v185, 16, v185
  v_add_f32 v185, 0x3727c5ac, v185
  v_cvt_pk_bf16_f32 v185, v185, v185
  s_waitcnt lgkmcnt(4)
  v_mfma_f32_32x32x16_bf16 v[152:167], v[232:235], v[124:127], v[152:167]
  ds_read_b64_tr_b16 v[224:225], v2 offset:26624
  ds_read_b64_tr_b16 v[226:227], v2 offset:26880
  buffer_load_dwordx4 v[56:59], v247, s[36:39], s58 offen offset:0 sc1
  v_lshlrev_b32 v185, 16, v185
  v_sqrt_f32 v185, v185
  v_mfma_f32_32x32x16_bf16 v[200:215], v[236:239], v[124:127], v[200:215]
  ds_read_b64_tr_b16 v[228:229], v8 offset:27648
  ds_read_b64_tr_b16 v[230:231], v8 offset:27904
  v_cvt_pk_bf16_f32 v185, v185, v185
  v_lshlrev_b32 v252, 16, v185
  v_rcp_f32 v251, v252
  s_nop 0
  v_mul_f32 v251, 0xbfb8aa3b, v251
  v_mfma_f32_32x32x16_bf16 v[136:151], a[224:227], v[240:243], v[136:151]
  v_mfma_f32_32x32x16_bf16 v[152:167], a[226:229], v[240:243], v[152:167]
  v_mfma_f32_32x32x16_bf16 v[200:215], a[228:231], v[240:243], v[200:215]
  v_mov_b32 v240, v250
  s_waitcnt vmcnt(10) lgkmcnt(4)
  v_mfma_f32_32x32x16_bf16 v[136:151], v[216:219], v[128:131], v[136:151]
  ds_read_b64_tr_b16 v[232:233], v8 offset:56320
  ds_read_b64_tr_b16 v[234:235], v8 offset:56576
  buffer_load_dwordx4 v[60:63], v247, s[36:39], s58 offen offset:1024 sc1
  v_mfma_f32_32x32x16_bf16 v[152:167], v[220:223], v[128:131], v[152:167]
  ds_read_b64_tr_b16 v[236:237], v2 offset:27648
  ds_read_b64_tr_b16 v[238:239], v2 offset:27904
  s_waitcnt lgkmcnt(4)
  v_mfma_f32_32x32x16_bf16 v[200:215], v[224:227], v[128:131], v[200:215]
  ds_read_b64_tr_b16 v[216:217], v8 offset:0
  ds_read_b64_tr_b16 v[218:219], v8 offset:256
  buffer_load_dwordx4 v[64:67], v247, s[36:39], s58 offen offset:2048 sc1
  s_waitcnt vmcnt(11)
  v_mfma_f32_32x32x16_bf16 v[136:151], v[228:231], v[132:135], v[136:151]
  ds_read_b64_tr_b16 v[220:221], v8 offset:28672
  ds_read_b64_tr_b16 v[222:223], v8 offset:28928
  s_waitcnt lgkmcnt(4)
  v_mfma_f32_32x32x16_bf16 v[152:167], v[232:235], v[132:135], v[152:167]
  ds_read_b64_tr_b16 v[224:225], v8 offset:1024
  ds_read_b64_tr_b16 v[226:227], v8 offset:1280
  buffer_load_dwordx4 v[68:71], v247, s[36:39], s58 offen offset:3072 sc1
  v_mfma_f32_32x32x16_bf16 v[200:215], v[236:239], v[132:135], v[200:215]
  ds_read_b64_tr_b16 v[228:229], v8 offset:29696
  ds_read_b64_tr_b16 v[230:231], v8 offset:29952
  s_waitcnt vmcnt(11) lgkmcnt(4)
  v_mfma_f32_32x32x16_bf16 v[168:183], v[216:219], v[24:27], 0
  ds_read_b64_tr_b16 v[232:233], v8 offset:2048
  ds_read_b64_tr_b16 v[234:235], v8 offset:2304
  v_mfma_f32_32x32x16_bf16 v[184:199], v[220:223], v[24:27], 0
  ds_read_b64_tr_b16 v[236:237], v8 offset:30720
  ds_read_b64_tr_b16 v[238:239], v8 offset:30976
  buffer_load_dwordx4 v[72:75], v247, s[36:39], s59 offen offset:0 sc1
  s_waitcnt vmcnt(11) lgkmcnt(4)
  v_mfma_f32_32x32x16_bf16 v[168:183], v[224:227], v[28:31], v[168:183]
  ds_read_b64_tr_b16 v[216:217], v8 offset:3072
  ds_read_b64_tr_b16 v[218:219], v8 offset:3328
  v_mul_f32 v136, v244, v136
  v_mul_f32 v137, v244, v137
  v_mul_f32 v138, v244, v138
  v_mul_f32 v139, v244, v139
  v_mfma_f32_32x32x16_bf16 v[184:199], v[228:231], v[28:31], v[184:199]
  ds_read_b64_tr_b16 v[220:221], v8 offset:31744
  ds_read_b64_tr_b16 v[222:223], v8 offset:32000
  buffer_load_dwordx4 v[76:79], v247, s[36:39], s59 offen offset:1024 sc1
  v_exp_f32 v136, v136
  s_waitcnt vmcnt(11) lgkmcnt(4)
  v_mfma_f32_32x32x16_bf16 v[168:183], v[232:235], v[32:35], v[168:183]
  ds_read_b64_tr_b16 v[224:225], v8 offset:4096
  ds_read_b64_tr_b16 v[226:227], v8 offset:4352
  v_exp_f32 v137, v137
  v_exp_f32 v138, v138
  v_mfma_f32_32x32x16_bf16 v[184:199], v[236:239], v[32:35], v[184:199]
  ds_read_b64_tr_b16 v[228:229], v8 offset:32768
  ds_read_b64_tr_b16 v[230:231], v8 offset:33024
  buffer_load_dwordx4 v[80:83], v247, s[36:39], s59 offen offset:2048 sc1
  v_exp_f32 v139, v139
  s_waitcnt vmcnt(11) lgkmcnt(4)
  v_mfma_f32_32x32x16_bf16 v[168:183], v[216:219], v[36:39], v[168:183]
  ds_read_b64_tr_b16 v[232:233], v8 offset:5120
  ds_read_b64_tr_b16 v[234:235], v8 offset:5376
  v_fma_f32 v136, v136, v245, v245
  v_fma_f32 v137, v137, v245, v245
  v_fma_f32 v138, v138, v245, v245
  v_fma_f32 v139, v139, v245, v245
  v_mfma_f32_32x32x16_bf16 v[184:199], v[220:223], v[36:39], v[184:199]
  ds_read_b64_tr_b16 v[236:237], v8 offset:33792
  ds_read_b64_tr_b16 v[238:239], v8 offset:34048
  buffer_load_dwordx4 v[84:87], v247, s[36:39], s59 offen offset:3072 sc1
  v_rcp_f32 v136, v136
  s_waitcnt vmcnt(11) lgkmcnt(4)
  v_mfma_f32_32x32x16_bf16 v[168:183], v[224:227], v[40:43], v[168:183]
  ds_read_b64_tr_b16 v[216:217], v8 offset:6144
  ds_read_b64_tr_b16 v[218:219], v8 offset:6400
  v_rcp_f32 v137, v137
  v_rcp_f32 v138, v138
  v_mfma_f32_32x32x16_bf16 v[184:199], v[228:231], v[40:43], v[184:199]
  ds_read_b64_tr_b16 v[220:221], v8 offset:34816
  ds_read_b64_tr_b16 v[222:223], v8 offset:35072
  buffer_load_dwordx4 v[88:91], v247, s[36:39], s60 offen offset:0 sc1
  v_rcp_f32 v139, v139
  s_waitcnt vmcnt(11) lgkmcnt(4)
  v_mfma_f32_32x32x16_bf16 v[168:183], v[232:235], v[44:47], v[168:183]
  ds_read_b64_tr_b16 v[224:225], v8 offset:7168
  ds_read_b64_tr_b16 v[226:227], v8 offset:7424
  v_mul_f32 v152, v152, v136
  v_mul_f32 v153, v153, v137
  v_mul_f32 v154, v154, v138
  v_mul_f32 v155, v155, v139
  v_mfma_f32_32x32x16_bf16 v[184:199], v[236:239], v[44:47], v[184:199]
  ds_read_b64_tr_b16 v[228:229], v8 offset:35840
  ds_read_b64_tr_b16 v[230:231], v8 offset:36096
  buffer_load_dwordx4 v[92:95], v247, s[36:39], s60 offen offset:1024 sc1
  v_cvt_pk_bf16_f32 v136, v152, v153
  v_cvt_pk_bf16_f32 v137, v154, v155
  s_waitcnt vmcnt(11) lgkmcnt(4)
  v_mfma_f32_32x32x16_bf16 v[168:183], v[216:219], v[48:51], v[168:183]
  ds_read_b64_tr_b16 v[232:233], v8 offset:8192
  ds_read_b64_tr_b16 v[234:235], v8 offset:8448
  v_mul_f32 v140, v244, v140
  v_mul_f32 v141, v244, v141
  v_mul_f32 v142, v244, v142
  v_mul_f32 v143, v244, v143
  v_mfma_f32_32x32x16_bf16 v[184:199], v[220:223], v[48:51], v[184:199]
  ds_read_b64_tr_b16 v[236:237], v8 offset:36864
  ds_read_b64_tr_b16 v[238:239], v8 offset:37120
  buffer_load_dwordx4 v[96:99], v247, s[36:39], s60 offen offset:2048 sc1
  v_exp_f32 v140, v140
  s_waitcnt vmcnt(11) lgkmcnt(4)
  v_mfma_f32_32x32x16_bf16 v[168:183], v[224:227], v[52:55], v[168:183]
  ds_read_b64_tr_b16 v[216:217], v8 offset:9216
  ds_read_b64_tr_b16 v[218:219], v8 offset:9472
  v_exp_f32 v141, v141
  v_exp_f32 v142, v142
  v_mfma_f32_32x32x16_bf16 v[184:199], v[228:231], v[52:55], v[184:199]
  ds_read_b64_tr_b16 v[220:221], v8 offset:37888
  ds_read_b64_tr_b16 v[222:223], v8 offset:38144
  buffer_load_dwordx4 v[100:103], v247, s[36:39], s60 offen offset:3072 sc1
  v_exp_f32 v143, v143
  s_waitcnt vmcnt(11) lgkmcnt(4)
  v_mfma_f32_32x32x16_bf16 v[168:183], v[232:235], v[56:59], v[168:183]
  ds_read_b64_tr_b16 v[224:225], v8 offset:10240
  ds_read_b64_tr_b16 v[226:227], v8 offset:10496
  v_fma_f32 v140, v140, v245, v245
  v_fma_f32 v141, v141, v245, v245
  v_fma_f32 v142, v142, v245, v245
  v_fma_f32 v143, v143, v245, v245
  v_mfma_f32_32x32x16_bf16 v[184:199], v[236:239], v[56:59], v[184:199]
  ds_read_b64_tr_b16 v[228:229], v8 offset:38912
  ds_read_b64_tr_b16 v[230:231], v8 offset:39168
  buffer_load_dwordx4 v[104:107], v247, s[36:39], s61 offen offset:0 sc1
  v_rcp_f32 v140, v140
  s_waitcnt vmcnt(11) lgkmcnt(4)
  v_mfma_f32_32x32x16_bf16 v[168:183], v[216:219], v[60:63], v[168:183]
  ds_read_b64_tr_b16 v[232:233], v8 offset:11264
  ds_read_b64_tr_b16 v[234:235], v8 offset:11520
  v_rcp_f32 v141, v141
  v_rcp_f32 v142, v142
  v_mfma_f32_32x32x16_bf16 v[184:199], v[220:223], v[60:63], v[184:199]
  ds_read_b64_tr_b16 v[236:237], v8 offset:39936
  ds_read_b64_tr_b16 v[238:239], v8 offset:40192
  buffer_load_dwordx4 v[108:111], v247, s[36:39], s61 offen offset:1024 sc1
  v_rcp_f32 v143, v143
  s_waitcnt vmcnt(11) lgkmcnt(4)
  v_mfma_f32_32x32x16_bf16 v[168:183], v[224:227], v[64:67], v[168:183]
  ds_read_b64_tr_b16 v[216:217], v8 offset:12288
  ds_read_b64_tr_b16 v[218:219], v8 offset:12544
  v_mul_f32 v156, v156, v140
  v_mul_f32 v157, v157, v141
  v_mul_f32 v158, v158, v142
  v_mul_f32 v159, v159, v143
  v_mfma_f32_32x32x16_bf16 v[184:199], v[228:231], v[64:67], v[184:199]
  ds_read_b64_tr_b16 v[220:221], v8 offset:40960
  ds_read_b64_tr_b16 v[222:223], v8 offset:41216
  buffer_load_dwordx4 v[112:115], v247, s[36:39], s61 offen offset:2048 sc1
  v_cvt_pk_bf16_f32 v138, v156, v157
  v_cvt_pk_bf16_f32 v139, v158, v159
  s_waitcnt vmcnt(11) lgkmcnt(4)
  v_mfma_f32_32x32x16_bf16 v[168:183], v[232:235], v[68:71], v[168:183]
  ds_read_b64_tr_b16 v[224:225], v8 offset:13312
  ds_read_b64_tr_b16 v[226:227], v8 offset:13568
  buffer_store_dwordx4 v[136:139], v1, s[36:39], s90 offen offset:0
  v_mul_f32 v144, v244, v144
  v_mul_f32 v145, v244, v145
  v_mul_f32 v146, v244, v146
  v_mfma_f32_32x32x16_bf16 v[184:199], v[236:239], v[68:71], v[184:199]
  ds_read_b64_tr_b16 v[228:229], v8 offset:41984
  ds_read_b64_tr_b16 v[230:231], v8 offset:42240
  buffer_load_dwordx4 v[116:119], v247, s[36:39], s61 offen offset:3072 sc1
  v_mul_f32 v147, v244, v147
  s_waitcnt vmcnt(12) lgkmcnt(4)
  v_mfma_f32_32x32x16_bf16 v[168:183], v[216:219], v[72:75], v[168:183]
  ds_read_b64_tr_b16 v[232:233], v8 offset:14336
  ds_read_b64_tr_b16 v[234:235], v8 offset:14592
  s_add_u32 m0, s63, 86016
  s_add_u32 s97, s99, 524288
  buffer_load_dwordx4 v1, s[36:39], s97 offen sc1 lds
  v_mfma_f32_32x32x16_bf16 v[184:199], v[220:223], v[72:75], v[184:199]
  ds_read_b64_tr_b16 v[236:237], v8 offset:43008
  ds_read_b64_tr_b16 v[238:239], v8 offset:43264
  buffer_load_dwordx4 v[120:123], v247, s[36:39], s62 offen offset:0 sc1
  v_exp_f32 v144, v144
  s_waitcnt vmcnt(13) lgkmcnt(4)
  v_mfma_f32_32x32x16_bf16 v[168:183], v[224:227], v[76:79], v[168:183]
  ds_read_b64_tr_b16 v[216:217], v8 offset:15360
  ds_read_b64_tr_b16 v[218:219], v8 offset:15616
  s_add_u32 m0, s63, 87040
  s_add_u32 s97, s99, 525312
  buffer_load_dwordx4 v1, s[36:39], s97 offen sc1 lds
  v_mfma_f32_32x32x16_bf16 v[184:199], v[228:231], v[76:79], v[184:199]
  ds_read_b64_tr_b16 v[220:221], v8 offset:44032
  ds_read_b64_tr_b16 v[222:223], v8 offset:44288
  buffer_load_dwordx4 v[124:127], v247, s[36:39], s62 offen offset:1024 sc1
  v_exp_f32 v145, v145
  s_waitcnt vmcnt(14) lgkmcnt(4)
  v_mfma_f32_32x32x16_bf16 v[168:183], v[232:235], v[80:83], v[168:183]
  ds_read_b64_tr_b16 v[224:225], v8 offset:16384
  ds_read_b64_tr_b16 v[226:227], v8 offset:16640
  s_add_u32 m0, s63, 88064
  s_add_u32 s97, s99, 526336
  buffer_load_dwordx4 v1, s[36:39], s97 offen sc1 lds
  v_mfma_f32_32x32x16_bf16 v[184:199], v[236:239], v[80:83], v[184:199]
  ds_read_b64_tr_b16 v[228:229], v8 offset:45056
  ds_read_b64_tr_b16 v[230:231], v8 offset:45312
  buffer_load_dwordx4 v[128:131], v247, s[36:39], s62 offen offset:2048 sc1
  v_exp_f32 v146, v146
  s_waitcnt vmcnt(15) lgkmcnt(4)
  v_mfma_f32_32x32x16_bf16 v[168:183], v[216:219], v[84:87], v[168:183]
  ds_read_b64_tr_b16 v[232:233], v8 offset:17408
  ds_read_b64_tr_b16 v[234:235], v8 offset:17664
  s_add_u32 m0, s63, 89088
  s_add_u32 s97, s99, 527360
  buffer_load_dwordx4 v1, s[36:39], s97 offen sc1 lds
  v_mfma_f32_32x32x16_bf16 v[184:199], v[220:223], v[84:87], v[184:199]
  ds_read_b64_tr_b16 v[236:237], v8 offset:46080
  ds_read_b64_tr_b16 v[238:239], v8 offset:46336
  buffer_load_dwordx4 v[132:135], v247, s[36:39], s62 offen offset:3072 sc1
  v_exp_f32 v147, v147
  s_waitcnt vmcnt(16) lgkmcnt(4)
  v_mfma_f32_32x32x16_bf16 v[168:183], v[224:227], v[88:91], v[168:183]
  ds_read_b64_tr_b16 v[216:217], v8 offset:18432
  ds_read_b64_tr_b16 v[218:219], v8 offset:18688
  s_add_u32 m0, s63, 90112
  s_add_u32 s97, s99, 528384
  buffer_load_dwordx4 v1, s[36:39], s97 offen sc1 lds
  v_fma_f32 v144, v144, v245, v245
  v_mfma_f32_32x32x16_bf16 v[184:199], v[228:231], v[88:91], v[184:199]
  ds_read_b64_tr_b16 v[220:221], v8 offset:47104
  ds_read_b64_tr_b16 v[222:223], v8 offset:47360
  v_fma_f32 v145, v145, v245, v245
  v_fma_f32 v146, v146, v245, v245
  v_fma_f32 v147, v147, v245, v245
  s_waitcnt vmcnt(16) lgkmcnt(4)
  v_mfma_f32_32x32x16_bf16 v[168:183], v[232:235], v[92:95], v[168:183]
  ds_read_b64_tr_b16 v[224:225], v8 offset:19456
  ds_read_b64_tr_b16 v[226:227], v8 offset:19712
  s_add_u32 m0, s63, 91136
  s_add_u32 s97, s99, 529408
  buffer_load_dwordx4 v1, s[36:39], s97 offen sc1 lds
  v_mfma_f32_32x32x16_bf16 v[184:199], v[236:239], v[92:95], v[184:199]
  ds_read_b64_tr_b16 v[228:229], v8 offset:48128
  ds_read_b64_tr_b16 v[230:231], v8 offset:48384
  v_rcp_f32 v144, v144
  s_waitcnt vmcnt(16) lgkmcnt(4)
  v_mfma_f32_32x32x16_bf16 v[168:183], v[216:219], v[96:99], v[168:183]
  ds_read_b64_tr_b16 v[232:233], v8 offset:20480
  ds_read_b64_tr_b16 v[234:235], v8 offset:20736
  s_add_u32 m0, s63, 92160
  s_add_u32 s97, s99, 530432
  buffer_load_dwordx4 v1, s[36:39], s97 offen sc1 lds
  v_mfma_f32_32x32x16_bf16 v[184:199], v[220:223], v[96:99], v[184:199]
  ds_read_b64_tr_b16 v[236:237], v8 offset:49152
  ds_read_b64_tr_b16 v[238:239], v8 offset:49408
  v_rcp_f32 v145, v145
  s_waitcnt vmcnt(16) lgkmcnt(4)
  v_mfma_f32_32x32x16_bf16 v[168:183], v[224:227], v[100:103], v[168:183]
  ds_read_b64_tr_b16 v[216:217], v8 offset:21504
  ds_read_b64_tr_b16 v[218:219], v8 offset:21760
  v_rcp_f32 v146, v146
  v_rcp_f32 v147, v147
  v_mfma_f32_32x32x16_bf16 v[184:199], v[228:231], v[100:103], v[184:199]
  ds_read_b64_tr_b16 v[220:221], v8 offset:50176
  ds_read_b64_tr_b16 v[222:223], v8 offset:50432
  v_mul_f32 v160, v160, v144
  v_mul_f32 v161, v161, v145
  v_mul_f32 v162, v162, v146
  s_waitcnt vmcnt(15) lgkmcnt(4)
  v_mfma_f32_32x32x16_bf16 v[168:183], v[232:235], v[104:107], v[168:183]
  ds_read_b64_tr_b16 v[224:225], v8 offset:22528
  ds_read_b64_tr_b16 v[226:227], v8 offset:22784
  v_mul_f32 v163, v163, v147
  v_cvt_pk_bf16_f32 v140, v160, v161
  v_cvt_pk_bf16_f32 v141, v162, v163
  v_mul_f32 v148, v244, v148
  v_mfma_f32_32x32x16_bf16 v[184:199], v[236:239], v[104:107], v[184:199]
  ds_read_b64_tr_b16 v[228:229], v8 offset:51200
  ds_read_b64_tr_b16 v[230:231], v8 offset:51456
  v_mul_f32 v149, v244, v149
  v_mul_f32 v150, v244, v150
  v_mul_f32 v151, v244, v151
  s_waitcnt vmcnt(14) lgkmcnt(4)
  v_mfma_f32_32x32x16_bf16 v[168:183], v[216:219], v[108:111], v[168:183]
  ds_read_b64_tr_b16 v[232:233], v8 offset:23552
  ds_read_b64_tr_b16 v[234:235], v8 offset:23808
  v_exp_f32 v148, v148
  v_exp_f32 v149, v149
  v_mfma_f32_32x32x16_bf16 v[184:199], v[220:223], v[108:111], v[184:199]
  ds_read_b64_tr_b16 v[236:237], v8 offset:52224
  ds_read_b64_tr_b16 v[238:239], v8 offset:52480
  v_exp_f32 v150, v150
  s_waitcnt vmcnt(13) lgkmcnt(4)
  v_mfma_f32_32x32x16_bf16 v[168:183], v[224:227], v[112:115], v[168:183]
  ds_read_b64_tr_b16 v[216:217], v8 offset:24576
  ds_read_b64_tr_b16 v[218:219], v8 offset:24832
  v_exp_f32 v151, v151
  v_fma_f32 v148, v148, v245, v245
  v_fma_f32 v149, v149, v245, v245
  v_mfma_f32_32x32x16_bf16 v[184:199], v[228:231], v[112:115], v[184:199]
  ds_read_b64_tr_b16 v[220:221], v8 offset:53248
  ds_read_b64_tr_b16 v[222:223], v8 offset:53504
  v_fma_f32 v150, v150, v245, v245
  v_fma_f32 v151, v151, v245, v245
  s_waitcnt vmcnt(11) lgkmcnt(4)
  v_mfma_f32_32x32x16_bf16 v[168:183], v[232:235], v[116:119], v[168:183]
  ds_read_b64_tr_b16 v[224:225], v8 offset:25600
  ds_read_b64_tr_b16 v[226:227], v8 offset:25856
  v_rcp_f32 v148, v148
  v_rcp_f32 v149, v149
  v_mfma_f32_32x32x16_bf16 v[184:199], v[236:239], v[116:119], v[184:199]
  ds_read_b64_tr_b16 v[228:229], v8 offset:54272
  ds_read_b64_tr_b16 v[230:231], v8 offset:54528
  v_rcp_f32 v150, v150
  s_waitcnt vmcnt(9) lgkmcnt(4)
  v_mfma_f32_32x32x16_bf16 v[168:183], v[216:219], v[120:123], v[168:183]
  ds_read_b64_tr_b16 v[232:233], v8 offset:26624
  ds_read_b64_tr_b16 v[234:235], v8 offset:26880
  v_rcp_f32 v151, v151
  v_mul_f32 v164, v164, v148
  v_mul_f32 v165, v165, v149
  v_mfma_f32_32x32x16_bf16 v[184:199], v[220:223], v[120:123], v[184:199]
  ds_read_b64_tr_b16 v[236:237], v8 offset:55296
  ds_read_b64_tr_b16 v[238:239], v8 offset:55552
  v_mul_f32 v166, v166, v150
  v_mul_f32 v167, v167, v151
  v_cvt_pk_bf16_f32 v142, v164, v165
  s_waitcnt vmcnt(7) lgkmcnt(4)
  v_mfma_f32_32x32x16_bf16 v[168:183], v[224:227], v[124:127], v[168:183]
  ds_read_b64_tr_b16 v[216:217], v8 offset:27648
  ds_read_b64_tr_b16 v[218:219], v8 offset:27904
  v_cvt_pk_bf16_f32 v143, v166, v167
  buffer_store_dwordx4 v[140:143], v1, s[36:39], s90 offen offset:1024
  v_mul_f32 v200, v244, v200
  v_mul_f32 v201, v244, v201
  v_mfma_f32_32x32x16_bf16 v[184:199], v[228:231], v[124:127], v[184:199]
  ds_read_b64_tr_b16 v[220:221], v8 offset:56320
  ds_read_b64_tr_b16 v[222:223], v8 offset:56576
  v_mul_f32 v202, v244, v202
  v_mul_f32 v203, v244, v203
  v_mfma_f32_32x32x16_bf16 v[168:183], a[224:227], v[240:243], v[168:183]
  v_exp_f32 v200, v200
  v_exp_f32 v201, v201
  v_exp_f32 v202, v202
  v_mfma_f32_32x32x16_bf16 v[184:199], a[226:229], v[240:243], v[184:199]
  v_exp_f32 v203, v203
  v_fma_f32 v200, v200, v245, v245
  v_fma_f32 v201, v201, v245, v245
  v_fma_f32 v202, v202, v245, v245
  s_waitcnt vmcnt(6) lgkmcnt(4)
  v_mfma_f32_32x32x16_bf16 v[168:183], v[232:235], v[128:131], v[168:183]
  ds_read_b64_tr_b16 v[224:225], v2 offset:0
  ds_read_b64_tr_b16 v[226:227], v2 offset:256
  v_fma_f32 v203, v203, v245, v245
  v_rcp_f32 v200, v200
  v_mfma_f32_32x32x16_bf16 v[184:199], v[236:239], v[128:131], v[184:199]
  ds_read_b64_tr_b16 v[228:229], v2 offset:1024
  ds_read_b64_tr_b16 v[230:231], v2 offset:1280
  v_rcp_f32 v201, v201
  s_waitcnt vmcnt(4) lgkmcnt(4)
  v_mfma_f32_32x32x16_bf16 v[168:183], v[216:219], v[132:135], v[168:183]
  ds_read_b64_tr_b16 v[232:233], v2 offset:2048
  ds_read_b64_tr_b16 v[234:235], v2 offset:2304
  v_rcp_f32 v202, v202
  v_rcp_f32 v203, v203
  v_mfma_f32_32x32x16_bf16 v[184:199], v[220:223], v[132:135], v[184:199]
  ds_read_b64_tr_b16 v[236:237], v2 offset:3072
  ds_read_b64_tr_b16 v[238:239], v2 offset:3328
  v_mul_f32 v208, v208, v200
  v_mul_f32 v209, v209, v201
  v_mul_f32 v210, v210, v202
  v_mul_f32 v211, v211, v203
  v_cvt_pk_bf16_f32 v200, v208, v209
  v_cvt_pk_bf16_f32 v201, v210, v211
  v_mul_f32 v204, v244, v204
  v_mul_f32 v205, v244, v205
  v_mul_f32 v206, v244, v206
  v_mul_f32 v207, v244, v207
  v_exp_f32 v204, v204
  v_exp_f32 v205, v205
  v_exp_f32 v206, v206
  v_exp_f32 v207, v207
  v_fma_f32 v204, v204, v245, v245
  v_fma_f32 v205, v205, v245, v245
  v_fma_f32 v206, v206, v245, v245
  v_fma_f32 v207, v207, v245, v245
  v_rcp_f32 v204, v204
  v_rcp_f32 v205, v205
  v_rcp_f32 v206, v206
  v_rcp_f32 v207, v207
  v_mul_f32 v212, v212, v204
  v_mul_f32 v213, v213, v205
  v_mul_f32 v214, v214, v206
  v_mul_f32 v215, v215, v207
  v_cvt_pk_bf16_f32 v202, v212, v213
  v_cvt_pk_bf16_f32 v203, v214, v215
  buffer_store_dwordx4 v[200:203], v1, s[36:39], s96 offen offset:0
  s_cmp_lg_u32 s71, 120
  s_cbranch_scc1 Lwb_35
  buffer_wbl2 sc1
Lwb_35:
  s_waitcnt lgkmcnt(4)
  v_mfma_f32_32x32x16_bf16 v[136:151], v[224:227], v[24:27], 0
  ds_read_b64_tr_b16 v[216:217], v2 offset:4096
  ds_read_b64_tr_b16 v[218:219], v2 offset:4352
  s_mul_i32 s79, s3, 28672
  s_add_u32 s79, s79, 9437184
  s_xor_b32 s78, s76, 0
  s_mul_i32 s78, s78, 114688
  v_mfma_f32_32x32x16_bf16 v[136:151], v[228:231], v[28:31], v[136:151]
  ds_read_b64_tr_b16 v[220:221], v2 offset:5120
  ds_read_b64_tr_b16 v[222:223], v2 offset:5376
  s_add_u32 s78, s78, s79
  v_add_u32 v246, s78, v1
  s_xor_b32 s78, s76, 1
  s_waitcnt lgkmcnt(4)
  v_mfma_f32_32x32x16_bf16 v[136:151], v[232:235], v[32:35], v[136:151]
  ds_read_b64_tr_b16 v[224:225], v2 offset:6144
  ds_read_b64_tr_b16 v[226:227], v2 offset:6400
  s_mul_i32 s78, s78, 114688
  s_add_u32 s78, s78, s79
  v_add_u32 v247, s78, v1
  v_mul_f32 v168, v251, v168
  v_mfma_f32_32x32x16_bf16 v[136:151], v[236:239], v[36:39], v[136:151]
  ds_read_b64_tr_b16 v[228:229], v2 offset:7168
  ds_read_b64_tr_b16 v[230:231], v2 offset:7424
  v_mul_f32 v169, v251, v169
  v_mul_f32 v170, v251, v170
  v_mul_f32 v171, v251, v171
  s_waitcnt lgkmcnt(4)
  v_mfma_f32_32x32x16_bf16 v[136:151], v[216:219], v[40:43], v[136:151]
  ds_read_b64_tr_b16 v[232:233], v2 offset:8192
  ds_read_b64_tr_b16 v[234:235], v2 offset:8448
  v_exp_f32 v168, v168
  v_exp_f32 v169, v169
  v_mfma_f32_32x32x16_bf16 v[136:151], v[220:223], v[44:47], v[136:151]
  ds_read_b64_tr_b16 v[236:237], v2 offset:9216
  ds_read_b64_tr_b16 v[238:239], v2 offset:9472
  v_exp_f32 v170, v170
  s_waitcnt lgkmcnt(4)
  v_mfma_f32_32x32x16_bf16 v[136:151], v[224:227], v[48:51], v[136:151]
  ds_read_b64_tr_b16 v[216:217], v2 offset:10240
  ds_read_b64_tr_b16 v[218:219], v2 offset:10496
  v_exp_f32 v171, v171
  v_fma_f32 v168, v168, v252, v252
  v_fma_f32 v169, v169, v252, v252
  v_mfma_f32_32x32x16_bf16 v[136:151], v[228:231], v[52:55], v[136:151]
  ds_read_b64_tr_b16 v[220:221], v2 offset:11264
  ds_read_b64_tr_b16 v[222:223], v2 offset:11520
  v_fma_f32 v170, v170, v252, v252
  v_fma_f32 v171, v171, v252, v252
  s_waitcnt lgkmcnt(4)
  v_mfma_f32_32x32x16_bf16 v[136:151], v[232:235], v[56:59], v[136:151]
  ds_read_b64_tr_b16 v[224:225], v2 offset:12288
  ds_read_b64_tr_b16 v[226:227], v2 offset:12544
  v_rcp_f32 v168, v168
  v_rcp_f32 v169, v169
  v_mfma_f32_32x32x16_bf16 v[136:151], v[236:239], v[60:63], v[136:151]
  ds_read_b64_tr_b16 v[228:229], v2 offset:13312
  ds_read_b64_tr_b16 v[230:231], v2 offset:13568
  v_rcp_f32 v170, v170
  s_waitcnt lgkmcnt(4)
  v_mfma_f32_32x32x16_bf16 v[136:151], v[216:219], v[64:67], v[136:151]
  ds_read_b64_tr_b16 v[232:233], v2 offset:14336
  ds_read_b64_tr_b16 v[234:235], v2 offset:14592
  v_rcp_f32 v171, v171
  v_mul_f32 v184, v184, v168
  v_mul_f32 v185, v185, v169
  v_mfma_f32_32x32x16_bf16 v[136:151], v[220:223], v[68:71], v[136:151]
  ds_read_b64_tr_b16 v[236:237], v2 offset:15360
  ds_read_b64_tr_b16 v[238:239], v2 offset:15616
  v_mul_f32 v186, v186, v170
  v_mul_f32 v187, v187, v171
  v_cvt_pk_bf16_f32 v168, v184, v185
  s_waitcnt lgkmcnt(4)
  v_mfma_f32_32x32x16_bf16 v[136:151], v[224:227], v[72:75], v[136:151]
  ds_read_b64_tr_b16 v[216:217], v2 offset:16384
  ds_read_b64_tr_b16 v[218:219], v2 offset:16640
  v_cvt_pk_bf16_f32 v169, v186, v187
  v_mul_f32 v172, v251, v172
  v_mul_f32 v173, v251, v173
  v_mul_f32 v174, v251, v174
  v_mfma_f32_32x32x16_bf16 v[136:151], v[228:231], v[76:79], v[136:151]
  ds_read_b64_tr_b16 v[220:221], v2 offset:17408
  ds_read_b64_tr_b16 v[222:223], v2 offset:17664
  v_mul_f32 v175, v251, v175
  v_exp_f32 v172, v172
  s_waitcnt lgkmcnt(4)
  v_mfma_f32_32x32x16_bf16 v[136:151], v[232:235], v[80:83], v[136:151]
  ds_read_b64_tr_b16 v[224:225], v2 offset:18432
  ds_read_b64_tr_b16 v[226:227], v2 offset:18688
  v_exp_f32 v173, v173
  v_exp_f32 v174, v174
  v_mfma_f32_32x32x16_bf16 v[136:151], v[236:239], v[84:87], v[136:151]
  ds_read_b64_tr_b16 v[228:229], v2 offset:19456
  ds_read_b64_tr_b16 v[230:231], v2 offset:19712
  v_exp_f32 v175, v175
  v_fma_f32 v172, v172, v252, v252
  s_waitcnt lgkmcnt(4)
  v_mfma_f32_32x32x16_bf16 v[136:151], v[216:219], v[88:91], v[136:151]
  ds_read_b64_tr_b16 v[232:233], v2 offset:20480
  ds_read_b64_tr_b16 v[234:235], v2 offset:20736
  v_fma_f32 v173, v173, v252, v252
  v_fma_f32 v174, v174, v252, v252
  v_fma_f32 v175, v175, v252, v252
  v_mfma_f32_32x32x16_bf16 v[136:151], v[220:223], v[92:95], v[136:151]
  ds_read_b64_tr_b16 v[236:237], v2 offset:21504
  ds_read_b64_tr_b16 v[238:239], v2 offset:21760
  v_rcp_f32 v172, v172
  s_waitcnt lgkmcnt(4)
  v_mfma_f32_32x32x16_bf16 v[136:151], v[224:227], v[96:99], v[136:151]
  ds_read_b64_tr_b16 v[216:217], v2 offset:22528
  ds_read_b64_tr_b16 v[218:219], v2 offset:22784
  v_rcp_f32 v173, v173
  v_rcp_f32 v174, v174
  v_mfma_f32_32x32x16_bf16 v[136:151], v[228:231], v[100:103], v[136:151]
  ds_read_b64_tr_b16 v[220:221], v2 offset:23552
  ds_read_b64_tr_b16 v[222:223], v2 offset:23808
  v_rcp_f32 v175, v175
  v_mul_f32 v188, v188, v172
  s_waitcnt lgkmcnt(4)
  v_mfma_f32_32x32x16_bf16 v[136:151], v[232:235], v[104:107], v[136:151]
  ds_read_b64_tr_b16 v[224:225], v2 offset:24576
  ds_read_b64_tr_b16 v[226:227], v2 offset:24832
  v_mul_f32 v189, v189, v173
  v_mul_f32 v190, v190, v174
  v_mul_f32 v191, v191, v175
  v_cvt_pk_bf16_f32 v170, v188, v189
  v_mfma_f32_32x32x16_bf16 v[136:151], v[236:239], v[108:111], v[136:151]
  ds_read_b64_tr_b16 v[228:229], v2 offset:25600
  ds_read_b64_tr_b16 v[230:231], v2 offset:25856
  v_cvt_pk_bf16_f32 v171, v190, v191
  buffer_store_dwordx4 v[168:171], v1, s[36:39], s91 offen offset:0
  s_waitcnt vmcnt(1)
  s_waitcnt lgkmcnt(4)
  v_mfma_f32_32x32x16_bf16 v[136:151], v[216:219], v[112:115], v[136:151]
  ds_read_b64_tr_b16 v[232:233], v2 offset:26624
  ds_read_b64_tr_b16 v[234:235], v2 offset:26880
  s_add_u32 s83, s52, 5
  v_mov_b32 v255, s83
  buffer_store_dword v255, v4, s[36:39], s92 offen
  buffer_load_dword v15, v12, s[36:39], s94 offen sc1
  v_mfma_f32_32x32x16_bf16 v[136:151], v[220:223], v[116:119], v[136:151]
  ds_read_b64_tr_b16 v[236:237], v2 offset:27648
  ds_read_b64_tr_b16 v[238:239], v2 offset:27904
  v_mul_f32 v176, v251, v176
  v_mul_f32 v177, v251, v177
  v_mul_f32 v178, v251, v178
  s_waitcnt lgkmcnt(4)
  v_mfma_f32_32x32x16_bf16 v[136:151], v[224:227], v[120:123], v[136:151]
  s_barrier
  ds_read_b128 v[216:219], v10 offset:0
  v_mul_f32 v179, v251, v179
  v_exp_f32 v176, v176
  v_mfma_f32_32x32x16_bf16 v[136:151], v[228:231], v[124:127], v[136:151]
  ds_read_b128 v[220:223], v10 offset:1024
  v_exp_f32 v177, v177
  v_exp_f32 v178, v178
  v_mfma_f32_32x32x16_bf16 v[136:151], a[228:231], v[240:243], v[136:151]
  v_exp_f32 v179, v179
  v_fma_f32 v176, v176, v252, v252
  v_fma_f32 v177, v177, v252, v252
  v_fma_f32 v178, v178, v252, v252
  s_waitcnt lgkmcnt(2)
  v_mfma_f32_32x32x16_bf16 v[136:151], v[232:235], v[128:131], v[136:151]
  ds_read_b128 v[224:227], v10 offset:2048
  v_fma_f32 v179, v179, v252, v252
  v_rcp_f32 v176, v176
  v_rcp_f32 v177, v177
  v_mfma_f32_32x32x16_bf16 v[136:151], v[236:239], v[132:135], v[136:151]
  ds_read_b128 v[228:231], v10 offset:3072
  v_rcp_f32 v178, v178
  v_rcp_f32 v179, v179
  s_waitcnt lgkmcnt(2)
  v_mfma_f32_32x32x16_bf16 v[152:167], v[216:219], v[24:27], 0
  ds_read_b128 v[232:235], v10 offset:4096
  v_mul_f32 v192, v192, v176
  v_mul_f32 v193, v193, v177
  v_mul_f32 v194, v194, v178
  v_mul_f32 v195, v195, v179
  v_cvt_pk_bf16_f32 v172, v192, v193
  v_mfma_f32_32x32x16_bf16 v[152:167], v[220:223], v[28:31], v[152:167]
  ds_read_b128 v[236:239], v10 offset:5120
  v_cvt_pk_bf16_f32 v173, v194, v195
  v_mul_f32 v180, v251, v180
  v_mul_f32 v181, v251, v181
  v_mul_f32 v182, v251, v182
  s_waitcnt lgkmcnt(2)
  v_mfma_f32_32x32x16_bf16 v[152:167], v[224:227], v[32:35], v[152:167]
  ds_read_b128 v[216:219], v10 offset:6144
  v_mul_f32 v183, v251, v183
  v_exp_f32 v180, v180
  v_exp_f32 v181, v181
  v_mfma_f32_32x32x16_bf16 v[152:167], v[228:231], v[36:39], v[152:167]
  ds_read_b128 v[220:223], v10 offset:7168
  v_exp_f32 v182, v182
  v_exp_f32 v183, v183
  s_waitcnt lgkmcnt(2)
  v_mfma_f32_32x32x16_bf16 v[152:167], v[232:235], v[40:43], v[152:167]
  ds_read_b128 v[224:227], v10 offset:8192
  v_fma_f32 v180, v180, v252, v252
  v_fma_f32 v181, v181, v252, v252
  v_fma_f32 v182, v182, v252, v252
  v_fma_f32 v183, v183, v252, v252
  v_mfma_f32_32x32x16_bf16 v[152:167], v[236:239], v[44:47], v[152:167]
  ds_read_b128 v[228:231], v10 offset:9216
  v_rcp_f32 v180, v180
  v_rcp_f32 v181, v181
  s_waitcnt lgkmcnt(2)
  v_mfma_f32_32x32x16_bf16 v[152:167], v[216:219], v[48:51], v[152:167]
  ds_read_b128 v[232:235], v10 offset:10240
  v_rcp_f32 v182, v182
  v_rcp_f32 v183, v183
  v_mul_f32 v196, v196, v180
  v_mfma_f32_32x32x16_bf16 v[152:167], v[220:223], v[52:55], v[152:167]
  ds_read_b128 v[236:239], v10 offset:11264
  s_add_u32 s84, s52, 5
  s_waitcnt vmcnt(0)
  v_subrev_u32 v15, s84, v15
  v_cmp_le_u32 vcc, 16, v15
  s_cbranch_vccnz Lslow_36
Lback_37:
  s_waitcnt lgkmcnt(2)
  v_mfma_f32_32x32x16_bf16 v[152:167], v[224:227], v[56:59], v[152:167]
  ds_read_b128 v[216:219], v10 offset:12288
  buffer_load_dwordx4 v[24:27], v246, s[40:43], 0 offen offset:0 sc1
  v_mul_f32 v197, v197, v181
  v_mul_f32 v198, v198, v182
  v_mul_f32 v199, v199, v183
  v_cvt_pk_bf16_f32 v174, v196, v197
  v_mfma_f32_32x32x16_bf16 v[152:167], v[228:231], v[60:63], v[152:167]
  ds_read_b128 v[220:223], v10 offset:13312
  v_cvt_pk_bf16_f32 v175, v198, v199
  buffer_store_dwordx4 v[172:175], v1, s[36:39], s91 offen offset:1024
  v_lshlrev_b32 v168, 16, v16
  v_and_b32 v169, 0xffff0000, v16
  s_waitcnt lgkmcnt(2)
  v_mfma_f32_32x32x16_bf16 v[152:167], v[232:235], v[64:67], v[152:167]
  ds_read_b128 v[224:227], v10 offset:14336
  buffer_load_dwordx4 v[28:31], v247, s[40:43], 0 offen offset:0 sc1
  v_lshlrev_b32 v170, 16, v17
  v_and_b32 v171, 0xffff0000, v17
  v_lshlrev_b32 v172, 16, v18
  v_and_b32 v173, 0xffff0000, v18
  v_mfma_f32_32x32x16_bf16 v[152:167], v[236:239], v[68:71], v[152:167]
  ds_read_b128 v[228:231], v10 offset:15360
  v_lshlrev_b32 v174, 16, v19
  v_and_b32 v175, 0xffff0000, v19
  v_lshlrev_b32 v176, 16, v20
  v_and_b32 v177, 0xffff0000, v20
  s_waitcnt lgkmcnt(2)
  v_mfma_f32_32x32x16_bf16 v[152:167], v[216:219], v[72:75], v[152:167]
  ds_read_b128 v[232:235], v10 offset:16384
  buffer_load_dwordx4 v[32:35], v246, s[40:43], 0 offen offset:1024 sc1
  v_lshlrev_b32 v178, 16, v21
  v_and_b32 v179, 0xffff0000, v21
  v_lshlrev_b32 v180, 16, v22
  v_and_b32 v181, 0xffff0000, v22
  v_mfma_f32_32x32x16_bf16 v[152:167], v[220:223], v[76:79], v[152:167]
  ds_read_b128 v[236:239], v10 offset:17408
  v_lshlrev_b32 v182, 16, v23
  v_and_b32 v183, 0xffff0000, v23
  s_add_u32 s91, s91, 8192
  v_lshrrev_b32 v249, 2, v1
  s_waitcnt lgkmcnt(2)
  v_mfma_f32_32x32x16_bf16 v[152:167], v[224:227], v[80:83], v[152:167]
  ds_read_b128 v[216:219], v10 offset:18432
  buffer_load_dwordx4 v[36:39], v247, s[40:43], 0 offen offset:1024 sc1
  v_and_b32 v249, 0x3c, v249
  v_mul_f32 v136, v251, v136
  v_mul_f32 v137, v251, v137
  v_mul_f32 v138, v251, v138
  v_mfma_f32_32x32x16_bf16 v[152:167], v[228:231], v[84:87], v[152:167]
  ds_read_b128 v[220:223], v10 offset:19456
  v_mul_f32 v139, v251, v139
  v_exp_f32 v136, v136
  s_waitcnt lgkmcnt(2)
  v_mfma_f32_32x32x16_bf16 v[152:167], v[232:235], v[88:91], v[152:167]
  ds_read_b128 v[224:227], v10 offset:20480
  buffer_load_dwordx4 v[40:43], v246, s[40:43], 0 offen offset:2048 sc1
  v_exp_f32 v137, v137
  v_exp_f32 v138, v138
  v_mfma_f32_32x32x16_bf16 v[152:167], v[236:239], v[92:95], v[152:167]
  ds_read_b128 v[228:231], v10 offset:21504
  v_exp_f32 v139, v139
  v_fma_f32 v136, v136, v252, v252
  v_fma_f32 v137, v137, v252, v252
  s_waitcnt lgkmcnt(2)
  v_mfma_f32_32x32x16_bf16 v[152:167], v[216:219], v[96:99], v[152:167]
  ds_read_b128 v[232:235], v10 offset:22528
  buffer_load_dwordx4 v[44:47], v247, s[40:43], 0 offen offset:2048 sc1
  v_fma_f32 v138, v138, v252, v252
  v_fma_f32 v139, v139, v252, v252
  v_rcp_f32 v136, v136
  v_mfma_f32_32x32x16_bf16 v[152:167], v[220:223], v[100:103], v[152:167]
  ds_read_b128 v[236:239], v10 offset:23552
  v_rcp_f32 v137, v137
  v_rcp_f32 v138, v138
  s_waitcnt lgkmcnt(2)
  v_mfma_f32_32x32x16_bf16 v[152:167], v[224:227], v[104:107], v[152:167]
  ds_read_b128 v[216:219], v10 offset:24576
  buffer_load_dwordx4 v[48:51], v246, s[40:43], 0 offen offset:3072 sc1
  v_rcp_f32 v139, v139
  v_mul_f32 v144, v144, v136
  v_mul_f32 v145, v145, v137
  v_mfma_f32_32x32x16_bf16 v[152:167], v[228:231], v[108:111], v[152:167]
  ds_read_b128 v[220:223], v10 offset:25600
  v_mul_f32 v146, v146, v138
  v_mul_f32 v147, v147, v139
  v_cvt_pk_bf16_f32 v136, v144, v145
  v_cvt_pk_bf16_f32 v137, v146, v147
  s_waitcnt lgkmcnt(2)
  v_mfma_f32_32x32x16_bf16 v[152:167], v[232:235], v[112:115], v[152:167]
  ds_read_b128 v[224:227], v10 offset:26624
  buffer_load_dwordx4 v[52:55], v247, s[40:43], 0 offen offset:3072 sc1
  v_mul_f32 v140, v251, v140
  v_mul_f32 v141, v251, v141
  v_mul_f32 v142, v251, v142
  v_mul_f32 v143, v251, v143
  v_mfma_f32_32x32x16_bf16 v[152:167], v[236:239], v[116:119], v[152:167]
  ds_read_b128 v[228:231], v10 offset:27648
  v_exp_f32 v140, v140
  v_exp_f32 v141, v141
  s_waitcnt lgkmcnt(2)
  v_mfma_f32_32x32x16_bf16 v[152:167], v[216:219], v[120:123], v[152:167]
  buffer_load_dwordx4 v[56:59], v246, s[40:43], s57 offen offset:0 sc1
  v_exp_f32 v142, v142
  v_exp_f32 v143, v143
  v_fma_f32 v140, v140, v252, v252
  v_mfma_f32_32x32x16_bf16 v[152:167], v[220:223], v[124:127], v[152:167]
  v_fma_f32 v141, v141, v252, v252
  v_fma_f32 v142, v142, v252, v252
  v_fma_f32 v143, v143, v252, v252
  v_rcp_f32 v140, v140
  v_mfma_f32_32x32x16_bf16 v[152:167], a[230:233], v[240:243], v[152:167]
  v_rcp_f32 v141, v141
  v_rcp_f32 v142, v142
  s_waitcnt lgkmcnt(0)
  v_mfma_f32_32x32x16_bf16 v[152:167], v[224:227], v[128:131], v[152:167]
  buffer_load_dwordx4 v[60:63], v247, s[40:43], s57 offen offset:0 sc1
  v_rcp_f32 v143, v143
  v_mul_f32 v148, v148, v140
  v_mul_f32 v149, v149, v141
  v_mul_f32 v150, v150, v142
  v_mfma_f32_32x32x16_bf16 v[152:167], v[228:231], v[132:135], v[152:167]
  v_mul_f32 v151, v151, v143
  v_cvt_pk_bf16_f32 v138, v148, v149
  v_cvt_pk_bf16_f32 v139, v150, v151
  buffer_store_dwordx4 v[136:139], v1, s[36:39], s91 offen offset:0
  s_waitcnt vmcnt(10)
  v_mfma_f32_32x32x16_bf16 v[168:183], a[0:3], v[24:27], v[168:183]
  s_add_u32 s83, s52, 5
  v_mov_b32 v255, s83
  buffer_store_dword v255, v4, s[36:39], s93 offen
  v_mfma_f32_32x32x16_bf16 v[184:199], a[4:7], v[24:27], 0
  buffer_load_dwordx4 v[64:67], v246, s[40:43], s57 offen offset:1024 sc1
  v_mul_f32 v152, v251, v152
  v_mul_f32 v153, v251, v153
  v_mul_f32 v154, v251, v154
  v_mul_f32 v155, v251, v155
  s_waitcnt vmcnt(11)
  v_mfma_f32_32x32x16_bf16 v[200:215], a[0:3], v[28:31], 0
  v_exp_f32 v152, v152
  v_exp_f32 v153, v153
  v_exp_f32 v154, v154
  v_mfma_f32_32x32x16_bf16 v[216:231], a[4:7], v[28:31], 0
  buffer_load_dwordx4 v[68:71], v247, s[40:43], s57 offen offset:1024 sc1
  v_exp_f32 v155, v155
  v_fma_f32 v152, v152, v252, v252
  v_fma_f32 v153, v153, v252, v252
  s_waitcnt vmcnt(11)
  v_mfma_f32_32x32x16_bf16 v[168:183], a[8:11], v[32:35], v[168:183]
  v_fma_f32 v154, v154, v252, v252
  v_fma_f32 v155, v155, v252, v252
  v_rcp_f32 v152, v152
  v_rcp_f32 v153, v153
  v_mfma_f32_32x32x16_bf16 v[184:199], a[12:15], v[32:35], v[184:199]
  buffer_load_dwordx4 v[72:75], v246, s[40:43], s57 offen offset:2048 sc1
  v_rcp_f32 v154, v154
  v_rcp_f32 v155, v155
  s_waitcnt vmcnt(11)
  v_mfma_f32_32x32x16_bf16 v[200:215], a[8:11], v[36:39], v[200:215]
  v_mul_f32 v160, v160, v152
  v_mul_f32 v161, v161, v153
  v_mul_f32 v162, v162, v154
  v_mul_f32 v163, v163, v155
  v_cvt_pk_bf16_f32 v152, v160, v161
  v_cvt_pk_bf16_f32 v153, v162, v163
  v_mfma_f32_32x32x16_bf16 v[216:231], a[12:15], v[36:39], v[216:231]
  buffer_load_dwordx4 v[76:79], v247, s[40:43], s57 offen offset:2048 sc1
  v_mul_f32 v156, v251, v156
  v_mul_f32 v157, v251, v157
  v_mul_f32 v158, v251, v158
  v_mul_f32 v159, v251, v159
  s_waitcnt vmcnt(11)
  v_mfma_f32_32x32x16_bf16 v[168:183], a[16:19], v[40:43], v[168:183]
  v_exp_f32 v156, v156
  v_exp_f32 v157, v157
  v_exp_f32 v158, v158
  v_mfma_f32_32x32x16_bf16 v[184:199], a[20:23], v[40:43], v[184:199]
  buffer_load_dwordx4 v[80:83], v246, s[40:43], s57 offen offset:3072 sc1
  v_exp_f32 v159, v159
  v_fma_f32 v156, v156, v252, v252
  v_fma_f32 v157, v157, v252, v252
  s_waitcnt vmcnt(11)
  v_mfma_f32_32x32x16_bf16 v[200:215], a[16:19], v[44:47], v[200:215]
  v_fma_f32 v158, v158, v252, v252
  v_fma_f32 v159, v159, v252, v252
  v_rcp_f32 v156, v156
  v_rcp_f32 v157, v157
  v_mfma_f32_32x32x16_bf16 v[216:231], a[20:23], v[44:47], v[216:231]
  buffer_load_dwordx4 v[84:87], v247, s[40:43], s57 offen offset:3072 sc1
  v_rcp_f32 v158, v158
  v_rcp_f32 v159, v159
  s_waitcnt vmcnt(11)
  v_mfma_f32_32x32x16_bf16 v[168:183], a[24:27], v[48:51], v[168:183]
  v_mul_f32 v164, v164, v156
  v_mul_f32 v165, v165, v157
  v_mul_f32 v166, v166, v158
  v_mul_f32 v167, v167, v159
  v_cvt_pk_bf16_f32 v154, v164, v165
  v_cvt_pk_bf16_f32 v155, v166, v167
  v_mfma_f32_32x32x16_bf16 v[184:199], a[28:31], v[48:51], v[184:199]
  buffer_load_dword v15, v12, s[36:39], s95 offen sc1
  buffer_load_dwordx4 v[88:91], v246, s[40:43], s58 offen offset:0 sc1
  buffer_store_dwordx4 v[152:155], v1, s[36:39], s91 offen offset:1024
  s_waitcnt vmcnt(13)
  v_mfma_f32_32x32x16_bf16 v[200:215], a[24:27], v[52:55], v[200:215]
  v_mfma_f32_32x32x16_bf16 v[216:231], a[28:31], v[52:55], v[216:231]
  buffer_load_dwordx4 v[92:95], v247, s[40:43], s58 offen offset:0 sc1
  s_waitcnt vmcnt(13)
  v_mfma_f32_32x32x16_bf16 v[168:183], a[32:35], v[56:59], v[168:183]
  v_mfma_f32_32x32x16_bf16 v[184:199], a[36:39], v[56:59], v[184:199]
  buffer_load_dwordx4 v[96:99], v246, s[40:43], s58 offen offset:1024 sc1
  s_waitcnt vmcnt(13)
  v_mfma_f32_32x32x16_bf16 v[200:215], a[32:35], v[60:63], v[200:215]
  v_mfma_f32_32x32x16_bf16 v[216:231], a[36:39], v[60:63], v[216:231]
  buffer_load_dwordx4 v[100:103], v247, s[40:43], s58 offen offset:1024 sc1
  s_waitcnt vmcnt(11)
  v_mfma_f32_32x32x16_bf16 v[168:183], a[40:43], v[64:67], v[168:183]
  v_mfma_f32_32x32x16_bf16 v[184:199], a[44:47], v[64:67], v[184:199]
  buffer_load_dwordx4 v[104:107], v246, s[40:43], s58 offen offset:2048 sc1
  s_waitcnt vmcnt(11)
  v_mfma_f32_32x32x16_bf16 v[200:215], a[40:43], v[68:71], v[200:215]
  v_mfma_f32_32x32x16_bf16 v[216:231], a[44:47], v[68:71], v[216:231]
  buffer_load_dwordx4 v[108:111], v247, s[40:43], s58 offen offset:2048 sc1
  s_waitcnt vmcnt(11)
  v_mfma_f32_32x32x16_bf16 v[168:183], a[48:51], v[72:75], v[168:183]
  v_mfma_f32_32x32x16_bf16 v[184:199], a[52:55], v[72:75], v[184:199]
  buffer_load_dwordx4 v[112:115], v246, s[40:43], s58 offen offset:3072 sc1
  s_waitcnt vmcnt(11)
  v_mfma_f32_32x32x16_bf16 v[200:215], a[48:51], v[76:79], v[200:215]
  v_mfma_f32_32x32x16_bf16 v[216:231], a[52:55], v[76:79], v[216:231]
  buffer_load_dwordx4 v[116:119], v247, s[40:43], s58 offen offset:3072 sc1
  s_waitcnt vmcnt(7)
  s_add_u32 s83, s52, 6
  v_mov_b32 v255, s83
  buffer_store_dword v255, v4, s[36:39], s93 offen
  v_mfma_f32_32x32x16_bf16 v[168:183], a[56:59], v[80:83], v[168:183]
  v_add_u32 v250, s64, v1
  s_xor_b32 s82, s3, 1
  s_mul_i32 s82, s82, 12288
  s_add_u32 s82, s82, 114688
  v_add_u32 v251, s82, v1
  s_xor_b32 s82, s3, 2
  v_mfma_f32_32x32x16_bf16 v[184:199], a[60:63], v[80:83], v[184:199]
  s_add_u32 s84, s52, 5
  v_subrev_u32 v15, s84, v15
  v_cmp_le_u32 vcc, 16, v15
  s_cbranch_vccnz Lslow_38
Lback_39:
  buffer_load_dwordx4 v[120:123], v246, s[40:43], s59 offen offset:0 sc1
  v_mfma_f32_32x32x16_bf16 v[200:215], a[56:59], v[84:87], v[200:215]
  s_mul_i32 s82, s82, 12288
  s_add_u32 s82, s82, 118784
  v_add_u32 v252, s82, v1
  s_xor_b32 s82, s3, 3
  s_mul_i32 s82, s82, 12288
  s_add_u32 s82, s82, 122880
  v_mfma_f32_32x32x16_bf16 v[216:231], a[60:63], v[84:87], v[216:231]
  buffer_load_dwordx4 v[124:127], v247, s[40:43], s59 offen offset:0 sc1
  v_add_u32 v253, s82, v1
  s_lshl_b32 s80, s76, 15
  s_add_u32 s80, s80, 5242880
  s_lshl_b32 s79, s77, 11
  v_mfma_f32_32x32x16_bf16 v[168:183], a[64:67], v[88:91], v[168:183]
  s_add_u32 s78, s80, s79
  s_lshl_b32 s79, s55, 9
  s_add_u32 s79, s79, s80
  s_and_b32 s80, s3, 1
  s_lshl_b32 s80, s80, 3
  s_add_u32 s79, s79, s80
  v_mfma_f32_32x32x16_bf16 v[184:199], a[68:71], v[88:91], v[184:199]
  buffer_load_dwordx4 v[128:131], v246, s[40:43], s59 offen offset:1024 sc1
  s_add_u32 s79, s79, 28672
  s_lshl_b32 s80, s76, 7
  s_lshl_b32 s82, s77, 2
  s_add_u32 s80, s80, s82
  s_waitcnt vmcnt(10)
  v_mfma_f32_32x32x16_bf16 v[200:215], a[64:67], v[92:95], v[200:215]
  s_add_u32 s80, s80, 24576
  v_mfma_f32_32x32x16_bf16 v[216:231], a[68:71], v[92:95], v[216:231]
  buffer_load_dwordx4 v[132:135], v247, s[40:43], s59 offen offset:1024 sc1
  s_waitcnt vmcnt(10)
  v_mfma_f32_32x32x16_bf16 v[168:183], a[72:75], v[96:99], v[168:183]
  v_mfma_f32_32x32x16_bf16 v[184:199], a[76:79], v[96:99], v[184:199]
  buffer_load_dwordx4 v[24:27], v246, s[40:43], s59 offen offset:2048 sc1
  s_waitcnt vmcnt(10)
  v_mfma_f32_32x32x16_bf16 v[200:215], a[72:75], v[100:103], v[200:215]
  v_mfma_f32_32x32x16_bf16 v[216:231], a[76:79], v[100:103], v[216:231]
  buffer_load_dwordx4 v[28:31], v247, s[40:43], s59 offen offset:2048 sc1
  s_waitcnt vmcnt(10)
  v_mfma_f32_32x32x16_bf16 v[168:183], a[80:83], v[104:107], v[168:183]
  v_mfma_f32_32x32x16_bf16 v[184:199], a[84:87], v[104:107], v[184:199]
  buffer_load_dwordx4 v[32:35], v246, s[40:43], s59 offen offset:3072 sc1
  s_waitcnt vmcnt(10)
  v_mfma_f32_32x32x16_bf16 v[200:215], a[80:83], v[108:111], v[200:215]
  v_mfma_f32_32x32x16_bf16 v[216:231], a[84:87], v[108:111], v[216:231]
  buffer_load_dword v15, v12, s[36:39], s95 offen sc1
  buffer_load_dwordx4 v[36:39], v247, s[40:43], s59 offen offset:3072 sc1
  s_waitcnt vmcnt(11)
  v_mfma_f32_32x32x16_bf16 v[168:183], a[88:91], v[112:115], v[168:183]
  v_mfma_f32_32x32x16_bf16 v[184:199], a[92:95], v[112:115], v[184:199]
  buffer_load_dwordx4 v[40:43], v246, s[40:43], s60 offen offset:0 sc1
  s_waitcnt vmcnt(11)
  v_mfma_f32_32x32x16_bf16 v[200:215], a[88:91], v[116:119], v[200:215]
  v_mfma_f32_32x32x16_bf16 v[216:231], a[92:95], v[116:119], v[216:231]
  buffer_load_dwordx4 v[44:47], v247, s[40:43], s60 offen offset:0 sc1
  s_waitcnt vmcnt(10)
  v_mfma_f32_32x32x16_bf16 v[168:183], a[96:99], v[120:123], v[168:183]
  v_mfma_f32_32x32x16_bf16 v[184:199], a[100:103], v[120:123], v[184:199]
  buffer_load_dwordx4 v[48:51], v246, s[40:43], s60 offen offset:1024 sc1
  s_waitcnt vmcnt(10)
  v_mfma_f32_32x32x16_bf16 v[200:215], a[96:99], v[124:127], v[200:215]
  v_mfma_f32_32x32x16_bf16 v[216:231], a[100:103], v[124:127], v[216:231]
  buffer_load_dwordx4 v[52:55], v247, s[40:43], s60 offen offset:1024 sc1
  s_waitcnt vmcnt(10)
  v_mfma_f32_32x32x16_bf16 v[168:183], a[104:107], v[128:131], v[168:183]
  v_mfma_f32_32x32x16_bf16 v[184:199], a[108:111], v[128:131], v[184:199]
  buffer_load_dwordx4 v[56:59], v246, s[40:43], s60 offen offset:2048 sc1
  s_waitcnt vmcnt(10)
  v_mfma_f32_32x32x16_bf16 v[200:215], a[104:107], v[132:135], v[200:215]
  v_mfma_f32_32x32x16_bf16 v[216:231], a[108:111], v[132:135], v[216:231]
  buffer_load_dwordx4 v[60:63], v247, s[40:43], s60 offen offset:2048 sc1
  s_waitcnt vmcnt(10)
  v_mfma_f32_32x32x16_bf16 v[168:183], a[112:115], v[24:27], v[168:183]
  v_mfma_f32_32x32x16_bf16 v[184:199], a[116:119], v[24:27], v[184:199]
  buffer_load_dwordx4 v[64:67], v246, s[40:43], s60 offen offset:3072 sc1
  s_waitcnt vmcnt(10)
  v_mfma_f32_32x32x16_bf16 v[200:215], a[112:115], v[28:31], v[200:215]
  v_mfma_f32_32x32x16_bf16 v[216:231], a[116:119], v[28:31], v[216:231]
  s_add_u32 s84, s52, 6
  s_waitcnt vmcnt(8)
  v_subrev_u32 v15, s84, v15
  v_cmp_le_u32 vcc, 16, v15
  s_cbranch_vccnz Lslow_40
Lback_41:
  buffer_load_dwordx4 v[68:71], v247, s[40:43], s60 offen offset:3072 sc1
  buffer_load_dwordx4 v[72:75], v246, s[40:43], s61 offen offset:0 sc1
  v_mfma_f32_32x32x16_bf16 v[168:183], a[120:123], v[32:35], v[168:183]
  v_mfma_f32_32x32x16_bf16 v[184:199], a[124:127], v[32:35], v[184:199]
  buffer_load_dwordx4 v[76:79], v247, s[40:43], s61 offen offset:0 sc1
  buffer_load_dwordx4 v[80:83], v246, s[40:43], s61 offen offset:1024 sc1
  s_waitcnt vmcnt(11)
  v_mfma_f32_32x32x16_bf16 v[200:215], a[120:123], v[36:39], v[200:215]
  v_mfma_f32_32x32x16_bf16 v[216:231], a[124:127], v[36:39], v[216:231]
  buffer_load_dwordx4 v[84:87], v247, s[40:43], s61 offen offset:1024 sc1
  buffer_load_dwordx4 v[92:95], v247, s[40:43], s61 offen offset:2048 sc1
  s_waitcnt vmcnt(12)
  v_mfma_f32_32x32x16_bf16 v[168:183], a[128:131], v[40:43], v[168:183]
  v_mfma_f32_32x32x16_bf16 v[184:199], a[132:135], v[40:43], v[184:199]
  buffer_load_dwordx4 v[100:103], v247, s[40:43], s61 offen offset:3072 sc1
  buffer_load_dwordx4 v[108:111], v247, s[40:43], s62 offen offset:0 sc1
  s_waitcnt vmcnt(13)
  v_mfma_f32_32x32x16_bf16 v[200:215], a[128:131], v[44:47], v[200:215]
  v_mfma_f32_32x32x16_bf16 v[216:231], a[132:135], v[44:47], v[216:231]
  buffer_load_dwordx4 v[116:119], v247, s[40:43], s62 offen offset:1024 sc1
  s_waitcnt vmcnt(13)
  v_mfma_f32_32x32x16_bf16 v[168:183], a[136:139], v[48:51], v[168:183]
  v_mfma_f32_32x32x16_bf16 v[184:199], a[140:143], v[48:51], v[184:199]
  buffer_load_dwordx4 v[124:127], v247, s[40:43], s62 offen offset:2048 sc1
  s_waitcnt vmcnt(13)
  v_mfma_f32_32x32x16_bf16 v[200:215], a[136:139], v[52:55], v[200:215]
  v_mfma_f32_32x32x16_bf16 v[216:231], a[140:143], v[52:55], v[216:231]
  buffer_load_dwordx4 v[132:135], v247, s[40:43], s62 offen offset:3072 sc1
  s_waitcnt vmcnt(13)
  v_mfma_f32_32x32x16_bf16 v[168:183], a[144:147], v[56:59], v[168:183]
  v_mfma_f32_32x32x16_bf16 v[184:199], a[148:151], v[56:59], v[184:199]
  buffer_load_dwordx4 v[88:91], v246, s[40:43], s61 offen offset:2048 sc1
  s_waitcnt vmcnt(13)
  v_mfma_f32_32x32x16_bf16 v[200:215], a[144:147], v[60:63], v[200:215]
  v_mfma_f32_32x32x16_bf16 v[216:231], a[148:151], v[60:63], v[216:231]
  buffer_load_dwordx4 v[96:99], v246, s[40:43], s61 offen offset:3072 sc1
  s_waitcnt vmcnt(13)
  v_mfma_f32_32x32x16_bf16 v[168:183], a[152:155], v[64:67], v[168:183]
  v_mfma_f32_32x32x16_bf16 v[184:199], a[156:159], v[64:67], v[184:199]
  buffer_load_dwordx4 v[104:107], v246, s[40:43], s62 offen offset:0 sc1
  s_waitcnt vmcnt(13)
  v_mfma_f32_32x32x16_bf16 v[200:215], a[152:155], v[68:71], v[200:215]
  v_mfma_f32_32x32x16_bf16 v[216:231], a[156:159], v[68:71], v[216:231]
  buffer_load_dwordx4 v[112:115], v246, s[40:43], s62 offen offset:1024 sc1
  s_waitcnt vmcnt(13)
  v_mfma_f32_32x32x16_bf16 v[168:183], a[160:163], v[72:75], v[168:183]
  v_mfma_f32_32x32x16_bf16 v[184:199], a[164:167], v[72:75], v[184:199]
  buffer_load_dwordx4 v[120:123], v246, s[40:43], s62 offen offset:2048 sc1
  s_waitcnt vmcnt(13)
  v_mfma_f32_32x32x16_bf16 v[200:215], a[160:163], v[76:79], v[200:215]
  v_mfma_f32_32x32x16_bf16 v[216:231], a[164:167], v[76:79], v[216:231]
  buffer_load_dwordx4 v[128:131], v246, s[40:43], s62 offen offset:3072 sc1
  s_waitcnt vmcnt(13)
  v_mfma_f32_32x32x16_bf16 v[168:183], a[168:171], v[80:83], v[168:183]
  v_mfma_f32_32x32x16_bf16 v[184:199], a[172:175], v[80:83], v[184:199]
  s_waitcnt vmcnt(12)
  v_mfma_f32_32x32x16_bf16 v[200:215], a[168:171], v[84:87], v[200:215]
  v_mfma_f32_32x32x16_bf16 v[216:231], a[172:175], v[84:87], v[216:231]
  s_waitcnt vmcnt(11)
  v_mfma_f32_32x32x16_bf16 v[216:231], a[180:183], v[92:95], v[216:231]
  s_waitcnt vmcnt(10)
  v_mfma_f32_32x32x16_bf16 v[216:231], a[188:191], v[100:103], v[216:231]
  s_waitcnt vmcnt(9)
  v_mfma_f32_32x32x16_bf16 v[216:231], a[196:199], v[108:111], v[216:231]
  s_waitcnt vmcnt(8)
  v_mfma_f32_32x32x16_bf16 v[216:231], a[204:207], v[116:119], v[216:231]
  s_waitcnt vmcnt(7)
  v_mfma_f32_32x32x16_bf16 v[216:231], a[212:215], v[124:127], v[216:231]
  s_waitcnt vmcnt(6)
  v_mfma_f32_32x32x16_bf16 v[216:231], a[220:223], v[132:135], v[216:231]
  v_mfma_f32_32x32x16_bf16 v[200:215], a[176:179], v[92:95], v[200:215]
  v_mfma_f32_32x32x16_bf16 v[200:215], a[184:187], v[100:103], v[200:215]
  ds_write_b128 v250, v[216:219] offset:8192
  v_mfma_f32_32x32x16_bf16 v[200:215], a[192:195], v[108:111], v[200:215]
  ds_write_b128 v250, v[220:223] offset:9216
  v_mfma_f32_32x32x16_bf16 v[200:215], a[200:203], v[116:119], v[200:215]
  ds_write_b128 v250, v[224:227] offset:10240
  v_mfma_f32_32x32x16_bf16 v[200:215], a[208:211], v[124:127], v[200:215]
  ds_write_b128 v250, v[228:231] offset:11264
  v_mfma_f32_32x32x16_bf16 v[200:215], a[216:219], v[132:135], v[200:215]
  s_waitcnt vmcnt(5)
  v_mfma_f32_32x32x16_bf16 v[184:199], a[180:183], v[88:91], v[184:199]
  s_waitcnt vmcnt(4)
  v_mfma_f32_32x32x16_bf16 v[184:199], a[188:191], v[96:99], v[184:199]
  s_cmp_lg_u32 s71, 124
  s_cbranch_scc1 Lwb_42
  buffer_wbl2 sc0 sc1
Lwb_42:
  ds_write_b128 v250, v[200:203] offset:4096
  s_waitcnt vmcnt(3)
  v_mfma_f32_32x32x16_bf16 v[184:199], a[196:199], v[104:107], v[184:199]
  ds_write_b128 v250, v[204:207] offset:5120
  s_waitcnt vmcnt(2)
  v_mfma_f32_32x32x16_bf16 v[184:199], a[204:207], v[112:115], v[184:199]
  ds_write_b128 v250, v[208:211] offset:6144
  s_waitcnt vmcnt(1)
  v_mfma_f32_32x32x16_bf16 v[184:199], a[212:215], v[120:123], v[184:199]
  ds_write_b128 v250, v[212:215] offset:7168
  s_waitcnt vmcnt(0)
  v_mfma_f32_32x32x16_bf16 v[184:199], a[220:223], v[128:131], v[184:199]
  v_mfma_f32_32x32x16_bf16 v[168:183], a[176:179], v[88:91], v[168:183]
  v_mfma_f32_32x32x16_bf16 v[168:183], a[184:187], v[96:99], v[168:183]
  ds_write_b128 v250, v[184:187] offset:0
  v_mfma_f32_32x32x16_bf16 v[168:183], a[192:195], v[104:107], v[168:183]
  ds_write_b128 v250, v[188:191] offset:1024
  v_mfma_f32_32x32x16_bf16 v[168:183], a[200:203], v[112:115], v[168:183]
  ds_write_b128 v250, v[192:195] offset:2048
  v_mfma_f32_32x32x16_bf16 v[168:183], a[208:211], v[120:123], v[168:183]
  ds_write_b128 v250, v[196:199] offset:3072
  v_mfma_f32_32x32x16_bf16 v[168:183], a[216:219], v[128:131], v[168:183]
  s_waitcnt lgkmcnt(0)
  s_barrier
  ds_read_b128 v[184:187], v251 offset:0
  ds_read_b128 v[200:203], v252 offset:0
  ds_read_b128 v[216:219], v253 offset:0
  ds_read_b128 v[188:191], v251 offset:1024
  ds_read_b128 v[204:207], v252 offset:1024
  ds_read_b128 v[220:223], v253 offset:1024
  ds_read_b128 v[192:195], v251 offset:2048
  ds_read_b128 v[208:211], v252 offset:2048
  ds_read_b128 v[224:227], v253 offset:2048
  ds_read_b128 v[196:199], v251 offset:3072
  ds_read_b128 v[212:215], v252 offset:3072
  ds_read_b128 v[228:231], v253 offset:3072
  v_mov_b32 v254, 0
  v_mov_b32 v255, 0
  s_waitcnt lgkmcnt(9)
  v_pk_add_f32 v[168:169], v[168:169], v[184:185]
  v_pk_add_f32 v[200:201], v[200:201], v[216:217]
  v_pk_add_f32 v[170:171], v[170:171], v[186:187]
  v_pk_add_f32 v[202:203], v[202:203], v[218:219]
  v_pk_add_f32 v[168:169], v[168:169], v[200:201]
  v_pk_add_f32 v[170:171], v[170:171], v[202:203]
  v_cvt_pk_bf16_f32 v16, v168, v169
  v_cvt_pk_bf16_f32 v17, v170, v171
  s_waitcnt lgkmcnt(6)
  v_pk_add_f32 v[172:173], v[172:173], v[188:189]
  v_pk_add_f32 v[204:205], v[204:205], v[220:221]
  v_pk_add_f32 v[174:175], v[174:175], v[190:191]
  v_pk_add_f32 v[206:207], v[206:207], v[222:223]
  v_pk_add_f32 v[172:173], v[172:173], v[204:205]
  v_pk_add_f32 v[174:175], v[174:175], v[206:207]
  v_cvt_pk_bf16_f32 v18, v172, v173
  v_cvt_pk_bf16_f32 v19, v174, v175
  buffer_store_dwordx4 v[16:19], v9, s[32:35], 0 offen offset:0
  s_waitcnt lgkmcnt(3)
  v_pk_add_f32 v[176:177], v[176:177], v[192:193]
  v_pk_add_f32 v[208:209], v[208:209], v[224:225]
  v_pk_add_f32 v[178:179], v[178:179], v[194:195]
  v_pk_add_f32 v[210:211], v[210:211], v[226:227]
  v_pk_add_f32 v[176:177], v[176:177], v[208:209]
  v_pk_add_f32 v[178:179], v[178:179], v[210:211]
  v_cvt_pk_bf16_f32 v20, v176, v177
  v_cvt_pk_bf16_f32 v21, v178, v179
  s_waitcnt lgkmcnt(0)
  v_pk_add_f32 v[180:181], v[180:181], v[196:197]
  v_pk_add_f32 v[212:213], v[212:213], v[228:229]
  v_pk_add_f32 v[182:183], v[182:183], v[198:199]
  v_pk_add_f32 v[214:215], v[214:215], v[230:231]
  v_pk_add_f32 v[180:181], v[180:181], v[212:213]
  v_pk_add_f32 v[182:183], v[182:183], v[214:215]
  v_cvt_pk_bf16_f32 v22, v180, v181
  v_cvt_pk_bf16_f32 v23, v182, v183
  buffer_store_dwordx4 v[20:23], v9, s[32:35], 0 offen offset:32
  s_add_u32 s78, s101, 1
  v_mov_b32 v250, s78
  s_lshl_b32 s79, s2, 2
  s_add_u32 s79, s79, s3
  s_cmp_lg_u32 s79, 0
  s_cselect_b32 s80, 0x40000000, 0
  buffer_store_dword v250, v4, s[36:39], s80 offen sc1
  s_endpgm
Lvr_2:
  s_add_u32 s53, s53, 1
  s_cmp_gt_u32 s53, 0x20000
  s_cbranch_scc1 Lvd_3
  s_add_u32 m0, s63, 114688
  s_add_u32 s97, s65, 16805888
  buffer_load_dwordx4 v1, s[36:39], s97 offen sc1 lds
  s_add_u32 m0, s63, 115712
  s_add_u32 s97, s65, 16806912
  buffer_load_dwordx4 v1, s[36:39], s97 offen sc1 lds
  s_add_u32 m0, s63, 116736
  s_add_u32 s97, s65, 16807936
  buffer_load_dwordx4 v1, s[36:39], s97 offen sc1 lds
  s_add_u32 m0, s63, 117760
  s_add_u32 s97, s65, 16808960
  buffer_load_dwordx4 v1, s[36:39], s97 offen sc1 lds
  s_add_u32 m0, s63, 118784
  s_add_u32 s97, s65, 16809984
  buffer_load_dwordx4 v1, s[36:39], s97 offen sc1 lds
  s_add_u32 m0, s63, 119808
  s_add_u32 s97, s65, 16811008
  buffer_load_dwordx4 v1, s[36:39], s97 offen sc1 lds
  s_add_u32 m0, s63, 120832
  s_add_u32 s97, s65, 16812032
  buffer_load_dwordx4 v1, s[36:39], s97 offen sc1 lds
  s_waitcnt vmcnt(0)
  s_branch Lvc_1
Lvr_5:
  s_add_u32 s53, s53, 1
  s_cmp_gt_u32 s53, 0x20000
  s_cbranch_scc1 Lvd_6
  s_add_u32 m0, s63, 86016
  s_add_u32 s97, s65, 16777216
  buffer_load_dwordx4 v1, s[36:39], s97 offen sc1 lds
  s_add_u32 m0, s63, 87040
  s_add_u32 s97, s65, 16778240
  buffer_load_dwordx4 v1, s[36:39], s97 offen sc1 lds
  s_add_u32 m0, s63, 88064
  s_add_u32 s97, s65, 16779264
  buffer_load_dwordx4 v1, s[36:39], s97 offen sc1 lds
  s_add_u32 m0, s63, 89088
  s_add_u32 s97, s65, 16780288
  buffer_load_dwordx4 v1, s[36:39], s97 offen sc1 lds
  s_add_u32 m0, s63, 90112
  s_add_u32 s97, s65, 16781312
  buffer_load_dwordx4 v1, s[36:39], s97 offen sc1 lds
  s_add_u32 m0, s63, 91136
  s_add_u32 s97, s65, 16782336
  buffer_load_dwordx4 v1, s[36:39], s97 offen sc1 lds
  s_add_u32 m0, s63, 92160
  s_add_u32 s97, s65, 16783360
  buffer_load_dwordx4 v1, s[36:39], s97 offen sc1 lds
  s_waitcnt vmcnt(0)
  s_branch Lvc_4
Lvr_8:
  s_add_u32 s53, s53, 1
  s_cmp_gt_u32 s53, 0x20000
  s_cbranch_scc1 Lvd_9
  s_add_u32 m0, s63, 86016
  s_add_u32 s97, s65, 16834560
  buffer_load_dwordx4 v1, s[36:39], s97 offen sc1 lds
  s_add_u32 m0, s63, 87040
  s_add_u32 s97, s65, 16835584
  buffer_load_dwordx4 v1, s[36:39], s97 offen sc1 lds
  s_add_u32 m0, s63, 88064
  s_add_u32 s97, s65, 16836608
  buffer_load_dwordx4 v1, s[36:39], s97 offen sc1 lds
  s_add_u32 m0, s63, 89088
  s_add_u32 s97, s65, 16837632
  buffer_load_dwordx4 v1, s[36:39], s97 offen sc1 lds
  s_add_u32 m0, s63, 90112
  s_add_u32 s97, s65, 16838656
  buffer_load_dwordx4 v1, s[36:39], s97 offen sc1 lds
  s_add_u32 m0, s63, 91136
  s_add_u32 s97, s65, 16839680
  buffer_load_dwordx4 v1, s[36:39], s97 offen sc1 lds
  s_add_u32 m0, s63, 92160
  s_add_u32 s97, s65, 16840704
  buffer_load_dwordx4 v1, s[36:39], s97 offen sc1 lds
  s_waitcnt vmcnt(0)
  s_branch Lvc_7
Lxi_10:
  s_add_u32 s53, s53, 1
  s_cmp_gt_u32 s53, 0x20000
  s_cbranch_scc1 Lxid_12
  s_sleep 8
  buffer_load_dwordx4 v[32:35], v1, s[36:39], s57 offen sc1
  s_waitcnt vmcnt(0)
  s_branch Lxc_11
Lre_14:
  s_add_u32 s53, s53, 1
  s_cmp_gt_u32 s53, 0x20000
  s_cbranch_scc1 Lgd_15
  buffer_load_dwordx4 v[184:187], v246, s[36:39], 0 offen offset:0 sc1
  buffer_load_dwordx4 v[188:191], v246, s[36:39], 0 offen offset:1024 sc1
  buffer_load_dwordx4 v[192:195], v246, s[36:39], 0 offen offset:2048 sc1
  buffer_load_dwordx4 v[196:199], v246, s[36:39], 0 offen offset:3072 sc1
  buffer_load_dwordx4 v[200:203], v246, s[36:39], s57 offen offset:0 sc1
  buffer_load_dwordx4 v[204:207], v246, s[36:39], s57 offen offset:1024 sc1
  buffer_load_dwordx4 v[208:211], v246, s[36:39], s57 offen offset:2048 sc1
  buffer_load_dwordx4 v[212:215], v246, s[36:39], s57 offen offset:3072 sc1
  s_waitcnt vmcnt(0)
  v_xor_b32 v252, v187, v253
  v_bitop3_b32 v252, v252, v191, v253 bitop3:0xf6
  v_bitop3_b32 v252, v252, v195, v253 bitop3:0xf6
  v_bitop3_b32 v252, v252, v199, v253 bitop3:0xf6
  v_bitop3_b32 v252, v252, v203, v253 bitop3:0xf6
  v_bitop3_b32 v252, v252, v207, v253 bitop3:0xf6
  v_bitop3_b32 v252, v252, v211, v253 bitop3:0xf6
  v_bitop3_b32 v252, v252, v215, v253 bitop3:0xf6
  v_cmp_ne_u32 vcc, 0, v252
  s_nop 1
  s_and_b64 vcc, vcc, s[80:81]
  s_cbranch_scc1 Lre_14
  s_branch Lchk_13
Lslow_20:
  buffer_load_dword v15, v12, s[36:39], s94 offen sc1
  s_add_u32 s53, s53, 1
  s_cmp_gt_u32 s53, 0x20000
  s_cbranch_scc1 Lback_21
  s_waitcnt vmcnt(0)
  v_subrev_u32 v15, s84, v15
  v_cmp_le_u32 vcc, 16, v15
  s_cbranch_vccnz Lslow_20
  s_branch Lback_21
Lslow_22:
  buffer_load_dword v15, v12, s[36:39], s95 offen sc1
  s_add_u32 s53, s53, 1
  s_cmp_gt_u32 s53, 0x20000
  s_cbranch_scc1 Lback_23
  s_waitcnt vmcnt(0)
  v_subrev_u32 v15, s84, v15
  v_cmp_le_u32 vcc, 16, v15
  s_cbranch_vccnz Lslow_22
  s_branch Lback_23
Lslow_24:
  buffer_load_dword v15, v12, s[36:39], s95 offen sc1
  s_add_u32 s53, s53, 1
  s_cmp_gt_u32 s53, 0x20000
  s_cbranch_scc1 Lback_25
  s_waitcnt vmcnt(0)
  v_subrev_u32 v15, s84, v15
  v_cmp_le_u32 vcc, 16, v15
  s_cbranch_vccnz Lslow_24
  s_branch Lback_25
Lre_29:
  s_add_u32 s53, s53, 1
  s_cmp_gt_u32 s53, 0x20000
  s_cbranch_scc1 Lgd_30
  buffer_load_dwordx4 v[184:187], v246, s[36:39], 0 offen offset:0 sc1
  buffer_load_dwordx4 v[188:191], v246, s[36:39], 0 offen offset:1024 sc1
  buffer_load_dwordx4 v[192:195], v246, s[36:39], 0 offen offset:2048 sc1
  buffer_load_dwordx4 v[196:199], v246, s[36:39], 0 offen offset:3072 sc1
  buffer_load_dwordx4 v[200:203], v246, s[36:39], s57 offen offset:0 sc1
  buffer_load_dwordx4 v[204:207], v246, s[36:39], s57 offen offset:1024 sc1
  buffer_load_dwordx4 v[208:211], v246, s[36:39], s57 offen offset:2048 sc1
  buffer_load_dwordx4 v[212:215], v246, s[36:39], s57 offen offset:3072 sc1
  s_waitcnt vmcnt(0)
  v_xor_b32 v252, v187, v253
  v_bitop3_b32 v252, v252, v191, v253 bitop3:0xf6
  v_bitop3_b32 v252, v252, v195, v253 bitop3:0xf6
  v_bitop3_b32 v252, v252, v199, v253 bitop3:0xf6
  v_bitop3_b32 v252, v252, v203, v253 bitop3:0xf6
  v_bitop3_b32 v252, v252, v207, v253 bitop3:0xf6
  v_bitop3_b32 v252, v252, v211, v253 bitop3:0xf6
  v_bitop3_b32 v252, v252, v215, v253 bitop3:0xf6
  v_cmp_ne_u32 vcc, 0, v252
  s_nop 1
  s_and_b64 vcc, vcc, s[80:81]
  s_cbranch_scc1 Lre_29
  s_branch Lchk_28
Lslow_36:
  buffer_load_dword v15, v12, s[36:39], s94 offen sc1
  s_add_u32 s53, s53, 1
  s_cmp_gt_u32 s53, 0x20000
  s_cbranch_scc1 Lback_37
  s_waitcnt vmcnt(0)
  v_subrev_u32 v15, s84, v15
  v_cmp_le_u32 vcc, 16, v15
  s_cbranch_vccnz Lslow_36
  s_branch Lback_37
Lslow_38:
  buffer_load_dword v15, v12, s[36:39], s95 offen sc1
  s_add_u32 s53, s53, 1
  s_cmp_gt_u32 s53, 0x20000
  s_cbranch_scc1 Lback_39
  s_waitcnt vmcnt(0)
  v_subrev_u32 v15, s84, v15
  v_cmp_le_u32 vcc, 16, v15
  s_cbranch_vccnz Lslow_38
  s_branch Lback_39
Lslow_40:
  buffer_load_dword v15, v12, s[36:39], s95 offen sc1
  s_add_u32 s53, s53, 1
  s_cmp_gt_u32 s53, 0x20000
  s_cbranch_scc1 Lback_41
  s_waitcnt vmcnt(0)
  v_subrev_u32 v15, s84, v15
  v_cmp_le_u32 vcc, 16, v15
  s_cbranch_vccnz Lslow_40
  s_branch Lback_41
L_fast_end:
L_slow:
  s_nop 7
  s_lshl_b32 s28, s45, 1
  s_add_u32 s28, s28, 0
  buffer_load_dwordx4 a[0:3], v7, s[40:43], s28 offen offset:0 sc1
  buffer_load_dwordx4 a[4:7], v3, s[40:43], s28 offen offset:0 sc1
  s_lshl_b32 s28, s45, 1
  s_add_u32 s28, s28, 0
  buffer_load_dwordx4 a[8:11], v7, s[40:43], s28 offen offset:1024 sc1
  buffer_load_dwordx4 a[12:15], v3, s[40:43], s28 offen offset:1024 sc1
  s_lshl_b32 s28, s45, 1
  s_add_u32 s28, s28, 4096
  buffer_load_dwordx4 a[16:19], v7, s[40:43], s28 offen offset:0 sc1
  buffer_load_dwordx4 a[20:23], v3, s[40:43], s28 offen offset:0 sc1
  v_add_u32 v2, 57344, v8
  v_and_b32 v250, 0x1f0, v1
  v_lshrrev_b32 v251, 6, v1
  v_and_b32 v251, 8, v251
  v_add3_u32 v250, v250, v251, s70
  v_lshlrev_b32 v251, 1, v251
  v_bfe_u32 v252, v1, 4, 3
  v_lshl_add_u32 v251, v252, 6, v251
  v_bfe_u32 v252, v1, 7, 2
  v_mul_u32_u24 v252, 5120, v252
  v_add_u32 v252, 147456, v252
  v_add_u32 v251, v251, v252
  s_lshl_b32 s78, s7, 2
  s_lshr_b32 s79, s6, 2
  s_add_u32 s78, s78, s79
  s_mul_i32 s78, s78, 28672
  s_and_b32 s79, s6, 3
  s_lshl_b32 s79, s79, 11
  s_add_u32 s78, s78, s79
  s_add_u32 s78, s78, 59789312
  s_mov_b32 s79, 0x3fb8aa3b
  v_mov_b32 v254, 0x35c1a2a0
  v_mov_b32 v253, s88
  s_mov_b32 s80, 0x88888888
  s_mov_b32 s81, 0x88888888
  s_movk_i32 s82, 0x3f80
  s_mov_b32 s83, 0x3f800000
Lchk_43:
  s_waitcnt vmcnt(20)
  v_xor_b32 v252, v187, v253
  v_lshlrev_b32 v24, 16, v184
  v_and_b32 v25, 0xffff0000, v184
  v_lshlrev_b32 v26, 16, v185
  v_and_b32 v27, 0xffff0000, v185
  v_lshlrev_b32 v28, 16, v186
  v_and_b32 v29, 0xffff0000, v186
  v_lshlrev_b32 v30, 16, v187
  v_and_b32 v31, 0xffff0000, v187
  s_waitcnt vmcnt(19)
  v_bitop3_b32 v252, v252, v191, v253 bitop3:0xf6
  v_dot2c_f32_bf16 v24, s82, v188
  v_dot2c_f32_bf16 v25, s83, v188
  v_dot2c_f32_bf16 v26, s82, v189
  v_dot2c_f32_bf16 v27, s83, v189
  v_dot2c_f32_bf16 v28, s82, v190
  v_dot2c_f32_bf16 v29, s83, v190
  v_dot2c_f32_bf16 v30, s82, v191
  v_dot2c_f32_bf16 v31, s83, v191
  s_waitcnt vmcnt(18)
  v_bitop3_b32 v252, v252, v195, v253 bitop3:0xf6
  v_dot2c_f32_bf16 v24, s82, v192
  v_dot2c_f32_bf16 v25, s83, v192
  v_dot2c_f32_bf16 v26, s82, v193
  v_dot2c_f32_bf16 v27, s83, v193
  v_dot2c_f32_bf16 v28, s82, v194
  v_dot2c_f32_bf16 v29, s83, v194
  v_dot2c_f32_bf16 v30, s82, v195
  v_dot2c_f32_bf16 v31, s83, v195
  s_waitcnt vmcnt(17)
  v_bitop3_b32 v252, v252, v199, v253 bitop3:0xf6
  v_dot2c_f32_bf16 v24, s82, v196
  v_dot2c_f32_bf16 v25, s83, v196
  v_dot2c_f32_bf16 v26, s82, v197
  v_dot2c_f32_bf16 v27, s83, v197
  v_dot2c_f32_bf16 v28, s82, v198
  v_dot2c_f32_bf16 v29, s83, v198
  v_dot2c_f32_bf16 v30, s82, v199
  v_dot2c_f32_bf16 v31, s83, v199
  s_waitcnt vmcnt(16)
  v_bitop3_b32 v252, v252, v203, v253 bitop3:0xf6
  v_dot2c_f32_bf16 v24, s82, v200
  v_dot2c_f32_bf16 v25, s83, v200
  v_dot2c_f32_bf16 v26, s82, v201
  v_dot2c_f32_bf16 v27, s83, v201
  v_dot2c_f32_bf16 v28, s82, v202
  v_dot2c_f32_bf16 v29, s83, v202
  v_dot2c_f32_bf16 v30, s82, v203
  v_dot2c_f32_bf16 v31, s83, v203
  s_waitcnt vmcnt(15)
  v_bitop3_b32 v252, v252, v207, v253 bitop3:0xf6
  v_dot2c_f32_bf16 v24, s82, v204
  v_dot2c_f32_bf16 v25, s83, v204
  v_dot2c_f32_bf16 v26, s82, v205
  v_dot2c_f32_bf16 v27, s83, v205
  v_dot2c_f32_bf16 v28, s82, v206
  v_dot2c_f32_bf16 v29, s83, v206
  v_dot2c_f32_bf16 v30, s82, v207
  v_dot2c_f32_bf16 v31, s83, v207
  s_waitcnt vmcnt(14)
  v_bitop3_b32 v252, v252, v211, v253 bitop3:0xf6
  v_dot2c_f32_bf16 v24, s82, v208
  v_dot2c_f32_bf16 v25, s83, v208
  v_dot2c_f32_bf16 v26, s82, v209
  v_dot2c_f32_bf16 v27, s83, v209
  v_dot2c_f32_bf16 v28, s82, v210
  v_dot2c_f32_bf16 v29, s83, v210
  v_dot2c_f32_bf16 v30, s82, v211
  v_dot2c_f32_bf16 v31, s83, v211
  s_waitcnt vmcnt(13)
  v_bitop3_b32 v252, v252, v215, v253 bitop3:0xf6
  v_dot2c_f32_bf16 v24, s82, v212
  v_dot2c_f32_bf16 v25, s83, v212
  v_dot2c_f32_bf16 v26, s82, v213
  v_dot2c_f32_bf16 v27, s83, v213
  v_dot2c_f32_bf16 v28, s82, v214
  v_dot2c_f32_bf16 v29, s83, v214
  v_dot2c_f32_bf16 v30, s82, v215
  v_dot2c_f32_bf16 v31, s83, v215
  v_cmp_ne_u32 vcc, 0, v252
  s_nop 0
  s_and_b64 vcc, vcc, s[80:81]
  s_cbranch_scc1 Lre_44
Lgd_45:
  s_mov_b32 s80, 0
  v_permlane32_swap_b32 v24, v28
  v_permlane32_swap_b32 v25, v29
  v_permlane32_swap_b32 v26, v30
  v_permlane32_swap_b32 v27, v31
  v_pk_add_f32 v[24:25], v[24:25], v[28:29]
  v_pk_add_f32 v[26:27], v[26:27], v[30:31]
  v_cvt_pk_bf16_f32 v24, v24, v25
  v_cvt_pk_bf16_f32 v25, v26, v27
  v_cndmask_b32 v25, v25, 0, s[80:81]
  ds_write_b64 v250, v[24:25] offset:4096
  s_waitcnt lgkmcnt(0)
  s_barrier
  ds_read_b128 v[216:219], v251
  ds_read_b128 v[220:223], v251 offset:32
  s_waitcnt lgkmcnt(1)
  v_mfma_f32_32x32x16_bf16 v[184:199], v[216:219], v[168:171], 0
  s_waitcnt lgkmcnt(0)
  v_mfma_f32_32x32x16_bf16 v[184:199], v[220:223], v[172:175], v[184:199]
  s_nop 11
  v_mov_b32 v252, v196
  v_mov_b32 v253, v196
  s_nop 1
  v_permlane32_swap_b32 v253, v252
  v_fma_f32 v252, v252, s79, v254
  v_rcp_f32 v252, v252
  s_nop 0
  v_cndmask_b32 v254, v252, 0, s[48:49]
  v_pk_mul_f32 v[184:185], v[184:185], v[252:253] op_sel_hi:[1,0]
  v_pk_mul_f32 v[186:187], v[186:187], v[252:253] op_sel_hi:[1,0]
  v_pk_mul_f32 v[188:189], v[188:189], v[252:253] op_sel_hi:[1,0]
  v_pk_mul_f32 v[190:191], v[190:191], v[252:253] op_sel_hi:[1,0]
  v_pk_mul_f32 v[192:193], v[192:193], v[252:253] op_sel_hi:[1,0]
  v_pk_mul_f32 v[194:195], v[194:195], v[252:253] op_sel_hi:[1,0]
  v_pk_mul_f32 v[196:197], v[196:197], v[254:255] op_sel_hi:[1,0]
  v_pk_mul_f32 v[198:199], v[198:199], v[254:255] op_sel_hi:[1,0]
  v_cvt_pk_bf16_f32 v184, v184, v185
  v_cvt_pk_bf16_f32 v185, v186, v187
  v_cvt_pk_bf16_f32 v186, v188, v189
  v_cvt_pk_bf16_f32 v187, v190, v191
  buffer_store_dwordx4 v[184:187], v1, s[36:39], s78 offen sc1
  v_cvt_pk_bf16_f32 v188, v192, v193
  v_cvt_pk_bf16_f32 v189, v194, v195
  v_cvt_pk_bf16_f32 v190, v196, v197
  v_cvt_pk_bf16_f32 v191, v198, v199
  buffer_store_dwordx4 v[188:191], v1, s[36:39], s78 offen offset:1024 sc1
  s_lshr_b32 s99, s5, 1
  s_mul_i32 s99, s99, 28672
  s_add_u32 s99, s99, s63
  v_lshlrev_b32 v168, 16, v16
  v_and_b32 v169, 0xffff0000, v16
  v_lshlrev_b32 v170, 16, v17
  v_and_b32 v171, 0xffff0000, v17
  v_lshlrev_b32 v172, 16, v18
  v_and_b32 v173, 0xffff0000, v18
  v_lshlrev_b32 v174, 16, v19
  v_and_b32 v175, 0xffff0000, v19
  v_lshlrev_b32 v176, 16, v20
  v_and_b32 v177, 0xffff0000, v20
  v_lshlrev_b32 v178, 16, v21
  v_and_b32 v179, 0xffff0000, v21
  v_lshlrev_b32 v180, 16, v22
  v_and_b32 v181, 0xffff0000, v22
  v_lshlrev_b32 v182, 16, v23
  v_and_b32 v183, 0xffff0000, v23
  s_waitcnt vmcnt(8)
  ds_read_b64_tr_b16 v[88:89], v248 offset:28672
  ds_read_b64_tr_b16 v[90:91], v248 offset:28928
  ds_read_b64_tr_b16 v[92:93], v248 offset:29184
  ds_read_b64_tr_b16 v[94:95], v248 offset:29440
  ds_read_b64_tr_b16 v[96:97], v248 offset:30720
  ds_read_b64_tr_b16 v[98:99], v249 offset:30976
  ds_read_b64_tr_b16 v[100:101], v248 offset:31232
  ds_read_b64_tr_b16 v[102:103], v249 offset:31488
  ds_read_b64_tr_b16 v[104:105], v248 offset:32000
  ds_read_b64_tr_b16 v[106:107], v248 offset:32768
  ds_read_b64_tr_b16 v[108:109], v248 offset:32512
  ds_read_b64_tr_b16 v[110:111], v248 offset:33280
  ds_read_b64_tr_b16 v[112:113], v248 offset:34048
  ds_read_b64_tr_b16 v[114:115], v249 offset:34816
  ds_read_b64_tr_b16 v[116:117], v248 offset:34560
  ds_read_b64_tr_b16 v[118:119], v249 offset:35328
  s_waitcnt lgkmcnt(0)
  v_add_u32 v248, s63, v8
  v_add_u32 v249, s63, v1
  ds_read_b64_tr_b16 v[216:217], v248 offset:0
  ds_read_b64_tr_b16 v[218:219], v248 offset:256
  ds_read_b64_tr_b16 v[220:221], v248 offset:1024
  ds_read_b64_tr_b16 v[222:223], v248 offset:1280
  ds_read_b64_tr_b16 v[224:225], v248 offset:2048
  ds_read_b64_tr_b16 v[226:227], v248 offset:2304
  s_waitcnt lgkmcnt(4)
  v_mfma_f32_32x32x16_bf16 v[56:71], a[236:239], v[216:219], 0
  ds_read_b64_tr_b16 v[228:229], v248 offset:3072
  ds_read_b64_tr_b16 v[230:231], v248 offset:3328
  s_waitcnt lgkmcnt(4)
  v_mfma_f32_32x32x16_bf16 v[56:71], a[236:239], v[220:223], v[56:71]
  ds_read_b64_tr_b16 v[232:233], v248 offset:4096
  ds_read_b64_tr_b16 v[234:235], v248 offset:4352
  s_waitcnt lgkmcnt(4)
  v_mfma_f32_32x32x16_bf16 v[56:71], a[236:239], v[224:227], v[56:71]
  ds_read_b64_tr_b16 v[236:237], v248 offset:5120
  ds_read_b64_tr_b16 v[238:239], v248 offset:5376
  s_waitcnt lgkmcnt(4)
  v_mfma_f32_32x32x16_bf16 v[56:71], a[236:239], v[228:231], v[56:71]
  ds_read_b64_tr_b16 v[216:217], v248 offset:6144
  ds_read_b64_tr_b16 v[218:219], v248 offset:6400
  s_waitcnt lgkmcnt(4)
  v_mfma_f32_32x32x16_bf16 v[56:71], a[236:239], v[232:235], v[56:71]
  ds_read_b64_tr_b16 v[220:221], v248 offset:28672
  ds_read_b64_tr_b16 v[222:223], v248 offset:28928
  s_waitcnt lgkmcnt(4)
  v_mfma_f32_32x32x16_bf16 v[56:71], a[236:239], v[236:239], v[56:71]
  ds_read_b64_tr_b16 v[224:225], v248 offset:29696
  ds_read_b64_tr_b16 v[226:227], v248 offset:29952
  s_waitcnt lgkmcnt(4)
  v_mfma_f32_32x32x16_bf16 v[56:71], a[236:239], v[216:219], v[56:71]
  ds_read_b64_tr_b16 v[228:229], v248 offset:30720
  ds_read_b64_tr_b16 v[230:231], v248 offset:30976
  s_waitcnt lgkmcnt(4)
  v_mfma_f32_32x32x16_bf16 v[200:215], a[236:239], v[220:223], 0
  ds_read_b64_tr_b16 v[232:233], v248 offset:31744
  ds_read_b64_tr_b16 v[234:235], v248 offset:32000
  s_waitcnt lgkmcnt(4)
  v_mfma_f32_32x32x16_bf16 v[200:215], a[236:239], v[224:227], v[200:215]
  ds_read_b64_tr_b16 v[236:237], v248 offset:32768
  ds_read_b64_tr_b16 v[238:239], v248 offset:33024
  s_waitcnt lgkmcnt(4)
  v_mfma_f32_32x32x16_bf16 v[200:215], a[236:239], v[228:231], v[200:215]
  ds_read_b64_tr_b16 v[216:217], v248 offset:33792
  ds_read_b64_tr_b16 v[218:219], v248 offset:34048
  s_waitcnt lgkmcnt(4)
  v_mfma_f32_32x32x16_bf16 v[200:215], a[236:239], v[232:235], v[200:215]
  ds_read_b64_tr_b16 v[220:221], v248 offset:34816
  ds_read_b64_tr_b16 v[222:223], v248 offset:35072
  s_waitcnt lgkmcnt(4)
  v_mfma_f32_32x32x16_bf16 v[200:215], a[236:239], v[236:239], v[200:215]
  ds_read_b64_tr_b16 v[224:225], v248 offset:57344
  ds_read_b64_tr_b16 v[226:227], v248 offset:57600
  s_waitcnt lgkmcnt(4)
  v_mfma_f32_32x32x16_bf16 v[200:215], a[236:239], v[216:219], v[200:215]
  ds_read_b64_tr_b16 v[228:229], v248 offset:58368
  ds_read_b64_tr_b16 v[230:231], v248 offset:58624
  s_waitcnt lgkmcnt(4)
  v_mfma_f32_32x32x16_bf16 v[200:215], a[236:239], v[220:223], v[200:215]
  ds_read_b64_tr_b16 v[232:233], v248 offset:59392
  ds_read_b64_tr_b16 v[234:235], v248 offset:59648
  s_waitcnt lgkmcnt(4)
  v_mfma_f32_32x32x16_bf16 v[120:135], a[236:239], v[224:227], 0
  ds_read_b64_tr_b16 v[236:237], v248 offset:60416
  ds_read_b64_tr_b16 v[238:239], v248 offset:60672
  s_waitcnt lgkmcnt(4)
  v_mfma_f32_32x32x16_bf16 v[120:135], a[236:239], v[228:231], v[120:135]
  ds_read_b64_tr_b16 v[216:217], v248 offset:61440
  ds_read_b64_tr_b16 v[218:219], v248 offset:61696
  s_waitcnt lgkmcnt(4)
  v_mfma_f32_32x32x16_bf16 v[120:135], a[236:239], v[232:235], v[120:135]
  ds_read_b64_tr_b16 v[220:221], v248 offset:62464
  ds_read_b64_tr_b16 v[222:223], v248 offset:62720
  s_waitcnt lgkmcnt(4)
  v_mfma_f32_32x32x16_bf16 v[120:135], a[236:239], v[236:239], v[120:135]
  ds_read_b64_tr_b16 v[224:225], v248 offset:63488
  ds_read_b64_tr_b16 v[226:227], v248 offset:63744
  s_waitcnt lgkmcnt(4)
  v_mfma_f32_32x32x16_bf16 v[120:135], a[236:239], v[216:219], v[120:135]
  s_waitcnt lgkmcnt(2)
  v_mfma_f32_32x32x16_bf16 v[120:135], a[236:239], v[220:223], v[120:135]
  s_waitcnt lgkmcnt(0)
  v_mfma_f32_32x32x16_bf16 v[120:135], a[236:239], v[224:227], v[120:135]
  s_waitcnt vmcnt(0)
  s_add_u32 s79, s52, 1
  v_mov_b32 v252, s79
  buffer_store_dword v252, v4, s[36:39], s72 offen sc1
  s_add_u32 m0, s63, 86016
  s_add_u32 s97, s99, 524288
  buffer_load_dwordx4 v1, s[36:39], s97 offen sc1 lds
  s_add_u32 m0, s63, 87040
  s_add_u32 s97, s99, 525312
  buffer_load_dwordx4 v1, s[36:39], s97 offen sc1 lds
  s_add_u32 m0, s63, 88064
  s_add_u32 s97, s99, 526336
  buffer_load_dwordx4 v1, s[36:39], s97 offen sc1 lds
  s_add_u32 m0, s63, 89088
  s_add_u32 s97, s99, 527360
  buffer_load_dwordx4 v1, s[36:39], s97 offen sc1 lds
  s_add_u32 m0, s63, 90112
  s_add_u32 s97, s99, 528384
  buffer_load_dwordx4 v1, s[36:39], s97 offen sc1 lds
  s_add_u32 m0, s63, 91136
  s_add_u32 s97, s99, 529408
  buffer_load_dwordx4 v1, s[36:39], s97 offen sc1 lds
  s_add_u32 m0, s63, 92160
  s_add_u32 s97, s99, 530432
  buffer_load_dwordx4 v1, s[36:39], s97 offen sc1 lds
  v_lshrrev_b32 v253, 2, v1
  v_and_b32 v253, 0x7c, v253
  v_add_u32 v253, s70, v253
  ds_write_b32 v253, v56 offset:0
  ds_write_b32 v253, v200 offset:128
  ds_write_b32 v253, v120 offset:256
  s_waitcnt lgkmcnt(0)
  s_barrier
  s_xor_b32 s78, s76, 0
  s_mul_i32 s78, s78, 114688
  s_mul_i32 s79, s3, 28672
  s_add_u32 s78, s78, s79
  s_add_u32 s78, s78, 59789312
  v_add_u32 v246, s78, v1
  s_xor_b32 s78, s76, 1
  s_mul_i32 s78, s78, 114688
  s_mul_i32 s79, s3, 28672
  s_add_u32 s78, s78, s79
  s_add_u32 s78, s78, 59789312
  v_add_u32 v247, s78, v1
  v_add_u32 v250, s64, v1
  s_xor_b32 s82, s3, 1
  s_mul_i32 s82, s82, 12288
  s_add_u32 s82, s82, 114688
  v_add_u32 v251, s82, v1
  s_xor_b32 s82, s3, 2
  s_mul_i32 s82, s82, 12288
  s_add_u32 s82, s82, 118784
  v_add_u32 v252, s82, v1
  s_xor_b32 s82, s3, 3
  s_mul_i32 s82, s82, 12288
  s_add_u32 s82, s82, 122880
  v_add_u32 v253, s82, v1
  s_lshl_b32 s80, s76, 15
  s_add_u32 s80, s80, 5242880
  s_lshl_b32 s79, s77, 11
  s_add_u32 s78, s80, s79
  s_lshl_b32 s79, s55, 9
  s_add_u32 s79, s79, s80
  s_and_b32 s80, s3, 1
  s_lshl_b32 s80, s80, 3
  s_add_u32 s79, s79, s80
  s_add_u32 s79, s79, 28672
  s_lshl_b32 s80, s76, 7
  s_lshl_b32 s82, s77, 2
  s_add_u32 s80, s80, s82
  s_add_u32 s80, s80, 24576
  s_add_u32 s81, s73, 8192
  s_add_u32 s84, s52, 1
Lpoll_46:
  buffer_load_dword v15, v12, s[36:39], s81 offen sc1
  s_add_u32 s53, s53, 1
  s_cmp_gt_u32 s53, 0x20000
  s_cbranch_scc1 Lpd_47
  s_waitcnt vmcnt(0)
  v_subrev_u32 v15, s84, v15
  v_cmp_le_u32 vcc, 16, v15
  s_cbranch_vccnz Lpoll_46
Lpd_47:
  buffer_load_dwordx4 v[28:31], v247, s[40:43], 0 offen offset:0 sc1
  buffer_load_dwordx4 v[36:39], v247, s[40:43], 0 offen offset:1024 sc1
  buffer_load_dwordx4 v[44:47], v247, s[40:43], 0 offen offset:2048 sc1
  buffer_load_dwordx4 v[52:55], v247, s[40:43], 0 offen offset:3072 sc1
  buffer_load_dwordx4 v[60:63], v247, s[40:43], s57 offen offset:0 sc1
  buffer_load_dwordx4 v[68:71], v247, s[40:43], s57 offen offset:1024 sc1
  buffer_load_dwordx4 v[76:79], v247, s[40:43], s57 offen offset:2048 sc1
  s_waitcnt vmcnt(6)
  v_mfma_f32_32x32x16_bf16 v[200:215], v[136:139], v[28:31], 0
  buffer_load_dwordx4 v[84:87], v247, s[40:43], s57 offen offset:3072 sc1
  v_lshrrev_b32 v248, 2, v1
  v_and_b32 v248, 0x7c, v248
  v_add_u32 v248, 143360, v248
  ds_read_b32 v120, v248 offset:0
  v_mfma_f32_32x32x16_bf16 v[216:231], v[140:143], v[28:31], 0
  ds_read_b32 v121, v248 offset:5120
  ds_read_b32 v122, v248 offset:10240
  ds_read_b32 v123, v248 offset:15360
  ds_read_b32 v124, v248 offset:128
  ds_read_b32 v125, v248 offset:5248
  s_waitcnt vmcnt(6)
  v_mfma_f32_32x32x16_bf16 v[200:215], v[144:147], v[36:39], v[200:215]
  buffer_load_dwordx4 v[24:27], v246, s[40:43], 0 offen offset:0 sc1
  ds_read_b32 v126, v248 offset:10368
  ds_read_b32 v127, v248 offset:15488
  ds_read_b32 v128, v248 offset:256
  ds_read_b32 v129, v248 offset:5376
  v_mfma_f32_32x32x16_bf16 v[216:231], v[148:151], v[36:39], v[216:231]
  ds_read_b32 v130, v248 offset:10496
  ds_read_b32 v131, v248 offset:15616
  s_waitcnt vmcnt(6)
  v_mfma_f32_32x32x16_bf16 v[200:215], v[152:155], v[44:47], v[200:215]
  buffer_load_dwordx4 v[32:35], v246, s[40:43], 0 offen offset:1024 sc1
  v_mfma_f32_32x32x16_bf16 v[216:231], v[156:159], v[44:47], v[216:231]
  s_waitcnt lgkmcnt(0)
  v_add_f32 v120, v120, v121
  v_add_f32 v122, v122, v123
  v_add_f32 v124, v124, v125
  v_add_f32 v126, v126, v127
  s_waitcnt vmcnt(6)
  v_mfma_f32_32x32x16_bf16 v[200:215], v[160:163], v[52:55], v[200:215]
  buffer_load_dwordx4 v[40:43], v246, s[40:43], 0 offen offset:2048 sc1
  v_add_f32 v128, v128, v129
  v_add_f32 v130, v130, v131
  v_add_f32 v120, v120, v122
  v_add_f32 v124, v124, v126
  v_mfma_f32_32x32x16_bf16 v[216:231], v[164:167], v[52:55], v[216:231]
  v_add_f32 v128, v128, v130
  v_cvt_pk_bf16_f32 v121, v120, v120
  v_cvt_pk_bf16_f32 v125, v124, v124
  v_cvt_pk_bf16_f32 v129, v128, v128
  v_lshlrev_b32 v121, 16, v121
  s_waitcnt vmcnt(6)
  v_mfma_f32_32x32x16_bf16 v[200:215], v[88:91], v[60:63], v[200:215]
  buffer_load_dwordx4 v[48:51], v246, s[40:43], 0 offen offset:3072 sc1
  v_lshlrev_b32 v125, 16, v125
  v_lshlrev_b32 v129, 16, v129
  v_sub_f32 v121, v120, v121
  v_sub_f32 v125, v124, v125
  v_mfma_f32_32x32x16_bf16 v[216:231], v[92:95], v[60:63], v[216:231]
  v_sub_f32 v129, v128, v129
  v_cvt_pk_bf16_f32 v120, v120, v121
  v_cvt_pk_bf16_f32 v124, v124, v125
  v_cvt_pk_bf16_f32 v128, v128, v129
  v_accvgpr_write_b32 a224, v120
  s_waitcnt vmcnt(6)
  v_mfma_f32_32x32x16_bf16 v[200:215], v[96:99], v[68:71], v[200:215]
  buffer_load_dwordx4 v[56:59], v246, s[40:43], s57 offen offset:0 sc1
  v_accvgpr_write_b32 a226, v124
  v_accvgpr_write_b32 a228, v128
  v_mfma_f32_32x32x16_bf16 v[216:231], v[100:103], v[68:71], v[216:231]
  s_waitcnt vmcnt(6)
  v_mfma_f32_32x32x16_bf16 v[200:215], v[104:107], v[76:79], v[200:215]
  buffer_load_dwordx4 v[64:67], v246, s[40:43], s57 offen offset:1024 sc1
  v_mfma_f32_32x32x16_bf16 v[216:231], v[108:111], v[76:79], v[216:231]
  s_waitcnt vmcnt(6)
  v_mfma_f32_32x32x16_bf16 v[200:215], v[112:115], v[84:87], v[200:215]
  buffer_load_dwordx4 v[72:75], v246, s[40:43], s57 offen offset:2048 sc1
  v_mfma_f32_32x32x16_bf16 v[216:231], v[116:119], v[84:87], v[216:231]
  s_waitcnt vmcnt(6)
  v_mfma_f32_32x32x16_bf16 v[168:183], v[136:139], v[24:27], v[168:183]
  buffer_load_dwordx4 v[80:83], v246, s[40:43], s57 offen offset:3072 sc1
  s_barrier
  v_mfma_f32_32x32x16_bf16 v[184:199], v[140:143], v[24:27], 0
  s_waitcnt vmcnt(6)
  v_mfma_f32_32x32x16_bf16 v[168:183], v[144:147], v[32:35], v[168:183]
  s_lshl_b32 s28, s45, 1
  s_add_u32 s28, s28, 4096
  buffer_load_dwordx4 a[24:27], v7, s[40:43], s28 offen offset:1024 sc1
  ds_write_b128 v250, v[200:203] offset:4096
  v_mfma_f32_32x32x16_bf16 v[184:199], v[148:151], v[32:35], v[184:199]
  buffer_load_dwordx4 a[28:31], v3, s[40:43], s28 offen offset:1024 sc1
  ds_write_b128 v250, v[204:207] offset:5120
  s_waitcnt vmcnt(7)
  v_mfma_f32_32x32x16_bf16 v[168:183], v[152:155], v[40:43], v[168:183]
  s_lshl_b32 s28, s45, 1
  s_add_u32 s28, s28, 8192
  buffer_load_dwordx4 a[32:35], v7, s[40:43], s28 offen offset:0 sc1
  ds_write_b128 v250, v[208:211] offset:6144
  v_mfma_f32_32x32x16_bf16 v[184:199], v[156:159], v[40:43], v[184:199]
  buffer_load_dwordx4 a[36:39], v3, s[40:43], s28 offen offset:0 sc1
  ds_write_b128 v250, v[212:215] offset:7168
  s_waitcnt vmcnt(8)
  v_mfma_f32_32x32x16_bf16 v[168:183], v[160:163], v[48:51], v[168:183]
  s_lshl_b32 s28, s45, 1
  s_add_u32 s28, s28, 8192
  buffer_load_dwordx4 a[40:43], v7, s[40:43], s28 offen offset:1024 sc1
  v_mfma_f32_32x32x16_bf16 v[184:199], v[164:167], v[48:51], v[184:199]
  buffer_load_dwordx4 a[44:47], v3, s[40:43], s28 offen offset:1024 sc1
  s_waitcnt vmcnt(9)
  v_mfma_f32_32x32x16_bf16 v[168:183], v[88:91], v[56:59], v[168:183]
  s_lshl_b32 s28, s45, 1
  s_add_u32 s28, s28, 12288
  buffer_load_dwordx4 a[48:51], v7, s[40:43], s28 offen offset:0 sc1
  ds_write_b128 v250, v[216:219] offset:8192
  v_mfma_f32_32x32x16_bf16 v[184:199], v[92:95], v[56:59], v[184:199]
  buffer_load_dwordx4 a[52:55], v3, s[40:43], s28 offen offset:0 sc1
  ds_write_b128 v250, v[220:223] offset:9216
  s_waitcnt vmcnt(10)
  v_mfma_f32_32x32x16_bf16 v[184:199], v[100:103], v[64:67], v[184:199]
  ds_write_b128 v250, v[224:227] offset:10240
  s_waitcnt vmcnt(9)
  v_mfma_f32_32x32x16_bf16 v[184:199], v[108:111], v[72:75], v[184:199]
  ds_write_b128 v250, v[228:231] offset:11264
  s_waitcnt vmcnt(8)
  v_mfma_f32_32x32x16_bf16 v[184:199], v[116:119], v[80:83], v[184:199]
  v_mfma_f32_32x32x16_bf16 v[168:183], v[96:99], v[64:67], v[168:183]
  v_mfma_f32_32x32x16_bf16 v[168:183], v[104:107], v[72:75], v[168:183]
  ds_write_b128 v250, v[184:187] offset:0
  v_mfma_f32_32x32x16_bf16 v[168:183], v[112:115], v[80:83], v[168:183]
  ds_write_b128 v250, v[188:191] offset:1024
  ds_write_b128 v250, v[192:195] offset:2048
  ds_write_b128 v250, v[196:199] offset:3072
  s_waitcnt lgkmcnt(0)
  s_barrier
  ds_read_b128 v[184:187], v251 offset:0
  ds_read_b128 v[200:203], v252 offset:0
  ds_read_b128 v[216:219], v253 offset:0
  ds_read_b128 v[188:191], v251 offset:1024
  ds_read_b128 v[204:207], v252 offset:1024
  ds_read_b128 v[220:223], v253 offset:1024
  ds_read_b128 v[192:195], v251 offset:2048
  ds_read_b128 v[208:211], v252 offset:2048
  ds_read_b128 v[224:227], v253 offset:2048
  ds_read_b128 v[196:199], v251 offset:3072
  ds_read_b128 v[212:215], v252 offset:3072
  ds_read_b128 v[228:231], v253 offset:3072
  v_mov_b32 v254, 0
  v_mov_b32 v255, 0
  s_waitcnt lgkmcnt(9)
  v_pk_add_f32 v[168:169], v[168:169], v[184:185]
  v_pk_add_f32 v[200:201], v[200:201], v[216:217]
  v_pk_add_f32 v[170:171], v[170:171], v[186:187]
  v_pk_add_f32 v[202:203], v[202:203], v[218:219]
  v_pk_add_f32 v[168:169], v[168:169], v[200:201]
  v_pk_add_f32 v[170:171], v[170:171], v[202:203]
  v_cvt_pk_bf16_f32 v16, v168, v169
  v_cvt_pk_bf16_f32 v17, v170, v171
  v_dot2c_f32_bf16 v254, s75, v16
  v_dot2c_f32_bf16 v255, v16, v16
  v_dot2c_f32_bf16 v254, s75, v17
  v_dot2c_f32_bf16 v255, v17, v17
  s_waitcnt lgkmcnt(6)
  v_pk_add_f32 v[172:173], v[172:173], v[188:189]
  v_pk_add_f32 v[204:205], v[204:205], v[220:221]
  v_pk_add_f32 v[174:175], v[174:175], v[190:191]
  v_pk_add_f32 v[206:207], v[206:207], v[222:223]
  v_pk_add_f32 v[172:173], v[172:173], v[204:205]
  v_pk_add_f32 v[174:175], v[174:175], v[206:207]
  v_cvt_pk_bf16_f32 v18, v172, v173
  v_cvt_pk_bf16_f32 v19, v174, v175
  buffer_store_dwordx4 v[16:19], v1, s[40:43], s78 offen offset:0 sc1
  v_dot2c_f32_bf16 v254, s75, v18
  v_dot2c_f32_bf16 v255, v18, v18
  v_dot2c_f32_bf16 v254, s75, v19
  v_dot2c_f32_bf16 v255, v19, v19
  s_waitcnt lgkmcnt(3)
  v_pk_add_f32 v[176:177], v[176:177], v[192:193]
  v_pk_add_f32 v[208:209], v[208:209], v[224:225]
  v_pk_add_f32 v[178:179], v[178:179], v[194:195]
  v_pk_add_f32 v[210:211], v[210:211], v[226:227]
  v_pk_add_f32 v[176:177], v[176:177], v[208:209]
  v_pk_add_f32 v[178:179], v[178:179], v[210:211]
  v_cvt_pk_bf16_f32 v20, v176, v177
  v_cvt_pk_bf16_f32 v21, v178, v179
  v_dot2c_f32_bf16 v254, s75, v20
  v_dot2c_f32_bf16 v255, v20, v20
  v_dot2c_f32_bf16 v254, s75, v21
  v_dot2c_f32_bf16 v255, v21, v21
  s_waitcnt lgkmcnt(0)
  v_pk_add_f32 v[180:181], v[180:181], v[196:197]
  v_pk_add_f32 v[212:213], v[212:213], v[228:229]
  v_pk_add_f32 v[182:183], v[182:183], v[198:199]
  v_pk_add_f32 v[214:215], v[214:215], v[230:231]
  v_pk_add_f32 v[180:181], v[180:181], v[212:213]
  v_pk_add_f32 v[182:183], v[182:183], v[214:215]
  v_cvt_pk_bf16_f32 v22, v180, v181
  v_cvt_pk_bf16_f32 v23, v182, v183
  buffer_store_dwordx4 v[20:23], v1, s[40:43], s78 offen offset:1024 sc1
  v_dot2c_f32_bf16 v254, s75, v22
  v_dot2c_f32_bf16 v255, v22, v22
  v_dot2c_f32_bf16 v254, s75, v23
  v_dot2c_f32_bf16 v255, v23, v23
  s_nop 2
  v_permlane32_swap_b32 v254, v255
  v_add_f32 v254, v254, v255
  buffer_store_dword v254, v11, s[40:43], s79 offen sc1
  s_waitcnt vmcnt(0)
  s_add_u32 s81, s52, 1
  v_mov_b32 v255, s81
  buffer_store_dword v255, v4, s[40:43], s80 offen sc1
  v_add_u32 v248, s63, v10
  ds_read_b128 v[216:219], v248 offset:0
  ds_read_b128 v[220:223], v248 offset:1024
  ds_read_b128 v[224:227], v248 offset:2048
  s_waitcnt lgkmcnt(2)
  v_mfma_f32_32x32x16_bf16 v[184:199], a[236:239], v[216:219], 0
  ds_read_b128 v[228:231], v248 offset:3072
  s_waitcnt lgkmcnt(2)
  v_mfma_f32_32x32x16_bf16 v[184:199], a[236:239], v[220:223], v[184:199]
  ds_read_b128 v[232:235], v248 offset:4096
  s_waitcnt lgkmcnt(2)
  v_mfma_f32_32x32x16_bf16 v[184:199], a[236:239], v[224:227], v[184:199]
  ds_read_b128 v[236:239], v248 offset:5120
  s_waitcnt lgkmcnt(2)
  v_mfma_f32_32x32x16_bf16 v[184:199], a[236:239], v[228:231], v[184:199]
  ds_read_b128 v[216:219], v248 offset:6144
  s_waitcnt lgkmcnt(2)
  v_mfma_f32_32x32x16_bf16 v[184:199], a[236:239], v[232:235], v[184:199]
  s_waitcnt lgkmcnt(1)
  v_mfma_f32_32x32x16_bf16 v[184:199], a[236:239], v[236:239], v[184:199]
  s_waitcnt lgkmcnt(0)
  v_mfma_f32_32x32x16_bf16 v[184:199], a[236:239], v[216:219], v[184:199]
  s_lshr_b32 s78, s5, 3
  s_mul_i32 s78, s78, 28672
  s_bfe_u32 s79, s5, 0x20001
  s_lshl_b32 s80, s79, 11
  s_add_u32 s78, s78, s80
  s_add_u32 s78, s78, 9437184
  s_mul_i32 s90, s89, 114688
  s_add_u32 s90, s90, s78
  s_xor_b32 s81, s89, 4
  s_mul_i32 s91, s81, 114688
  s_add_u32 s91, s91, s78
  s_add_u32 s91, s91, 12288
  s_lshl_b32 s80, s79, 10
  s_sub_u32 s96, s90, s80
  s_add_u32 s96, s96, 8192
  s_lshr_b32 s78, s5, 3
  s_lshl_b32 s78, s78, 6
  s_lshl_b32 s80, s79, 3
  s_add_u32 s78, s78, s80
  s_and_b32 s80, s3, 1
  s_lshl_b32 s80, s80, 2
  s_add_u32 s78, s78, s80
  s_add_u32 s78, s78, 16384
  s_lshr_b32 s80, s89, 1
  s_lshl_b32 s80, s80, 8
  s_add_u32 s92, s78, s80
  s_xor_b32 s80, s80, 512
  s_add_u32 s93, s78, s80
  s_add_u32 s93, s93, 32
  s_lshl_b32 s94, s73, 1
  s_add_u32 s94, s94, 16384
  s_add_u32 s95, s94, 32
  s_lshr_b32 s99, s5, 1
  s_mul_i32 s99, s99, 28672
  s_add_u32 s99, s99, s63
  ds_read_b64_tr_b16 v[216:217], v8 offset:0
  ds_read_b64_tr_b16 v[218:219], v8 offset:256
  ds_read_b64_tr_b16 v[220:221], v8 offset:28672
  ds_read_b64_tr_b16 v[222:223], v8 offset:28928
  ds_read_b64_tr_b16 v[224:225], v2 offset:0
  ds_read_b64_tr_b16 v[226:227], v2 offset:256
  ds_read_b64_tr_b16 v[228:229], v8 offset:1024
  ds_read_b64_tr_b16 v[230:231], v8 offset:1280
  s_andn2_b32 s78, s89, 4
  s_lshl_b32 s78, s78, 7
  v_and_b32 v248, 0x200, v1
  v_add_u32 v248, v248, v13
  s_add_u32 s78, s78, 24576
  s_lshl_b32 s80, s89, 15
  s_add_u32 s80, s80, 5242880
  v_add_u32 v246, s80, v1
  v_xor_b32 v247, 131072, v246
  s_add_u32 s84, s52, 1
Lpoll_48:
  buffer_load_dword v15, v248, s[36:39], s78 offen sc1
  s_add_u32 s53, s53, 1
  s_cmp_gt_u32 s53, 0x20000
  s_cbranch_scc1 Lpd_49
  s_waitcnt vmcnt(0)
  v_subrev_u32 v15, s84, v15
  v_cmp_le_u32 vcc, 16, v15
  s_cbranch_vccnz Lpoll_48
Lpd_49:
  buffer_load_dwordx4 v[24:27], v246, s[36:39], 0 offen offset:0 sc1
  buffer_load_dwordx4 v[28:31], v246, s[36:39], 0 offen offset:1024 sc1
  buffer_load_dwordx4 v[32:35], v246, s[36:39], 0 offen offset:2048 sc1
  buffer_load_dwordx4 v[36:39], v246, s[36:39], 0 offen offset:3072 sc1
  buffer_load_dwordx4 v[40:43], v246, s[36:39], s57 offen offset:0 sc1
  buffer_load_dwordx4 v[44:47], v246, s[36:39], s57 offen offset:1024 sc1
  s_barrier
  v_lshrrev_b32 v248, 2, v1
  v_and_b32 v248, 0x7c, v248
  v_add_u32 v248, s70, v248
  ds_write_b32 v248, v184 offset:512
  s_waitcnt vmcnt(5) lgkmcnt(5)
  v_mfma_f32_32x32x16_bf16 v[136:151], v[216:219], v[24:27], 0
  ds_read_b64_tr_b16 v[232:233], v8 offset:29696
  ds_read_b64_tr_b16 v[234:235], v8 offset:29952
  buffer_load_dwordx4 v[48:51], v246, s[36:39], s57 offen offset:2048 sc1
  v_mfma_f32_32x32x16_bf16 v[152:167], v[220:223], v[24:27], 0
  ds_read_b64_tr_b16 v[236:237], v2 offset:1024
  ds_read_b64_tr_b16 v[238:239], v2 offset:1280
  s_waitcnt lgkmcnt(5)
  v_mfma_f32_32x32x16_bf16 v[200:215], v[224:227], v[24:27], 0
  ds_read_b64_tr_b16 v[216:217], v8 offset:2048
  ds_read_b64_tr_b16 v[218:219], v8 offset:2304
  buffer_load_dwordx4 v[52:55], v246, s[36:39], s57 offen offset:3072 sc1
  s_waitcnt vmcnt(6)
  v_mfma_f32_32x32x16_bf16 v[136:151], v[228:231], v[28:31], v[136:151]
  ds_read_b64_tr_b16 v[220:221], v8 offset:30720
  ds_read_b64_tr_b16 v[222:223], v8 offset:30976
  s_waitcnt lgkmcnt(4)
  v_mfma_f32_32x32x16_bf16 v[152:167], v[232:235], v[28:31], v[152:167]
  ds_read_b64_tr_b16 v[224:225], v2 offset:2048
  ds_read_b64_tr_b16 v[226:227], v2 offset:2304
  buffer_load_dwordx4 v[56:59], v246, s[36:39], s58 offen offset:0 sc1
  v_mfma_f32_32x32x16_bf16 v[200:215], v[236:239], v[28:31], v[200:215]
  ds_read_b64_tr_b16 v[228:229], v8 offset:3072
  ds_read_b64_tr_b16 v[230:231], v8 offset:3328
  s_waitcnt vmcnt(6) lgkmcnt(4)
  v_mfma_f32_32x32x16_bf16 v[136:151], v[216:219], v[32:35], v[136:151]
  ds_read_b64_tr_b16 v[232:233], v8 offset:31744
  ds_read_b64_tr_b16 v[234:235], v8 offset:32000
  buffer_load_dwordx4 v[60:63], v246, s[36:39], s58 offen offset:1024 sc1
  v_mfma_f32_32x32x16_bf16 v[152:167], v[220:223], v[32:35], v[152:167]
  ds_read_b64_tr_b16 v[236:237], v2 offset:3072
  ds_read_b64_tr_b16 v[238:239], v2 offset:3328
  s_waitcnt lgkmcnt(4)
  v_mfma_f32_32x32x16_bf16 v[200:215], v[224:227], v[32:35], v[200:215]
  ds_read_b64_tr_b16 v[216:217], v8 offset:4096
  ds_read_b64_tr_b16 v[218:219], v8 offset:4352
  buffer_load_dwordx4 v[64:67], v246, s[36:39], s58 offen offset:2048 sc1
  s_waitcnt vmcnt(7)
  v_mfma_f32_32x32x16_bf16 v[136:151], v[228:231], v[36:39], v[136:151]
  ds_read_b64_tr_b16 v[220:221], v8 offset:32768
  ds_read_b64_tr_b16 v[222:223], v8 offset:33024
  s_waitcnt lgkmcnt(4)
  v_mfma_f32_32x32x16_bf16 v[152:167], v[232:235], v[36:39], v[152:167]
  ds_read_b64_tr_b16 v[224:225], v2 offset:4096
  ds_read_b64_tr_b16 v[226:227], v2 offset:4352
  buffer_load_dwordx4 v[68:71], v246, s[36:39], s58 offen offset:3072 sc1
  v_mfma_f32_32x32x16_bf16 v[200:215], v[236:239], v[36:39], v[200:215]
  ds_read_b64_tr_b16 v[228:229], v8 offset:5120
  ds_read_b64_tr_b16 v[230:231], v8 offset:5376
  s_waitcnt vmcnt(7) lgkmcnt(4)
  v_mfma_f32_32x32x16_bf16 v[136:151], v[216:219], v[40:43], v[136:151]
  ds_read_b64_tr_b16 v[232:233], v8 offset:33792
  ds_read_b64_tr_b16 v[234:235], v8 offset:34048
  buffer_load_dwordx4 v[72:75], v246, s[36:39], s59 offen offset:0 sc1
  v_mfma_f32_32x32x16_bf16 v[152:167], v[220:223], v[40:43], v[152:167]
  ds_read_b64_tr_b16 v[236:237], v2 offset:5120
  ds_read_b64_tr_b16 v[238:239], v2 offset:5376
  s_waitcnt lgkmcnt(4)
  v_mfma_f32_32x32x16_bf16 v[200:215], v[224:227], v[40:43], v[200:215]
  s_barrier
  ds_read_b64_tr_b16 v[216:217], v8 offset:6144
  ds_read_b64_tr_b16 v[218:219], v8 offset:6400
  buffer_load_dwordx4 v[76:79], v246, s[36:39], s59 offen offset:1024 sc1
  v_lshrrev_b32 v248, 2, v1
  s_waitcnt vmcnt(8)
  v_mfma_f32_32x32x16_bf16 v[136:151], v[228:231], v[44:47], v[136:151]
  ds_read_b64_tr_b16 v[220:221], v8 offset:34816
  ds_read_b64_tr_b16 v[222:223], v8 offset:35072
  v_and_b32 v248, 0x7c, v248
  v_add_u32 v248, 143360, v248
  ds_read_b32 v188, v248 offset:512
  s_waitcnt lgkmcnt(5)
  v_mfma_f32_32x32x16_bf16 v[152:167], v[232:235], v[44:47], v[152:167]
  ds_read_b64_tr_b16 v[224:225], v2 offset:6144
  ds_read_b64_tr_b16 v[226:227], v2 offset:6400
  buffer_load_dwordx4 v[168:171], v246, s[36:39], s98 offen offset:0 sc1
  ds_read_b32 v189, v248 offset:5632
  ds_read_b32 v190, v248 offset:10752
  ds_read_b32 v191, v248 offset:15872
  v_mfma_f32_32x32x16_bf16 v[200:215], v[236:239], v[44:47], v[200:215]
  ds_read_b64_tr_b16 v[228:229], v8 offset:7168
  ds_read_b64_tr_b16 v[230:231], v8 offset:7424
  s_waitcnt vmcnt(8) lgkmcnt(8)
  v_mfma_f32_32x32x16_bf16 v[136:151], v[216:219], v[48:51], v[136:151]
  ds_read_b64_tr_b16 v[232:233], v8 offset:35840
  ds_read_b64_tr_b16 v[234:235], v8 offset:36096
  buffer_load_dwordx4 v[172:175], v246, s[36:39], s98 offen offset:1024 sc1
  v_mfma_f32_32x32x16_bf16 v[152:167], v[220:223], v[48:51], v[152:167]
  ds_read_b64_tr_b16 v[236:237], v2 offset:7168
  ds_read_b64_tr_b16 v[238:239], v2 offset:7424
  s_waitcnt lgkmcnt(4)
  v_mfma_f32_32x32x16_bf16 v[200:215], v[224:227], v[48:51], v[200:215]
  ds_read_b64_tr_b16 v[216:217], v8 offset:8192
  ds_read_b64_tr_b16 v[218:219], v8 offset:8448
  buffer_load_dwordx4 v[176:179], v246, s[36:39], s98 offen offset:2048 sc1
  v_add_f32 v188, v188, v189
  s_waitcnt vmcnt(9)
  v_mfma_f32_32x32x16_bf16 v[136:151], v[228:231], v[52:55], v[136:151]
  ds_read_b64_tr_b16 v[220:221], v8 offset:36864
  ds_read_b64_tr_b16 v[222:223], v8 offset:37120
  v_add_f32 v190, v190, v191
  v_add_f32 v188, v188, v190
  v_cvt_pk_bf16_f32 v189, v188, v188
  s_waitcnt lgkmcnt(4)
  v_mfma_f32_32x32x16_bf16 v[152:167], v[232:235], v[52:55], v[152:167]
  ds_read_b64_tr_b16 v[224:225], v2 offset:8192
  ds_read_b64_tr_b16 v[226:227], v2 offset:8448
  buffer_load_dwordx4 v[180:183], v246, s[36:39], s98 offen offset:3072 sc1
  v_lshlrev_b32 v189, 16, v189
  v_sub_f32 v189, v188, v189
  v_cvt_pk_bf16_f32 v188, v188, v189
  v_mfma_f32_32x32x16_bf16 v[200:215], v[236:239], v[52:55], v[200:215]
  ds_read_b64_tr_b16 v[228:229], v8 offset:9216
  ds_read_b64_tr_b16 v[230:231], v8 offset:9472
  v_accvgpr_write_b32 a230, v188
  s_waitcnt vmcnt(9) lgkmcnt(4)
  v_mfma_f32_32x32x16_bf16 v[136:151], v[216:219], v[56:59], v[136:151]
  ds_read_b64_tr_b16 v[232:233], v8 offset:37888
  ds_read_b64_tr_b16 v[234:235], v8 offset:38144
  buffer_load_dwordx4 v[80:83], v246, s[36:39], s59 offen offset:2048 sc1
  v_mfma_f32_32x32x16_bf16 v[152:167], v[220:223], v[56:59], v[152:167]
  ds_read_b64_tr_b16 v[236:237], v2 offset:9216
  ds_read_b64_tr_b16 v[238:239], v2 offset:9472
  s_waitcnt lgkmcnt(4)
  v_mfma_f32_32x32x16_bf16 v[200:215], v[224:227], v[56:59], v[200:215]
  ds_read_b64_tr_b16 v[216:217], v8 offset:10240
  ds_read_b64_tr_b16 v[218:219], v8 offset:10496
  buffer_load_dwordx4 v[84:87], v246, s[36:39], s59 offen offset:3072 sc1
  s_waitcnt vmcnt(10)
  v_mfma_f32_32x32x16_bf16 v[136:151], v[228:231], v[60:63], v[136:151]
  ds_read_b64_tr_b16 v[220:221], v8 offset:38912
  ds_read_b64_tr_b16 v[222:223], v8 offset:39168
  s_waitcnt lgkmcnt(4)
  v_mfma_f32_32x32x16_bf16 v[152:167], v[232:235], v[60:63], v[152:167]
  ds_read_b64_tr_b16 v[224:225], v2 offset:10240
  ds_read_b64_tr_b16 v[226:227], v2 offset:10496
  buffer_load_dwordx4 v[88:91], v246, s[36:39], s60 offen offset:0 sc1
  v_mfma_f32_32x32x16_bf16 v[200:215], v[236:239], v[60:63], v[200:215]
  ds_read_b64_tr_b16 v[228:229], v8 offset:11264
  ds_read_b64_tr_b16 v[230:231], v8 offset:11520
  s_waitcnt vmcnt(10) lgkmcnt(4)
  v_mfma_f32_32x32x16_bf16 v[136:151], v[216:219], v[64:67], v[136:151]
  ds_read_b64_tr_b16 v[232:233], v8 offset:39936
  ds_read_b64_tr_b16 v[234:235], v8 offset:40192
  buffer_load_dwordx4 v[92:95], v246, s[36:39], s60 offen offset:1024 sc1
  v_mfma_f32_32x32x16_bf16 v[152:167], v[220:223], v[64:67], v[152:167]
  ds_read_b64_tr_b16 v[236:237], v2 offset:11264
  ds_read_b64_tr_b16 v[238:239], v2 offset:11520
  s_waitcnt lgkmcnt(4)
  v_mfma_f32_32x32x16_bf16 v[200:215], v[224:227], v[64:67], v[200:215]
  ds_read_b64_tr_b16 v[216:217], v8 offset:12288
  ds_read_b64_tr_b16 v[218:219], v8 offset:12544
  buffer_load_dwordx4 v[96:99], v246, s[36:39], s60 offen offset:2048 sc1
  s_waitcnt vmcnt(11)
  v_mfma_f32_32x32x16_bf16 v[136:151], v[228:231], v[68:71], v[136:151]
  ds_read_b64_tr_b16 v[220:221], v8 offset:40960
  ds_read_b64_tr_b16 v[222:223], v8 offset:41216
  s_waitcnt lgkmcnt(4)
  v_mfma_f32_32x32x16_bf16 v[152:167], v[232:235], v[68:71], v[152:167]
  ds_read_b64_tr_b16 v[224:225], v2 offset:12288
  ds_read_b64_tr_b16 v[226:227], v2 offset:12544
  buffer_load_dwordx4 v[100:103], v246, s[36:39], s60 offen offset:3072 sc1
  v_mfma_f32_32x32x16_bf16 v[200:215], v[236:239], v[68:71], v[200:215]
  ds_read_b64_tr_b16 v[228:229], v8 offset:13312
  ds_read_b64_tr_b16 v[230:231], v8 offset:13568
  s_waitcnt vmcnt(11) lgkmcnt(4)
  v_mfma_f32_32x32x16_bf16 v[136:151], v[216:219], v[72:75], v[136:151]
  ds_read_b64_tr_b16 v[232:233], v8 offset:41984
  ds_read_b64_tr_b16 v[234:235], v8 offset:42240
  buffer_load_dwordx4 v[104:107], v246, s[36:39], s61 offen offset:0 sc1
  v_mfma_f32_32x32x16_bf16 v[152:167], v[220:223], v[72:75], v[152:167]
  ds_read_b64_tr_b16 v[236:237], v2 offset:13312
  ds_read_b64_tr_b16 v[238:239], v2 offset:13568
  s_waitcnt lgkmcnt(4)
  v_mfma_f32_32x32x16_bf16 v[200:215], v[224:227], v[72:75], v[200:215]
  ds_read_b64_tr_b16 v[216:217], v8 offset:14336
  ds_read_b64_tr_b16 v[218:219], v8 offset:14592
  buffer_load_dwordx4 v[108:111], v246, s[36:39], s61 offen offset:1024 sc1
  s_waitcnt vmcnt(12)
  v_mfma_f32_32x32x16_bf16 v[136:151], v[228:231], v[76:79], v[136:151]
  ds_read_b64_tr_b16 v[220:221], v8 offset:43008
  ds_read_b64_tr_b16 v[222:223], v8 offset:43264
  s_waitcnt vmcnt(8)
  v_add_f32 v180, v180, v182
  v_add_f32 v181, v181, v183
  s_waitcnt lgkmcnt(4)
  v_mfma_f32_32x32x16_bf16 v[152:167], v[232:235], v[76:79], v[152:167]
  ds_read_b64_tr_b16 v[224:225], v2 offset:14336
  ds_read_b64_tr_b16 v[226:227], v2 offset:14592
  buffer_load_dwordx4 v[184:187], v247, s[36:39], s98 offen offset:0 sc1
  v_add_f32 v168, v168, v170
  v_add_f32 v169, v169, v171
  v_add_f32 v172, v172, v174
  v_mfma_f32_32x32x16_bf16 v[200:215], v[236:239], v[76:79], v[200:215]
  ds_read_b64_tr_b16 v[228:229], v8 offset:15360
  ds_read_b64_tr_b16 v[230:231], v8 offset:15616
  v_add_f32 v173, v173, v175
  v_add_f32 v176, v176, v178
  v_add_f32 v177, v177, v179
  s_waitcnt vmcnt(8) lgkmcnt(4)
  v_mfma_f32_32x32x16_bf16 v[136:151], v[216:219], v[80:83], v[136:151]
  ds_read_b64_tr_b16 v[232:233], v8 offset:44032
  ds_read_b64_tr_b16 v[234:235], v8 offset:44288
  buffer_load_dwordx4 v[188:191], v247, s[36:39], s98 offen offset:1024 sc1
  v_cndmask_b32 v180, v180, 0, s[48:49]
  v_cndmask_b32 v181, v181, 0, s[48:49]
  v_add_f32 v168, v168, v172
  v_mfma_f32_32x32x16_bf16 v[152:167], v[220:223], v[80:83], v[152:167]
  ds_read_b64_tr_b16 v[236:237], v2 offset:15360
  ds_read_b64_tr_b16 v[238:239], v2 offset:15616
  v_add_f32 v169, v169, v173
  v_add_f32 v176, v176, v180
  v_add_f32 v177, v177, v181
  s_waitcnt lgkmcnt(4)
  v_mfma_f32_32x32x16_bf16 v[200:215], v[224:227], v[80:83], v[200:215]
  ds_read_b64_tr_b16 v[216:217], v8 offset:16384
  ds_read_b64_tr_b16 v[218:219], v8 offset:16640
  buffer_load_dwordx4 v[192:195], v247, s[36:39], s98 offen offset:2048 sc1
  v_add_f32 v168, v168, v176
  v_add_f32 v169, v169, v177
  s_waitcnt vmcnt(9)
  v_mfma_f32_32x32x16_bf16 v[136:151], v[228:231], v[84:87], v[136:151]
  ds_read_b64_tr_b16 v[220:221], v8 offset:45056
  ds_read_b64_tr_b16 v[222:223], v8 offset:45312
  v_mov_b32 v241, 0
  v_mov_b32 v242, 0
  v_mov_b32 v243, 0
  s_waitcnt lgkmcnt(4)
  v_mfma_f32_32x32x16_bf16 v[152:167], v[232:235], v[84:87], v[152:167]
  ds_read_b64_tr_b16 v[224:225], v2 offset:16384
  ds_read_b64_tr_b16 v[226:227], v2 offset:16640
  buffer_load_dwordx4 v[196:199], v247, s[36:39], s98 offen offset:3072 sc1
  v_permlane32_swap_b32 v168, v169
  v_add_f32 v168, v168, v169
  v_mul_f32 v168, 0x3b124925, v168
  v_mfma_f32_32x32x16_bf16 v[200:215], v[236:239], v[84:87], v[200:215]
  ds_read_b64_tr_b16 v[228:229], v8 offset:17408
  ds_read_b64_tr_b16 v[230:231], v8 offset:17664
  v_mov_b32 v169, v168
  s_nop 1
  v_permlane32_swap_b32 v168, v169
  s_waitcnt vmcnt(9) lgkmcnt(4)
  v_mfma_f32_32x32x16_bf16 v[136:151], v[216:219], v[88:91], v[136:151]
  ds_read_b64_tr_b16 v[232:233], v8 offset:46080
  ds_read_b64_tr_b16 v[234:235], v8 offset:46336
  buffer_load_dwordx4 v[112:115], v246, s[36:39], s61 offen offset:2048 sc1
  v_fma_f32 v169, -v168, v168, v169
  v_cvt_pk_bf16_f32 v168, -v168, -v168
  v_max_f32 v169, 0, v169
  v_mfma_f32_32x32x16_bf16 v[152:167], v[220:223], v[88:91], v[152:167]
  ds_read_b64_tr_b16 v[236:237], v2 offset:17408
  ds_read_b64_tr_b16 v[238:239], v2 offset:17664
  v_cndmask_b32 v240, v168, 0, s[48:49]
  v_cvt_pk_bf16_f32 v169, v169, v169
  v_lshlrev_b32 v169, 16, v169
  s_waitcnt lgkmcnt(4)
  v_mfma_f32_32x32x16_bf16 v[200:215], v[224:227], v[88:91], v[200:215]
  ds_read_b64_tr_b16 v[216:217], v8 offset:18432
  ds_read_b64_tr_b16 v[218:219], v8 offset:18688
  buffer_load_dwordx4 v[116:119], v246, s[36:39], s61 offen offset:3072 sc1
  v_add_f32 v169, 0x3727c5ac, v169
  v_cvt_pk_bf16_f32 v169, v169, v169
  s_waitcnt vmcnt(10)
  v_mfma_f32_32x32x16_bf16 v[136:151], v[228:231], v[92:95], v[136:151]
  ds_read_b64_tr_b16 v[220:221], v8 offset:47104
  ds_read_b64_tr_b16 v[222:223], v8 offset:47360
  v_lshlrev_b32 v169, 16, v169
  v_sqrt_f32 v169, v169
  s_waitcnt lgkmcnt(4)
  v_mfma_f32_32x32x16_bf16 v[152:167], v[232:235], v[92:95], v[152:167]
  ds_read_b64_tr_b16 v[224:225], v2 offset:18432
  ds_read_b64_tr_b16 v[226:227], v2 offset:18688
  buffer_load_dwordx4 v[120:123], v246, s[36:39], s62 offen offset:0 sc1
  v_cvt_pk_bf16_f32 v169, v169, v169
  v_lshlrev_b32 v245, 16, v169
  v_mfma_f32_32x32x16_bf16 v[200:215], v[236:239], v[92:95], v[200:215]
  ds_read_b64_tr_b16 v[228:229], v8 offset:19456
  ds_read_b64_tr_b16 v[230:231], v8 offset:19712
  v_rcp_f32 v244, v245
  s_nop 0
  v_mul_f32 v244, 0xbfb8aa3b, v244
  s_waitcnt vmcnt(10) lgkmcnt(4)
  v_mfma_f32_32x32x16_bf16 v[136:151], v[216:219], v[96:99], v[136:151]
  ds_read_b64_tr_b16 v[232:233], v8 offset:48128
  ds_read_b64_tr_b16 v[234:235], v8 offset:48384
  buffer_load_dwordx4 v[124:127], v246, s[36:39], s62 offen offset:1024 sc1
  v_mfma_f32_32x32x16_bf16 v[152:167], v[220:223], v[96:99], v[152:167]
  ds_read_b64_tr_b16 v[236:237], v2 offset:19456
  ds_read_b64_tr_b16 v[238:239], v2 offset:19712
  s_waitcnt lgkmcnt(4)
  v_mfma_f32_32x32x16_bf16 v[200:215], v[224:227], v[96:99], v[200:215]
  ds_read_b64_tr_b16 v[216:217], v8 offset:20480
  ds_read_b64_tr_b16 v[218:219], v8 offset:20736
  buffer_load_dwordx4 v[128:131], v246, s[36:39], s62 offen offset:2048 sc1
  s_waitcnt vmcnt(11)
  v_mfma_f32_32x32x16_bf16 v[136:151], v[228:231], v[100:103], v[136:151]
  ds_read_b64_tr_b16 v[220:221], v8 offset:49152
  ds_read_b64_tr_b16 v[222:223], v8 offset:49408
  s_waitcnt lgkmcnt(4)
  v_mfma_f32_32x32x16_bf16 v[152:167], v[232:235], v[100:103], v[152:167]
  ds_read_b64_tr_b16 v[224:225], v2 offset:20480
  ds_read_b64_tr_b16 v[226:227], v2 offset:20736
  buffer_load_dwordx4 v[132:135], v246, s[36:39], s62 offen offset:3072 sc1
  v_mfma_f32_32x32x16_bf16 v[200:215], v[236:239], v[100:103], v[200:215]
  ds_read_b64_tr_b16 v[228:229], v8 offset:21504
  ds_read_b64_tr_b16 v[230:231], v8 offset:21760
  s_waitcnt vmcnt(11) lgkmcnt(4)
  v_mfma_f32_32x32x16_bf16 v[136:151], v[216:219], v[104:107], v[136:151]
  ds_read_b64_tr_b16 v[232:233], v8 offset:50176
  ds_read_b64_tr_b16 v[234:235], v8 offset:50432
  buffer_load_dwordx4 v[24:27], v247, s[36:39], 0 offen offset:0 sc1
  v_mfma_f32_32x32x16_bf16 v[152:167], v[220:223], v[104:107], v[152:167]
  ds_read_b64_tr_b16 v[236:237], v2 offset:21504
  ds_read_b64_tr_b16 v[238:239], v2 offset:21760
  s_waitcnt lgkmcnt(4)
  v_mfma_f32_32x32x16_bf16 v[200:215], v[224:227], v[104:107], v[200:215]
  ds_read_b64_tr_b16 v[216:217], v8 offset:22528
  ds_read_b64_tr_b16 v[218:219], v8 offset:22784
  buffer_load_dwordx4 v[28:31], v247, s[36:39], 0 offen offset:1024 sc1
  s_waitcnt vmcnt(12)
  v_mfma_f32_32x32x16_bf16 v[136:151], v[228:231], v[108:111], v[136:151]
  ds_read_b64_tr_b16 v[220:221], v8 offset:51200
  ds_read_b64_tr_b16 v[222:223], v8 offset:51456
  s_waitcnt lgkmcnt(4)
  v_mfma_f32_32x32x16_bf16 v[152:167], v[232:235], v[108:111], v[152:167]
  ds_read_b64_tr_b16 v[224:225], v2 offset:22528
  ds_read_b64_tr_b16 v[226:227], v2 offset:22784
  buffer_load_dwordx4 v[32:35], v247, s[36:39], 0 offen offset:2048 sc1
  v_mfma_f32_32x32x16_bf16 v[200:215], v[236:239], v[108:111], v[200:215]
  ds_read_b64_tr_b16 v[228:229], v8 offset:23552
  ds_read_b64_tr_b16 v[230:231], v8 offset:23808
  s_waitcnt vmcnt(9)
  v_add_f32 v196, v196, v198
  v_add_f32 v197, v197, v199
  s_waitcnt vmcnt(8) lgkmcnt(4)
  v_mfma_f32_32x32x16_bf16 v[136:151], v[216:219], v[112:115], v[136:151]
  ds_read_b64_tr_b16 v[232:233], v8 offset:52224
  ds_read_b64_tr_b16 v[234:235], v8 offset:52480
  buffer_load_dwordx4 v[36:39], v247, s[36:39], 0 offen offset:3072 sc1
  v_add_f32 v184, v184, v186
  v_add_f32 v185, v185, v187
  v_add_f32 v188, v188, v190
  v_mfma_f32_32x32x16_bf16 v[152:167], v[220:223], v[112:115], v[152:167]
  ds_read_b64_tr_b16 v[236:237], v2 offset:23552
  ds_read_b64_tr_b16 v[238:239], v2 offset:23808
  v_add_f32 v189, v189, v191
  v_add_f32 v192, v192, v194
  v_add_f32 v193, v193, v195
  s_waitcnt lgkmcnt(4)
  v_mfma_f32_32x32x16_bf16 v[200:215], v[224:227], v[112:115], v[200:215]
  ds_read_b64_tr_b16 v[216:217], v8 offset:24576
  ds_read_b64_tr_b16 v[218:219], v8 offset:24832
  buffer_load_dwordx4 v[40:43], v247, s[36:39], s57 offen offset:0 sc1
  v_cndmask_b32 v196, v196, 0, s[48:49]
  v_cndmask_b32 v197, v197, 0, s[48:49]
  s_waitcnt vmcnt(9)
  v_mfma_f32_32x32x16_bf16 v[136:151], v[228:231], v[116:119], v[136:151]
  ds_read_b64_tr_b16 v[220:221], v8 offset:53248
  ds_read_b64_tr_b16 v[222:223], v8 offset:53504
  v_add_f32 v184, v184, v188
  v_add_f32 v185, v185, v189
  v_add_f32 v192, v192, v196
  s_waitcnt lgkmcnt(4)
  v_mfma_f32_32x32x16_bf16 v[152:167], v[232:235], v[116:119], v[152:167]
  ds_read_b64_tr_b16 v[224:225], v2 offset:24576
  ds_read_b64_tr_b16 v[226:227], v2 offset:24832
  buffer_load_dwordx4 v[44:47], v247, s[36:39], s57 offen offset:1024 sc1
  v_add_f32 v193, v193, v197
  v_add_f32 v184, v184, v192
  v_add_f32 v185, v185, v193
  v_mfma_f32_32x32x16_bf16 v[200:215], v[236:239], v[116:119], v[200:215]
  ds_read_b64_tr_b16 v[228:229], v8 offset:25600
  ds_read_b64_tr_b16 v[230:231], v8 offset:25856
  v_permlane32_swap_b32 v184, v185
  v_add_f32 v184, v184, v185
  v_mul_f32 v184, 0x3b124925, v184
  s_waitcnt vmcnt(9) lgkmcnt(4)
  v_mfma_f32_32x32x16_bf16 v[136:151], v[216:219], v[120:123], v[136:151]
  ds_read_b64_tr_b16 v[232:233], v8 offset:54272
  ds_read_b64_tr_b16 v[234:235], v8 offset:54528
  buffer_load_dwordx4 v[48:51], v247, s[36:39], s57 offen offset:2048 sc1
  v_mov_b32 v185, v184
  s_nop 1
  v_permlane32_swap_b32 v184, v185
  v_mfma_f32_32x32x16_bf16 v[152:167], v[220:223], v[120:123], v[152:167]
  ds_read_b64_tr_b16 v[236:237], v2 offset:25600
  ds_read_b64_tr_b16 v[238:239], v2 offset:25856
  v_fma_f32 v185, -v184, v184, v185
  v_cvt_pk_bf16_f32 v184, -v184, -v184
  v_max_f32 v185, 0, v185
  s_waitcnt lgkmcnt(4)
  v_mfma_f32_32x32x16_bf16 v[200:215], v[224:227], v[120:123], v[200:215]
  ds_read_b64_tr_b16 v[216:217], v8 offset:26624
  ds_read_b64_tr_b16 v[218:219], v8 offset:26880
  buffer_load_dwordx4 v[52:55], v247, s[36:39], s57 offen offset:3072 sc1
  v_cndmask_b32 v250, v184, 0, s[48:49]
  v_cvt_pk_bf16_f32 v185, v185, v185
  s_waitcnt vmcnt(10)
  v_mfma_f32_32x32x16_bf16 v[136:151], v[228:231], v[124:127], v[136:151]
  ds_read_b64_tr_b16 v[220:221], v8 offset:55296
  ds_read_b64_tr_b16 v[222:223], v8 offset:55552
  v_lshlrev_b32 v185, 16, v185
  v_add_f32 v185, 0x3727c5ac, v185
  v_cvt_pk_bf16_f32 v185, v185, v185
  s_waitcnt lgkmcnt(4)
  v_mfma_f32_32x32x16_bf16 v[152:167], v[232:235], v[124:127], v[152:167]
  ds_read_b64_tr_b16 v[224:225], v2 offset:26624
  ds_read_b64_tr_b16 v[226:227], v2 offset:26880
  buffer_load_dwordx4 v[56:59], v247, s[36:39], s58 offen offset:0 sc1
  v_lshlrev_b32 v185, 16, v185
  v_sqrt_f32 v185, v185
  v_mfma_f32_32x32x16_bf16 v[200:215], v[236:239], v[124:127], v[200:215]
  ds_read_b64_tr_b16 v[228:229], v8 offset:27648
  ds_read_b64_tr_b16 v[230:231], v8 offset:27904
  v_cvt_pk_bf16_f32 v185, v185, v185
  v_lshlrev_b32 v252, 16, v185
  v_rcp_f32 v251, v252
  s_nop 0
  v_mul_f32 v251, 0xbfb8aa3b, v251
  v_mfma_f32_32x32x16_bf16 v[136:151], a[224:227], v[240:243], v[136:151]
  v_mfma_f32_32x32x16_bf16 v[152:167], a[226:229], v[240:243], v[152:167]
  v_mfma_f32_32x32x16_bf16 v[200:215], a[228:231], v[240:243], v[200:215]
  v_mov_b32 v240, v250
  s_waitcnt vmcnt(10) lgkmcnt(4)
  v_mfma_f32_32x32x16_bf16 v[136:151], v[216:219], v[128:131], v[136:151]
  ds_read_b64_tr_b16 v[232:233], v8 offset:56320
  ds_read_b64_tr_b16 v[234:235], v8 offset:56576
  buffer_load_dwordx4 v[60:63], v247, s[36:39], s58 offen offset:1024 sc1
  v_mfma_f32_32x32x16_bf16 v[152:167], v[220:223], v[128:131], v[152:167]
  ds_read_b64_tr_b16 v[236:237], v2 offset:27648
  ds_read_b64_tr_b16 v[238:239], v2 offset:27904
  s_waitcnt lgkmcnt(4)
  v_mfma_f32_32x32x16_bf16 v[200:215], v[224:227], v[128:131], v[200:215]
  ds_read_b64_tr_b16 v[216:217], v8 offset:0
  ds_read_b64_tr_b16 v[218:219], v8 offset:256
  buffer_load_dwordx4 v[64:67], v247, s[36:39], s58 offen offset:2048 sc1
  s_waitcnt vmcnt(11)
  v_mfma_f32_32x32x16_bf16 v[136:151], v[228:231], v[132:135], v[136:151]
  ds_read_b64_tr_b16 v[220:221], v8 offset:28672
  ds_read_b64_tr_b16 v[222:223], v8 offset:28928
  s_waitcnt lgkmcnt(4)
  v_mfma_f32_32x32x16_bf16 v[152:167], v[232:235], v[132:135], v[152:167]
  ds_read_b64_tr_b16 v[224:225], v8 offset:1024
  ds_read_b64_tr_b16 v[226:227], v8 offset:1280
  buffer_load_dwordx4 v[68:71], v247, s[36:39], s58 offen offset:3072 sc1
  v_mfma_f32_32x32x16_bf16 v[200:215], v[236:239], v[132:135], v[200:215]
  ds_read_b64_tr_b16 v[228:229], v8 offset:29696
  ds_read_b64_tr_b16 v[230:231], v8 offset:29952
  s_waitcnt vmcnt(11) lgkmcnt(4)
  v_mfma_f32_32x32x16_bf16 v[168:183], v[216:219], v[24:27], 0
  ds_read_b64_tr_b16 v[232:233], v8 offset:2048
  ds_read_b64_tr_b16 v[234:235], v8 offset:2304
  s_lshl_b32 s28, s45, 1
  s_add_u32 s28, s28, 12288
  buffer_load_dwordx4 a[56:59], v7, s[40:43], s28 offen offset:1024 sc1
  v_mfma_f32_32x32x16_bf16 v[184:199], v[220:223], v[24:27], 0
  ds_read_b64_tr_b16 v[236:237], v8 offset:30720
  ds_read_b64_tr_b16 v[238:239], v8 offset:30976
  buffer_load_dwordx4 v[72:75], v247, s[36:39], s59 offen offset:0 sc1
  s_waitcnt vmcnt(12) lgkmcnt(4)
  v_mfma_f32_32x32x16_bf16 v[168:183], v[224:227], v[28:31], v[168:183]
  ds_read_b64_tr_b16 v[216:217], v8 offset:3072
  ds_read_b64_tr_b16 v[218:219], v8 offset:3328
  v_mul_f32 v136, v244, v136
  v_mul_f32 v137, v244, v137
  v_mul_f32 v138, v244, v138
  v_mul_f32 v139, v244, v139
  v_mfma_f32_32x32x16_bf16 v[184:199], v[228:231], v[28:31], v[184:199]
  ds_read_b64_tr_b16 v[220:221], v8 offset:31744
  ds_read_b64_tr_b16 v[222:223], v8 offset:32000
  buffer_load_dwordx4 v[76:79], v247, s[36:39], s59 offen offset:1024 sc1
  buffer_load_dwordx4 a[60:63], v3, s[40:43], s28 offen offset:1024 sc1
  s_waitcnt vmcnt(13) lgkmcnt(4)
  v_mfma_f32_32x32x16_bf16 v[168:183], v[232:235], v[32:35], v[168:183]
  ds_read_b64_tr_b16 v[224:225], v8 offset:4096
  ds_read_b64_tr_b16 v[226:227], v8 offset:4352
  v_exp_f32 v136, v136
  v_exp_f32 v137, v137
  v_mfma_f32_32x32x16_bf16 v[184:199], v[236:239], v[32:35], v[184:199]
  ds_read_b64_tr_b16 v[228:229], v8 offset:32768
  ds_read_b64_tr_b16 v[230:231], v8 offset:33024
  buffer_load_dwordx4 v[80:83], v247, s[36:39], s59 offen offset:2048 sc1
  v_exp_f32 v138, v138
  s_waitcnt vmcnt(13) lgkmcnt(4)
  v_mfma_f32_32x32x16_bf16 v[168:183], v[216:219], v[36:39], v[168:183]
  ds_read_b64_tr_b16 v[232:233], v8 offset:5120
  ds_read_b64_tr_b16 v[234:235], v8 offset:5376
  s_add_u32 s28, s45, 65536
  buffer_load_dwordx4 a[64:67], v7, s[40:43], s28 offen offset:0 sc1
  v_exp_f32 v139, v139
  v_mfma_f32_32x32x16_bf16 v[184:199], v[220:223], v[36:39], v[184:199]
  ds_read_b64_tr_b16 v[236:237], v8 offset:33792
  ds_read_b64_tr_b16 v[238:239], v8 offset:34048
  buffer_load_dwordx4 v[84:87], v247, s[36:39], s59 offen offset:3072 sc1
  v_fma_f32 v136, v136, v245, v245
  v_fma_f32 v137, v137, v245, v245
  s_waitcnt vmcnt(14) lgkmcnt(4)
  v_mfma_f32_32x32x16_bf16 v[168:183], v[224:227], v[40:43], v[168:183]
  ds_read_b64_tr_b16 v[216:217], v8 offset:6144
  ds_read_b64_tr_b16 v[218:219], v8 offset:6400
  v_fma_f32 v138, v138, v245, v245
  v_fma_f32 v139, v139, v245, v245
  v_rcp_f32 v136, v136
  v_mfma_f32_32x32x16_bf16 v[184:199], v[228:231], v[40:43], v[184:199]
  ds_read_b64_tr_b16 v[220:221], v8 offset:34816
  ds_read_b64_tr_b16 v[222:223], v8 offset:35072
  buffer_load_dwordx4 v[88:91], v247, s[36:39], s60 offen offset:0 sc1
  buffer_load_dwordx4 a[68:71], v3, s[40:43], s28 offen offset:0 sc1
  s_waitcnt vmcnt(15) lgkmcnt(4)
  v_mfma_f32_32x32x16_bf16 v[168:183], v[232:235], v[44:47], v[168:183]
  ds_read_b64_tr_b16 v[224:225], v8 offset:7168
  ds_read_b64_tr_b16 v[226:227], v8 offset:7424
  v_rcp_f32 v137, v137
  v_rcp_f32 v138, v138
  v_mfma_f32_32x32x16_bf16 v[184:199], v[236:239], v[44:47], v[184:199]
  ds_read_b64_tr_b16 v[228:229], v8 offset:35840
  ds_read_b64_tr_b16 v[230:231], v8 offset:36096
  buffer_load_dwordx4 v[92:95], v247, s[36:39], s60 offen offset:1024 sc1
  v_rcp_f32 v139, v139
  s_waitcnt vmcnt(15) lgkmcnt(4)
  v_mfma_f32_32x32x16_bf16 v[168:183], v[216:219], v[48:51], v[168:183]
  ds_read_b64_tr_b16 v[232:233], v8 offset:8192
  ds_read_b64_tr_b16 v[234:235], v8 offset:8448
  s_add_u32 s28, s45, 67584
  buffer_load_dwordx4 a[72:75], v7, s[40:43], s28 offen offset:0 sc1
  v_mul_f32 v152, v152, v136
  v_mul_f32 v153, v153, v137
  v_mfma_f32_32x32x16_bf16 v[184:199], v[220:223], v[48:51], v[184:199]
  ds_read_b64_tr_b16 v[236:237], v8 offset:36864
  ds_read_b64_tr_b16 v[238:239], v8 offset:37120
  buffer_load_dwordx4 v[96:99], v247, s[36:39], s60 offen offset:2048 sc1
  v_mul_f32 v154, v154, v138
  v_mul_f32 v155, v155, v139
  s_waitcnt vmcnt(16) lgkmcnt(4)
  v_mfma_f32_32x32x16_bf16 v[168:183], v[224:227], v[52:55], v[168:183]
  ds_read_b64_tr_b16 v[216:217], v8 offset:9216
  ds_read_b64_tr_b16 v[218:219], v8 offset:9472
  v_cvt_pk_bf16_f32 v136, v152, v153
  v_cvt_pk_bf16_f32 v137, v154, v155
  v_mul_f32 v140, v244, v140
  v_mul_f32 v141, v244, v141
  v_mfma_f32_32x32x16_bf16 v[184:199], v[228:231], v[52:55], v[184:199]
  ds_read_b64_tr_b16 v[220:221], v8 offset:37888
  ds_read_b64_tr_b16 v[222:223], v8 offset:38144
  buffer_load_dwordx4 v[100:103], v247, s[36:39], s60 offen offset:3072 sc1
  buffer_load_dwordx4 a[76:79], v3, s[40:43], s28 offen offset:0 sc1
  v_mul_f32 v142, v244, v142
  s_waitcnt vmcnt(17) lgkmcnt(4)
  v_mfma_f32_32x32x16_bf16 v[168:183], v[232:235], v[56:59], v[168:183]
  ds_read_b64_tr_b16 v[224:225], v8 offset:10240
  ds_read_b64_tr_b16 v[226:227], v8 offset:10496
  v_mul_f32 v143, v244, v143
  v_exp_f32 v140, v140
  v_mfma_f32_32x32x16_bf16 v[184:199], v[236:239], v[56:59], v[184:199]
  ds_read_b64_tr_b16 v[228:229], v8 offset:38912
  ds_read_b64_tr_b16 v[230:231], v8 offset:39168
  buffer_load_dwordx4 v[104:107], v247, s[36:39], s61 offen offset:0 sc1
  v_exp_f32 v141, v141
  s_waitcnt vmcnt(17) lgkmcnt(4)
  v_mfma_f32_32x32x16_bf16 v[168:183], v[216:219], v[60:63], v[168:183]
  ds_read_b64_tr_b16 v[232:233], v8 offset:11264
  ds_read_b64_tr_b16 v[234:235], v8 offset:11520
  s_add_u32 s28, s45, 69632
  buffer_load_dwordx4 a[80:83], v7, s[40:43], s28 offen offset:0 sc1
  v_exp_f32 v142, v142
  v_mfma_f32_32x32x16_bf16 v[184:199], v[220:223], v[60:63], v[184:199]
  ds_read_b64_tr_b16 v[236:237], v8 offset:39936
  ds_read_b64_tr_b16 v[238:239], v8 offset:40192
  buffer_load_dwordx4 v[108:111], v247, s[36:39], s61 offen offset:1024 sc1
  v_exp_f32 v143, v143
  s_waitcnt vmcnt(18) lgkmcnt(4)
  v_mfma_f32_32x32x16_bf16 v[168:183], v[224:227], v[64:67], v[168:183]
  ds_read_b64_tr_b16 v[216:217], v8 offset:12288
  ds_read_b64_tr_b16 v[218:219], v8 offset:12544
  v_fma_f32 v140, v140, v245, v245
  v_fma_f32 v141, v141, v245, v245
  v_fma_f32 v142, v142, v245, v245
  v_fma_f32 v143, v143, v245, v245
  v_mfma_f32_32x32x16_bf16 v[184:199], v[228:231], v[64:67], v[184:199]
  ds_read_b64_tr_b16 v[220:221], v8 offset:40960
  ds_read_b64_tr_b16 v[222:223], v8 offset:41216
  buffer_load_dwordx4 v[112:115], v247, s[36:39], s61 offen offset:2048 sc1
  buffer_load_dwordx4 a[84:87], v3, s[40:43], s28 offen offset:0 sc1
  s_waitcnt vmcnt(19) lgkmcnt(4)
  v_mfma_f32_32x32x16_bf16 v[168:183], v[232:235], v[68:71], v[168:183]
  ds_read_b64_tr_b16 v[224:225], v8 offset:13312
  ds_read_b64_tr_b16 v[226:227], v8 offset:13568
  v_rcp_f32 v140, v140
  v_rcp_f32 v141, v141
  v_mfma_f32_32x32x16_bf16 v[184:199], v[236:239], v[68:71], v[184:199]
  ds_read_b64_tr_b16 v[228:229], v8 offset:41984
  ds_read_b64_tr_b16 v[230:231], v8 offset:42240
  buffer_load_dwordx4 v[116:119], v247, s[36:39], s61 offen offset:3072 sc1
  v_rcp_f32 v142, v142
  s_waitcnt vmcnt(18) lgkmcnt(4)
  v_mfma_f32_32x32x16_bf16 v[168:183], v[216:219], v[72:75], v[168:183]
  ds_read_b64_tr_b16 v[232:233], v8 offset:14336
  ds_read_b64_tr_b16 v[234:235], v8 offset:14592
  s_add_u32 s28, s45, 71680
  buffer_load_dwordx4 a[88:91], v7, s[40:43], s28 offen offset:0 sc1
  v_rcp_f32 v143, v143
  v_mfma_f32_32x32x16_bf16 v[184:199], v[220:223], v[72:75], v[184:199]
  ds_read_b64_tr_b16 v[236:237], v8 offset:43008
  ds_read_b64_tr_b16 v[238:239], v8 offset:43264
  buffer_load_dwordx4 v[120:123], v247, s[36:39], s62 offen offset:0 sc1
  v_mul_f32 v156, v156, v140
  v_mul_f32 v157, v157, v141
  s_waitcnt vmcnt(19) lgkmcnt(4)
  v_mfma_f32_32x32x16_bf16 v[168:183], v[224:227], v[76:79], v[168:183]
  ds_read_b64_tr_b16 v[216:217], v8 offset:15360
  ds_read_b64_tr_b16 v[218:219], v8 offset:15616
  v_mul_f32 v158, v158, v142
  v_mul_f32 v159, v159, v143
  v_cvt_pk_bf16_f32 v138, v156, v157
  v_cvt_pk_bf16_f32 v139, v158, v159
  v_mfma_f32_32x32x16_bf16 v[184:199], v[228:231], v[76:79], v[184:199]
  ds_read_b64_tr_b16 v[220:221], v8 offset:44032
  ds_read_b64_tr_b16 v[222:223], v8 offset:44288
  buffer_load_dwordx4 v[124:127], v247, s[36:39], s62 offen offset:1024 sc1
  buffer_load_dwordx4 a[92:95], v3, s[40:43], s28 offen offset:0 sc1
  buffer_store_dwordx4 v[136:139], v1, s[36:39], s90 offen offset:0 sc1
  s_waitcnt vmcnt(20) lgkmcnt(4)
  v_mfma_f32_32x32x16_bf16 v[168:183], v[232:235], v[80:83], v[168:183]
  ds_read_b64_tr_b16 v[224:225], v8 offset:16384
  ds_read_b64_tr_b16 v[226:227], v8 offset:16640
  v_mul_f32 v144, v244, v144
  v_mul_f32 v145, v244, v145
  v_mul_f32 v146, v244, v146
  v_mul_f32 v147, v244, v147
  v_mfma_f32_32x32x16_bf16 v[184:199], v[236:239], v[80:83], v[184:199]
  ds_read_b64_tr_b16 v[228:229], v8 offset:45056
  ds_read_b64_tr_b16 v[230:231], v8 offset:45312
  buffer_load_dwordx4 v[128:131], v247, s[36:39], s62 offen offset:2048 sc1
  v_exp_f32 v144, v144
  s_waitcnt vmcnt(19) lgkmcnt(4)
  v_mfma_f32_32x32x16_bf16 v[168:183], v[216:219], v[84:87], v[168:183]
  ds_read_b64_tr_b16 v[232:233], v8 offset:17408
  ds_read_b64_tr_b16 v[234:235], v8 offset:17664
  s_lshl_b32 s28, s44, 1
  s_add_u32 s28, s28, 0
  buffer_load_dwordx4 a[96:99], v7, s[40:43], s28 offen offset:0 sc1
  v_mfma_f32_32x32x16_bf16 v[184:199], v[220:223], v[84:87], v[184:199]
  ds_read_b64_tr_b16 v[236:237], v8 offset:46080
  ds_read_b64_tr_b16 v[238:239], v8 offset:46336
  buffer_load_dwordx4 v[132:135], v247, s[36:39], s62 offen offset:3072 sc1
  v_exp_f32 v145, v145
  s_waitcnt vmcnt(20) lgkmcnt(4)
  v_mfma_f32_32x32x16_bf16 v[168:183], v[224:227], v[88:91], v[168:183]
  ds_read_b64_tr_b16 v[216:217], v8 offset:18432
  ds_read_b64_tr_b16 v[218:219], v8 offset:18688
  v_exp_f32 v146, v146
  v_exp_f32 v147, v147
  v_mfma_f32_32x32x16_bf16 v[184:199], v[228:231], v[88:91], v[184:199]
  ds_read_b64_tr_b16 v[220:221], v8 offset:47104
  ds_read_b64_tr_b16 v[222:223], v8 offset:47360
  buffer_load_dwordx4 a[100:103], v3, s[40:43], s28 offen offset:0 sc1
  v_fma_f32 v144, v144, v245, v245
  v_fma_f32 v145, v145, v245, v245
  s_waitcnt vmcnt(19) lgkmcnt(4)
  v_mfma_f32_32x32x16_bf16 v[168:183], v[232:235], v[92:95], v[168:183]
  ds_read_b64_tr_b16 v[224:225], v8 offset:19456
  ds_read_b64_tr_b16 v[226:227], v8 offset:19712
  v_fma_f32 v146, v146, v245, v245
  v_fma_f32 v147, v147, v245, v245
  v_rcp_f32 v144, v144
  v_mfma_f32_32x32x16_bf16 v[184:199], v[236:239], v[92:95], v[184:199]
  ds_read_b64_tr_b16 v[228:229], v8 offset:48128
  ds_read_b64_tr_b16 v[230:231], v8 offset:48384
  v_rcp_f32 v145, v145
  s_waitcnt vmcnt(17) lgkmcnt(4)
  v_mfma_f32_32x32x16_bf16 v[168:183], v[216:219], v[96:99], v[168:183]
  ds_read_b64_tr_b16 v[232:233], v8 offset:20480
  ds_read_b64_tr_b16 v[234:235], v8 offset:20736
  s_lshl_b32 s28, s44, 1
  s_add_u32 s28, s28, 0
  buffer_load_dwordx4 a[104:107], v7, s[40:43], s28 offen offset:1024 sc1
  v_mfma_f32_32x32x16_bf16 v[184:199], v[220:223], v[96:99], v[184:199]
  ds_read_b64_tr_b16 v[236:237], v8 offset:49152
  ds_read_b64_tr_b16 v[238:239], v8 offset:49408
  v_rcp_f32 v146, v146
  s_waitcnt vmcnt(17) lgkmcnt(4)
  v_mfma_f32_32x32x16_bf16 v[168:183], v[224:227], v[100:103], v[168:183]
  ds_read_b64_tr_b16 v[216:217], v8 offset:21504
  ds_read_b64_tr_b16 v[218:219], v8 offset:21760
  v_rcp_f32 v147, v147
  v_mul_f32 v160, v160, v144
  v_mul_f32 v161, v161, v145
  v_mfma_f32_32x32x16_bf16 v[184:199], v[228:231], v[100:103], v[184:199]
  ds_read_b64_tr_b16 v[220:221], v8 offset:50176
  ds_read_b64_tr_b16 v[222:223], v8 offset:50432
  buffer_load_dwordx4 a[108:111], v3, s[40:43], s28 offen offset:1024 sc1
  v_mul_f32 v162, v162, v146
  v_mul_f32 v163, v163, v147
  s_waitcnt vmcnt(16) lgkmcnt(4)
  v_mfma_f32_32x32x16_bf16 v[168:183], v[232:235], v[104:107], v[168:183]
  ds_read_b64_tr_b16 v[224:225], v8 offset:22528
  ds_read_b64_tr_b16 v[226:227], v8 offset:22784
  v_cvt_pk_bf16_f32 v140, v160, v161
  v_cvt_pk_bf16_f32 v141, v162, v163
  v_mul_f32 v148, v244, v148
  v_mul_f32 v149, v244, v149
  v_mfma_f32_32x32x16_bf16 v[184:199], v[236:239], v[104:107], v[184:199]
  ds_read_b64_tr_b16 v[228:229], v8 offset:51200
  ds_read_b64_tr_b16 v[230:231], v8 offset:51456
  v_mul_f32 v150, v244, v150
  v_mul_f32 v151, v244, v151
  s_waitcnt vmcnt(14) lgkmcnt(4)
  v_mfma_f32_32x32x16_bf16 v[168:183], v[216:219], v[108:111], v[168:183]
  ds_read_b64_tr_b16 v[232:233], v8 offset:23552
  ds_read_b64_tr_b16 v[234:235], v8 offset:23808
  s_lshl_b32 s28, s44, 1
  s_add_u32 s28, s28, 4096
  buffer_load_dwordx4 a[112:115], v7, s[40:43], s28 offen offset:0 sc1
  v_mfma_f32_32x32x16_bf16 v[184:199], v[220:223], v[108:111], v[184:199]
  ds_read_b64_tr_b16 v[236:237], v8 offset:52224
  ds_read_b64_tr_b16 v[238:239], v8 offset:52480
  v_exp_f32 v148, v148
  s_waitcnt vmcnt(14) lgkmcnt(4)
  v_mfma_f32_32x32x16_bf16 v[168:183], v[224:227], v[112:115], v[168:183]
  ds_read_b64_tr_b16 v[216:217], v8 offset:24576
  ds_read_b64_tr_b16 v[218:219], v8 offset:24832
  v_exp_f32 v149, v149
  v_exp_f32 v150, v150
  v_mfma_f32_32x32x16_bf16 v[184:199], v[228:231], v[112:115], v[184:199]
  ds_read_b64_tr_b16 v[220:221], v8 offset:53248
  ds_read_b64_tr_b16 v[222:223], v8 offset:53504
  buffer_load_dwordx4 a[116:119], v3, s[40:43], s28 offen offset:0 sc1
  v_exp_f32 v151, v151
  s_waitcnt vmcnt(13) lgkmcnt(4)
  v_mfma_f32_32x32x16_bf16 v[168:183], v[232:235], v[116:119], v[168:183]
  ds_read_b64_tr_b16 v[224:225], v8 offset:25600
  ds_read_b64_tr_b16 v[226:227], v8 offset:25856
  v_fma_f32 v148, v148, v245, v245
  v_fma_f32 v149, v149, v245, v245
  v_fma_f32 v150, v150, v245, v245
  v_fma_f32 v151, v151, v245, v245
  v_mfma_f32_32x32x16_bf16 v[184:199], v[236:239], v[116:119], v[184:199]
  ds_read_b64_tr_b16 v[228:229], v8 offset:54272
  ds_read_b64_tr_b16 v[230:231], v8 offset:54528
  v_rcp_f32 v148, v148
  s_waitcnt vmcnt(11) lgkmcnt(4)
  v_mfma_f32_32x32x16_bf16 v[168:183], v[216:219], v[120:123], v[168:183]
  ds_read_b64_tr_b16 v[232:233], v8 offset:26624
  ds_read_b64_tr_b16 v[234:235], v8 offset:26880
  s_lshl_b32 s28, s44, 1
  s_add_u32 s28, s28, 4096
  buffer_load_dwordx4 a[120:123], v7, s[40:43], s28 offen offset:1024 sc1
  v_mfma_f32_32x32x16_bf16 v[184:199], v[220:223], v[120:123], v[184:199]
  ds_read_b64_tr_b16 v[236:237], v8 offset:55296
  ds_read_b64_tr_b16 v[238:239], v8 offset:55552
  v_rcp_f32 v149, v149
  s_waitcnt vmcnt(11) lgkmcnt(4)
  v_mfma_f32_32x32x16_bf16 v[168:183], v[224:227], v[124:127], v[168:183]
  ds_read_b64_tr_b16 v[216:217], v8 offset:27648
  ds_read_b64_tr_b16 v[218:219], v8 offset:27904
  v_rcp_f32 v150, v150
  v_rcp_f32 v151, v151
  v_mfma_f32_32x32x16_bf16 v[184:199], v[228:231], v[124:127], v[184:199]
  ds_read_b64_tr_b16 v[220:221], v8 offset:56320
  ds_read_b64_tr_b16 v[222:223], v8 offset:56576
  buffer_load_dwordx4 a[124:127], v3, s[40:43], s28 offen offset:1024 sc1
  v_mul_f32 v164, v164, v148
  v_mul_f32 v165, v165, v149
  v_mfma_f32_32x32x16_bf16 v[168:183], a[224:227], v[240:243], v[168:183]
  v_mul_f32 v166, v166, v150
  v_mul_f32 v167, v167, v151
  v_cvt_pk_bf16_f32 v142, v164, v165
  v_cvt_pk_bf16_f32 v143, v166, v167
  buffer_store_dwordx4 v[140:143], v1, s[36:39], s90 offen offset:1024 sc1
  v_mul_f32 v200, v244, v200
  v_mfma_f32_32x32x16_bf16 v[184:199], a[226:229], v[240:243], v[184:199]
  v_mul_f32 v201, v244, v201
  v_mul_f32 v202, v244, v202
  v_mul_f32 v203, v244, v203
  v_exp_f32 v200, v200
  s_waitcnt vmcnt(10) lgkmcnt(4)
  v_mfma_f32_32x32x16_bf16 v[168:183], v[232:235], v[128:131], v[168:183]
  ds_read_b64_tr_b16 v[224:225], v2 offset:0
  ds_read_b64_tr_b16 v[226:227], v2 offset:256
  s_lshl_b32 s28, s44, 1
  s_add_u32 s28, s28, 8192
  buffer_load_dwordx4 a[128:131], v7, s[40:43], s28 offen offset:0 sc1
  v_mfma_f32_32x32x16_bf16 v[184:199], v[236:239], v[128:131], v[184:199]
  ds_read_b64_tr_b16 v[228:229], v2 offset:1024
  ds_read_b64_tr_b16 v[230:231], v2 offset:1280
  v_exp_f32 v201, v201
  s_waitcnt vmcnt(9) lgkmcnt(4)
  v_mfma_f32_32x32x16_bf16 v[168:183], v[216:219], v[132:135], v[168:183]
  ds_read_b64_tr_b16 v[232:233], v2 offset:2048
  ds_read_b64_tr_b16 v[234:235], v2 offset:2304
  v_exp_f32 v202, v202
  v_exp_f32 v203, v203
  v_mfma_f32_32x32x16_bf16 v[184:199], v[220:223], v[132:135], v[184:199]
  ds_read_b64_tr_b16 v[236:237], v2 offset:3072
  ds_read_b64_tr_b16 v[238:239], v2 offset:3328
  buffer_load_dwordx4 a[132:135], v3, s[40:43], s28 offen offset:0 sc1
  v_fma_f32 v200, v200, v245, v245
  v_fma_f32 v201, v201, v245, v245
  v_fma_f32 v202, v202, v245, v245
  v_fma_f32 v203, v203, v245, v245
  v_rcp_f32 v200, v200
  v_rcp_f32 v201, v201
  v_rcp_f32 v202, v202
  v_rcp_f32 v203, v203
  v_mul_f32 v208, v208, v200
  v_mul_f32 v209, v209, v201
  v_mul_f32 v210, v210, v202
  v_mul_f32 v211, v211, v203
  v_cvt_pk_bf16_f32 v200, v208, v209
  v_cvt_pk_bf16_f32 v201, v210, v211
  v_mul_f32 v204, v244, v204
  v_mul_f32 v205, v244, v205
  v_mul_f32 v206, v244, v206
  v_mul_f32 v207, v244, v207
  v_exp_f32 v204, v204
  v_exp_f32 v205, v205
  v_exp_f32 v206, v206
  v_exp_f32 v207, v207
  v_fma_f32 v204, v204, v245, v245
  v_fma_f32 v205, v205, v245, v245
  v_fma_f32 v206, v206, v245, v245
  v_fma_f32 v207, v207, v245, v245
  v_rcp_f32 v204, v204
  v_rcp_f32 v205, v205
  v_rcp_f32 v206, v206
  v_rcp_f32 v207, v207
  v_mul_f32 v212, v212, v204
  v_mul_f32 v213, v213, v205
  v_mul_f32 v214, v214, v206
  v_mul_f32 v215, v215, v207
  v_cvt_pk_bf16_f32 v202, v212, v213
  v_cvt_pk_bf16_f32 v203, v214, v215
  buffer_store_dwordx4 v[200:203], v1, s[36:39], s96 offen offset:0 sc1
  s_waitcnt lgkmcnt(4)
  v_mfma_f32_32x32x16_bf16 v[136:151], v[224:227], v[24:27], 0
  ds_read_b64_tr_b16 v[216:217], v2 offset:4096
  ds_read_b64_tr_b16 v[218:219], v2 offset:4352
  s_mul_i32 s79, s3, 28672
  s_add_u32 s79, s79, 9437184
  s_xor_b32 s78, s76, 0
  s_mul_i32 s78, s78, 114688
  v_mfma_f32_32x32x16_bf16 v[136:151], v[228:231], v[28:31], v[136:151]
  ds_read_b64_tr_b16 v[220:221], v2 offset:5120
  ds_read_b64_tr_b16 v[222:223], v2 offset:5376
  s_add_u32 s78, s78, s79
  v_add_u32 v246, s78, v1
  s_xor_b32 s78, s76, 1
  s_waitcnt lgkmcnt(4)
  v_mfma_f32_32x32x16_bf16 v[136:151], v[232:235], v[32:35], v[136:151]
  ds_read_b64_tr_b16 v[224:225], v2 offset:6144
  ds_read_b64_tr_b16 v[226:227], v2 offset:6400
  s_lshl_b32 s28, s44, 1
  s_add_u32 s28, s28, 8192
  buffer_load_dwordx4 a[136:139], v7, s[40:43], s28 offen offset:1024 sc1
  s_mul_i32 s78, s78, 114688
  v_mfma_f32_32x32x16_bf16 v[136:151], v[236:239], v[36:39], v[136:151]
  ds_read_b64_tr_b16 v[228:229], v2 offset:7168
  ds_read_b64_tr_b16 v[230:231], v2 offset:7424
  s_add_u32 s78, s78, s79
  v_add_u32 v247, s78, v1
  v_mul_f32 v168, v251, v168
  s_waitcnt lgkmcnt(4)
  v_mfma_f32_32x32x16_bf16 v[136:151], v[216:219], v[40:43], v[136:151]
  ds_read_b64_tr_b16 v[232:233], v2 offset:8192
  ds_read_b64_tr_b16 v[234:235], v2 offset:8448
  v_mul_f32 v169, v251, v169
  v_mul_f32 v170, v251, v170
  v_mul_f32 v171, v251, v171
  v_mfma_f32_32x32x16_bf16 v[136:151], v[220:223], v[44:47], v[136:151]
  ds_read_b64_tr_b16 v[236:237], v2 offset:9216
  ds_read_b64_tr_b16 v[238:239], v2 offset:9472
  buffer_load_dwordx4 a[140:143], v3, s[40:43], s28 offen offset:1024 sc1
  v_exp_f32 v168, v168
  s_waitcnt lgkmcnt(4)
  v_mfma_f32_32x32x16_bf16 v[136:151], v[224:227], v[48:51], v[136:151]
  ds_read_b64_tr_b16 v[216:217], v2 offset:10240
  ds_read_b64_tr_b16 v[218:219], v2 offset:10496
  v_exp_f32 v169, v169
  v_exp_f32 v170, v170
  v_mfma_f32_32x32x16_bf16 v[136:151], v[228:231], v[52:55], v[136:151]
  ds_read_b64_tr_b16 v[220:221], v2 offset:11264
  ds_read_b64_tr_b16 v[222:223], v2 offset:11520
  v_exp_f32 v171, v171
  v_fma_f32 v168, v168, v252, v252
  s_waitcnt lgkmcnt(4)
  v_mfma_f32_32x32x16_bf16 v[136:151], v[232:235], v[56:59], v[136:151]
  ds_read_b64_tr_b16 v[224:225], v2 offset:12288
  ds_read_b64_tr_b16 v[226:227], v2 offset:12544
  s_lshl_b32 s28, s44, 1
  s_add_u32 s28, s28, 12288
  buffer_load_dwordx4 a[144:147], v7, s[40:43], s28 offen offset:0 sc1
  v_fma_f32 v169, v169, v252, v252
  v_mfma_f32_32x32x16_bf16 v[136:151], v[236:239], v[60:63], v[136:151]
  ds_read_b64_tr_b16 v[228:229], v2 offset:13312
  ds_read_b64_tr_b16 v[230:231], v2 offset:13568
  v_fma_f32 v170, v170, v252, v252
  v_fma_f32 v171, v171, v252, v252
  s_waitcnt lgkmcnt(4)
  v_mfma_f32_32x32x16_bf16 v[136:151], v[216:219], v[64:67], v[136:151]
  ds_read_b64_tr_b16 v[232:233], v2 offset:14336
  ds_read_b64_tr_b16 v[234:235], v2 offset:14592
  v_rcp_f32 v168, v168
  v_rcp_f32 v169, v169
  v_mfma_f32_32x32x16_bf16 v[136:151], v[220:223], v[68:71], v[136:151]
  ds_read_b64_tr_b16 v[236:237], v2 offset:15360
  ds_read_b64_tr_b16 v[238:239], v2 offset:15616
  buffer_load_dwordx4 a[148:151], v3, s[40:43], s28 offen offset:0 sc1
  v_rcp_f32 v170, v170
  s_waitcnt lgkmcnt(4)
  v_mfma_f32_32x32x16_bf16 v[136:151], v[224:227], v[72:75], v[136:151]
  ds_read_b64_tr_b16 v[216:217], v2 offset:16384
  ds_read_b64_tr_b16 v[218:219], v2 offset:16640
  v_rcp_f32 v171, v171
  v_mul_f32 v184, v184, v168
  v_mul_f32 v185, v185, v169
  v_mfma_f32_32x32x16_bf16 v[136:151], v[228:231], v[76:79], v[136:151]
  ds_read_b64_tr_b16 v[220:221], v2 offset:17408
  ds_read_b64_tr_b16 v[222:223], v2 offset:17664
  v_mul_f32 v186, v186, v170
  v_mul_f32 v187, v187, v171
  v_cvt_pk_bf16_f32 v168, v184, v185
  s_waitcnt lgkmcnt(4)
  v_mfma_f32_32x32x16_bf16 v[136:151], v[232:235], v[80:83], v[136:151]
  ds_read_b64_tr_b16 v[224:225], v2 offset:18432
  ds_read_b64_tr_b16 v[226:227], v2 offset:18688
  s_lshl_b32 s28, s44, 1
  s_add_u32 s28, s28, 12288
  buffer_load_dwordx4 a[152:155], v7, s[40:43], s28 offen offset:1024 sc1
  v_cvt_pk_bf16_f32 v169, v186, v187
  v_mfma_f32_32x32x16_bf16 v[136:151], v[236:239], v[84:87], v[136:151]
  ds_read_b64_tr_b16 v[228:229], v2 offset:19456
  ds_read_b64_tr_b16 v[230:231], v2 offset:19712
  v_mul_f32 v172, v251, v172
  v_mul_f32 v173, v251, v173
  v_mul_f32 v174, v251, v174
  s_waitcnt lgkmcnt(4)
  v_mfma_f32_32x32x16_bf16 v[136:151], v[216:219], v[88:91], v[136:151]
  ds_read_b64_tr_b16 v[232:233], v2 offset:20480
  ds_read_b64_tr_b16 v[234:235], v2 offset:20736
  v_mul_f32 v175, v251, v175
  v_exp_f32 v172, v172
  v_mfma_f32_32x32x16_bf16 v[136:151], v[220:223], v[92:95], v[136:151]
  ds_read_b64_tr_b16 v[236:237], v2 offset:21504
  ds_read_b64_tr_b16 v[238:239], v2 offset:21760
  buffer_load_dwordx4 a[156:159], v3, s[40:43], s28 offen offset:1024 sc1
  v_exp_f32 v173, v173
  s_waitcnt lgkmcnt(4)
  v_mfma_f32_32x32x16_bf16 v[136:151], v[224:227], v[96:99], v[136:151]
  ds_read_b64_tr_b16 v[216:217], v2 offset:22528
  ds_read_b64_tr_b16 v[218:219], v2 offset:22784
  v_exp_f32 v174, v174
  v_exp_f32 v175, v175
  v_mfma_f32_32x32x16_bf16 v[136:151], v[228:231], v[100:103], v[136:151]
  ds_read_b64_tr_b16 v[220:221], v2 offset:23552
  ds_read_b64_tr_b16 v[222:223], v2 offset:23808
  v_fma_f32 v172, v172, v252, v252
  v_fma_f32 v173, v173, v252, v252
  v_fma_f32 v174, v174, v252, v252
  s_waitcnt lgkmcnt(4)
  v_mfma_f32_32x32x16_bf16 v[136:151], v[232:235], v[104:107], v[136:151]
  ds_read_b64_tr_b16 v[224:225], v2 offset:24576
  ds_read_b64_tr_b16 v[226:227], v2 offset:24832
  s_add_u32 s28, s44, 65536
  buffer_load_dwordx4 a[160:163], v7, s[40:43], s28 offen offset:0 sc1
  v_fma_f32 v175, v175, v252, v252
  v_mfma_f32_32x32x16_bf16 v[136:151], v[236:239], v[108:111], v[136:151]
  ds_read_b64_tr_b16 v[228:229], v2 offset:25600
  ds_read_b64_tr_b16 v[230:231], v2 offset:25856
  v_rcp_f32 v172, v172
  s_waitcnt lgkmcnt(4)
  v_mfma_f32_32x32x16_bf16 v[136:151], v[216:219], v[112:115], v[136:151]
  ds_read_b64_tr_b16 v[232:233], v2 offset:26624
  ds_read_b64_tr_b16 v[234:235], v2 offset:26880
  v_rcp_f32 v173, v173
  v_rcp_f32 v174, v174
  v_rcp_f32 v175, v175
  v_mul_f32 v188, v188, v172
  v_mul_f32 v189, v189, v173
  v_mul_f32 v190, v190, v174
  v_mul_f32 v191, v191, v175
  v_cvt_pk_bf16_f32 v170, v188, v189
  v_cvt_pk_bf16_f32 v171, v190, v191
  buffer_store_dwordx4 v[168:171], v1, s[36:39], s91 offen offset:0 sc1
  s_waitcnt vmcnt(8)
  s_add_u32 s83, s52, 2
  v_mov_b32 v255, s83
  buffer_store_dword v255, v4, s[36:39], s92 offen sc1
  buffer_load_dword v15, v12, s[36:39], s94 offen sc1
  v_mfma_f32_32x32x16_bf16 v[136:151], v[220:223], v[116:119], v[136:151]
  ds_read_b64_tr_b16 v[236:237], v2 offset:27648
  ds_read_b64_tr_b16 v[238:239], v2 offset:27904
  buffer_load_dwordx4 a[164:167], v3, s[40:43], s28 offen offset:0 sc1
  v_mul_f32 v176, v251, v176
  v_mul_f32 v177, v251, v177
  s_waitcnt lgkmcnt(4)
  v_mfma_f32_32x32x16_bf16 v[136:151], v[224:227], v[120:123], v[136:151]
  ds_read_b128 v[216:219], v10 offset:0
  v_mul_f32 v178, v251, v178
  v_mul_f32 v179, v251, v179
  v_exp_f32 v176, v176
  v_mfma_f32_32x32x16_bf16 v[136:151], v[228:231], v[124:127], v[136:151]
  ds_read_b128 v[220:223], v10 offset:1024
  v_exp_f32 v177, v177
  v_exp_f32 v178, v178
  v_mfma_f32_32x32x16_bf16 v[136:151], a[228:231], v[240:243], v[136:151]
  s_add_u32 s28, s46, 98304
  buffer_load_dwordx4 a[168:171], v7, s[40:43], s28 offen offset:0 sc1
  v_exp_f32 v179, v179
  v_fma_f32 v176, v176, v252, v252
  s_waitcnt lgkmcnt(2)
  v_mfma_f32_32x32x16_bf16 v[136:151], v[232:235], v[128:131], v[136:151]
  ds_read_b128 v[224:227], v10 offset:2048
  v_fma_f32 v177, v177, v252, v252
  v_fma_f32 v178, v178, v252, v252
  v_fma_f32 v179, v179, v252, v252
  v_rcp_f32 v176, v176
  v_mfma_f32_32x32x16_bf16 v[136:151], v[236:239], v[132:135], v[136:151]
  ds_read_b128 v[228:231], v10 offset:3072
  v_rcp_f32 v177, v177
  v_rcp_f32 v178, v178
  s_waitcnt lgkmcnt(2)
  v_mfma_f32_32x32x16_bf16 v[152:167], v[216:219], v[24:27], 0
  ds_read_b128 v[232:235], v10 offset:4096
  buffer_load_dwordx4 a[172:175], v3, s[40:43], s28 offen offset:0 sc1
  v_rcp_f32 v179, v179
  v_mul_f32 v192, v192, v176
  v_mul_f32 v193, v193, v177
  v_mfma_f32_32x32x16_bf16 v[152:167], v[220:223], v[28:31], v[152:167]
  ds_read_b128 v[236:239], v10 offset:5120
  v_mul_f32 v194, v194, v178
  v_mul_f32 v195, v195, v179
  v_cvt_pk_bf16_f32 v172, v192, v193
  v_cvt_pk_bf16_f32 v173, v194, v195
  s_waitcnt lgkmcnt(2)
  v_mfma_f32_32x32x16_bf16 v[152:167], v[224:227], v[32:35], v[152:167]
  ds_read_b128 v[216:219], v10 offset:6144
  v_mul_f32 v180, v251, v180
  v_mul_f32 v181, v251, v181
  v_mul_f32 v182, v251, v182
  v_mul_f32 v183, v251, v183
  v_mfma_f32_32x32x16_bf16 v[152:167], v[228:231], v[36:39], v[152:167]
  ds_read_b128 v[220:223], v10 offset:7168
  s_add_u32 s28, s44, 67584
  buffer_load_dwordx4 a[176:179], v7, s[40:43], s28 offen offset:0 sc1
  v_exp_f32 v180, v180
  s_waitcnt lgkmcnt(2)
  v_mfma_f32_32x32x16_bf16 v[152:167], v[232:235], v[40:43], v[152:167]
  ds_read_b128 v[224:227], v10 offset:8192
  v_exp_f32 v181, v181
  v_exp_f32 v182, v182
  v_mfma_f32_32x32x16_bf16 v[152:167], v[236:239], v[44:47], v[152:167]
  ds_read_b128 v[228:231], v10 offset:9216
  v_exp_f32 v183, v183
  v_fma_f32 v180, v180, v252, v252
  v_fma_f32 v181, v181, v252, v252
  s_waitcnt lgkmcnt(2)
  v_mfma_f32_32x32x16_bf16 v[152:167], v[216:219], v[48:51], v[152:167]
  ds_read_b128 v[232:235], v10 offset:10240
  buffer_load_dwordx4 a[180:183], v3, s[40:43], s28 offen offset:0 sc1
  v_fma_f32 v182, v182, v252, v252
  v_fma_f32 v183, v183, v252, v252
  v_rcp_f32 v180, v180
  v_mfma_f32_32x32x16_bf16 v[152:167], v[220:223], v[52:55], v[152:167]
  ds_read_b128 v[236:239], v10 offset:11264
  s_add_u32 s84, s52, 2
  s_waitcnt vmcnt(5)
  v_subrev_u32 v15, s84, v15
  v_cmp_le_u32 vcc, 16, v15
  s_cbranch_vccnz Lslow_50
Lback_51:
  s_waitcnt lgkmcnt(2)
  v_mfma_f32_32x32x16_bf16 v[152:167], v[224:227], v[56:59], v[152:167]
  ds_read_b128 v[216:219], v10 offset:12288
  buffer_load_dwordx4 v[24:27], v246, s[40:43], 0 offen offset:0 sc1
  v_rcp_f32 v181, v181
  v_rcp_f32 v182, v182
  v_mfma_f32_32x32x16_bf16 v[152:167], v[228:231], v[60:63], v[152:167]
  ds_read_b128 v[220:223], v10 offset:13312
  s_add_u32 s28, s46, 99328
  buffer_load_dwordx4 a[184:187], v7, s[40:43], s28 offen offset:0 sc1
  v_rcp_f32 v183, v183
  s_waitcnt lgkmcnt(2)
  v_mfma_f32_32x32x16_bf16 v[152:167], v[232:235], v[64:67], v[152:167]
  ds_read_b128 v[224:227], v10 offset:14336
  buffer_load_dwordx4 v[28:31], v247, s[40:43], 0 offen offset:0 sc1
  v_mul_f32 v196, v196, v180
  v_mul_f32 v197, v197, v181
  v_mul_f32 v198, v198, v182
  v_mul_f32 v199, v199, v183
  v_mfma_f32_32x32x16_bf16 v[152:167], v[236:239], v[68:71], v[152:167]
  ds_read_b128 v[228:231], v10 offset:15360
  v_cvt_pk_bf16_f32 v174, v196, v197
  v_cvt_pk_bf16_f32 v175, v198, v199
  buffer_store_dwordx4 v[172:175], v1, s[36:39], s91 offen offset:1024 sc1
  v_lshlrev_b32 v168, 16, v16
  s_waitcnt lgkmcnt(2)
  v_mfma_f32_32x32x16_bf16 v[152:167], v[216:219], v[72:75], v[152:167]
  ds_read_b128 v[232:235], v10 offset:16384
  buffer_load_dwordx4 v[32:35], v246, s[40:43], 0 offen offset:1024 sc1
  buffer_load_dwordx4 a[188:191], v3, s[40:43], s28 offen offset:0 sc1
  v_and_b32 v169, 0xffff0000, v16
  v_lshlrev_b32 v170, 16, v17
  v_and_b32 v171, 0xffff0000, v17
  v_mfma_f32_32x32x16_bf16 v[152:167], v[220:223], v[76:79], v[152:167]
  ds_read_b128 v[236:239], v10 offset:17408
  v_lshlrev_b32 v172, 16, v18
  v_and_b32 v173, 0xffff0000, v18
  v_lshlrev_b32 v174, 16, v19
  v_and_b32 v175, 0xffff0000, v19
  s_waitcnt lgkmcnt(2)
  v_mfma_f32_32x32x16_bf16 v[152:167], v[224:227], v[80:83], v[152:167]
  ds_read_b128 v[216:219], v10 offset:18432
  buffer_load_dwordx4 v[36:39], v247, s[40:43], 0 offen offset:1024 sc1
  v_lshlrev_b32 v176, 16, v20
  v_and_b32 v177, 0xffff0000, v20
  v_lshlrev_b32 v178, 16, v21
  v_and_b32 v179, 0xffff0000, v21
  v_mfma_f32_32x32x16_bf16 v[152:167], v[228:231], v[84:87], v[152:167]
  ds_read_b128 v[220:223], v10 offset:19456
  s_add_u32 s28, s44, 69632
  buffer_load_dwordx4 a[192:195], v7, s[40:43], s28 offen offset:0 sc1
  v_lshlrev_b32 v180, 16, v22
  v_and_b32 v181, 0xffff0000, v22
  s_waitcnt lgkmcnt(2)
  v_mfma_f32_32x32x16_bf16 v[152:167], v[232:235], v[88:91], v[152:167]
  ds_read_b128 v[224:227], v10 offset:20480
  buffer_load_dwordx4 v[40:43], v246, s[40:43], 0 offen offset:2048 sc1
  v_lshlrev_b32 v182, 16, v23
  v_and_b32 v183, 0xffff0000, v23
  s_add_u32 s91, s91, 8192
  v_lshrrev_b32 v249, 2, v1
  v_mfma_f32_32x32x16_bf16 v[152:167], v[236:239], v[92:95], v[152:167]
  ds_read_b128 v[228:231], v10 offset:21504
  v_and_b32 v249, 0x3c, v249
  v_mul_f32 v136, v251, v136
  v_mul_f32 v137, v251, v137
  v_mul_f32 v138, v251, v138
  s_waitcnt lgkmcnt(2)
  v_mfma_f32_32x32x16_bf16 v[152:167], v[216:219], v[96:99], v[152:167]
  ds_read_b128 v[232:235], v10 offset:22528
  buffer_load_dwordx4 v[44:47], v247, s[40:43], 0 offen offset:2048 sc1
  buffer_load_dwordx4 a[196:199], v3, s[40:43], s28 offen offset:0 sc1
  v_mul_f32 v139, v251, v139
  v_exp_f32 v136, v136
  v_mfma_f32_32x32x16_bf16 v[152:167], v[220:223], v[100:103], v[152:167]
  ds_read_b128 v[236:239], v10 offset:23552
  v_exp_f32 v137, v137
  v_exp_f32 v138, v138
  s_waitcnt lgkmcnt(2)
  v_mfma_f32_32x32x16_bf16 v[152:167], v[224:227], v[104:107], v[152:167]
  ds_read_b128 v[216:219], v10 offset:24576
  buffer_load_dwordx4 v[48:51], v246, s[40:43], 0 offen offset:3072 sc1
  v_exp_f32 v139, v139
  v_fma_f32 v136, v136, v252, v252
  v_fma_f32 v137, v137, v252, v252
  v_mfma_f32_32x32x16_bf16 v[152:167], v[228:231], v[108:111], v[152:167]
  ds_read_b128 v[220:223], v10 offset:25600
  s_add_u32 s28, s46, 100352
  buffer_load_dwordx4 a[200:203], v7, s[40:43], s28 offen offset:0 sc1
  v_fma_f32 v138, v138, v252, v252
  v_fma_f32 v139, v139, v252, v252
  s_waitcnt lgkmcnt(2)
  v_mfma_f32_32x32x16_bf16 v[152:167], v[232:235], v[112:115], v[152:167]
  ds_read_b128 v[224:227], v10 offset:26624
  buffer_load_dwordx4 v[52:55], v247, s[40:43], 0 offen offset:3072 sc1
  v_rcp_f32 v136, v136
  v_rcp_f32 v137, v137
  v_mfma_f32_32x32x16_bf16 v[152:167], v[236:239], v[116:119], v[152:167]
  ds_read_b128 v[228:231], v10 offset:27648
  v_rcp_f32 v138, v138
  v_rcp_f32 v139, v139
  s_waitcnt lgkmcnt(2)
  v_mfma_f32_32x32x16_bf16 v[152:167], v[216:219], v[120:123], v[152:167]
  buffer_load_dwordx4 v[56:59], v246, s[40:43], s57 offen offset:0 sc1
  buffer_load_dwordx4 a[204:207], v3, s[40:43], s28 offen offset:0 sc1
  v_mul_f32 v144, v144, v136
  v_mul_f32 v145, v145, v137
  v_mul_f32 v146, v146, v138
  v_mul_f32 v147, v147, v139
  v_mfma_f32_32x32x16_bf16 v[152:167], v[220:223], v[124:127], v[152:167]
  v_cvt_pk_bf16_f32 v136, v144, v145
  v_cvt_pk_bf16_f32 v137, v146, v147
  v_mul_f32 v140, v251, v140
  v_mul_f32 v141, v251, v141
  v_mul_f32 v142, v251, v142
  v_mfma_f32_32x32x16_bf16 v[152:167], a[230:233], v[240:243], v[152:167]
  v_mul_f32 v143, v251, v143
  v_exp_f32 v140, v140
  v_exp_f32 v141, v141
  s_waitcnt lgkmcnt(0)
  v_mfma_f32_32x32x16_bf16 v[152:167], v[224:227], v[128:131], v[152:167]
  buffer_load_dwordx4 v[60:63], v247, s[40:43], s57 offen offset:0 sc1
  s_add_u32 s28, s44, 71680
  buffer_load_dwordx4 a[208:211], v7, s[40:43], s28 offen offset:0 sc1
  v_exp_f32 v142, v142
  v_mfma_f32_32x32x16_bf16 v[152:167], v[228:231], v[132:135], v[152:167]
  v_exp_f32 v143, v143
  v_fma_f32 v140, v140, v252, v252
  v_fma_f32 v141, v141, v252, v252
  v_fma_f32 v142, v142, v252, v252
  v_fma_f32 v143, v143, v252, v252
  s_barrier
  s_waitcnt vmcnt(17)
  v_mfma_f32_32x32x16_bf16 v[168:183], a[0:3], v[24:27], v[168:183]
  v_rcp_f32 v140, v140
  v_rcp_f32 v141, v141
  v_rcp_f32 v142, v142
  v_mfma_f32_32x32x16_bf16 v[184:199], a[4:7], v[24:27], 0
  buffer_load_dwordx4 v[64:67], v246, s[40:43], s57 offen offset:1024 sc1
  buffer_load_dwordx4 a[212:215], v3, s[40:43], s28 offen offset:0 sc1
  v_rcp_f32 v143, v143
  v_mul_f32 v148, v148, v140
  s_waitcnt vmcnt(17)
  v_mfma_f32_32x32x16_bf16 v[200:215], a[0:3], v[28:31], 0
  v_mul_f32 v149, v149, v141
  v_mul_f32 v150, v150, v142
  v_mul_f32 v151, v151, v143
  v_cvt_pk_bf16_f32 v138, v148, v149
  v_cvt_pk_bf16_f32 v139, v150, v151
  buffer_store_dwordx4 v[136:139], v1, s[36:39], s91 offen offset:0 sc1
  v_mfma_f32_32x32x16_bf16 v[216:231], a[4:7], v[28:31], 0
  buffer_load_dwordx4 v[68:71], v247, s[40:43], s57 offen offset:1024 sc1
  s_add_u32 s28, s46, 101376
  buffer_load_dwordx4 a[216:219], v7, s[40:43], s28 offen offset:0 sc1
  s_waitcnt vmcnt(19)
  s_waitcnt vmcnt(18)
  v_mfma_f32_32x32x16_bf16 v[168:183], a[8:11], v[32:35], v[168:183]
  s_add_u32 s83, s52, 2
  v_mov_b32 v255, s83
  buffer_store_dword v255, v4, s[36:39], s93 offen sc1
  v_mul_f32 v152, v251, v152
  v_mul_f32 v153, v251, v153
  v_mul_f32 v154, v251, v154
  v_mfma_f32_32x32x16_bf16 v[184:199], a[12:15], v[32:35], v[184:199]
  buffer_load_dwordx4 v[72:75], v246, s[40:43], s57 offen offset:2048 sc1
  buffer_load_dwordx4 a[220:223], v3, s[40:43], s28 offen offset:0 sc1
  v_mul_f32 v155, v251, v155
  v_exp_f32 v152, v152
  s_waitcnt vmcnt(19)
  v_mfma_f32_32x32x16_bf16 v[200:215], a[8:11], v[36:39], v[200:215]
  v_exp_f32 v153, v153
  v_exp_f32 v154, v154
  v_exp_f32 v155, v155
  v_mfma_f32_32x32x16_bf16 v[216:231], a[12:15], v[36:39], v[216:231]
  buffer_load_dwordx4 v[76:79], v247, s[40:43], s57 offen offset:2048 sc1
  v_fma_f32 v152, v152, v252, v252
  v_fma_f32 v153, v153, v252, v252
  v_fma_f32 v154, v154, v252, v252
  v_fma_f32 v155, v155, v252, v252
  s_waitcnt vmcnt(18)
  v_mfma_f32_32x32x16_bf16 v[168:183], a[16:19], v[40:43], v[168:183]
  v_rcp_f32 v152, v152
  v_rcp_f32 v153, v153
  v_rcp_f32 v154, v154
  v_mfma_f32_32x32x16_bf16 v[184:199], a[20:23], v[40:43], v[184:199]
  buffer_load_dwordx4 v[80:83], v246, s[40:43], s57 offen offset:3072 sc1
  v_rcp_f32 v155, v155
  v_mul_f32 v160, v160, v152
  v_mul_f32 v161, v161, v153
  s_waitcnt vmcnt(18)
  v_mfma_f32_32x32x16_bf16 v[200:215], a[16:19], v[44:47], v[200:215]
  v_mul_f32 v162, v162, v154
  v_mul_f32 v163, v163, v155
  v_cvt_pk_bf16_f32 v152, v160, v161
  v_cvt_pk_bf16_f32 v153, v162, v163
  v_mul_f32 v156, v251, v156
  v_mul_f32 v157, v251, v157
  v_mfma_f32_32x32x16_bf16 v[216:231], a[20:23], v[44:47], v[216:231]
  buffer_load_dwordx4 v[84:87], v247, s[40:43], s57 offen offset:3072 sc1
  v_mul_f32 v158, v251, v158
  v_mul_f32 v159, v251, v159
  v_exp_f32 v156, v156
  s_waitcnt vmcnt(17)
  v_mfma_f32_32x32x16_bf16 v[168:183], a[24:27], v[48:51], v[168:183]
  v_exp_f32 v157, v157
  v_exp_f32 v158, v158
  v_exp_f32 v159, v159
  v_mfma_f32_32x32x16_bf16 v[184:199], a[28:31], v[48:51], v[184:199]
  buffer_load_dword v15, v12, s[36:39], s95 offen sc1
  buffer_load_dwordx4 v[88:91], v246, s[40:43], s58 offen offset:0 sc1
  v_fma_f32 v156, v156, v252, v252
  v_fma_f32 v157, v157, v252, v252
  v_fma_f32 v158, v158, v252, v252
  s_waitcnt vmcnt(17)
  v_mfma_f32_32x32x16_bf16 v[200:215], a[24:27], v[52:55], v[200:215]
  v_fma_f32 v159, v159, v252, v252
  v_rcp_f32 v156, v156
  v_rcp_f32 v157, v157
  v_mfma_f32_32x32x16_bf16 v[216:231], a[28:31], v[52:55], v[216:231]
  buffer_load_dwordx4 v[92:95], v247, s[40:43], s58 offen offset:0 sc1
  v_rcp_f32 v158, v158
  v_rcp_f32 v159, v159
  s_waitcnt vmcnt(17)
  v_mfma_f32_32x32x16_bf16 v[168:183], a[32:35], v[56:59], v[168:183]
  v_mul_f32 v164, v164, v156
  v_mul_f32 v165, v165, v157
  v_mul_f32 v166, v166, v158
  v_mul_f32 v167, v167, v159
  v_cvt_pk_bf16_f32 v154, v164, v165
  v_cvt_pk_bf16_f32 v155, v166, v167
  v_mfma_f32_32x32x16_bf16 v[184:199], a[36:39], v[56:59], v[184:199]
  buffer_load_dwordx4 v[96:99], v246, s[40:43], s58 offen offset:1024 sc1
  buffer_store_dwordx4 v[152:155], v1, s[36:39], s91 offen offset:1024 sc1
  s_waitcnt vmcnt(17)
  v_mfma_f32_32x32x16_bf16 v[200:215], a[32:35], v[60:63], v[200:215]
  v_mfma_f32_32x32x16_bf16 v[216:231], a[36:39], v[60:63], v[216:231]
  buffer_load_dwordx4 v[100:103], v247, s[40:43], s58 offen offset:1024 sc1
  s_waitcnt vmcnt(16)
  v_mfma_f32_32x32x16_bf16 v[168:183], a[40:43], v[64:67], v[168:183]
  v_mfma_f32_32x32x16_bf16 v[184:199], a[44:47], v[64:67], v[184:199]
  buffer_load_dwordx4 v[104:107], v246, s[40:43], s58 offen offset:2048 sc1
  s_waitcnt vmcnt(14)
  v_mfma_f32_32x32x16_bf16 v[200:215], a[40:43], v[68:71], v[200:215]
  v_mfma_f32_32x32x16_bf16 v[216:231], a[44:47], v[68:71], v[216:231]
  buffer_load_dwordx4 v[108:111], v247, s[40:43], s58 offen offset:2048 sc1
  s_waitcnt vmcnt(12)
  v_mfma_f32_32x32x16_bf16 v[168:183], a[48:51], v[72:75], v[168:183]
  v_mfma_f32_32x32x16_bf16 v[184:199], a[52:55], v[72:75], v[184:199]
  buffer_load_dwordx4 v[112:115], v246, s[40:43], s58 offen offset:3072 sc1
  s_waitcnt vmcnt(11)
  v_mfma_f32_32x32x16_bf16 v[200:215], a[48:51], v[76:79], v[200:215]
  v_mfma_f32_32x32x16_bf16 v[216:231], a[52:55], v[76:79], v[216:231]
  buffer_load_dwordx4 v[116:119], v247, s[40:43], s58 offen offset:3072 sc1
  s_waitcnt vmcnt(11)
  v_mfma_f32_32x32x16_bf16 v[168:183], a[56:59], v[80:83], v[168:183]
  v_mfma_f32_32x32x16_bf16 v[184:199], a[60:63], v[80:83], v[184:199]
  s_add_u32 s84, s52, 2
  s_waitcnt vmcnt(9)
  v_subrev_u32 v15, s84, v15
  v_cmp_le_u32 vcc, 16, v15
  s_cbranch_vccnz Lslow_52
Lback_53:
  buffer_load_dwordx4 v[120:123], v246, s[40:43], s59 offen offset:0 sc1
  v_mfma_f32_32x32x16_bf16 v[200:215], a[56:59], v[84:87], v[200:215]
  v_mfma_f32_32x32x16_bf16 v[216:231], a[60:63], v[84:87], v[216:231]
  buffer_load_dwordx4 v[124:127], v247, s[40:43], s59 offen offset:0 sc1
  s_waitcnt vmcnt(10)
  v_mfma_f32_32x32x16_bf16 v[168:183], a[64:67], v[88:91], v[168:183]
  v_mfma_f32_32x32x16_bf16 v[184:199], a[68:71], v[88:91], v[184:199]
  buffer_load_dwordx4 v[128:131], v246, s[40:43], s59 offen offset:1024 sc1
  s_waitcnt vmcnt(10)
  v_mfma_f32_32x32x16_bf16 v[200:215], a[64:67], v[92:95], v[200:215]
  v_mfma_f32_32x32x16_bf16 v[216:231], a[68:71], v[92:95], v[216:231]
  buffer_load_dwordx4 v[132:135], v247, s[40:43], s59 offen offset:1024 sc1
  s_waitcnt vmcnt(10)
  v_mfma_f32_32x32x16_bf16 v[168:183], a[72:75], v[96:99], v[168:183]
  v_mfma_f32_32x32x16_bf16 v[184:199], a[76:79], v[96:99], v[184:199]
  buffer_load_dwordx4 v[24:27], v246, s[40:43], s59 offen offset:2048 sc1
  s_waitcnt vmcnt(9)
  v_mfma_f32_32x32x16_bf16 v[200:215], a[72:75], v[100:103], v[200:215]
  v_mfma_f32_32x32x16_bf16 v[216:231], a[76:79], v[100:103], v[216:231]
  buffer_load_dwordx4 v[28:31], v247, s[40:43], s59 offen offset:2048 sc1
  s_waitcnt vmcnt(9)
  v_mfma_f32_32x32x16_bf16 v[168:183], a[80:83], v[104:107], v[168:183]
  v_mfma_f32_32x32x16_bf16 v[184:199], a[84:87], v[104:107], v[184:199]
  buffer_load_dwordx4 v[32:35], v246, s[40:43], s59 offen offset:3072 sc1
  s_waitcnt vmcnt(9)
  v_mfma_f32_32x32x16_bf16 v[200:215], a[80:83], v[108:111], v[200:215]
  v_mfma_f32_32x32x16_bf16 v[216:231], a[84:87], v[108:111], v[216:231]
  buffer_load_dwordx4 v[36:39], v247, s[40:43], s59 offen offset:3072 sc1
  s_waitcnt vmcnt(9)
  v_mfma_f32_32x32x16_bf16 v[168:183], a[88:91], v[112:115], v[168:183]
  v_mfma_f32_32x32x16_bf16 v[184:199], a[92:95], v[112:115], v[184:199]
  buffer_load_dwordx4 v[40:43], v246, s[40:43], s60 offen offset:0 sc1
  s_add_u32 s83, s52, 3
  v_mov_b32 v255, s83
  buffer_store_dword v255, v4, s[36:39], s93 offen sc1
  s_waitcnt vmcnt(10)
  v_mfma_f32_32x32x16_bf16 v[200:215], a[88:91], v[116:119], v[200:215]
  v_mfma_f32_32x32x16_bf16 v[216:231], a[92:95], v[116:119], v[216:231]
  buffer_load_dwordx4 v[44:47], v247, s[40:43], s60 offen offset:0 sc1
  s_waitcnt vmcnt(10)
  v_mfma_f32_32x32x16_bf16 v[168:183], a[96:99], v[120:123], v[168:183]
  v_mfma_f32_32x32x16_bf16 v[184:199], a[100:103], v[120:123], v[184:199]
  buffer_load_dwordx4 v[48:51], v246, s[40:43], s60 offen offset:1024 sc1
  s_waitcnt vmcnt(10)
  v_mfma_f32_32x32x16_bf16 v[200:215], a[96:99], v[124:127], v[200:215]
  v_mfma_f32_32x32x16_bf16 v[216:231], a[100:103], v[124:127], v[216:231]
  buffer_load_dword v15, v12, s[36:39], s95 offen sc1
  buffer_load_dwordx4 v[52:55], v247, s[40:43], s60 offen offset:1024 sc1
  s_waitcnt vmcnt(11)
  v_mfma_f32_32x32x16_bf16 v[168:183], a[104:107], v[128:131], v[168:183]
  v_mfma_f32_32x32x16_bf16 v[184:199], a[108:111], v[128:131], v[184:199]
  buffer_load_dwordx4 v[56:59], v246, s[40:43], s60 offen offset:2048 sc1
  s_waitcnt vmcnt(11)
  v_mfma_f32_32x32x16_bf16 v[200:215], a[104:107], v[132:135], v[200:215]
  v_mfma_f32_32x32x16_bf16 v[216:231], a[108:111], v[132:135], v[216:231]
  buffer_load_dwordx4 v[60:63], v247, s[40:43], s60 offen offset:2048 sc1
  s_waitcnt vmcnt(11)
  v_mfma_f32_32x32x16_bf16 v[168:183], a[112:115], v[24:27], v[168:183]
  v_mfma_f32_32x32x16_bf16 v[184:199], a[116:119], v[24:27], v[184:199]
  buffer_load_dwordx4 v[64:67], v246, s[40:43], s60 offen offset:3072 sc1
  s_waitcnt vmcnt(11)
  v_mfma_f32_32x32x16_bf16 v[200:215], a[112:115], v[28:31], v[200:215]
  v_mfma_f32_32x32x16_bf16 v[216:231], a[116:119], v[28:31], v[216:231]
  buffer_load_dwordx4 v[68:71], v247, s[40:43], s60 offen offset:3072 sc1
  v_add_u32 v250, s64, v1
  s_xor_b32 s82, s3, 1
  s_mul_i32 s82, s82, 12288
  s_waitcnt vmcnt(11)
  v_mfma_f32_32x32x16_bf16 v[168:183], a[120:123], v[32:35], v[168:183]
  s_add_u32 m0, s63, 86016
  s_add_u32 s97, s65, 16777216
  buffer_load_dwordx4 v1, s[36:39], s97 offen sc1 lds
  s_add_u32 s82, s82, 114688
  v_add_u32 v251, s82, v1
  s_xor_b32 s82, s3, 2
  v_mfma_f32_32x32x16_bf16 v[184:199], a[124:127], v[32:35], v[184:199]
  s_mul_i32 s82, s82, 12288
  s_add_u32 s82, s82, 118784
  v_add_u32 v252, s82, v1
  s_xor_b32 s82, s3, 3
  s_mul_i32 s82, s82, 12288
  s_waitcnt vmcnt(11)
  v_mfma_f32_32x32x16_bf16 v[200:215], a[120:123], v[36:39], v[200:215]
  s_add_u32 s82, s82, 122880
  v_add_u32 v253, s82, v1
  s_lshl_b32 s80, s76, 15
  s_add_u32 s80, s80, 5242880
  s_lshl_b32 s79, s77, 11
  s_add_u32 s78, s80, s79
  v_mfma_f32_32x32x16_bf16 v[216:231], a[124:127], v[36:39], v[216:231]
  s_add_u32 m0, s63, 87040
  s_add_u32 s97, s65, 16778240
  buffer_load_dwordx4 v1, s[36:39], s97 offen sc1 lds
  s_lshl_b32 s79, s55, 9
  s_add_u32 s79, s79, s80
  s_waitcnt vmcnt(11)
  v_mfma_f32_32x32x16_bf16 v[168:183], a[128:131], v[40:43], v[168:183]
  s_and_b32 s80, s3, 1
  s_lshl_b32 s80, s80, 3
  s_add_u32 s79, s79, s80
  s_add_u32 s79, s79, 28672
  s_lshl_b32 s80, s76, 7
  s_lshl_b32 s82, s77, 2
  v_mfma_f32_32x32x16_bf16 v[184:199], a[132:135], v[40:43], v[184:199]
  s_add_u32 s80, s80, s82
  s_add_u32 s80, s80, 24576
  s_waitcnt vmcnt(9)
  v_mfma_f32_32x32x16_bf16 v[200:215], a[128:131], v[44:47], v[200:215]
  s_add_u32 m0, s63, 88064
  s_add_u32 s97, s65, 16779264
  buffer_load_dwordx4 v1, s[36:39], s97 offen sc1 lds
  v_mfma_f32_32x32x16_bf16 v[216:231], a[132:135], v[44:47], v[216:231]
  s_add_u32 s84, s52, 3
  s_waitcnt vmcnt(8)
  v_subrev_u32 v15, s84, v15
  v_cmp_le_u32 vcc, 16, v15
  s_cbranch_vccnz Lslow_54
Lback_55:
  buffer_load_dwordx4 v[72:75], v246, s[40:43], s61 offen offset:0 sc1
  buffer_load_dwordx4 v[76:79], v247, s[40:43], s61 offen offset:0 sc1
  v_mfma_f32_32x32x16_bf16 v[168:183], a[136:139], v[48:51], v[168:183]
  v_mfma_f32_32x32x16_bf16 v[184:199], a[140:143], v[48:51], v[184:199]
  buffer_load_dwordx4 v[80:83], v246, s[40:43], s61 offen offset:1024 sc1
  buffer_load_dwordx4 v[84:87], v247, s[40:43], s61 offen offset:1024 sc1
  s_add_u32 m0, s63, 89088
  s_add_u32 s97, s65, 16780288
  buffer_load_dwordx4 v1, s[36:39], s97 offen sc1 lds
  s_waitcnt vmcnt(12)
  v_mfma_f32_32x32x16_bf16 v[200:215], a[136:139], v[52:55], v[200:215]
  v_mfma_f32_32x32x16_bf16 v[216:231], a[140:143], v[52:55], v[216:231]
  buffer_load_dwordx4 v[92:95], v247, s[40:43], s61 offen offset:2048 sc1
  buffer_load_dwordx4 v[100:103], v247, s[40:43], s61 offen offset:3072 sc1
  s_waitcnt vmcnt(13)
  v_mfma_f32_32x32x16_bf16 v[168:183], a[144:147], v[56:59], v[168:183]
  s_add_u32 m0, s63, 90112
  s_add_u32 s97, s65, 16781312
  buffer_load_dwordx4 v1, s[36:39], s97 offen sc1 lds
  v_mfma_f32_32x32x16_bf16 v[184:199], a[148:151], v[56:59], v[184:199]
  buffer_load_dwordx4 v[108:111], v247, s[40:43], s62 offen offset:0 sc1
  buffer_load_dwordx4 v[116:119], v247, s[40:43], s62 offen offset:1024 sc1
  s_waitcnt vmcnt(15)
  v_mfma_f32_32x32x16_bf16 v[200:215], a[144:147], v[60:63], v[200:215]
  v_mfma_f32_32x32x16_bf16 v[216:231], a[148:151], v[60:63], v[216:231]
  buffer_load_dwordx4 v[124:127], v247, s[40:43], s62 offen offset:2048 sc1
  buffer_load_dwordx4 v[132:135], v247, s[40:43], s62 offen offset:3072 sc1
  s_add_u32 m0, s63, 91136
  s_add_u32 s97, s65, 16782336
  buffer_load_dwordx4 v1, s[36:39], s97 offen sc1 lds
  s_waitcnt vmcnt(17)
  v_mfma_f32_32x32x16_bf16 v[168:183], a[152:155], v[64:67], v[168:183]
  v_mfma_f32_32x32x16_bf16 v[184:199], a[156:159], v[64:67], v[184:199]
  buffer_load_dwordx4 v[88:91], v246, s[40:43], s61 offen offset:2048 sc1
  buffer_load_dwordx4 v[96:99], v246, s[40:43], s61 offen offset:3072 sc1
  s_waitcnt vmcnt(18)
  v_mfma_f32_32x32x16_bf16 v[200:215], a[152:155], v[68:71], v[200:215]
  s_add_u32 m0, s63, 92160
  s_add_u32 s97, s65, 16783360
  buffer_load_dwordx4 v1, s[36:39], s97 offen sc1 lds
  v_mfma_f32_32x32x16_bf16 v[216:231], a[156:159], v[68:71], v[216:231]
  buffer_load_dwordx4 v[104:107], v246, s[40:43], s62 offen offset:0 sc1
  buffer_load_dwordx4 v[112:115], v246, s[40:43], s62 offen offset:1024 sc1
  s_waitcnt vmcnt(17)
  v_mfma_f32_32x32x16_bf16 v[168:183], a[160:163], v[72:75], v[168:183]
  v_mfma_f32_32x32x16_bf16 v[184:199], a[164:167], v[72:75], v[184:199]
  buffer_load_dwordx4 v[120:123], v246, s[40:43], s62 offen offset:2048 sc1
  s_waitcnt vmcnt(17)
  v_mfma_f32_32x32x16_bf16 v[200:215], a[160:163], v[76:79], v[200:215]
  v_mfma_f32_32x32x16_bf16 v[216:231], a[164:167], v[76:79], v[216:231]
  buffer_load_dwordx4 v[128:131], v246, s[40:43], s62 offen offset:3072 sc1
  s_waitcnt vmcnt(17)
  v_mfma_f32_32x32x16_bf16 v[168:183], a[168:171], v[80:83], v[168:183]
  v_mfma_f32_32x32x16_bf16 v[184:199], a[172:175], v[80:83], v[184:199]
  s_waitcnt vmcnt(16)
  v_mfma_f32_32x32x16_bf16 v[200:215], a[168:171], v[84:87], v[200:215]
  v_mfma_f32_32x32x16_bf16 v[216:231], a[172:175], v[84:87], v[216:231]
  s_waitcnt vmcnt(14)
  v_mfma_f32_32x32x16_bf16 v[216:231], a[180:183], v[92:95], v[216:231]
  s_waitcnt vmcnt(13)
  v_mfma_f32_32x32x16_bf16 v[216:231], a[188:191], v[100:103], v[216:231]
  s_waitcnt vmcnt(11)
  v_mfma_f32_32x32x16_bf16 v[216:231], a[196:199], v[108:111], v[216:231]
  s_waitcnt vmcnt(10)
  v_mfma_f32_32x32x16_bf16 v[216:231], a[204:207], v[116:119], v[216:231]
  s_waitcnt vmcnt(9)
  v_mfma_f32_32x32x16_bf16 v[216:231], a[212:215], v[124:127], v[216:231]
  s_waitcnt vmcnt(8)
  v_mfma_f32_32x32x16_bf16 v[216:231], a[220:223], v[132:135], v[216:231]
  s_lshr_b32 s83, s71, 3
  s_mul_i32 s83, s83, 86016
  s_and_b32 s97, s71, 7
  s_mul_i32 s97, s97, 7168
  s_add_u32 s83, s83, s97
  s_add_u32 s83, s83, 16805888
  v_lshlrev_b32 v248, 3, v1
  v_min_u32 v248, 7040, v248
  buffer_load_dword a240, v248, s[36:39], s83 offen sc1
  v_mfma_f32_32x32x16_bf16 v[200:215], a[176:179], v[92:95], v[200:215]
  v_mfma_f32_32x32x16_bf16 v[200:215], a[184:187], v[100:103], v[200:215]
  ds_write_b128 v250, v[216:219] offset:8192
  v_mfma_f32_32x32x16_bf16 v[200:215], a[192:195], v[108:111], v[200:215]
  ds_write_b128 v250, v[220:223] offset:9216
  v_mfma_f32_32x32x16_bf16 v[200:215], a[200:203], v[116:119], v[200:215]
  ds_write_b128 v250, v[224:227] offset:10240
  v_mfma_f32_32x32x16_bf16 v[200:215], a[208:211], v[124:127], v[200:215]
  ds_write_b128 v250, v[228:231] offset:11264
  v_mfma_f32_32x32x16_bf16 v[200:215], a[216:219], v[132:135], v[200:215]
  s_waitcnt vmcnt(7)
  v_mfma_f32_32x32x16_bf16 v[184:199], a[180:183], v[88:91], v[184:199]
  s_waitcnt vmcnt(6)
  v_mfma_f32_32x32x16_bf16 v[184:199], a[188:191], v[96:99], v[184:199]
  ds_write_b128 v250, v[200:203] offset:4096
  s_waitcnt vmcnt(4)
  v_mfma_f32_32x32x16_bf16 v[184:199], a[196:199], v[104:107], v[184:199]
  ds_write_b128 v250, v[204:207] offset:5120
  s_waitcnt vmcnt(3)
  v_mfma_f32_32x32x16_bf16 v[184:199], a[204:207], v[112:115], v[184:199]
  ds_write_b128 v250, v[208:211] offset:6144
  s_waitcnt vmcnt(2)
  v_mfma_f32_32x32x16_bf16 v[184:199], a[212:215], v[120:123], v[184:199]
  ds_write_b128 v250, v[212:215] offset:7168
  s_waitcnt vmcnt(1)
  v_mfma_f32_32x32x16_bf16 v[184:199], a[220:223], v[128:131], v[184:199]
  v_mfma_f32_32x32x16_bf16 v[168:183], a[176:179], v[88:91], v[168:183]
  v_mfma_f32_32x32x16_bf16 v[168:183], a[184:187], v[96:99], v[168:183]
  ds_write_b128 v250, v[184:187] offset:0
  v_mfma_f32_32x32x16_bf16 v[168:183], a[192:195], v[104:107], v[168:183]
  ds_write_b128 v250, v[188:191] offset:1024
  v_mfma_f32_32x32x16_bf16 v[168:183], a[200:203], v[112:115], v[168:183]
  ds_write_b128 v250, v[192:195] offset:2048
  v_mfma_f32_32x32x16_bf16 v[168:183], a[208:211], v[120:123], v[168:183]
  ds_write_b128 v250, v[196:199] offset:3072
  v_mfma_f32_32x32x16_bf16 v[168:183], a[216:219], v[128:131], v[168:183]
  s_waitcnt lgkmcnt(0)
  s_barrier
  ds_read_b128 v[184:187], v251 offset:0
  ds_read_b128 v[200:203], v252 offset:0
  ds_read_b128 v[216:219], v253 offset:0
  ds_read_b128 v[188:191], v251 offset:1024
  ds_read_b128 v[204:207], v252 offset:1024
  ds_read_b128 v[220:223], v253 offset:1024
  ds_read_b128 v[192:195], v251 offset:2048
  ds_read_b128 v[208:211], v252 offset:2048
  ds_read_b128 v[224:227], v253 offset:2048
  ds_read_b128 v[196:199], v251 offset:3072
  ds_read_b128 v[212:215], v252 offset:3072
  ds_read_b128 v[228:231], v253 offset:3072
  v_mov_b32 v254, 0
  v_mov_b32 v255, 0
  s_waitcnt lgkmcnt(9)
  v_pk_add_f32 v[168:169], v[168:169], v[184:185]
  v_pk_add_f32 v[200:201], v[200:201], v[216:217]
  v_pk_add_f32 v[170:171], v[170:171], v[186:187]
  v_pk_add_f32 v[202:203], v[202:203], v[218:219]
  v_pk_add_f32 v[168:169], v[168:169], v[200:201]
  v_pk_add_f32 v[170:171], v[170:171], v[202:203]
  v_cvt_pk_bf16_f32 v16, v168, v169
  v_cvt_pk_bf16_f32 v17, v170, v171
  v_dot2c_f32_bf16 v254, s75, v16
  v_dot2c_f32_bf16 v255, v16, v16
  v_dot2c_f32_bf16 v254, s75, v17
  v_dot2c_f32_bf16 v255, v17, v17
  s_waitcnt lgkmcnt(6)
  v_pk_add_f32 v[172:173], v[172:173], v[188:189]
  v_pk_add_f32 v[204:205], v[204:205], v[220:221]
  v_pk_add_f32 v[174:175], v[174:175], v[190:191]
  v_pk_add_f32 v[206:207], v[206:207], v[222:223]
  v_pk_add_f32 v[172:173], v[172:173], v[204:205]
  v_pk_add_f32 v[174:175], v[174:175], v[206:207]
  v_cvt_pk_bf16_f32 v18, v172, v173
  v_cvt_pk_bf16_f32 v19, v174, v175
  buffer_store_dwordx4 v[16:19], v1, s[40:43], s78 offen offset:0 sc1
  v_dot2c_f32_bf16 v254, s75, v18
  v_dot2c_f32_bf16 v255, v18, v18
  v_dot2c_f32_bf16 v254, s75, v19
  v_dot2c_f32_bf16 v255, v19, v19
  s_waitcnt lgkmcnt(3)
  v_pk_add_f32 v[176:177], v[176:177], v[192:193]
  v_pk_add_f32 v[208:209], v[208:209], v[224:225]
  v_pk_add_f32 v[178:179], v[178:179], v[194:195]
  v_pk_add_f32 v[210:211], v[210:211], v[226:227]
  v_pk_add_f32 v[176:177], v[176:177], v[208:209]
  v_pk_add_f32 v[178:179], v[178:179], v[210:211]
  v_cvt_pk_bf16_f32 v20, v176, v177
  v_cvt_pk_bf16_f32 v21, v178, v179
  v_dot2c_f32_bf16 v254, s75, v20
  v_dot2c_f32_bf16 v255, v20, v20
  v_dot2c_f32_bf16 v254, s75, v21
  v_dot2c_f32_bf16 v255, v21, v21
  s_waitcnt lgkmcnt(0)
  v_pk_add_f32 v[180:181], v[180:181], v[196:197]
  v_pk_add_f32 v[212:213], v[212:213], v[228:229]
  v_pk_add_f32 v[182:183], v[182:183], v[198:199]
  v_pk_add_f32 v[214:215], v[214:215], v[230:231]
  v_pk_add_f32 v[180:181], v[180:181], v[212:213]
  v_pk_add_f32 v[182:183], v[182:183], v[214:215]
  v_cvt_pk_bf16_f32 v22, v180, v181
  v_cvt_pk_bf16_f32 v23, v182, v183
  buffer_store_dwordx4 v[20:23], v1, s[40:43], s78 offen offset:1024 sc1
  v_dot2c_f32_bf16 v254, s75, v22
  v_dot2c_f32_bf16 v255, v22, v22
  v_dot2c_f32_bf16 v254, s75, v23
  v_dot2c_f32_bf16 v255, v23, v23
  s_nop 2
  v_permlane32_swap_b32 v254, v255
  v_add_f32 v254, v254, v255
  buffer_store_dword v254, v11, s[40:43], s79 offen sc1
  s_barrier
  s_add_u32 m0, s63, 114688
  s_add_u32 s97, s65, 16805888
  buffer_load_dwordx4 v1, s[36:39], s97 offen sc1 lds
  s_add_u32 m0, s63, 115712
  s_add_u32 s97, s65, 16806912
  buffer_load_dwordx4 v1, s[36:39], s97 offen sc1 lds
  s_add_u32 m0, s63, 116736
  s_add_u32 s97, s65, 16807936
  buffer_load_dwordx4 v1, s[36:39], s97 offen sc1 lds
  s_add_u32 m0, s63, 117760
  s_add_u32 s97, s65, 16808960
  buffer_load_dwordx4 v1, s[36:39], s97 offen sc1 lds
  s_add_u32 m0, s63, 118784
  s_add_u32 s97, s65, 16809984
  buffer_load_dwordx4 v1, s[36:39], s97 offen sc1 lds
  s_add_u32 m0, s63, 119808
  s_add_u32 s97, s65, 16811008
  buffer_load_dwordx4 v1, s[36:39], s97 offen sc1 lds
  s_add_u32 m0, s63, 120832
  s_add_u32 s97, s65, 16812032
  buffer_load_dwordx4 v1, s[36:39], s97 offen sc1 lds
  s_waitcnt vmcnt(7)
  s_add_u32 s81, s52, 2
  v_mov_b32 v255, s81
  buffer_store_dword v255, v4, s[40:43], s80 offen sc1
  s_waitcnt vmcnt(1)
  s_barrier
  ds_read_b64_tr_b16 v[216:217], v14 offset:0
  ds_read_b64_tr_b16 v[218:219], v14 offset:256
  ds_read_b64_tr_b16 v[220:221], v14 offset:28672
  ds_read_b64_tr_b16 v[222:223], v14 offset:28928
  ds_read_b64_tr_b16 v[224:225], v14 offset:1024
  ds_read_b64_tr_b16 v[226:227], v14 offset:1280
  ds_read_b64_tr_b16 v[228:229], v14 offset:29696
  ds_read_b64_tr_b16 v[230:231], v14 offset:29952
  s_lshl_b32 s78, s7, 7
  s_add_u32 s78, s78, 24576
  s_lshl_b32 s80, s7, 15
  s_add_u32 s80, s80, 5242880
  v_add_u32 v246, s80, v1
  s_add_u32 s84, s52, 2
Lpoll_56:
  buffer_load_dword v15, v13, s[36:39], s78 offen sc1
  s_add_u32 s53, s53, 1
  s_cmp_gt_u32 s53, 0x20000
  s_cbranch_scc1 Lpd_57
  s_waitcnt vmcnt(0)
  v_subrev_u32 v15, s84, v15
  v_cmp_le_u32 vcc, 16, v15
  s_cbranch_vccnz Lpoll_56
Lpd_57:
  buffer_load_dwordx4 v[24:27], v246, s[36:39], 0 offen offset:0 sc1
  buffer_load_dwordx4 v[28:31], v246, s[36:39], 0 offen offset:1024 sc1
  buffer_load_dwordx4 v[32:35], v246, s[36:39], 0 offen offset:2048 sc1
  buffer_load_dwordx4 v[36:39], v246, s[36:39], 0 offen offset:3072 sc1
  buffer_load_dwordx4 v[40:43], v246, s[36:39], s57 offen offset:0 sc1
  buffer_load_dwordx4 v[44:47], v246, s[36:39], s57 offen offset:1024 sc1
  buffer_load_dwordx4 v[48:51], v246, s[36:39], s57 offen offset:2048 sc1
  buffer_load_dwordx4 v[52:55], v246, s[36:39], s57 offen offset:3072 sc1
  s_waitcnt vmcnt(7) lgkmcnt(4)
  v_mfma_f32_32x32x16_bf16 v[136:151], v[24:27], v[216:219], 0
  ds_read_b64_tr_b16 v[232:233], v14 offset:2048
  ds_read_b64_tr_b16 v[234:235], v14 offset:2304
  buffer_load_dwordx4 v[56:59], v246, s[36:39], s58 offen offset:0 sc1
  v_mfma_f32_32x32x16_bf16 v[152:167], v[24:27], v[220:223], 0
  ds_read_b64_tr_b16 v[236:237], v14 offset:30720
  ds_read_b64_tr_b16 v[238:239], v14 offset:30976
  buffer_load_dwordx4 v[60:63], v246, s[36:39], s58 offen offset:1024 sc1
  s_waitcnt vmcnt(8) lgkmcnt(4)
  v_mfma_f32_32x32x16_bf16 v[136:151], v[28:31], v[224:227], v[136:151]
  ds_read_b64_tr_b16 v[216:217], v14 offset:3072
  ds_read_b64_tr_b16 v[218:219], v14 offset:3328
  buffer_load_dwordx4 v[200:203], v246, s[36:39], s98 offen offset:0 sc1
  v_mfma_f32_32x32x16_bf16 v[152:167], v[28:31], v[228:231], v[152:167]
  ds_read_b64_tr_b16 v[220:221], v14 offset:31744
  ds_read_b64_tr_b16 v[222:223], v14 offset:32000
  buffer_load_dwordx4 v[204:207], v246, s[36:39], s98 offen offset:1024 sc1
  s_waitcnt vmcnt(9) lgkmcnt(4)
  v_mfma_f32_32x32x16_bf16 v[136:151], v[32:35], v[232:235], v[136:151]
  ds_read_b64_tr_b16 v[224:225], v14 offset:4096
  ds_read_b64_tr_b16 v[226:227], v14 offset:4352
  v_mfma_f32_32x32x16_bf16 v[152:167], v[32:35], v[236:239], v[152:167]
  ds_read_b64_tr_b16 v[228:229], v14 offset:32768
  ds_read_b64_tr_b16 v[230:231], v14 offset:33024
  buffer_load_dwordx4 v[208:211], v246, s[36:39], s98 offen offset:2048 sc1
  s_waitcnt vmcnt(9) lgkmcnt(4)
  v_mfma_f32_32x32x16_bf16 v[136:151], v[36:39], v[216:219], v[136:151]
  ds_read_b64_tr_b16 v[232:233], v14 offset:5120
  ds_read_b64_tr_b16 v[234:235], v14 offset:5376
  buffer_load_dwordx4 v[212:215], v246, s[36:39], s98 offen offset:3072 sc1
  v_mfma_f32_32x32x16_bf16 v[152:167], v[36:39], v[220:223], v[152:167]
  ds_read_b64_tr_b16 v[236:237], v14 offset:33792
  ds_read_b64_tr_b16 v[238:239], v14 offset:34048
  buffer_load_dwordx4 v[64:67], v246, s[36:39], s58 offen offset:2048 sc1
  s_waitcnt vmcnt(10) lgkmcnt(4)
  v_mfma_f32_32x32x16_bf16 v[136:151], v[40:43], v[224:227], v[136:151]
  ds_read_b64_tr_b16 v[216:217], v14 offset:6144
  ds_read_b64_tr_b16 v[218:219], v14 offset:6400
  buffer_load_dwordx4 v[68:71], v246, s[36:39], s58 offen offset:3072 sc1
  v_mfma_f32_32x32x16_bf16 v[152:167], v[40:43], v[228:231], v[152:167]
  ds_read_b64_tr_b16 v[220:221], v14 offset:34816
  ds_read_b64_tr_b16 v[222:223], v14 offset:35072
  s_waitcnt vmcnt(10) lgkmcnt(4)
  v_mfma_f32_32x32x16_bf16 v[136:151], v[44:47], v[232:235], v[136:151]
  ds_read_b64_tr_b16 v[224:225], v14 offset:7168
  ds_read_b64_tr_b16 v[226:227], v14 offset:7424
  buffer_load_dwordx4 v[72:75], v246, s[36:39], s59 offen offset:0 sc1
  v_mfma_f32_32x32x16_bf16 v[152:167], v[44:47], v[236:239], v[152:167]
  ds_read_b64_tr_b16 v[228:229], v14 offset:35840
  ds_read_b64_tr_b16 v[230:231], v14 offset:36096
  buffer_load_dwordx4 v[76:79], v246, s[36:39], s59 offen offset:1024 sc1
  s_waitcnt vmcnt(11) lgkmcnt(4)
  v_mfma_f32_32x32x16_bf16 v[136:151], v[48:51], v[216:219], v[136:151]
  ds_read_b64_tr_b16 v[232:233], v14 offset:8192
  ds_read_b64_tr_b16 v[234:235], v14 offset:8448
  buffer_load_dwordx4 v[80:83], v246, s[36:39], s59 offen offset:2048 sc1
  v_mfma_f32_32x32x16_bf16 v[152:167], v[48:51], v[220:223], v[152:167]
  ds_read_b64_tr_b16 v[236:237], v14 offset:36864
  ds_read_b64_tr_b16 v[238:239], v14 offset:37120
  buffer_load_dwordx4 v[84:87], v246, s[36:39], s59 offen offset:3072 sc1
  s_waitcnt vmcnt(12) lgkmcnt(4)
  v_mfma_f32_32x32x16_bf16 v[136:151], v[52:55], v[224:227], v[136:151]
  ds_read_b64_tr_b16 v[216:217], v14 offset:9216
  ds_read_b64_tr_b16 v[218:219], v14 offset:9472
  v_mfma_f32_32x32x16_bf16 v[152:167], v[52:55], v[228:231], v[152:167]
  ds_read_b64_tr_b16 v[220:221], v14 offset:37888
  ds_read_b64_tr_b16 v[222:223], v14 offset:38144
  buffer_load_dwordx4 v[88:91], v246, s[36:39], s60 offen offset:0 sc1
  s_waitcnt vmcnt(12) lgkmcnt(4)
  v_mfma_f32_32x32x16_bf16 v[136:151], v[56:59], v[232:235], v[136:151]
  ds_read_b64_tr_b16 v[224:225], v14 offset:10240
  ds_read_b64_tr_b16 v[226:227], v14 offset:10496
  buffer_load_dwordx4 v[92:95], v246, s[36:39], s60 offen offset:1024 sc1
  v_mfma_f32_32x32x16_bf16 v[152:167], v[56:59], v[236:239], v[152:167]
  ds_read_b64_tr_b16 v[228:229], v14 offset:38912
  ds_read_b64_tr_b16 v[230:231], v14 offset:39168
  buffer_load_dwordx4 v[96:99], v246, s[36:39], s60 offen offset:2048 sc1
  s_waitcnt vmcnt(13) lgkmcnt(4)
  v_mfma_f32_32x32x16_bf16 v[136:151], v[60:63], v[216:219], v[136:151]
  ds_read_b64_tr_b16 v[232:233], v14 offset:11264
  ds_read_b64_tr_b16 v[234:235], v14 offset:11520
  buffer_load_dwordx4 v[100:103], v246, s[36:39], s60 offen offset:3072 sc1
  v_mfma_f32_32x32x16_bf16 v[152:167], v[60:63], v[220:223], v[152:167]
  ds_read_b64_tr_b16 v[236:237], v14 offset:39936
  ds_read_b64_tr_b16 v[238:239], v14 offset:40192
  s_waitcnt vmcnt(9) lgkmcnt(4)
  v_mfma_f32_32x32x16_bf16 v[136:151], v[64:67], v[224:227], v[136:151]
  ds_read_b64_tr_b16 v[216:217], v14 offset:12288
  ds_read_b64_tr_b16 v[218:219], v14 offset:12544
  buffer_load_dwordx4 v[104:107], v246, s[36:39], s61 offen offset:0 sc1
  v_mfma_f32_32x32x16_bf16 v[152:167], v[64:67], v[228:231], v[152:167]
  ds_read_b64_tr_b16 v[220:221], v14 offset:40960
  ds_read_b64_tr_b16 v[222:223], v14 offset:41216
  buffer_load_dwordx4 v[108:111], v246, s[36:39], s61 offen offset:1024 sc1
  v_add_f32 v212, v212, v214
  s_waitcnt vmcnt(10) lgkmcnt(4)
  v_mfma_f32_32x32x16_bf16 v[136:151], v[68:71], v[232:235], v[136:151]
  ds_read_b64_tr_b16 v[224:225], v14 offset:13312
  ds_read_b64_tr_b16 v[226:227], v14 offset:13568
  buffer_load_dwordx4 v[112:115], v246, s[36:39], s61 offen offset:2048 sc1
  v_add_f32 v213, v213, v215
  v_add_f32 v200, v200, v202
  v_add_f32 v201, v201, v203
  v_mfma_f32_32x32x16_bf16 v[152:167], v[68:71], v[236:239], v[152:167]
  ds_read_b64_tr_b16 v[228:229], v14 offset:41984
  ds_read_b64_tr_b16 v[230:231], v14 offset:42240
  buffer_load_dwordx4 v[116:119], v246, s[36:39], s61 offen offset:3072 sc1
  v_add_f32 v204, v204, v206
  v_add_f32 v205, v205, v207
  s_waitcnt vmcnt(11) lgkmcnt(4)
  v_mfma_f32_32x32x16_bf16 v[136:151], v[72:75], v[216:219], v[136:151]
  ds_read_b64_tr_b16 v[232:233], v14 offset:14336
  ds_read_b64_tr_b16 v[234:235], v14 offset:14592
  v_add_f32 v208, v208, v210
  v_add_f32 v209, v209, v211
  v_cndmask_b32 v212, v212, 0, s[48:49]
  v_cndmask_b32 v213, v213, 0, s[48:49]
  v_mfma_f32_32x32x16_bf16 v[152:167], v[72:75], v[220:223], v[152:167]
  ds_read_b64_tr_b16 v[236:237], v14 offset:43008
  ds_read_b64_tr_b16 v[238:239], v14 offset:43264
  buffer_load_dwordx4 v[120:123], v246, s[36:39], s62 offen offset:0 sc1
  v_add_f32 v200, v200, v204
  v_add_f32 v201, v201, v205
  s_waitcnt vmcnt(11) lgkmcnt(4)
  v_mfma_f32_32x32x16_bf16 v[136:151], v[76:79], v[224:227], v[136:151]
  ds_read_b64_tr_b16 v[216:217], v14 offset:15360
  ds_read_b64_tr_b16 v[218:219], v14 offset:15616
  buffer_load_dwordx4 v[124:127], v246, s[36:39], s62 offen offset:1024 sc1
  v_add_f32 v208, v208, v212
  v_add_f32 v209, v209, v213
  v_add_f32 v200, v200, v208
  v_mfma_f32_32x32x16_bf16 v[152:167], v[76:79], v[228:231], v[152:167]
  ds_read_b64_tr_b16 v[220:221], v14 offset:44032
  ds_read_b64_tr_b16 v[222:223], v14 offset:44288
  buffer_load_dwordx4 v[128:131], v246, s[36:39], s62 offen offset:2048 sc1
  v_add_f32 v201, v201, v209
  v_mov_b32 v240, 0
  s_waitcnt vmcnt(12) lgkmcnt(4)
  v_mfma_f32_32x32x16_bf16 v[136:151], v[80:83], v[232:235], v[136:151]
  ds_read_b64_tr_b16 v[224:225], v14 offset:16384
  ds_read_b64_tr_b16 v[226:227], v14 offset:16640
  buffer_load_dwordx4 v[132:135], v246, s[36:39], s62 offen offset:3072 sc1
  v_mov_b32 v242, 0
  v_mov_b32 v243, 0
  v_permlane32_swap_b32 v200, v201
  v_mfma_f32_32x32x16_bf16 v[152:167], v[80:83], v[236:239], v[152:167]
  ds_read_b64_tr_b16 v[228:229], v14 offset:45056
  ds_read_b64_tr_b16 v[230:231], v14 offset:45312
  v_add_f32 v200, v200, v201
  v_mul_f32 v200, 0x3b124925, v200
  v_mov_b32 v201, v200
  s_waitcnt vmcnt(12) lgkmcnt(4)
  v_mfma_f32_32x32x16_bf16 v[136:151], v[84:87], v[216:219], v[136:151]
  ds_read_b64_tr_b16 v[232:233], v14 offset:17408
  ds_read_b64_tr_b16 v[234:235], v14 offset:17664
  v_permlane32_swap_b32 v200, v201
  v_fma_f32 v201, -v200, v200, v201
  v_cvt_pk_bf16_f32 v200, -v200, -v200
  v_max_f32 v201, 0, v201
  v_mfma_f32_32x32x16_bf16 v[152:167], v[84:87], v[220:223], v[152:167]
  ds_read_b64_tr_b16 v[236:237], v14 offset:46080
  ds_read_b64_tr_b16 v[238:239], v14 offset:46336
  v_cndmask_b32 v241, v200, 0, s[48:49]
  v_cvt_pk_bf16_f32 v201, v201, v201
  v_lshlrev_b32 v201, 16, v201
  s_waitcnt vmcnt(11) lgkmcnt(4)
  v_mfma_f32_32x32x16_bf16 v[136:151], v[88:91], v[224:227], v[136:151]
  ds_read_b64_tr_b16 v[216:217], v14 offset:18432
  ds_read_b64_tr_b16 v[218:219], v14 offset:18688
  v_add_f32 v201, 0x3727c5ac, v201
  v_cvt_pk_bf16_f32 v201, v201, v201
  v_lshlrev_b32 v201, 16, v201
  v_mfma_f32_32x32x16_bf16 v[152:167], v[88:91], v[228:231], v[152:167]
  ds_read_b64_tr_b16 v[220:221], v14 offset:47104
  ds_read_b64_tr_b16 v[222:223], v14 offset:47360
  v_sqrt_f32 v201, v201
  s_nop 0
  v_cvt_pk_bf16_f32 v201, v201, v201
  s_waitcnt vmcnt(10) lgkmcnt(4)
  v_mfma_f32_32x32x16_bf16 v[136:151], v[92:95], v[232:235], v[136:151]
  ds_read_b64_tr_b16 v[224:225], v14 offset:19456
  ds_read_b64_tr_b16 v[226:227], v14 offset:19712
  v_lshlrev_b32 v245, 16, v201
  v_rcp_f32 v244, v245
  s_nop 0
  v_mul_f32 v244, 0x3fb8aa3b, v244
  v_mfma_f32_32x32x16_bf16 v[152:167], v[92:95], v[236:239], v[152:167]
  ds_read_b64_tr_b16 v[228:229], v14 offset:48128
  ds_read_b64_tr_b16 v[230:231], v14 offset:48384
  v_lshrrev_b32 v248, 2, v1
  v_and_b32 v248, 0x7c, v248
  v_add_u32 v248, s70, v248
  s_waitcnt vmcnt(9) lgkmcnt(4)
  v_mfma_f32_32x32x16_bf16 v[136:151], v[96:99], v[216:219], v[136:151]
  ds_read_b64_tr_b16 v[232:233], v14 offset:20480
  ds_read_b64_tr_b16 v[234:235], v14 offset:20736
  v_lshrrev_b32 v249, 5, v1
  v_and_b32 v249, 16, v249
  v_add_u32 v249, s70, v249
  ds_write_b32 v248, v244 offset:4096
  v_mfma_f32_32x32x16_bf16 v[152:167], v[96:99], v[220:223], v[152:167]
  ds_read_b64_tr_b16 v[236:237], v14 offset:49152
  ds_read_b64_tr_b16 v[238:239], v14 offset:49408
  ds_read_b128 v[200:203], v249 offset:4096
  ds_read_b128 v[204:207], v249 offset:4128
  ds_read_b128 v[208:211], v249 offset:4160
  s_waitcnt vmcnt(8) lgkmcnt(8)
  v_mfma_f32_32x32x16_bf16 v[136:151], v[100:103], v[224:227], v[136:151]
  ds_read_b64_tr_b16 v[216:217], v14 offset:21504
  ds_read_b64_tr_b16 v[218:219], v14 offset:21760
  ds_read_b128 v[212:215], v249 offset:4192
  v_add_u32 v248, s70, v1
  v_lshrrev_b32 v249, 3, v1
  v_and_b32 v249, 0x70, v249
  v_mfma_f32_32x32x16_bf16 v[152:167], v[100:103], v[228:231], v[152:167]
  ds_read_b64_tr_b16 v[220:221], v14 offset:50176
  ds_read_b64_tr_b16 v[222:223], v14 offset:50432
  v_bfe_u32 v252, v1, 5, 1
  v_lshl_add_u32 v249, v252, 9, v249
  v_bfe_u32 v252, v1, 6, 1
  s_waitcnt vmcnt(7) lgkmcnt(8)
  v_mfma_f32_32x32x16_bf16 v[136:151], v[104:107], v[232:235], v[136:151]
  ds_read_b64_tr_b16 v[224:225], v14 offset:22528
  ds_read_b64_tr_b16 v[226:227], v14 offset:22784
  v_lshl_add_u32 v249, v252, 11, v249
  v_bfe_u32 v252, v1, 4, 1
  v_lshl_add_u32 v249, v252, 10, v249
  s_lshl_b32 s78, s3, 7
  v_mfma_f32_32x32x16_bf16 v[152:167], v[104:107], v[236:239], v[152:167]
  ds_read_b64_tr_b16 v[228:229], v14 offset:51200
  ds_read_b64_tr_b16 v[230:231], v14 offset:51456
  s_barrier
  s_mul_i32 s44, s3, 4096
  s_sub_u32 s45, s65, s63
  s_add_u32 s45, s45, s44
  s_waitcnt vmcnt(6) lgkmcnt(4)
  v_mfma_f32_32x32x16_bf16 v[136:151], v[108:111], v[216:219], v[136:151]
  ds_read_b64_tr_b16 v[232:233], v14 offset:23552
  ds_read_b64_tr_b16 v[234:235], v14 offset:23808
  s_add_u32 m0, s44, 86016
  s_add_u32 s97, s45, 16834560
  buffer_load_dwordx4 v1, s[36:39], s97 offen sc1 lds
  s_add_u32 s78, s78, 143360
  v_mfma_f32_32x32x16_bf16 v[152:167], v[108:111], v[220:223], v[152:167]
  ds_read_b64_tr_b16 v[236:237], v14 offset:52224
  ds_read_b64_tr_b16 v[238:239], v14 offset:52480
  v_add_u32 v249, s78, v249
  v_mov_b32 v252, s75
  s_lshl_b32 s78, s6, 2
  s_waitcnt vmcnt(6) lgkmcnt(4)
  v_mfma_f32_32x32x16_bf16 v[136:151], v[112:115], v[224:227], v[136:151]
  ds_read_b64_tr_b16 v[216:217], v14 offset:24576
  ds_read_b64_tr_b16 v[218:219], v14 offset:24832
  s_add_u32 m0, s44, 87040
  s_add_u32 s97, s45, 16835584
  buffer_load_dwordx4 v1, s[36:39], s97 offen sc1 lds
  s_add_u32 s78, s78, s3
  v_mfma_f32_32x32x16_bf16 v[152:167], v[112:115], v[228:231], v[152:167]
  ds_read_b64_tr_b16 v[220:221], v14 offset:53248
  ds_read_b64_tr_b16 v[222:223], v14 offset:53504
  s_lshl_b32 s78, s78, 13
  s_add_u32 s78, s78, 1572864
  s_lshl_b32 s79, s56, 9
  s_waitcnt vmcnt(6) lgkmcnt(4)
  v_mfma_f32_32x32x16_bf16 v[136:151], v[116:119], v[232:235], v[136:151]
  ds_read_b64_tr_b16 v[224:225], v14 offset:25600
  ds_read_b64_tr_b16 v[226:227], v14 offset:25856
  s_add_u32 m0, s44, 88064
  s_add_u32 s97, s45, 16836608
  buffer_load_dwordx4 v1, s[36:39], s97 offen sc1 lds
  s_add_u32 s79, s79, s78
  v_mfma_f32_32x32x16_bf16 v[152:167], v[116:119], v[236:239], v[152:167]
  ds_read_b64_tr_b16 v[228:229], v14 offset:54272
  ds_read_b64_tr_b16 v[230:231], v14 offset:54528
  v_mov_b32 v253, s88
  v_lshrrev_b32 v254, 1, v1
  s_mov_b32 s80, 0x80808080
  s_waitcnt vmcnt(6) lgkmcnt(4)
  v_mfma_f32_32x32x16_bf16 v[136:151], v[120:123], v[216:219], v[136:151]
  ds_read_b64_tr_b16 v[232:233], v14 offset:26624
  ds_read_b64_tr_b16 v[234:235], v14 offset:26880
  s_add_u32 m0, s44, 89088
  s_add_u32 s97, s45, 16837632
  buffer_load_dwordx4 v1, s[36:39], s97 offen sc1 lds
  s_mov_b32 s81, 0x80808080
  v_mfma_f32_32x32x16_bf16 v[152:167], v[120:123], v[220:223], v[152:167]
  ds_read_b64_tr_b16 v[236:237], v14 offset:55296
  ds_read_b64_tr_b16 v[238:239], v14 offset:55552
  s_mul_i32 s83, s71, 3200
  s_add_u32 s83, s83, 0
  v_lshlrev_b32 v255, 3, v1
  v_min_u32 v255, 3072, v255
  buffer_load_dword a240, v255, s[16:19], s83 offen
  s_waitcnt vmcnt(7) lgkmcnt(4)
  v_mfma_f32_32x32x16_bf16 v[136:151], v[124:127], v[224:227], v[136:151]
  ds_read_b64_tr_b16 v[216:217], v14 offset:27648
  ds_read_b64_tr_b16 v[218:219], v14 offset:27904
  v_mfma_f32_32x32x16_bf16 v[152:167], v[124:127], v[228:231], v[152:167]
  ds_read_b64_tr_b16 v[220:221], v14 offset:56320
  ds_read_b64_tr_b16 v[222:223], v14 offset:56576
  s_mul_i32 s83, s71, 3584
  s_add_u32 s83, s83, 524288
  v_lshlrev_b32 v255, 3, v1
  v_min_u32 v255, 3456, v255
  buffer_load_dword a240, v255, s[36:39], s83 offen sc1
  v_mfma_f32_32x32x16_bf16 v[136:151], v[240:243], a[224:227], v[136:151]
  v_mfma_f32_32x32x16_bf16 v[152:167], v[240:243], a[226:229], v[152:167]
  s_waitcnt vmcnt(7) lgkmcnt(4)
  v_mfma_f32_32x32x16_bf16 v[136:151], v[128:131], v[232:235], v[136:151]
  v_mfma_f32_32x32x16_bf16 v[152:167], v[128:131], v[236:239], v[152:167]
  s_waitcnt vmcnt(6) lgkmcnt(0)
  v_mfma_f32_32x32x16_bf16 v[136:151], v[132:135], v[216:219], v[136:151]
  v_mfma_f32_32x32x16_bf16 v[152:167], v[132:135], v[220:223], v[152:167]
  v_add_u32 v246, s78, v1
  s_nop 3
  v_pk_mul_f32 v[136:137], v[136:137], v[200:201]
  v_pk_mul_f32 v[138:139], v[138:139], v[202:203]
  v_pk_mul_f32 v[140:141], v[140:141], v[204:205]
  v_pk_mul_f32 v[142:143], v[142:143], v[206:207]
  v_pk_mul_f32 v[144:145], v[144:145], v[208:209]
  v_pk_mul_f32 v[146:147], v[146:147], v[210:211]
  v_pk_mul_f32 v[148:149], v[148:149], v[212:213]
  v_pk_mul_f32 v[150:151], v[150:151], v[214:215]
  v_exp_f32_e64 v168, v136 clamp
  v_max_f32 v136, 0x35c1a2a0, v136
  v_exp_f32_e64 v169, v137 clamp
  v_max_f32 v137, 0x35c1a2a0, v137
  v_exp_f32_e64 v170, v138 clamp
  v_max_f32 v138, 0x35c1a2a0, v138
  v_exp_f32_e64 v171, v139 clamp
  v_max_f32 v139, 0x35c1a2a0, v139
  v_exp_f32_e64 v172, v140 clamp
  v_max_f32 v140, 0x35c1a2a0, v140
  v_exp_f32_e64 v173, v141 clamp
  v_max_f32 v141, 0x35c1a2a0, v141
  v_exp_f32_e64 v174, v142 clamp
  v_max_f32 v142, 0x35c1a2a0, v142
  v_exp_f32_e64 v175, v143 clamp
  v_max_f32 v143, 0x35c1a2a0, v143
  v_exp_f32_e64 v176, v144 clamp
  v_max_f32 v144, 0x35c1a2a0, v144
  v_exp_f32_e64 v177, v145 clamp
  v_max_f32 v145, 0x35c1a2a0, v145
  v_exp_f32_e64 v178, v146 clamp
  v_max_f32 v146, 0x35c1a2a0, v146
  v_exp_f32_e64 v179, v147 clamp
  v_max_f32 v147, 0x35c1a2a0, v147
  v_exp_f32_e64 v180, v148 clamp
  v_max_f32 v148, 0x35c1a2a0, v148
  v_exp_f32_e64 v181, v149 clamp
  v_max_f32 v149, 0x35c1a2a0, v149
  v_exp_f32_e64 v182, v150 clamp
  v_max_f32 v150, 0x35c1a2a0, v150
  v_exp_f32_e64 v183, v151 clamp
  v_max_f32 v151, 0x35c1a2a0, v151
  v_fmac_f32 v168, s74, v136
  v_fmac_f32 v169, s74, v137
  v_fmac_f32 v170, s74, v138
  v_fmac_f32 v171, s74, v139
  v_fmac_f32 v172, s74, v140
  v_fmac_f32 v173, s74, v141
  v_fmac_f32 v174, s74, v142
  v_fmac_f32 v175, s74, v143
  v_fmac_f32 v176, s74, v144
  v_fmac_f32 v177, s74, v145
  v_fmac_f32 v178, s74, v146
  v_fmac_f32 v179, s74, v147
  v_fmac_f32 v180, s74, v148
  v_fmac_f32 v181, s74, v149
  v_fmac_f32 v182, s74, v150
  v_fmac_f32 v183, s74, v151
  v_cvt_pk_bf16_f32 v136, v168, v169
  v_cvt_pk_bf16_f32 v137, v170, v171
  v_cvt_pk_bf16_f32 v138, v172, v173
  v_cvt_pk_bf16_f32 v139, v174, v175
  v_cvt_pk_bf16_f32 v140, v176, v177
  v_cvt_pk_bf16_f32 v141, v178, v179
  v_cvt_pk_bf16_f32 v142, v180, v181
  v_cvt_pk_bf16_f32 v143, v182, v183
  v_pk_mul_f32 v[152:153], v[152:153], v[200:201]
  v_pk_mul_f32 v[154:155], v[154:155], v[202:203]
  v_pk_mul_f32 v[156:157], v[156:157], v[204:205]
  v_pk_mul_f32 v[158:159], v[158:159], v[206:207]
  v_pk_mul_f32 v[160:161], v[160:161], v[208:209]
  v_pk_mul_f32 v[162:163], v[162:163], v[210:211]
  v_pk_mul_f32 v[164:165], v[164:165], v[212:213]
  v_pk_mul_f32 v[166:167], v[166:167], v[214:215]
  v_cvt_pk_bf16_f32 v152, v152, v153
  v_cvt_pk_bf16_f32 v153, v154, v155
  v_cvt_pk_bf16_f32 v154, v156, v157
  v_cvt_pk_bf16_f32 v155, v158, v159
  v_cvt_pk_bf16_f32 v156, v160, v161
  v_cvt_pk_bf16_f32 v157, v162, v163
  v_cvt_pk_bf16_f32 v158, v164, v165
  v_cvt_pk_bf16_f32 v159, v166, v167
  v_cndmask_b32 v152, v152, v252, s[50:51]
  v_cndmask_b32 v153, v153, v252, s[50:51]
  v_cndmask_b32 v154, v154, v252, s[50:51]
  v_cndmask_b32 v155, v155, v252, s[50:51]
  v_cndmask_b32 v156, v156, v252, s[50:51]
  v_cndmask_b32 v157, v157, v252, s[50:51]
  v_cndmask_b32 v158, v158, v252, s[50:51]
  v_cndmask_b32 v159, v159, v252, s[50:51]
  v_mfma_f32_32x32x16_bf16 v[184:199], v[136:139], v[152:155], 0
  s_nop 0
  v_mfma_f32_32x32x16_bf16 v[184:199], v[140:143], v[156:159], v[184:199]
  s_nop 11
  ds_write_b128 v248, v[184:187] offset:0
  ds_write_b128 v248, v[188:191] offset:1024
  ds_write_b128 v248, v[192:195] offset:2048
  ds_write_b128 v248, v[196:199] offset:3072
  s_waitcnt vmcnt(2) lgkmcnt(0)
  s_barrier
  ds_read_b128 v[152:155], v249 offset:0
  ds_read_b128 v[156:159], v249 offset:5120
  ds_read_b128 v[160:163], v249 offset:10240
  ds_read_b128 v[164:167], v249 offset:15360
  s_waitcnt lgkmcnt(2)
  v_pk_add_f32 v[152:153], v[152:153], v[156:157]
  v_pk_add_f32 v[154:155], v[154:155], v[158:159]
  s_waitcnt lgkmcnt(0)
  v_pk_add_f32 v[160:161], v[160:161], v[164:165]
  v_pk_add_f32 v[162:163], v[162:163], v[166:167]
  v_pk_add_f32 v[152:153], v[152:153], v[160:161]
  v_pk_add_f32 v[154:155], v[154:155], v[162:163]
  v_cvt_pk_bf16_f32 v152, v152, v153
  v_cvt_pk_bf16_f32 v153, v154, v155
  v_cndmask_b32 v153, v153, v253, s[80:81]
  buffer_store_dwordx2 v[152:153], v254, s[36:39], s79 offen sc1
  s_mul_i32 s44, s3, 3072
  s_sub_u32 s45, s65, s63
  s_add_u32 s45, s45, s44
  s_add_u32 m0, s44, 102400
  s_add_u32 s97, s45, 16850944
  buffer_load_dwordx4 v1, s[36:39], s97 offen sc1 lds
  s_add_u32 m0, s44, 103424
  s_add_u32 s97, s45, 16851968
  buffer_load_dwordx4 v1, s[36:39], s97 offen sc1 lds
  s_add_u32 m0, s44, 104448
  s_add_u32 s97, s45, 16852992
  buffer_load_dwordx4 v1, s[36:39], s97 offen sc1 lds
  v_and_b32 v249, 0x1ff, v8
  s_add_u32 s78, s63, 86016
  v_add_u32 v249, s78, v249
  v_and_b32 v248, 0x200, v8
  v_lshl_add_u32 v248, v248, 1, v249
  ds_read_b64_tr_b16 v[216:217], v14 offset:0
  ds_read_b64_tr_b16 v[218:219], v14 offset:256
  ds_read_b64_tr_b16 v[220:221], v14 offset:1024
  ds_read_b64_tr_b16 v[222:223], v14 offset:1280
  ds_read_b64_tr_b16 v[224:225], v14 offset:2048
  ds_read_b64_tr_b16 v[226:227], v14 offset:2304
  ds_read_b64_tr_b16 v[228:229], v14 offset:3072
  ds_read_b64_tr_b16 v[230:231], v14 offset:3328
  s_waitcnt lgkmcnt(4)
  v_mfma_f32_32x32x16_bf16 v[168:183], v[216:219], v[24:27], 0
  ds_read_b64_tr_b16 v[232:233], v14 offset:4096
  ds_read_b64_tr_b16 v[234:235], v14 offset:4352
  s_add_u32 m0, s63, 114688
  s_add_u32 s97, s69, 0
  buffer_load_dwordx4 v6, s[16:19], s97 offen  lds
  v_mfma_f32_32x32x16_bf16 v[168:183], v[220:223], v[28:31], v[168:183]
  ds_read_b64_tr_b16 v[236:237], v14 offset:5120
  ds_read_b64_tr_b16 v[238:239], v14 offset:5376
  s_add_u32 m0, s63, 115712
  s_add_u32 s97, s69, 7168
  buffer_load_dwordx4 v6, s[16:19], s97 offen  lds
  s_waitcnt lgkmcnt(4)
  v_mfma_f32_32x32x16_bf16 v[168:183], v[224:227], v[32:35], v[168:183]
  ds_read_b64_tr_b16 v[216:217], v14 offset:6144
  ds_read_b64_tr_b16 v[218:219], v14 offset:6400
  s_add_u32 m0, s63, 116736
  s_add_u32 s97, s69, 14336
  buffer_load_dwordx4 v6, s[16:19], s97 offen  lds
  v_mfma_f32_32x32x16_bf16 v[168:183], v[228:231], v[36:39], v[168:183]
  ds_read_b64_tr_b16 v[220:221], v14 offset:7168
  ds_read_b64_tr_b16 v[222:223], v14 offset:7424
  s_add_u32 m0, s63, 117760
  s_add_u32 s97, s69, 21504
  buffer_load_dwordx4 v6, s[16:19], s97 offen  lds
  s_waitcnt lgkmcnt(4)
  v_mfma_f32_32x32x16_bf16 v[168:183], v[232:235], v[40:43], v[168:183]
  ds_read_b64_tr_b16 v[224:225], v14 offset:8192
  ds_read_b64_tr_b16 v[226:227], v14 offset:8448
  s_add_u32 m0, s63, 118784
  s_add_u32 s97, s69, 28672
  buffer_load_dwordx4 v6, s[16:19], s97 offen  lds
  v_mfma_f32_32x32x16_bf16 v[168:183], v[236:239], v[44:47], v[168:183]
  ds_read_b64_tr_b16 v[228:229], v14 offset:9216
  ds_read_b64_tr_b16 v[230:231], v14 offset:9472
  s_add_u32 m0, s63, 119808
  s_add_u32 s97, s69, 35840
  buffer_load_dwordx4 v6, s[16:19], s97 offen  lds
  s_waitcnt lgkmcnt(4)
  v_mfma_f32_32x32x16_bf16 v[168:183], v[216:219], v[48:51], v[168:183]
  ds_read_b64_tr_b16 v[232:233], v14 offset:10240
  ds_read_b64_tr_b16 v[234:235], v14 offset:10496
  s_add_u32 m0, s63, 120832
  s_add_u32 s97, s69, 43008
  buffer_load_dwordx4 v6, s[16:19], s97 offen  lds
  v_mfma_f32_32x32x16_bf16 v[168:183], v[220:223], v[52:55], v[168:183]
  ds_read_b64_tr_b16 v[236:237], v14 offset:11264
  ds_read_b64_tr_b16 v[238:239], v14 offset:11520
  s_waitcnt lgkmcnt(4)
  v_mfma_f32_32x32x16_bf16 v[168:183], v[224:227], v[56:59], v[168:183]
  ds_read_b64_tr_b16 v[216:217], v14 offset:12288
  ds_read_b64_tr_b16 v[218:219], v14 offset:12544
  v_mfma_f32_32x32x16_bf16 v[168:183], v[228:231], v[60:63], v[168:183]
  ds_read_b64_tr_b16 v[220:221], v14 offset:13312
  ds_read_b64_tr_b16 v[222:223], v14 offset:13568
  s_waitcnt lgkmcnt(4)
  v_mfma_f32_32x32x16_bf16 v[168:183], v[232:235], v[64:67], v[168:183]
  ds_read_b64_tr_b16 v[224:225], v14 offset:14336
  ds_read_b64_tr_b16 v[226:227], v14 offset:14592
  v_mfma_f32_32x32x16_bf16 v[168:183], v[236:239], v[68:71], v[168:183]
  ds_read_b64_tr_b16 v[228:229], v14 offset:15360
  ds_read_b64_tr_b16 v[230:231], v14 offset:15616
  s_waitcnt lgkmcnt(4)
  v_mfma_f32_32x32x16_bf16 v[168:183], v[216:219], v[72:75], v[168:183]
  s_waitcnt vmcnt(7)
  s_barrier
  ds_read_b64_tr_b16 v[232:233], v14 offset:16384
  ds_read_b64_tr_b16 v[234:235], v14 offset:16640
  buffer_load_dwordx4 v[184:187], v246, s[36:39], 0 offen offset:0 sc1
  v_mfma_f32_32x32x16_bf16 v[168:183], v[220:223], v[76:79], v[168:183]
  ds_read_b64_tr_b16 v[236:237], v14 offset:17408
  ds_read_b64_tr_b16 v[238:239], v14 offset:17664
  buffer_load_dwordx4 v[188:191], v246, s[36:39], 0 offen offset:1024 sc1
  s_waitcnt lgkmcnt(4)
  v_mfma_f32_32x32x16_bf16 v[168:183], v[224:227], v[80:83], v[168:183]
  ds_read_b64_tr_b16 v[216:217], v14 offset:18432
  ds_read_b64_tr_b16 v[218:219], v14 offset:18688
  buffer_load_dwordx4 v[192:195], v246, s[36:39], 0 offen offset:2048 sc1
  v_mfma_f32_32x32x16_bf16 v[168:183], v[228:231], v[84:87], v[168:183]
  ds_read_b64_tr_b16 v[220:221], v14 offset:19456
  ds_read_b64_tr_b16 v[222:223], v14 offset:19712
  buffer_load_dwordx4 v[196:199], v246, s[36:39], 0 offen offset:3072 sc1
  s_waitcnt lgkmcnt(4)
  v_mfma_f32_32x32x16_bf16 v[168:183], v[232:235], v[88:91], v[168:183]
  ds_read_b64_tr_b16 v[224:225], v14 offset:20480
  ds_read_b64_tr_b16 v[226:227], v14 offset:20736
  buffer_load_dwordx4 v[200:203], v246, s[36:39], s57 offen offset:0 sc1
  v_mfma_f32_32x32x16_bf16 v[168:183], v[236:239], v[92:95], v[168:183]
  ds_read_b64_tr_b16 v[228:229], v14 offset:21504
  ds_read_b64_tr_b16 v[230:231], v14 offset:21760
  buffer_load_dwordx4 v[204:207], v246, s[36:39], s57 offen offset:1024 sc1
  s_waitcnt lgkmcnt(4)
  v_mfma_f32_32x32x16_bf16 v[168:183], v[216:219], v[96:99], v[168:183]
  ds_read_b64_tr_b16 v[232:233], v14 offset:22528
  ds_read_b64_tr_b16 v[234:235], v14 offset:22784
  buffer_load_dwordx4 v[208:211], v246, s[36:39], s57 offen offset:2048 sc1
  v_mfma_f32_32x32x16_bf16 v[168:183], v[220:223], v[100:103], v[168:183]
  ds_read_b64_tr_b16 v[236:237], v14 offset:23552
  ds_read_b64_tr_b16 v[238:239], v14 offset:23808
  buffer_load_dwordx4 v[212:215], v246, s[36:39], s57 offen offset:3072 sc1
  s_waitcnt lgkmcnt(4)
  v_mfma_f32_32x32x16_bf16 v[168:183], v[224:227], v[104:107], v[168:183]
  ds_read_b64_tr_b16 v[216:217], v14 offset:24576
  ds_read_b64_tr_b16 v[218:219], v14 offset:24832
  v_mfma_f32_32x32x16_bf16 v[168:183], v[228:231], v[108:111], v[168:183]
  ds_read_b64_tr_b16 v[220:221], v14 offset:25600
  ds_read_b64_tr_b16 v[222:223], v14 offset:25856
  s_waitcnt lgkmcnt(4)
  v_mfma_f32_32x32x16_bf16 v[168:183], v[232:235], v[112:115], v[168:183]
  ds_read_b64_tr_b16 v[224:225], v14 offset:26624
  ds_read_b64_tr_b16 v[226:227], v14 offset:26880
  v_mfma_f32_32x32x16_bf16 v[168:183], v[236:239], v[116:119], v[168:183]
  ds_read_b64_tr_b16 v[228:229], v14 offset:27648
  ds_read_b64_tr_b16 v[230:231], v14 offset:27904
  s_waitcnt vmcnt(8)
  ds_read_b64_tr_b16 v[136:137], v248 offset:28672
  ds_read_b64_tr_b16 v[138:139], v248 offset:28928
  s_waitcnt lgkmcnt(6)
  v_mfma_f32_32x32x16_bf16 v[168:183], v[216:219], v[120:123], v[168:183]
  ds_read_b64_tr_b16 v[140:141], v248 offset:29184
  ds_read_b64_tr_b16 v[142:143], v248 offset:29440
  ds_read_b64_tr_b16 v[144:145], v248 offset:30720
  ds_read_b64_tr_b16 v[146:147], v249 offset:30976
  ds_read_b64_tr_b16 v[148:149], v248 offset:31232
  ds_read_b64_tr_b16 v[150:151], v249 offset:31488
  v_mfma_f32_32x32x16_bf16 v[168:183], v[220:223], v[124:127], v[168:183]
  ds_read_b64_tr_b16 v[152:153], v248 offset:32000
  ds_read_b64_tr_b16 v[154:155], v248 offset:32768
  ds_read_b64_tr_b16 v[156:157], v248 offset:32512
  ds_read_b64_tr_b16 v[158:159], v248 offset:33280
  ds_read_b64_tr_b16 v[160:161], v248 offset:34048
  v_mfma_f32_32x32x16_bf16 v[168:183], a[228:231], v[240:243], v[168:183]
  ds_read_b64_tr_b16 v[162:163], v249 offset:34816
  ds_read_b64_tr_b16 v[164:165], v248 offset:34560
  ds_read_b64_tr_b16 v[166:167], v249 offset:35328
  s_waitcnt lgkmcnt(0)
  v_mfma_f32_32x32x16_bf16 v[168:183], v[224:227], v[128:131], v[168:183]
  v_mfma_f32_32x32x16_bf16 v[168:183], v[228:231], v[132:135], v[168:183]
  s_nop 11
  v_pk_mul_f32 v[168:169], v[168:169], v[244:245] op_sel_hi:[1,0]
  v_pk_mul_f32 v[170:171], v[170:171], v[244:245] op_sel_hi:[1,0]
  v_pk_mul_f32 v[172:173], v[172:173], v[244:245] op_sel_hi:[1,0]
  v_pk_mul_f32 v[174:175], v[174:175], v[244:245] op_sel_hi:[1,0]
  v_pk_mul_f32 v[176:177], v[176:177], v[244:245] op_sel_hi:[1,0]
  v_pk_mul_f32 v[178:179], v[178:179], v[244:245] op_sel_hi:[1,0]
  v_pk_mul_f32 v[180:181], v[180:181], v[244:245] op_sel_hi:[1,0]
  v_pk_mul_f32 v[182:183], v[182:183], v[244:245] op_sel_hi:[1,0]
  v_exp_f32_e64 v40, v168 clamp
  v_max_f32 v168, 0x35c1a2a0, v168
  v_exp_f32_e64 v41, v169 clamp
  v_max_f32 v169, 0x35c1a2a0, v169
  v_exp_f32_e64 v42, v170 clamp
  v_max_f32 v170, 0x35c1a2a0, v170
  v_exp_f32_e64 v43, v171 clamp
  v_max_f32 v171, 0x35c1a2a0, v171
  v_exp_f32_e64 v44, v172 clamp
  v_max_f32 v172, 0x35c1a2a0, v172
  v_exp_f32_e64 v45, v173 clamp
  v_max_f32 v173, 0x35c1a2a0, v173
  v_exp_f32_e64 v46, v174 clamp
  v_max_f32 v174, 0x35c1a2a0, v174
  v_exp_f32_e64 v47, v175 clamp
  v_max_f32 v175, 0x35c1a2a0, v175
  v_exp_f32_e64 v48, v176 clamp
  v_max_f32 v176, 0x35c1a2a0, v176
  v_exp_f32_e64 v49, v177 clamp
  v_max_f32 v177, 0x35c1a2a0, v177
  v_exp_f32_e64 v50, v178 clamp
  v_max_f32 v178, 0x35c1a2a0, v178
  v_exp_f32_e64 v51, v179 clamp
  v_max_f32 v179, 0x35c1a2a0, v179
  v_exp_f32_e64 v52, v180 clamp
  v_max_f32 v180, 0x35c1a2a0, v180
  v_exp_f32_e64 v53, v181 clamp
  v_max_f32 v181, 0x35c1a2a0, v181
  v_exp_f32_e64 v54, v182 clamp
  v_max_f32 v182, 0x35c1a2a0, v182
  v_exp_f32_e64 v55, v183 clamp
  v_max_f32 v183, 0x35c1a2a0, v183
  v_fmac_f32 v40, s74, v168
  v_fmac_f32 v41, s74, v169
  v_fmac_f32 v42, s74, v170
  v_fmac_f32 v43, s74, v171
  v_fmac_f32 v44, s74, v172
  v_fmac_f32 v45, s74, v173
  v_fmac_f32 v46, s74, v174
  v_fmac_f32 v47, s74, v175
  v_fmac_f32 v48, s74, v176
  v_fmac_f32 v49, s74, v177
  v_fmac_f32 v50, s74, v178
  v_fmac_f32 v51, s74, v179
  v_fmac_f32 v52, s74, v180
  v_fmac_f32 v53, s74, v181
  v_fmac_f32 v54, s74, v182
  v_fmac_f32 v55, s74, v183
  v_cvt_pk_bf16_f32 v168, v40, v41
  v_cvt_pk_bf16_f32 v169, v42, v43
  v_cvt_pk_bf16_f32 v170, v44, v45
  v_cvt_pk_bf16_f32 v171, v46, v47
  v_cvt_pk_bf16_f32 v172, v48, v49
  v_cvt_pk_bf16_f32 v173, v50, v51
  v_cvt_pk_bf16_f32 v174, v52, v53
  v_cvt_pk_bf16_f32 v175, v54, v55
  v_cndmask_b32 v174, v174, 0, s[48:49]
  v_cndmask_b32 v175, v175, 0, s[48:49]
  s_add_u32 m0, s63, 114688
  s_add_u32 s97, s69, 50176
  buffer_load_dwordx4 v6, s[16:19], s97 offen  lds
  s_add_u32 m0, s63, 115712
  s_add_u32 s97, s69, 57344
  buffer_load_dwordx4 v6, s[16:19], s97 offen  lds
  s_add_u32 m0, s63, 116736
  s_add_u32 s97, s69, 64512
  buffer_load_dwordx4 v6, s[16:19], s97 offen  lds
  s_add_u32 m0, s63, 117760
  s_add_u32 s97, s69, 71680
  buffer_load_dwordx4 v6, s[16:19], s97 offen  lds
  s_add_u32 m0, s63, 118784
  s_add_u32 s97, s69, 78848
  buffer_load_dwordx4 v6, s[16:19], s97 offen  lds
  s_add_u32 m0, s63, 119808
  s_add_u32 s97, s69, 86016
  buffer_load_dwordx4 v6, s[16:19], s97 offen  lds
  s_add_u32 m0, s63, 120832
  s_add_u32 s97, s69, 93184
  buffer_load_dwordx4 v6, s[16:19], s97 offen  lds
  v_and_b32 v250, 0x1f0, v1
  v_lshrrev_b32 v251, 6, v1
  v_and_b32 v251, 8, v251
  v_add3_u32 v250, v250, v251, s70
  v_lshlrev_b32 v251, 1, v251
  v_bfe_u32 v252, v1, 4, 3
  v_lshl_add_u32 v251, v252, 6, v251
  v_bfe_u32 v252, v1, 7, 2
  v_mul_u32_u24 v252, 5120, v252
  v_add_u32 v252, 147456, v252
  v_add_u32 v251, v251, v252
  s_lshl_b32 s78, s7, 2
  s_lshr_b32 s79, s6, 2
  s_add_u32 s78, s78, s79
  s_mul_i32 s78, s78, 28672
  s_and_b32 s79, s6, 3
  s_lshl_b32 s79, s79, 11
  s_add_u32 s78, s78, s79
  s_add_u32 s78, s78, 9457664
  s_mov_b32 s79, 0x3fb8aa3b
  v_mov_b32 v254, 0x35c1a2a0
  v_mov_b32 v253, s88
  s_mov_b32 s80, 0x88888888
  s_mov_b32 s81, 0x88888888
  s_movk_i32 s82, 0x3f80
  s_mov_b32 s83, 0x3f800000
Lchk_58:
  s_waitcnt vmcnt(14)
  v_xor_b32 v252, v187, v253
  v_lshlrev_b32 v24, 16, v184
  v_and_b32 v25, 0xffff0000, v184
  v_lshlrev_b32 v26, 16, v185
  v_and_b32 v27, 0xffff0000, v185
  v_lshlrev_b32 v28, 16, v186
  v_and_b32 v29, 0xffff0000, v186
  v_lshlrev_b32 v30, 16, v187
  v_and_b32 v31, 0xffff0000, v187
  s_waitcnt vmcnt(13)
  v_bitop3_b32 v252, v252, v191, v253 bitop3:0xf6
  v_dot2c_f32_bf16 v24, s82, v188
  v_dot2c_f32_bf16 v25, s83, v188
  v_dot2c_f32_bf16 v26, s82, v189
  v_dot2c_f32_bf16 v27, s83, v189
  v_dot2c_f32_bf16 v28, s82, v190
  v_dot2c_f32_bf16 v29, s83, v190
  v_dot2c_f32_bf16 v30, s82, v191
  v_dot2c_f32_bf16 v31, s83, v191
  s_waitcnt vmcnt(12)
  v_bitop3_b32 v252, v252, v195, v253 bitop3:0xf6
  v_dot2c_f32_bf16 v24, s82, v192
  v_dot2c_f32_bf16 v25, s83, v192
  v_dot2c_f32_bf16 v26, s82, v193
  v_dot2c_f32_bf16 v27, s83, v193
  v_dot2c_f32_bf16 v28, s82, v194
  v_dot2c_f32_bf16 v29, s83, v194
  v_dot2c_f32_bf16 v30, s82, v195
  v_dot2c_f32_bf16 v31, s83, v195
  s_waitcnt vmcnt(11)
  v_bitop3_b32 v252, v252, v199, v253 bitop3:0xf6
  v_dot2c_f32_bf16 v24, s82, v196
  v_dot2c_f32_bf16 v25, s83, v196
  v_dot2c_f32_bf16 v26, s82, v197
  v_dot2c_f32_bf16 v27, s83, v197
  v_dot2c_f32_bf16 v28, s82, v198
  v_dot2c_f32_bf16 v29, s83, v198
  v_dot2c_f32_bf16 v30, s82, v199
  v_dot2c_f32_bf16 v31, s83, v199
  s_waitcnt vmcnt(10)
  v_bitop3_b32 v252, v252, v203, v253 bitop3:0xf6
  v_dot2c_f32_bf16 v24, s82, v200
  v_dot2c_f32_bf16 v25, s83, v200
  v_dot2c_f32_bf16 v26, s82, v201
  v_dot2c_f32_bf16 v27, s83, v201
  v_dot2c_f32_bf16 v28, s82, v202
  v_dot2c_f32_bf16 v29, s83, v202
  v_dot2c_f32_bf16 v30, s82, v203
  v_dot2c_f32_bf16 v31, s83, v203
  s_waitcnt vmcnt(9)
  v_bitop3_b32 v252, v252, v207, v253 bitop3:0xf6
  v_dot2c_f32_bf16 v24, s82, v204
  v_dot2c_f32_bf16 v25, s83, v204
  v_dot2c_f32_bf16 v26, s82, v205
  v_dot2c_f32_bf16 v27, s83, v205
  v_dot2c_f32_bf16 v28, s82, v206
  v_dot2c_f32_bf16 v29, s83, v206
  v_dot2c_f32_bf16 v30, s82, v207
  v_dot2c_f32_bf16 v31, s83, v207
  s_waitcnt vmcnt(8)
  v_bitop3_b32 v252, v252, v211, v253 bitop3:0xf6
  v_dot2c_f32_bf16 v24, s82, v208
  v_dot2c_f32_bf16 v25, s83, v208
  v_dot2c_f32_bf16 v26, s82, v209
  v_dot2c_f32_bf16 v27, s83, v209
  v_dot2c_f32_bf16 v28, s82, v210
  v_dot2c_f32_bf16 v29, s83, v210
  v_dot2c_f32_bf16 v30, s82, v211
  v_dot2c_f32_bf16 v31, s83, v211
  s_waitcnt vmcnt(7)
  v_bitop3_b32 v252, v252, v215, v253 bitop3:0xf6
  v_dot2c_f32_bf16 v24, s82, v212
  v_dot2c_f32_bf16 v25, s83, v212
  v_dot2c_f32_bf16 v26, s82, v213
  v_dot2c_f32_bf16 v27, s83, v213
  v_dot2c_f32_bf16 v28, s82, v214
  v_dot2c_f32_bf16 v29, s83, v214
  v_dot2c_f32_bf16 v30, s82, v215
  v_dot2c_f32_bf16 v31, s83, v215
  v_cmp_ne_u32 vcc, 0, v252
  s_nop 0
  s_and_b64 vcc, vcc, s[80:81]
  s_cbranch_scc1 Lre_59
Lgd_60:
  s_mov_b32 s80, 0
  v_permlane32_swap_b32 v24, v28
  v_permlane32_swap_b32 v25, v29
  v_permlane32_swap_b32 v26, v30
  v_permlane32_swap_b32 v27, v31
  v_pk_add_f32 v[24:25], v[24:25], v[28:29]
  v_pk_add_f32 v[26:27], v[26:27], v[30:31]
  v_cvt_pk_bf16_f32 v24, v24, v25
  v_cvt_pk_bf16_f32 v25, v26, v27
  v_cndmask_b32 v25, v25, 0, s[80:81]
  ds_write_b64 v250, v[24:25] offset:4096
  s_waitcnt lgkmcnt(0)
  s_barrier
  ds_read_b128 v[216:219], v251
  ds_read_b128 v[220:223], v251 offset:32
  s_waitcnt lgkmcnt(1)
  v_mfma_f32_32x32x16_bf16 v[184:199], v[216:219], v[168:171], 0
  s_waitcnt lgkmcnt(0)
  v_mfma_f32_32x32x16_bf16 v[184:199], v[220:223], v[172:175], v[184:199]
  s_nop 11
  v_mov_b32 v252, v196
  v_mov_b32 v253, v196
  s_nop 1
  v_permlane32_swap_b32 v253, v252
  v_fma_f32 v252, v252, s79, v254
  v_rcp_f32 v252, v252
  s_nop 0
  v_cndmask_b32 v254, v252, 0, s[48:49]
  v_pk_mul_f32 v[184:185], v[184:185], v[252:253] op_sel_hi:[1,0]
  v_pk_mul_f32 v[186:187], v[186:187], v[252:253] op_sel_hi:[1,0]
  v_pk_mul_f32 v[188:189], v[188:189], v[252:253] op_sel_hi:[1,0]
  v_pk_mul_f32 v[190:191], v[190:191], v[252:253] op_sel_hi:[1,0]
  v_pk_mul_f32 v[192:193], v[192:193], v[252:253] op_sel_hi:[1,0]
  v_pk_mul_f32 v[194:195], v[194:195], v[252:253] op_sel_hi:[1,0]
  v_pk_mul_f32 v[196:197], v[196:197], v[254:255] op_sel_hi:[1,0]
  v_pk_mul_f32 v[198:199], v[198:199], v[254:255] op_sel_hi:[1,0]
  v_cvt_pk_bf16_f32 v184, v184, v185
  v_cvt_pk_bf16_f32 v185, v186, v187
  v_cvt_pk_bf16_f32 v186, v188, v189
  v_cvt_pk_bf16_f32 v187, v190, v191
  buffer_store_dwordx4 v[184:187], v1, s[36:39], s78 offen sc1
  v_cvt_pk_bf16_f32 v188, v192, v193
  v_cvt_pk_bf16_f32 v189, v194, v195
  v_cvt_pk_bf16_f32 v190, v196, v197
  v_cvt_pk_bf16_f32 v191, v198, v199
  buffer_store_dwordx4 v[188:191], v1, s[36:39], s78 offen offset:1024 sc1
  v_lshlrev_b32 v168, 16, v16
  v_and_b32 v169, 0xffff0000, v16
  v_lshlrev_b32 v170, 16, v17
  v_and_b32 v171, 0xffff0000, v17
  v_lshlrev_b32 v172, 16, v18
  v_and_b32 v173, 0xffff0000, v18
  v_lshlrev_b32 v174, 16, v19
  v_and_b32 v175, 0xffff0000, v19
  v_lshlrev_b32 v176, 16, v20
  v_and_b32 v177, 0xffff0000, v20
  v_lshlrev_b32 v178, 16, v21
  v_and_b32 v179, 0xffff0000, v21
  v_lshlrev_b32 v180, 16, v22
  v_and_b32 v181, 0xffff0000, v22
  v_lshlrev_b32 v182, 16, v23
  v_and_b32 v183, 0xffff0000, v23
  s_waitcnt vmcnt(2)
  ds_read_b64_tr_b16 v[88:89], v248 offset:28672
  ds_read_b64_tr_b16 v[90:91], v248 offset:28928
  ds_read_b64_tr_b16 v[92:93], v248 offset:29184
  ds_read_b64_tr_b16 v[94:95], v248 offset:29440
  ds_read_b64_tr_b16 v[96:97], v248 offset:30720
  ds_read_b64_tr_b16 v[98:99], v249 offset:30976
  ds_read_b64_tr_b16 v[100:101], v248 offset:31232
  ds_read_b64_tr_b16 v[102:103], v249 offset:31488
  ds_read_b64_tr_b16 v[104:105], v248 offset:32000
  ds_read_b64_tr_b16 v[106:107], v248 offset:32768
  ds_read_b64_tr_b16 v[108:109], v248 offset:32512
  ds_read_b64_tr_b16 v[110:111], v248 offset:33280
  ds_read_b64_tr_b16 v[112:113], v248 offset:34048
  ds_read_b64_tr_b16 v[114:115], v249 offset:34816
  ds_read_b64_tr_b16 v[116:117], v248 offset:34560
  ds_read_b64_tr_b16 v[118:119], v249 offset:35328
  s_waitcnt vmcnt(0)
  s_add_u32 s79, s52, 2
  v_mov_b32 v252, s79
  buffer_store_dword v252, v4, s[36:39], s72 offen sc1
  s_waitcnt lgkmcnt(0)
  s_barrier
  s_xor_b32 s78, s76, 0
  s_mul_i32 s78, s78, 114688
  s_mul_i32 s79, s3, 28672
  s_add_u32 s78, s78, s79
  s_add_u32 s78, s78, 9457664
  v_add_u32 v246, s78, v1
  s_xor_b32 s78, s76, 1
  s_mul_i32 s78, s78, 114688
  s_mul_i32 s79, s3, 28672
  s_add_u32 s78, s78, s79
  s_add_u32 s78, s78, 9457664
  v_add_u32 v247, s78, v1
  v_add_u32 v250, s64, v1
  s_xor_b32 s82, s3, 1
  s_mul_i32 s82, s82, 12288
  s_add_u32 s82, s82, 114688
  v_add_u32 v251, s82, v1
  s_xor_b32 s82, s3, 2
  s_mul_i32 s82, s82, 12288
  s_add_u32 s82, s82, 118784
  v_add_u32 v252, s82, v1
  s_xor_b32 s82, s3, 3
  s_mul_i32 s82, s82, 12288
  s_add_u32 s82, s82, 122880
  v_add_u32 v253, s82, v1
  s_lshl_b32 s80, s76, 15
  s_add_u32 s80, s80, 5242880
  s_lshl_b32 s79, s77, 11
  s_add_u32 s78, s80, s79
  s_lshl_b32 s79, s55, 9
  s_add_u32 s79, s79, s80
  s_and_b32 s80, s3, 1
  s_lshl_b32 s80, s80, 3
  s_add_u32 s79, s79, s80
  s_add_u32 s79, s79, 28672
  s_lshl_b32 s80, s76, 7
  s_lshl_b32 s82, s77, 2
  s_add_u32 s80, s80, s82
  s_add_u32 s80, s80, 24576
  s_add_u32 s81, s73, 8192
  s_add_u32 s84, s52, 2
Lpoll_61:
  buffer_load_dword v15, v12, s[36:39], s81 offen sc1
  s_add_u32 s53, s53, 1
  s_cmp_gt_u32 s53, 0x20000
  s_cbranch_scc1 Lpd_62
  s_waitcnt vmcnt(0)
  v_subrev_u32 v15, s84, v15
  v_cmp_le_u32 vcc, 16, v15
  s_cbranch_vccnz Lpoll_61
Lpd_62:
  buffer_load_dwordx4 v[28:31], v247, s[40:43], 0 offen offset:0 sc1
  buffer_load_dwordx4 v[36:39], v247, s[40:43], 0 offen offset:1024 sc1
  buffer_load_dwordx4 v[44:47], v247, s[40:43], 0 offen offset:2048 sc1
  buffer_load_dwordx4 v[52:55], v247, s[40:43], 0 offen offset:3072 sc1
  buffer_load_dwordx4 v[60:63], v247, s[40:43], s57 offen offset:0 sc1
  buffer_load_dwordx4 v[68:71], v247, s[40:43], s57 offen offset:1024 sc1
  buffer_load_dwordx4 v[76:79], v247, s[40:43], s57 offen offset:2048 sc1
  s_waitcnt vmcnt(6)
  v_mfma_f32_32x32x16_bf16 v[200:215], v[136:139], v[28:31], 0
  buffer_load_dwordx4 v[84:87], v247, s[40:43], s57 offen offset:3072 sc1
  v_mfma_f32_32x32x16_bf16 v[216:231], v[140:143], v[28:31], 0
  s_waitcnt vmcnt(6)
  v_mfma_f32_32x32x16_bf16 v[200:215], v[144:147], v[36:39], v[200:215]
  buffer_load_dwordx4 v[24:27], v246, s[40:43], 0 offen offset:0 sc1
  v_mfma_f32_32x32x16_bf16 v[216:231], v[148:151], v[36:39], v[216:231]
  s_waitcnt vmcnt(6)
  v_mfma_f32_32x32x16_bf16 v[200:215], v[152:155], v[44:47], v[200:215]
  buffer_load_dwordx4 v[32:35], v246, s[40:43], 0 offen offset:1024 sc1
  v_mfma_f32_32x32x16_bf16 v[216:231], v[156:159], v[44:47], v[216:231]
  s_waitcnt vmcnt(6)
  v_mfma_f32_32x32x16_bf16 v[200:215], v[160:163], v[52:55], v[200:215]
  buffer_load_dwordx4 v[40:43], v246, s[40:43], 0 offen offset:2048 sc1
  v_mfma_f32_32x32x16_bf16 v[216:231], v[164:167], v[52:55], v[216:231]
  s_waitcnt vmcnt(6)
  v_mfma_f32_32x32x16_bf16 v[200:215], v[88:91], v[60:63], v[200:215]
  buffer_load_dwordx4 v[48:51], v246, s[40:43], 0 offen offset:3072 sc1
  v_mfma_f32_32x32x16_bf16 v[216:231], v[92:95], v[60:63], v[216:231]
  s_waitcnt vmcnt(6)
  v_mfma_f32_32x32x16_bf16 v[200:215], v[96:99], v[68:71], v[200:215]
  buffer_load_dwordx4 v[56:59], v246, s[40:43], s57 offen offset:0 sc1
  v_mfma_f32_32x32x16_bf16 v[216:231], v[100:103], v[68:71], v[216:231]
  s_waitcnt vmcnt(6)
  v_mfma_f32_32x32x16_bf16 v[200:215], v[104:107], v[76:79], v[200:215]
  buffer_load_dwordx4 v[64:67], v246, s[40:43], s57 offen offset:1024 sc1
  v_mfma_f32_32x32x16_bf16 v[216:231], v[108:111], v[76:79], v[216:231]
  s_waitcnt vmcnt(6)
  v_mfma_f32_32x32x16_bf16 v[200:215], v[112:115], v[84:87], v[200:215]
  buffer_load_dwordx4 v[72:75], v246, s[40:43], s57 offen offset:2048 sc1
  v_mfma_f32_32x32x16_bf16 v[216:231], v[116:119], v[84:87], v[216:231]
  s_waitcnt vmcnt(6)
  v_mfma_f32_32x32x16_bf16 v[168:183], v[136:139], v[24:27], v[168:183]
  buffer_load_dwordx4 v[80:83], v246, s[40:43], s57 offen offset:3072 sc1
  v_mfma_f32_32x32x16_bf16 v[184:199], v[140:143], v[24:27], 0
  s_waitcnt vmcnt(6)
  v_mfma_f32_32x32x16_bf16 v[168:183], v[144:147], v[32:35], v[168:183]
  ds_write_b128 v250, v[200:203] offset:4096
  v_mfma_f32_32x32x16_bf16 v[184:199], v[148:151], v[32:35], v[184:199]
  ds_write_b128 v250, v[204:207] offset:5120
  s_waitcnt vmcnt(5)
  v_mfma_f32_32x32x16_bf16 v[168:183], v[152:155], v[40:43], v[168:183]
  ds_write_b128 v250, v[208:211] offset:6144
  v_mfma_f32_32x32x16_bf16 v[184:199], v[156:159], v[40:43], v[184:199]
  ds_write_b128 v250, v[212:215] offset:7168
  s_waitcnt vmcnt(4)
  v_mfma_f32_32x32x16_bf16 v[168:183], v[160:163], v[48:51], v[168:183]
  v_mfma_f32_32x32x16_bf16 v[184:199], v[164:167], v[48:51], v[184:199]
  s_waitcnt vmcnt(3)
  v_mfma_f32_32x32x16_bf16 v[168:183], v[88:91], v[56:59], v[168:183]
  ds_write_b128 v250, v[216:219] offset:8192
  v_mfma_f32_32x32x16_bf16 v[184:199], v[92:95], v[56:59], v[184:199]
  ds_write_b128 v250, v[220:223] offset:9216
  s_waitcnt vmcnt(2)
  v_mfma_f32_32x32x16_bf16 v[184:199], v[100:103], v[64:67], v[184:199]
  ds_write_b128 v250, v[224:227] offset:10240
  s_waitcnt vmcnt(1)
  v_mfma_f32_32x32x16_bf16 v[184:199], v[108:111], v[72:75], v[184:199]
  ds_write_b128 v250, v[228:231] offset:11264
  s_waitcnt vmcnt(0)
  v_mfma_f32_32x32x16_bf16 v[184:199], v[116:119], v[80:83], v[184:199]
  v_mfma_f32_32x32x16_bf16 v[168:183], v[96:99], v[64:67], v[168:183]
  v_mfma_f32_32x32x16_bf16 v[168:183], v[104:107], v[72:75], v[168:183]
  ds_write_b128 v250, v[184:187] offset:0
  v_mfma_f32_32x32x16_bf16 v[168:183], v[112:115], v[80:83], v[168:183]
  ds_write_b128 v250, v[188:191] offset:1024
  ds_write_b128 v250, v[192:195] offset:2048
  ds_write_b128 v250, v[196:199] offset:3072
  s_waitcnt lgkmcnt(0)
  s_barrier
  ds_read_b128 v[184:187], v251 offset:0
  ds_read_b128 v[200:203], v252 offset:0
  ds_read_b128 v[216:219], v253 offset:0
  ds_read_b128 v[188:191], v251 offset:1024
  ds_read_b128 v[204:207], v252 offset:1024
  ds_read_b128 v[220:223], v253 offset:1024
  ds_read_b128 v[192:195], v251 offset:2048
  ds_read_b128 v[208:211], v252 offset:2048
  ds_read_b128 v[224:227], v253 offset:2048
  ds_read_b128 v[196:199], v251 offset:3072
  ds_read_b128 v[212:215], v252 offset:3072
  ds_read_b128 v[228:231], v253 offset:3072
  v_mov_b32 v254, 0
  v_mov_b32 v255, 0
  s_waitcnt lgkmcnt(9)
  v_pk_add_f32 v[168:169], v[168:169], v[184:185]
  v_pk_add_f32 v[200:201], v[200:201], v[216:217]
  v_pk_add_f32 v[170:171], v[170:171], v[186:187]
  v_pk_add_f32 v[202:203], v[202:203], v[218:219]
  v_pk_add_f32 v[168:169], v[168:169], v[200:201]
  v_pk_add_f32 v[170:171], v[170:171], v[202:203]
  v_cvt_pk_bf16_f32 v16, v168, v169
  v_cvt_pk_bf16_f32 v17, v170, v171
  v_dot2c_f32_bf16 v254, s75, v16
  v_dot2c_f32_bf16 v255, v16, v16
  v_dot2c_f32_bf16 v254, s75, v17
  v_dot2c_f32_bf16 v255, v17, v17
  s_waitcnt lgkmcnt(6)
  v_pk_add_f32 v[172:173], v[172:173], v[188:189]
  v_pk_add_f32 v[204:205], v[204:205], v[220:221]
  v_pk_add_f32 v[174:175], v[174:175], v[190:191]
  v_pk_add_f32 v[206:207], v[206:207], v[222:223]
  v_pk_add_f32 v[172:173], v[172:173], v[204:205]
  v_pk_add_f32 v[174:175], v[174:175], v[206:207]
  v_cvt_pk_bf16_f32 v18, v172, v173
  v_cvt_pk_bf16_f32 v19, v174, v175
  buffer_store_dwordx4 v[16:19], v1, s[40:43], s78 offen offset:0 sc1
  v_dot2c_f32_bf16 v254, s75, v18
  v_dot2c_f32_bf16 v255, v18, v18
  v_dot2c_f32_bf16 v254, s75, v19
  v_dot2c_f32_bf16 v255, v19, v19
  s_waitcnt lgkmcnt(3)
  v_pk_add_f32 v[176:177], v[176:177], v[192:193]
  v_pk_add_f32 v[208:209], v[208:209], v[224:225]
  v_pk_add_f32 v[178:179], v[178:179], v[194:195]
  v_pk_add_f32 v[210:211], v[210:211], v[226:227]
  v_pk_add_f32 v[176:177], v[176:177], v[208:209]
  v_pk_add_f32 v[178:179], v[178:179], v[210:211]
  v_cvt_pk_bf16_f32 v20, v176, v177
  v_cvt_pk_bf16_f32 v21, v178, v179
  v_dot2c_f32_bf16 v254, s75, v20
  v_dot2c_f32_bf16 v255, v20, v20
  v_dot2c_f32_bf16 v254, s75, v21
  v_dot2c_f32_bf16 v255, v21, v21
  s_waitcnt lgkmcnt(0)
  v_pk_add_f32 v[180:181], v[180:181], v[196:197]
  v_pk_add_f32 v[212:213], v[212:213], v[228:229]
  v_pk_add_f32 v[182:183], v[182:183], v[198:199]
  v_pk_add_f32 v[214:215], v[214:215], v[230:231]
  v_pk_add_f32 v[180:181], v[180:181], v[212:213]
  v_pk_add_f32 v[182:183], v[182:183], v[214:215]
  v_cvt_pk_bf16_f32 v22, v180, v181
  v_cvt_pk_bf16_f32 v23, v182, v183
  buffer_store_dwordx4 v[20:23], v1, s[40:43], s78 offen offset:1024 sc1
  v_dot2c_f32_bf16 v254, s75, v22
  v_dot2c_f32_bf16 v255, v22, v22
  v_dot2c_f32_bf16 v254, s75, v23
  v_dot2c_f32_bf16 v255, v23, v23
  s_nop 2
  v_permlane32_swap_b32 v254, v255
  v_add_f32 v254, v254, v255
  buffer_store_dword v254, v11, s[40:43], s79 offen sc1
  s_waitcnt vmcnt(0)
  s_add_u32 s81, s52, 3
  v_mov_b32 v255, s81
  buffer_store_dword v255, v4, s[40:43], s80 offen sc1
  s_lshr_b32 s78, s5, 3
  s_mul_i32 s78, s78, 28672
  s_bfe_u32 s79, s5, 0x20001
  s_lshl_b32 s80, s79, 11
  s_add_u32 s78, s78, s80
  s_add_u32 s78, s78, 9437184
  s_mul_i32 s90, s89, 114688
  s_add_u32 s90, s90, s78
  s_xor_b32 s81, s89, 4
  s_mul_i32 s91, s81, 114688
  s_add_u32 s91, s91, s78
  s_add_u32 s91, s91, 12288
  s_lshl_b32 s80, s79, 10
  s_sub_u32 s96, s90, s80
  s_add_u32 s96, s96, 8192
  s_lshr_b32 s78, s5, 3
  s_lshl_b32 s78, s78, 6
  s_lshl_b32 s80, s79, 3
  s_add_u32 s78, s78, s80
  s_and_b32 s80, s3, 1
  s_lshl_b32 s80, s80, 2
  s_add_u32 s78, s78, s80
  s_add_u32 s78, s78, 16384
  s_lshr_b32 s80, s89, 1
  s_lshl_b32 s80, s80, 8
  s_add_u32 s92, s78, s80
  s_xor_b32 s80, s80, 512
  s_add_u32 s93, s78, s80
  s_add_u32 s93, s93, 32
  s_lshl_b32 s94, s73, 1
  s_add_u32 s94, s94, 16384
  s_add_u32 s95, s94, 32
  s_lshr_b32 s99, s5, 1
  s_mul_i32 s99, s99, 28672
  s_add_u32 s99, s99, s63
  ds_read_b64_tr_b16 v[216:217], v8 offset:0
  ds_read_b64_tr_b16 v[218:219], v8 offset:256
  ds_read_b64_tr_b16 v[220:221], v8 offset:28672
  ds_read_b64_tr_b16 v[222:223], v8 offset:28928
  ds_read_b64_tr_b16 v[224:225], v2 offset:0
  ds_read_b64_tr_b16 v[226:227], v2 offset:256
  ds_read_b64_tr_b16 v[228:229], v8 offset:1024
  ds_read_b64_tr_b16 v[230:231], v8 offset:1280
  s_andn2_b32 s78, s89, 4
  s_lshl_b32 s78, s78, 7
  v_and_b32 v248, 0x200, v1
  v_add_u32 v248, v248, v13
  s_add_u32 s78, s78, 24576
  s_lshl_b32 s80, s89, 15
  s_add_u32 s80, s80, 5242880
  v_add_u32 v246, s80, v1
  v_xor_b32 v247, 131072, v246
  s_add_u32 s84, s52, 3
Lpoll_63:
  buffer_load_dword v15, v248, s[36:39], s78 offen sc1
  s_add_u32 s53, s53, 1
  s_cmp_gt_u32 s53, 0x20000
  s_cbranch_scc1 Lpd_64
  s_waitcnt vmcnt(0)
  v_subrev_u32 v15, s84, v15
  v_cmp_le_u32 vcc, 16, v15
  s_cbranch_vccnz Lpoll_63
Lpd_64:
  buffer_load_dwordx4 v[24:27], v246, s[36:39], 0 offen offset:0 sc1
  buffer_load_dwordx4 v[28:31], v246, s[36:39], 0 offen offset:1024 sc1
  buffer_load_dwordx4 v[32:35], v246, s[36:39], 0 offen offset:2048 sc1
  buffer_load_dwordx4 v[36:39], v246, s[36:39], 0 offen offset:3072 sc1
  buffer_load_dwordx4 v[40:43], v246, s[36:39], s57 offen offset:0 sc1
  buffer_load_dwordx4 v[44:47], v246, s[36:39], s57 offen offset:1024 sc1
  s_waitcnt vmcnt(5) lgkmcnt(4)
  v_mfma_f32_32x32x16_bf16 v[136:151], v[216:219], v[24:27], 0
  ds_read_b64_tr_b16 v[232:233], v8 offset:29696
  ds_read_b64_tr_b16 v[234:235], v8 offset:29952
  buffer_load_dwordx4 v[48:51], v246, s[36:39], s57 offen offset:2048 sc1
  v_mfma_f32_32x32x16_bf16 v[152:167], v[220:223], v[24:27], 0
  ds_read_b64_tr_b16 v[236:237], v2 offset:1024
  ds_read_b64_tr_b16 v[238:239], v2 offset:1280
  s_waitcnt lgkmcnt(4)
  v_mfma_f32_32x32x16_bf16 v[200:215], v[224:227], v[24:27], 0
  ds_read_b64_tr_b16 v[216:217], v8 offset:2048
  ds_read_b64_tr_b16 v[218:219], v8 offset:2304
  buffer_load_dwordx4 v[52:55], v246, s[36:39], s57 offen offset:3072 sc1
  s_waitcnt vmcnt(6)
  v_mfma_f32_32x32x16_bf16 v[136:151], v[228:231], v[28:31], v[136:151]
  ds_read_b64_tr_b16 v[220:221], v8 offset:30720
  ds_read_b64_tr_b16 v[222:223], v8 offset:30976
  s_waitcnt lgkmcnt(4)
  v_mfma_f32_32x32x16_bf16 v[152:167], v[232:235], v[28:31], v[152:167]
  ds_read_b64_tr_b16 v[224:225], v2 offset:2048
  ds_read_b64_tr_b16 v[226:227], v2 offset:2304
  buffer_load_dwordx4 v[56:59], v246, s[36:39], s58 offen offset:0 sc1
  v_mfma_f32_32x32x16_bf16 v[200:215], v[236:239], v[28:31], v[200:215]
  ds_read_b64_tr_b16 v[228:229], v8 offset:3072
  ds_read_b64_tr_b16 v[230:231], v8 offset:3328
  s_waitcnt vmcnt(6) lgkmcnt(4)
  v_mfma_f32_32x32x16_bf16 v[136:151], v[216:219], v[32:35], v[136:151]
  ds_read_b64_tr_b16 v[232:233], v8 offset:31744
  ds_read_b64_tr_b16 v[234:235], v8 offset:32000
  buffer_load_dwordx4 v[60:63], v246, s[36:39], s58 offen offset:1024 sc1
  v_mfma_f32_32x32x16_bf16 v[152:167], v[220:223], v[32:35], v[152:167]
  ds_read_b64_tr_b16 v[236:237], v2 offset:3072
  ds_read_b64_tr_b16 v[238:239], v2 offset:3328
  s_waitcnt lgkmcnt(4)
  v_mfma_f32_32x32x16_bf16 v[200:215], v[224:227], v[32:35], v[200:215]
  ds_read_b64_tr_b16 v[216:217], v8 offset:4096
  ds_read_b64_tr_b16 v[218:219], v8 offset:4352
  buffer_load_dwordx4 v[64:67], v246, s[36:39], s58 offen offset:2048 sc1
  s_waitcnt vmcnt(7)
  v_mfma_f32_32x32x16_bf16 v[136:151], v[228:231], v[36:39], v[136:151]
  ds_read_b64_tr_b16 v[220:221], v8 offset:32768
  ds_read_b64_tr_b16 v[222:223], v8 offset:33024
  s_waitcnt lgkmcnt(4)
  v_mfma_f32_32x32x16_bf16 v[152:167], v[232:235], v[36:39], v[152:167]
  ds_read_b64_tr_b16 v[224:225], v2 offset:4096
  ds_read_b64_tr_b16 v[226:227], v2 offset:4352
  buffer_load_dwordx4 v[68:71], v246, s[36:39], s58 offen offset:3072 sc1
  v_mfma_f32_32x32x16_bf16 v[200:215], v[236:239], v[36:39], v[200:215]
  ds_read_b64_tr_b16 v[228:229], v8 offset:5120
  ds_read_b64_tr_b16 v[230:231], v8 offset:5376
  s_waitcnt vmcnt(7) lgkmcnt(4)
  v_mfma_f32_32x32x16_bf16 v[136:151], v[216:219], v[40:43], v[136:151]
  ds_read_b64_tr_b16 v[232:233], v8 offset:33792
  ds_read_b64_tr_b16 v[234:235], v8 offset:34048
  buffer_load_dwordx4 v[72:75], v246, s[36:39], s59 offen offset:0 sc1
  v_mfma_f32_32x32x16_bf16 v[152:167], v[220:223], v[40:43], v[152:167]
  ds_read_b64_tr_b16 v[236:237], v2 offset:5120
  ds_read_b64_tr_b16 v[238:239], v2 offset:5376
  s_waitcnt lgkmcnt(4)
  v_mfma_f32_32x32x16_bf16 v[200:215], v[224:227], v[40:43], v[200:215]
  ds_read_b64_tr_b16 v[216:217], v8 offset:6144
  ds_read_b64_tr_b16 v[218:219], v8 offset:6400
  buffer_load_dwordx4 v[76:79], v246, s[36:39], s59 offen offset:1024 sc1
  s_waitcnt vmcnt(8)
  v_mfma_f32_32x32x16_bf16 v[136:151], v[228:231], v[44:47], v[136:151]
  ds_read_b64_tr_b16 v[220:221], v8 offset:34816
  ds_read_b64_tr_b16 v[222:223], v8 offset:35072
  s_waitcnt lgkmcnt(4)
  v_mfma_f32_32x32x16_bf16 v[152:167], v[232:235], v[44:47], v[152:167]
  ds_read_b64_tr_b16 v[224:225], v2 offset:6144
  ds_read_b64_tr_b16 v[226:227], v2 offset:6400
  buffer_load_dwordx4 v[168:171], v246, s[36:39], s98 offen offset:0 sc1
  v_mfma_f32_32x32x16_bf16 v[200:215], v[236:239], v[44:47], v[200:215]
  ds_read_b64_tr_b16 v[228:229], v8 offset:7168
  ds_read_b64_tr_b16 v[230:231], v8 offset:7424
  s_waitcnt vmcnt(8) lgkmcnt(4)
  v_mfma_f32_32x32x16_bf16 v[136:151], v[216:219], v[48:51], v[136:151]
  ds_read_b64_tr_b16 v[232:233], v8 offset:35840
  ds_read_b64_tr_b16 v[234:235], v8 offset:36096
  buffer_load_dwordx4 v[172:175], v246, s[36:39], s98 offen offset:1024 sc1
  v_mfma_f32_32x32x16_bf16 v[152:167], v[220:223], v[48:51], v[152:167]
  ds_read_b64_tr_b16 v[236:237], v2 offset:7168
  ds_read_b64_tr_b16 v[238:239], v2 offset:7424
  s_waitcnt lgkmcnt(4)
  v_mfma_f32_32x32x16_bf16 v[200:215], v[224:227], v[48:51], v[200:215]
  ds_read_b64_tr_b16 v[216:217], v8 offset:8192
  ds_read_b64_tr_b16 v[218:219], v8 offset:8448
  buffer_load_dwordx4 v[176:179], v246, s[36:39], s98 offen offset:2048 sc1
  s_waitcnt vmcnt(9)
  v_mfma_f32_32x32x16_bf16 v[136:151], v[228:231], v[52:55], v[136:151]
  ds_read_b64_tr_b16 v[220:221], v8 offset:36864
  ds_read_b64_tr_b16 v[222:223], v8 offset:37120
  s_waitcnt lgkmcnt(4)
  v_mfma_f32_32x32x16_bf16 v[152:167], v[232:235], v[52:55], v[152:167]
  ds_read_b64_tr_b16 v[224:225], v2 offset:8192
  ds_read_b64_tr_b16 v[226:227], v2 offset:8448
  buffer_load_dwordx4 v[180:183], v246, s[36:39], s98 offen offset:3072 sc1
  v_mfma_f32_32x32x16_bf16 v[200:215], v[236:239], v[52:55], v[200:215]
  ds_read_b64_tr_b16 v[228:229], v8 offset:9216
  ds_read_b64_tr_b16 v[230:231], v8 offset:9472
  s_waitcnt vmcnt(9) lgkmcnt(4)
  v_mfma_f32_32x32x16_bf16 v[136:151], v[216:219], v[56:59], v[136:151]
  ds_read_b64_tr_b16 v[232:233], v8 offset:37888
  ds_read_b64_tr_b16 v[234:235], v8 offset:38144
  buffer_load_dwordx4 v[80:83], v246, s[36:39], s59 offen offset:2048 sc1
  v_mfma_f32_32x32x16_bf16 v[152:167], v[220:223], v[56:59], v[152:167]
  ds_read_b64_tr_b16 v[236:237], v2 offset:9216
  ds_read_b64_tr_b16 v[238:239], v2 offset:9472
  s_waitcnt lgkmcnt(4)
  v_mfma_f32_32x32x16_bf16 v[200:215], v[224:227], v[56:59], v[200:215]
  ds_read_b64_tr_b16 v[216:217], v8 offset:10240
  ds_read_b64_tr_b16 v[218:219], v8 offset:10496
  buffer_load_dwordx4 v[84:87], v246, s[36:39], s59 offen offset:3072 sc1
  s_waitcnt vmcnt(10)
  v_mfma_f32_32x32x16_bf16 v[136:151], v[228:231], v[60:63], v[136:151]
  ds_read_b64_tr_b16 v[220:221], v8 offset:38912
  ds_read_b64_tr_b16 v[222:223], v8 offset:39168
  s_waitcnt lgkmcnt(4)
  v_mfma_f32_32x32x16_bf16 v[152:167], v[232:235], v[60:63], v[152:167]
  ds_read_b64_tr_b16 v[224:225], v2 offset:10240
  ds_read_b64_tr_b16 v[226:227], v2 offset:10496
  buffer_load_dwordx4 v[88:91], v246, s[36:39], s60 offen offset:0 sc1
  v_mfma_f32_32x32x16_bf16 v[200:215], v[236:239], v[60:63], v[200:215]
  ds_read_b64_tr_b16 v[228:229], v8 offset:11264
  ds_read_b64_tr_b16 v[230:231], v8 offset:11520
  s_waitcnt vmcnt(10) lgkmcnt(4)
  v_mfma_f32_32x32x16_bf16 v[136:151], v[216:219], v[64:67], v[136:151]
  ds_read_b64_tr_b16 v[232:233], v8 offset:39936
  ds_read_b64_tr_b16 v[234:235], v8 offset:40192
  buffer_load_dwordx4 v[92:95], v246, s[36:39], s60 offen offset:1024 sc1
  v_mfma_f32_32x32x16_bf16 v[152:167], v[220:223], v[64:67], v[152:167]
  ds_read_b64_tr_b16 v[236:237], v2 offset:11264
  ds_read_b64_tr_b16 v[238:239], v2 offset:11520
  s_waitcnt lgkmcnt(4)
  v_mfma_f32_32x32x16_bf16 v[200:215], v[224:227], v[64:67], v[200:215]
  ds_read_b64_tr_b16 v[216:217], v8 offset:12288
  ds_read_b64_tr_b16 v[218:219], v8 offset:12544
  buffer_load_dwordx4 v[96:99], v246, s[36:39], s60 offen offset:2048 sc1
  s_waitcnt vmcnt(11)
  v_mfma_f32_32x32x16_bf16 v[136:151], v[228:231], v[68:71], v[136:151]
  ds_read_b64_tr_b16 v[220:221], v8 offset:40960
  ds_read_b64_tr_b16 v[222:223], v8 offset:41216
  s_waitcnt lgkmcnt(4)
  v_mfma_f32_32x32x16_bf16 v[152:167], v[232:235], v[68:71], v[152:167]
  ds_read_b64_tr_b16 v[224:225], v2 offset:12288
  ds_read_b64_tr_b16 v[226:227], v2 offset:12544
  buffer_load_dwordx4 v[100:103], v246, s[36:39], s60 offen offset:3072 sc1
  v_mfma_f32_32x32x16_bf16 v[200:215], v[236:239], v[68:71], v[200:215]
  ds_read_b64_tr_b16 v[228:229], v8 offset:13312
  ds_read_b64_tr_b16 v[230:231], v8 offset:13568
  s_waitcnt vmcnt(11) lgkmcnt(4)
  v_mfma_f32_32x32x16_bf16 v[136:151], v[216:219], v[72:75], v[136:151]
  ds_read_b64_tr_b16 v[232:233], v8 offset:41984
  ds_read_b64_tr_b16 v[234:235], v8 offset:42240
  buffer_load_dwordx4 v[104:107], v246, s[36:39], s61 offen offset:0 sc1
  v_mfma_f32_32x32x16_bf16 v[152:167], v[220:223], v[72:75], v[152:167]
  ds_read_b64_tr_b16 v[236:237], v2 offset:13312
  ds_read_b64_tr_b16 v[238:239], v2 offset:13568
  s_waitcnt lgkmcnt(4)
  v_mfma_f32_32x32x16_bf16 v[200:215], v[224:227], v[72:75], v[200:215]
  ds_read_b64_tr_b16 v[216:217], v8 offset:14336
  ds_read_b64_tr_b16 v[218:219], v8 offset:14592
  buffer_load_dwordx4 v[108:111], v246, s[36:39], s61 offen offset:1024 sc1
  s_waitcnt vmcnt(12)
  v_mfma_f32_32x32x16_bf16 v[136:151], v[228:231], v[76:79], v[136:151]
  ds_read_b64_tr_b16 v[220:221], v8 offset:43008
  ds_read_b64_tr_b16 v[222:223], v8 offset:43264
  s_waitcnt vmcnt(8)
  v_add_f32 v180, v180, v182
  v_add_f32 v181, v181, v183
  s_waitcnt lgkmcnt(4)
  v_mfma_f32_32x32x16_bf16 v[152:167], v[232:235], v[76:79], v[152:167]
  ds_read_b64_tr_b16 v[224:225], v2 offset:14336
  ds_read_b64_tr_b16 v[226:227], v2 offset:14592
  buffer_load_dwordx4 v[184:187], v247, s[36:39], s98 offen offset:0 sc1
  v_add_f32 v168, v168, v170
  v_add_f32 v169, v169, v171
  v_add_f32 v172, v172, v174
  v_mfma_f32_32x32x16_bf16 v[200:215], v[236:239], v[76:79], v[200:215]
  ds_read_b64_tr_b16 v[228:229], v8 offset:15360
  ds_read_b64_tr_b16 v[230:231], v8 offset:15616
  v_add_f32 v173, v173, v175
  v_add_f32 v176, v176, v178
  v_add_f32 v177, v177, v179
  s_waitcnt vmcnt(8) lgkmcnt(4)
  v_mfma_f32_32x32x16_bf16 v[136:151], v[216:219], v[80:83], v[136:151]
  ds_read_b64_tr_b16 v[232:233], v8 offset:44032
  ds_read_b64_tr_b16 v[234:235], v8 offset:44288
  buffer_load_dwordx4 v[188:191], v247, s[36:39], s98 offen offset:1024 sc1
  v_cndmask_b32 v180, v180, 0, s[48:49]
  v_cndmask_b32 v181, v181, 0, s[48:49]
  v_add_f32 v168, v168, v172
  v_mfma_f32_32x32x16_bf16 v[152:167], v[220:223], v[80:83], v[152:167]
  ds_read_b64_tr_b16 v[236:237], v2 offset:15360
  ds_read_b64_tr_b16 v[238:239], v2 offset:15616
  v_add_f32 v169, v169, v173
  v_add_f32 v176, v176, v180
  v_add_f32 v177, v177, v181
  s_waitcnt lgkmcnt(4)
  v_mfma_f32_32x32x16_bf16 v[200:215], v[224:227], v[80:83], v[200:215]
  ds_read_b64_tr_b16 v[216:217], v8 offset:16384
  ds_read_b64_tr_b16 v[218:219], v8 offset:16640
  buffer_load_dwordx4 v[192:195], v247, s[36:39], s98 offen offset:2048 sc1
  v_add_f32 v168, v168, v176
  v_add_f32 v169, v169, v177
  s_waitcnt vmcnt(9)
  v_mfma_f32_32x32x16_bf16 v[136:151], v[228:231], v[84:87], v[136:151]
  ds_read_b64_tr_b16 v[220:221], v8 offset:45056
  ds_read_b64_tr_b16 v[222:223], v8 offset:45312
  v_mov_b32 v241, 0
  v_mov_b32 v242, 0
  v_mov_b32 v243, 0
  s_waitcnt lgkmcnt(4)
  v_mfma_f32_32x32x16_bf16 v[152:167], v[232:235], v[84:87], v[152:167]
  ds_read_b64_tr_b16 v[224:225], v2 offset:16384
  ds_read_b64_tr_b16 v[226:227], v2 offset:16640
  buffer_load_dwordx4 v[196:199], v247, s[36:39], s98 offen offset:3072 sc1
  v_permlane32_swap_b32 v168, v169
  v_add_f32 v168, v168, v169
  v_mul_f32 v168, 0x3b124925, v168
  v_mfma_f32_32x32x16_bf16 v[200:215], v[236:239], v[84:87], v[200:215]
  ds_read_b64_tr_b16 v[228:229], v8 offset:17408
  ds_read_b64_tr_b16 v[230:231], v8 offset:17664
  v_mov_b32 v169, v168
  s_nop 1
  v_permlane32_swap_b32 v168, v169
  s_waitcnt vmcnt(9) lgkmcnt(4)
  v_mfma_f32_32x32x16_bf16 v[136:151], v[216:219], v[88:91], v[136:151]
  ds_read_b64_tr_b16 v[232:233], v8 offset:46080
  ds_read_b64_tr_b16 v[234:235], v8 offset:46336
  buffer_load_dwordx4 v[112:115], v246, s[36:39], s61 offen offset:2048 sc1
  v_fma_f32 v169, -v168, v168, v169
  v_cvt_pk_bf16_f32 v168, -v168, -v168
  v_max_f32 v169, 0, v169
  v_mfma_f32_32x32x16_bf16 v[152:167], v[220:223], v[88:91], v[152:167]
  ds_read_b64_tr_b16 v[236:237], v2 offset:17408
  ds_read_b64_tr_b16 v[238:239], v2 offset:17664
  v_cndmask_b32 v240, v168, 0, s[48:49]
  v_cvt_pk_bf16_f32 v169, v169, v169
  v_lshlrev_b32 v169, 16, v169
  s_waitcnt lgkmcnt(4)
  v_mfma_f32_32x32x16_bf16 v[200:215], v[224:227], v[88:91], v[200:215]
  ds_read_b64_tr_b16 v[216:217], v8 offset:18432
  ds_read_b64_tr_b16 v[218:219], v8 offset:18688
  buffer_load_dwordx4 v[116:119], v246, s[36:39], s61 offen offset:3072 sc1
  v_add_f32 v169, 0x3727c5ac, v169
  v_cvt_pk_bf16_f32 v169, v169, v169
  s_waitcnt vmcnt(10)
  v_mfma_f32_32x32x16_bf16 v[136:151], v[228:231], v[92:95], v[136:151]
  ds_read_b64_tr_b16 v[220:221], v8 offset:47104
  ds_read_b64_tr_b16 v[222:223], v8 offset:47360
  v_lshlrev_b32 v169, 16, v169
  v_sqrt_f32 v169, v169
  s_waitcnt lgkmcnt(4)
  v_mfma_f32_32x32x16_bf16 v[152:167], v[232:235], v[92:95], v[152:167]
  ds_read_b64_tr_b16 v[224:225], v2 offset:18432
  ds_read_b64_tr_b16 v[226:227], v2 offset:18688
  buffer_load_dwordx4 v[120:123], v246, s[36:39], s62 offen offset:0 sc1
  v_cvt_pk_bf16_f32 v169, v169, v169
  v_lshlrev_b32 v245, 16, v169
  v_mfma_f32_32x32x16_bf16 v[200:215], v[236:239], v[92:95], v[200:215]
  ds_read_b64_tr_b16 v[228:229], v8 offset:19456
  ds_read_b64_tr_b16 v[230:231], v8 offset:19712
  v_rcp_f32 v244, v245
  s_nop 0
  v_mul_f32 v244, 0xbfb8aa3b, v244
  s_waitcnt vmcnt(10) lgkmcnt(4)
  v_mfma_f32_32x32x16_bf16 v[136:151], v[216:219], v[96:99], v[136:151]
  ds_read_b64_tr_b16 v[232:233], v8 offset:48128
  ds_read_b64_tr_b16 v[234:235], v8 offset:48384
  buffer_load_dwordx4 v[124:127], v246, s[36:39], s62 offen offset:1024 sc1
  v_mfma_f32_32x32x16_bf16 v[152:167], v[220:223], v[96:99], v[152:167]
  ds_read_b64_tr_b16 v[236:237], v2 offset:19456
  ds_read_b64_tr_b16 v[238:239], v2 offset:19712
  s_waitcnt lgkmcnt(4)
  v_mfma_f32_32x32x16_bf16 v[200:215], v[224:227], v[96:99], v[200:215]
  ds_read_b64_tr_b16 v[216:217], v8 offset:20480
  ds_read_b64_tr_b16 v[218:219], v8 offset:20736
  buffer_load_dwordx4 v[128:131], v246, s[36:39], s62 offen offset:2048 sc1
  s_waitcnt vmcnt(11)
  v_mfma_f32_32x32x16_bf16 v[136:151], v[228:231], v[100:103], v[136:151]
  ds_read_b64_tr_b16 v[220:221], v8 offset:49152
  ds_read_b64_tr_b16 v[222:223], v8 offset:49408
  s_waitcnt lgkmcnt(4)
  v_mfma_f32_32x32x16_bf16 v[152:167], v[232:235], v[100:103], v[152:167]
  ds_read_b64_tr_b16 v[224:225], v2 offset:20480
  ds_read_b64_tr_b16 v[226:227], v2 offset:20736
  buffer_load_dwordx4 v[132:135], v246, s[36:39], s62 offen offset:3072 sc1
  v_mfma_f32_32x32x16_bf16 v[200:215], v[236:239], v[100:103], v[200:215]
  ds_read_b64_tr_b16 v[228:229], v8 offset:21504
  ds_read_b64_tr_b16 v[230:231], v8 offset:21760
  s_waitcnt vmcnt(11) lgkmcnt(4)
  v_mfma_f32_32x32x16_bf16 v[136:151], v[216:219], v[104:107], v[136:151]
  ds_read_b64_tr_b16 v[232:233], v8 offset:50176
  ds_read_b64_tr_b16 v[234:235], v8 offset:50432
  buffer_load_dwordx4 v[24:27], v247, s[36:39], 0 offen offset:0 sc1
  v_mfma_f32_32x32x16_bf16 v[152:167], v[220:223], v[104:107], v[152:167]
  ds_read_b64_tr_b16 v[236:237], v2 offset:21504
  ds_read_b64_tr_b16 v[238:239], v2 offset:21760
  s_waitcnt lgkmcnt(4)
  v_mfma_f32_32x32x16_bf16 v[200:215], v[224:227], v[104:107], v[200:215]
  ds_read_b64_tr_b16 v[216:217], v8 offset:22528
  ds_read_b64_tr_b16 v[218:219], v8 offset:22784
  buffer_load_dwordx4 v[28:31], v247, s[36:39], 0 offen offset:1024 sc1
  s_waitcnt vmcnt(12)
  v_mfma_f32_32x32x16_bf16 v[136:151], v[228:231], v[108:111], v[136:151]
  ds_read_b64_tr_b16 v[220:221], v8 offset:51200
  ds_read_b64_tr_b16 v[222:223], v8 offset:51456
  s_waitcnt lgkmcnt(4)
  v_mfma_f32_32x32x16_bf16 v[152:167], v[232:235], v[108:111], v[152:167]
  ds_read_b64_tr_b16 v[224:225], v2 offset:22528
  ds_read_b64_tr_b16 v[226:227], v2 offset:22784
  buffer_load_dwordx4 v[32:35], v247, s[36:39], 0 offen offset:2048 sc1
  v_mfma_f32_32x32x16_bf16 v[200:215], v[236:239], v[108:111], v[200:215]
  ds_read_b64_tr_b16 v[228:229], v8 offset:23552
  ds_read_b64_tr_b16 v[230:231], v8 offset:23808
  s_waitcnt vmcnt(9)
  v_add_f32 v196, v196, v198
  v_add_f32 v197, v197, v199
  s_waitcnt vmcnt(8) lgkmcnt(4)
  v_mfma_f32_32x32x16_bf16 v[136:151], v[216:219], v[112:115], v[136:151]
  ds_read_b64_tr_b16 v[232:233], v8 offset:52224
  ds_read_b64_tr_b16 v[234:235], v8 offset:52480
  buffer_load_dwordx4 v[36:39], v247, s[36:39], 0 offen offset:3072 sc1
  v_add_f32 v184, v184, v186
  v_add_f32 v185, v185, v187
  v_add_f32 v188, v188, v190
  v_mfma_f32_32x32x16_bf16 v[152:167], v[220:223], v[112:115], v[152:167]
  ds_read_b64_tr_b16 v[236:237], v2 offset:23552
  ds_read_b64_tr_b16 v[238:239], v2 offset:23808
  v_add_f32 v189, v189, v191
  v_add_f32 v192, v192, v194
  v_add_f32 v193, v193, v195
  s_waitcnt lgkmcnt(4)
  v_mfma_f32_32x32x16_bf16 v[200:215], v[224:227], v[112:115], v[200:215]
  ds_read_b64_tr_b16 v[216:217], v8 offset:24576
  ds_read_b64_tr_b16 v[218:219], v8 offset:24832
  buffer_load_dwordx4 v[40:43], v247, s[36:39], s57 offen offset:0 sc1
  v_cndmask_b32 v196, v196, 0, s[48:49]
  v_cndmask_b32 v197, v197, 0, s[48:49]
  s_waitcnt vmcnt(9)
  v_mfma_f32_32x32x16_bf16 v[136:151], v[228:231], v[116:119], v[136:151]
  ds_read_b64_tr_b16 v[220:221], v8 offset:53248
  ds_read_b64_tr_b16 v[222:223], v8 offset:53504
  v_add_f32 v184, v184, v188
  v_add_f32 v185, v185, v189
  v_add_f32 v192, v192, v196
  s_waitcnt lgkmcnt(4)
  v_mfma_f32_32x32x16_bf16 v[152:167], v[232:235], v[116:119], v[152:167]
  ds_read_b64_tr_b16 v[224:225], v2 offset:24576
  ds_read_b64_tr_b16 v[226:227], v2 offset:24832
  buffer_load_dwordx4 v[44:47], v247, s[36:39], s57 offen offset:1024 sc1
  v_add_f32 v193, v193, v197
  v_add_f32 v184, v184, v192
  v_add_f32 v185, v185, v193
  v_mfma_f32_32x32x16_bf16 v[200:215], v[236:239], v[116:119], v[200:215]
  ds_read_b64_tr_b16 v[228:229], v8 offset:25600
  ds_read_b64_tr_b16 v[230:231], v8 offset:25856
  v_permlane32_swap_b32 v184, v185
  v_add_f32 v184, v184, v185
  v_mul_f32 v184, 0x3b124925, v184
  s_waitcnt vmcnt(9) lgkmcnt(4)
  v_mfma_f32_32x32x16_bf16 v[136:151], v[216:219], v[120:123], v[136:151]
  ds_read_b64_tr_b16 v[232:233], v8 offset:54272
  ds_read_b64_tr_b16 v[234:235], v8 offset:54528
  buffer_load_dwordx4 v[48:51], v247, s[36:39], s57 offen offset:2048 sc1
  v_mov_b32 v185, v184
  s_nop 1
  v_permlane32_swap_b32 v184, v185
  v_mfma_f32_32x32x16_bf16 v[152:167], v[220:223], v[120:123], v[152:167]
  ds_read_b64_tr_b16 v[236:237], v2 offset:25600
  ds_read_b64_tr_b16 v[238:239], v2 offset:25856
  v_fma_f32 v185, -v184, v184, v185
  v_cvt_pk_bf16_f32 v184, -v184, -v184
  v_max_f32 v185, 0, v185
  s_waitcnt lgkmcnt(4)
  v_mfma_f32_32x32x16_bf16 v[200:215], v[224:227], v[120:123], v[200:215]
  ds_read_b64_tr_b16 v[216:217], v8 offset:26624
  ds_read_b64_tr_b16 v[218:219], v8 offset:26880
  buffer_load_dwordx4 v[52:55], v247, s[36:39], s57 offen offset:3072 sc1
  v_cndmask_b32 v250, v184, 0, s[48:49]
  v_cvt_pk_bf16_f32 v185, v185, v185
  s_waitcnt vmcnt(10)
  v_mfma_f32_32x32x16_bf16 v[136:151], v[228:231], v[124:127], v[136:151]
  ds_read_b64_tr_b16 v[220:221], v8 offset:55296
  ds_read_b64_tr_b16 v[222:223], v8 offset:55552
  v_lshlrev_b32 v185, 16, v185
  v_add_f32 v185, 0x3727c5ac, v185
  v_cvt_pk_bf16_f32 v185, v185, v185
  s_waitcnt lgkmcnt(4)
  v_mfma_f32_32x32x16_bf16 v[152:167], v[232:235], v[124:127], v[152:167]
  ds_read_b64_tr_b16 v[224:225], v2 offset:26624
  ds_read_b64_tr_b16 v[226:227], v2 offset:26880
  buffer_load_dwordx4 v[56:59], v247, s[36:39], s58 offen offset:0 sc1
  v_lshlrev_b32 v185, 16, v185
  v_sqrt_f32 v185, v185
  v_mfma_f32_32x32x16_bf16 v[200:215], v[236:239], v[124:127], v[200:215]
  ds_read_b64_tr_b16 v[228:229], v8 offset:27648
  ds_read_b64_tr_b16 v[230:231], v8 offset:27904
  v_cvt_pk_bf16_f32 v185, v185, v185
  v_lshlrev_b32 v252, 16, v185
  v_rcp_f32 v251, v252
  s_nop 0
  v_mul_f32 v251, 0xbfb8aa3b, v251
  v_mfma_f32_32x32x16_bf16 v[136:151], a[224:227], v[240:243], v[136:151]
  v_mfma_f32_32x32x16_bf16 v[152:167], a[226:229], v[240:243], v[152:167]
  v_mfma_f32_32x32x16_bf16 v[200:215], a[228:231], v[240:243], v[200:215]
  v_mov_b32 v240, v250
  s_waitcnt vmcnt(10) lgkmcnt(4)
  v_mfma_f32_32x32x16_bf16 v[136:151], v[216:219], v[128:131], v[136:151]
  ds_read_b64_tr_b16 v[232:233], v8 offset:56320
  ds_read_b64_tr_b16 v[234:235], v8 offset:56576
  buffer_load_dwordx4 v[60:63], v247, s[36:39], s58 offen offset:1024 sc1
  v_mfma_f32_32x32x16_bf16 v[152:167], v[220:223], v[128:131], v[152:167]
  ds_read_b64_tr_b16 v[236:237], v2 offset:27648
  ds_read_b64_tr_b16 v[238:239], v2 offset:27904
  s_waitcnt lgkmcnt(4)
  v_mfma_f32_32x32x16_bf16 v[200:215], v[224:227], v[128:131], v[200:215]
  ds_read_b64_tr_b16 v[216:217], v8 offset:0
  ds_read_b64_tr_b16 v[218:219], v8 offset:256
  buffer_load_dwordx4 v[64:67], v247, s[36:39], s58 offen offset:2048 sc1
  s_waitcnt vmcnt(11)
  v_mfma_f32_32x32x16_bf16 v[136:151], v[228:231], v[132:135], v[136:151]
  ds_read_b64_tr_b16 v[220:221], v8 offset:28672
  ds_read_b64_tr_b16 v[222:223], v8 offset:28928
  s_waitcnt lgkmcnt(4)
  v_mfma_f32_32x32x16_bf16 v[152:167], v[232:235], v[132:135], v[152:167]
  ds_read_b64_tr_b16 v[224:225], v8 offset:1024
  ds_read_b64_tr_b16 v[226:227], v8 offset:1280
  buffer_load_dwordx4 v[68:71], v247, s[36:39], s58 offen offset:3072 sc1
  v_mfma_f32_32x32x16_bf16 v[200:215], v[236:239], v[132:135], v[200:215]
  ds_read_b64_tr_b16 v[228:229], v8 offset:29696
  ds_read_b64_tr_b16 v[230:231], v8 offset:29952
  s_waitcnt vmcnt(11) lgkmcnt(4)
  v_mfma_f32_32x32x16_bf16 v[168:183], v[216:219], v[24:27], 0
  ds_read_b64_tr_b16 v[232:233], v8 offset:2048
  ds_read_b64_tr_b16 v[234:235], v8 offset:2304
  v_mfma_f32_32x32x16_bf16 v[184:199], v[220:223], v[24:27], 0
  ds_read_b64_tr_b16 v[236:237], v8 offset:30720
  ds_read_b64_tr_b16 v[238:239], v8 offset:30976
  buffer_load_dwordx4 v[72:75], v247, s[36:39], s59 offen offset:0 sc1
  s_waitcnt vmcnt(11) lgkmcnt(4)
  v_mfma_f32_32x32x16_bf16 v[168:183], v[224:227], v[28:31], v[168:183]
  ds_read_b64_tr_b16 v[216:217], v8 offset:3072
  ds_read_b64_tr_b16 v[218:219], v8 offset:3328
  v_mul_f32 v136, v244, v136
  v_mul_f32 v137, v244, v137
  v_mul_f32 v138, v244, v138
  v_mul_f32 v139, v244, v139
  v_mfma_f32_32x32x16_bf16 v[184:199], v[228:231], v[28:31], v[184:199]
  ds_read_b64_tr_b16 v[220:221], v8 offset:31744
  ds_read_b64_tr_b16 v[222:223], v8 offset:32000
  buffer_load_dwordx4 v[76:79], v247, s[36:39], s59 offen offset:1024 sc1
  v_exp_f32 v136, v136
  s_waitcnt vmcnt(11) lgkmcnt(4)
  v_mfma_f32_32x32x16_bf16 v[168:183], v[232:235], v[32:35], v[168:183]
  ds_read_b64_tr_b16 v[224:225], v8 offset:4096
  ds_read_b64_tr_b16 v[226:227], v8 offset:4352
  v_exp_f32 v137, v137
  v_exp_f32 v138, v138
  v_mfma_f32_32x32x16_bf16 v[184:199], v[236:239], v[32:35], v[184:199]
  ds_read_b64_tr_b16 v[228:229], v8 offset:32768
  ds_read_b64_tr_b16 v[230:231], v8 offset:33024
  buffer_load_dwordx4 v[80:83], v247, s[36:39], s59 offen offset:2048 sc1
  v_exp_f32 v139, v139
  s_waitcnt vmcnt(11) lgkmcnt(4)
  v_mfma_f32_32x32x16_bf16 v[168:183], v[216:219], v[36:39], v[168:183]
  ds_read_b64_tr_b16 v[232:233], v8 offset:5120
  ds_read_b64_tr_b16 v[234:235], v8 offset:5376
  v_fma_f32 v136, v136, v245, v245
  v_fma_f32 v137, v137, v245, v245
  v_fma_f32 v138, v138, v245, v245
  v_fma_f32 v139, v139, v245, v245
  v_mfma_f32_32x32x16_bf16 v[184:199], v[220:223], v[36:39], v[184:199]
  ds_read_b64_tr_b16 v[236:237], v8 offset:33792
  ds_read_b64_tr_b16 v[238:239], v8 offset:34048
  buffer_load_dwordx4 v[84:87], v247, s[36:39], s59 offen offset:3072 sc1
  v_rcp_f32 v136, v136
  s_waitcnt vmcnt(11) lgkmcnt(4)
  v_mfma_f32_32x32x16_bf16 v[168:183], v[224:227], v[40:43], v[168:183]
  ds_read_b64_tr_b16 v[216:217], v8 offset:6144
  ds_read_b64_tr_b16 v[218:219], v8 offset:6400
  v_rcp_f32 v137, v137
  v_rcp_f32 v138, v138
  v_mfma_f32_32x32x16_bf16 v[184:199], v[228:231], v[40:43], v[184:199]
  ds_read_b64_tr_b16 v[220:221], v8 offset:34816
  ds_read_b64_tr_b16 v[222:223], v8 offset:35072
  buffer_load_dwordx4 v[88:91], v247, s[36:39], s60 offen offset:0 sc1
  v_rcp_f32 v139, v139
  s_waitcnt vmcnt(11) lgkmcnt(4)
  v_mfma_f32_32x32x16_bf16 v[168:183], v[232:235], v[44:47], v[168:183]
  ds_read_b64_tr_b16 v[224:225], v8 offset:7168
  ds_read_b64_tr_b16 v[226:227], v8 offset:7424
  v_mul_f32 v152, v152, v136
  v_mul_f32 v153, v153, v137
  v_mul_f32 v154, v154, v138
  v_mul_f32 v155, v155, v139
  v_mfma_f32_32x32x16_bf16 v[184:199], v[236:239], v[44:47], v[184:199]
  ds_read_b64_tr_b16 v[228:229], v8 offset:35840
  ds_read_b64_tr_b16 v[230:231], v8 offset:36096
  buffer_load_dwordx4 v[92:95], v247, s[36:39], s60 offen offset:1024 sc1
  v_cvt_pk_bf16_f32 v136, v152, v153
  v_cvt_pk_bf16_f32 v137, v154, v155
  s_waitcnt vmcnt(11) lgkmcnt(4)
  v_mfma_f32_32x32x16_bf16 v[168:183], v[216:219], v[48:51], v[168:183]
  ds_read_b64_tr_b16 v[232:233], v8 offset:8192
  ds_read_b64_tr_b16 v[234:235], v8 offset:8448
  v_mul_f32 v140, v244, v140
  v_mul_f32 v141, v244, v141
  v_mul_f32 v142, v244, v142
  v_mul_f32 v143, v244, v143
  v_mfma_f32_32x32x16_bf16 v[184:199], v[220:223], v[48:51], v[184:199]
  ds_read_b64_tr_b16 v[236:237], v8 offset:36864
  ds_read_b64_tr_b16 v[238:239], v8 offset:37120
  buffer_load_dwordx4 v[96:99], v247, s[36:39], s60 offen offset:2048 sc1
  v_exp_f32 v140, v140
  s_waitcnt vmcnt(11) lgkmcnt(4)
  v_mfma_f32_32x32x16_bf16 v[168:183], v[224:227], v[52:55], v[168:183]
  ds_read_b64_tr_b16 v[216:217], v8 offset:9216
  ds_read_b64_tr_b16 v[218:219], v8 offset:9472
  v_exp_f32 v141, v141
  v_exp_f32 v142, v142
  v_mfma_f32_32x32x16_bf16 v[184:199], v[228:231], v[52:55], v[184:199]
  ds_read_b64_tr_b16 v[220:221], v8 offset:37888
  ds_read_b64_tr_b16 v[222:223], v8 offset:38144
  buffer_load_dwordx4 v[100:103], v247, s[36:39], s60 offen offset:3072 sc1
  v_exp_f32 v143, v143
  s_waitcnt vmcnt(11) lgkmcnt(4)
  v_mfma_f32_32x32x16_bf16 v[168:183], v[232:235], v[56:59], v[168:183]
  ds_read_b64_tr_b16 v[224:225], v8 offset:10240
  ds_read_b64_tr_b16 v[226:227], v8 offset:10496
  v_fma_f32 v140, v140, v245, v245
  v_fma_f32 v141, v141, v245, v245
  v_fma_f32 v142, v142, v245, v245
  v_fma_f32 v143, v143, v245, v245
  v_mfma_f32_32x32x16_bf16 v[184:199], v[236:239], v[56:59], v[184:199]
  ds_read_b64_tr_b16 v[228:229], v8 offset:38912
  ds_read_b64_tr_b16 v[230:231], v8 offset:39168
  buffer_load_dwordx4 v[104:107], v247, s[36:39], s61 offen offset:0 sc1
  v_rcp_f32 v140, v140
  s_waitcnt vmcnt(11) lgkmcnt(4)
  v_mfma_f32_32x32x16_bf16 v[168:183], v[216:219], v[60:63], v[168:183]
  ds_read_b64_tr_b16 v[232:233], v8 offset:11264
  ds_read_b64_tr_b16 v[234:235], v8 offset:11520
  v_rcp_f32 v141, v141
  v_rcp_f32 v142, v142
  v_mfma_f32_32x32x16_bf16 v[184:199], v[220:223], v[60:63], v[184:199]
  ds_read_b64_tr_b16 v[236:237], v8 offset:39936
  ds_read_b64_tr_b16 v[238:239], v8 offset:40192
  buffer_load_dwordx4 v[108:111], v247, s[36:39], s61 offen offset:1024 sc1
  v_rcp_f32 v143, v143
  s_waitcnt vmcnt(11) lgkmcnt(4)
  v_mfma_f32_32x32x16_bf16 v[168:183], v[224:227], v[64:67], v[168:183]
  ds_read_b64_tr_b16 v[216:217], v8 offset:12288
  ds_read_b64_tr_b16 v[218:219], v8 offset:12544
  v_mul_f32 v156, v156, v140
  v_mul_f32 v157, v157, v141
  v_mul_f32 v158, v158, v142
  v_mul_f32 v159, v159, v143
  v_mfma_f32_32x32x16_bf16 v[184:199], v[228:231], v[64:67], v[184:199]
  ds_read_b64_tr_b16 v[220:221], v8 offset:40960
  ds_read_b64_tr_b16 v[222:223], v8 offset:41216
  buffer_load_dwordx4 v[112:115], v247, s[36:39], s61 offen offset:2048 sc1
  v_cvt_pk_bf16_f32 v138, v156, v157
  v_cvt_pk_bf16_f32 v139, v158, v159
  s_waitcnt vmcnt(11) lgkmcnt(4)
  v_mfma_f32_32x32x16_bf16 v[168:183], v[232:235], v[68:71], v[168:183]
  ds_read_b64_tr_b16 v[224:225], v8 offset:13312
  ds_read_b64_tr_b16 v[226:227], v8 offset:13568
  buffer_store_dwordx4 v[136:139], v1, s[36:39], s90 offen offset:0 sc1
  v_mul_f32 v144, v244, v144
  v_mul_f32 v145, v244, v145
  v_mul_f32 v146, v244, v146
  v_mfma_f32_32x32x16_bf16 v[184:199], v[236:239], v[68:71], v[184:199]
  ds_read_b64_tr_b16 v[228:229], v8 offset:41984
  ds_read_b64_tr_b16 v[230:231], v8 offset:42240
  buffer_load_dwordx4 v[116:119], v247, s[36:39], s61 offen offset:3072 sc1
  v_mul_f32 v147, v244, v147
  s_waitcnt vmcnt(12) lgkmcnt(4)
  v_mfma_f32_32x32x16_bf16 v[168:183], v[216:219], v[72:75], v[168:183]
  ds_read_b64_tr_b16 v[232:233], v8 offset:14336
  ds_read_b64_tr_b16 v[234:235], v8 offset:14592
  s_add_u32 m0, s63, 86016
  s_add_u32 s97, s99, 524288
  buffer_load_dwordx4 v1, s[36:39], s97 offen sc1 lds
  v_mfma_f32_32x32x16_bf16 v[184:199], v[220:223], v[72:75], v[184:199]
  ds_read_b64_tr_b16 v[236:237], v8 offset:43008
  ds_read_b64_tr_b16 v[238:239], v8 offset:43264
  buffer_load_dwordx4 v[120:123], v247, s[36:39], s62 offen offset:0 sc1
  v_exp_f32 v144, v144
  s_waitcnt vmcnt(13) lgkmcnt(4)
  v_mfma_f32_32x32x16_bf16 v[168:183], v[224:227], v[76:79], v[168:183]
  ds_read_b64_tr_b16 v[216:217], v8 offset:15360
  ds_read_b64_tr_b16 v[218:219], v8 offset:15616
  s_add_u32 m0, s63, 87040
  s_add_u32 s97, s99, 525312
  buffer_load_dwordx4 v1, s[36:39], s97 offen sc1 lds
  v_mfma_f32_32x32x16_bf16 v[184:199], v[228:231], v[76:79], v[184:199]
  ds_read_b64_tr_b16 v[220:221], v8 offset:44032
  ds_read_b64_tr_b16 v[222:223], v8 offset:44288
  buffer_load_dwordx4 v[124:127], v247, s[36:39], s62 offen offset:1024 sc1
  v_exp_f32 v145, v145
  s_waitcnt vmcnt(14) lgkmcnt(4)
  v_mfma_f32_32x32x16_bf16 v[168:183], v[232:235], v[80:83], v[168:183]
  ds_read_b64_tr_b16 v[224:225], v8 offset:16384
  ds_read_b64_tr_b16 v[226:227], v8 offset:16640
  s_add_u32 m0, s63, 88064
  s_add_u32 s97, s99, 526336
  buffer_load_dwordx4 v1, s[36:39], s97 offen sc1 lds
  v_mfma_f32_32x32x16_bf16 v[184:199], v[236:239], v[80:83], v[184:199]
  ds_read_b64_tr_b16 v[228:229], v8 offset:45056
  ds_read_b64_tr_b16 v[230:231], v8 offset:45312
  buffer_load_dwordx4 v[128:131], v247, s[36:39], s62 offen offset:2048 sc1
  v_exp_f32 v146, v146
  s_waitcnt vmcnt(15) lgkmcnt(4)
  v_mfma_f32_32x32x16_bf16 v[168:183], v[216:219], v[84:87], v[168:183]
  ds_read_b64_tr_b16 v[232:233], v8 offset:17408
  ds_read_b64_tr_b16 v[234:235], v8 offset:17664
  s_add_u32 m0, s63, 89088
  s_add_u32 s97, s99, 527360
  buffer_load_dwordx4 v1, s[36:39], s97 offen sc1 lds
  v_mfma_f32_32x32x16_bf16 v[184:199], v[220:223], v[84:87], v[184:199]
  ds_read_b64_tr_b16 v[236:237], v8 offset:46080
  ds_read_b64_tr_b16 v[238:239], v8 offset:46336
  buffer_load_dwordx4 v[132:135], v247, s[36:39], s62 offen offset:3072 sc1
  v_exp_f32 v147, v147
  s_waitcnt vmcnt(16) lgkmcnt(4)
  v_mfma_f32_32x32x16_bf16 v[168:183], v[224:227], v[88:91], v[168:183]
  ds_read_b64_tr_b16 v[216:217], v8 offset:18432
  ds_read_b64_tr_b16 v[218:219], v8 offset:18688
  s_add_u32 m0, s63, 90112
  s_add_u32 s97, s99, 528384
  buffer_load_dwordx4 v1, s[36:39], s97 offen sc1 lds
  v_fma_f32 v144, v144, v245, v245
  v_mfma_f32_32x32x16_bf16 v[184:199], v[228:231], v[88:91], v[184:199]
  ds_read_b64_tr_b16 v[220:221], v8 offset:47104
  ds_read_b64_tr_b16 v[222:223], v8 offset:47360
  v_fma_f32 v145, v145, v245, v245
  v_fma_f32 v146, v146, v245, v245
  v_fma_f32 v147, v147, v245, v245
  s_waitcnt vmcnt(16) lgkmcnt(4)
  v_mfma_f32_32x32x16_bf16 v[168:183], v[232:235], v[92:95], v[168:183]
  ds_read_b64_tr_b16 v[224:225], v8 offset:19456
  ds_read_b64_tr_b16 v[226:227], v8 offset:19712
  s_add_u32 m0, s63, 91136
  s_add_u32 s97, s99, 529408
  buffer_load_dwordx4 v1, s[36:39], s97 offen sc1 lds
  v_mfma_f32_32x32x16_bf16 v[184:199], v[236:239], v[92:95], v[184:199]
  ds_read_b64_tr_b16 v[228:229], v8 offset:48128
  ds_read_b64_tr_b16 v[230:231], v8 offset:48384
  v_rcp_f32 v144, v144
  s_waitcnt vmcnt(16) lgkmcnt(4)
  v_mfma_f32_32x32x16_bf16 v[168:183], v[216:219], v[96:99], v[168:183]
  ds_read_b64_tr_b16 v[232:233], v8 offset:20480
  ds_read_b64_tr_b16 v[234:235], v8 offset:20736
  s_add_u32 m0, s63, 92160
  s_add_u32 s97, s99, 530432
  buffer_load_dwordx4 v1, s[36:39], s97 offen sc1 lds
  v_mfma_f32_32x32x16_bf16 v[184:199], v[220:223], v[96:99], v[184:199]
  ds_read_b64_tr_b16 v[236:237], v8 offset:49152
  ds_read_b64_tr_b16 v[238:239], v8 offset:49408
  v_rcp_f32 v145, v145
  s_waitcnt vmcnt(16) lgkmcnt(4)
  v_mfma_f32_32x32x16_bf16 v[168:183], v[224:227], v[100:103], v[168:183]
  ds_read_b64_tr_b16 v[216:217], v8 offset:21504
  ds_read_b64_tr_b16 v[218:219], v8 offset:21760
  v_rcp_f32 v146, v146
  v_rcp_f32 v147, v147
  v_mfma_f32_32x32x16_bf16 v[184:199], v[228:231], v[100:103], v[184:199]
  ds_read_b64_tr_b16 v[220:221], v8 offset:50176
  ds_read_b64_tr_b16 v[222:223], v8 offset:50432
  v_mul_f32 v160, v160, v144
  v_mul_f32 v161, v161, v145
  v_mul_f32 v162, v162, v146
  s_waitcnt vmcnt(15) lgkmcnt(4)
  v_mfma_f32_32x32x16_bf16 v[168:183], v[232:235], v[104:107], v[168:183]
  ds_read_b64_tr_b16 v[224:225], v8 offset:22528
  ds_read_b64_tr_b16 v[226:227], v8 offset:22784
  v_mul_f32 v163, v163, v147
  v_cvt_pk_bf16_f32 v140, v160, v161
  v_cvt_pk_bf16_f32 v141, v162, v163
  v_mul_f32 v148, v244, v148
  v_mfma_f32_32x32x16_bf16 v[184:199], v[236:239], v[104:107], v[184:199]
  ds_read_b64_tr_b16 v[228:229], v8 offset:51200
  ds_read_b64_tr_b16 v[230:231], v8 offset:51456
  v_mul_f32 v149, v244, v149
  v_mul_f32 v150, v244, v150
  v_mul_f32 v151, v244, v151
  s_waitcnt vmcnt(14) lgkmcnt(4)
  v_mfma_f32_32x32x16_bf16 v[168:183], v[216:219], v[108:111], v[168:183]
  ds_read_b64_tr_b16 v[232:233], v8 offset:23552
  ds_read_b64_tr_b16 v[234:235], v8 offset:23808
  v_exp_f32 v148, v148
  v_exp_f32 v149, v149
  v_mfma_f32_32x32x16_bf16 v[184:199], v[220:223], v[108:111], v[184:199]
  ds_read_b64_tr_b16 v[236:237], v8 offset:52224
  ds_read_b64_tr_b16 v[238:239], v8 offset:52480
  v_exp_f32 v150, v150
  s_waitcnt vmcnt(13) lgkmcnt(4)
  v_mfma_f32_32x32x16_bf16 v[168:183], v[224:227], v[112:115], v[168:183]
  ds_read_b64_tr_b16 v[216:217], v8 offset:24576
  ds_read_b64_tr_b16 v[218:219], v8 offset:24832
  v_exp_f32 v151, v151
  v_fma_f32 v148, v148, v245, v245
  v_fma_f32 v149, v149, v245, v245
  v_mfma_f32_32x32x16_bf16 v[184:199], v[228:231], v[112:115], v[184:199]
  ds_read_b64_tr_b16 v[220:221], v8 offset:53248
  ds_read_b64_tr_b16 v[222:223], v8 offset:53504
  v_fma_f32 v150, v150, v245, v245
  v_fma_f32 v151, v151, v245, v245
  s_waitcnt vmcnt(11) lgkmcnt(4)
  v_mfma_f32_32x32x16_bf16 v[168:183], v[232:235], v[116:119], v[168:183]
  ds_read_b64_tr_b16 v[224:225], v8 offset:25600
  ds_read_b64_tr_b16 v[226:227], v8 offset:25856
  v_rcp_f32 v148, v148
  v_rcp_f32 v149, v149
  v_mfma_f32_32x32x16_bf16 v[184:199], v[236:239], v[116:119], v[184:199]
  ds_read_b64_tr_b16 v[228:229], v8 offset:54272
  ds_read_b64_tr_b16 v[230:231], v8 offset:54528
  v_rcp_f32 v150, v150
  s_waitcnt vmcnt(9) lgkmcnt(4)
  v_mfma_f32_32x32x16_bf16 v[168:183], v[216:219], v[120:123], v[168:183]
  ds_read_b64_tr_b16 v[232:233], v8 offset:26624
  ds_read_b64_tr_b16 v[234:235], v8 offset:26880
  v_rcp_f32 v151, v151
  v_mul_f32 v164, v164, v148
  v_mul_f32 v165, v165, v149
  v_mfma_f32_32x32x16_bf16 v[184:199], v[220:223], v[120:123], v[184:199]
  ds_read_b64_tr_b16 v[236:237], v8 offset:55296
  ds_read_b64_tr_b16 v[238:239], v8 offset:55552
  v_mul_f32 v166, v166, v150
  v_mul_f32 v167, v167, v151
  v_cvt_pk_bf16_f32 v142, v164, v165
  s_waitcnt vmcnt(7) lgkmcnt(4)
  v_mfma_f32_32x32x16_bf16 v[168:183], v[224:227], v[124:127], v[168:183]
  ds_read_b64_tr_b16 v[216:217], v8 offset:27648
  ds_read_b64_tr_b16 v[218:219], v8 offset:27904
  v_cvt_pk_bf16_f32 v143, v166, v167
  buffer_store_dwordx4 v[140:143], v1, s[36:39], s90 offen offset:1024 sc1
  v_mul_f32 v200, v244, v200
  v_mul_f32 v201, v244, v201
  v_mfma_f32_32x32x16_bf16 v[184:199], v[228:231], v[124:127], v[184:199]
  ds_read_b64_tr_b16 v[220:221], v8 offset:56320
  ds_read_b64_tr_b16 v[222:223], v8 offset:56576
  v_mul_f32 v202, v244, v202
  v_mul_f32 v203, v244, v203
  v_mfma_f32_32x32x16_bf16 v[168:183], a[224:227], v[240:243], v[168:183]
  v_exp_f32 v200, v200
  v_exp_f32 v201, v201
  v_exp_f32 v202, v202
  v_mfma_f32_32x32x16_bf16 v[184:199], a[226:229], v[240:243], v[184:199]
  v_exp_f32 v203, v203
  v_fma_f32 v200, v200, v245, v245
  v_fma_f32 v201, v201, v245, v245
  v_fma_f32 v202, v202, v245, v245
  s_waitcnt vmcnt(6) lgkmcnt(4)
  v_mfma_f32_32x32x16_bf16 v[168:183], v[232:235], v[128:131], v[168:183]
  ds_read_b64_tr_b16 v[224:225], v2 offset:0
  ds_read_b64_tr_b16 v[226:227], v2 offset:256
  v_fma_f32 v203, v203, v245, v245
  v_rcp_f32 v200, v200
  v_mfma_f32_32x32x16_bf16 v[184:199], v[236:239], v[128:131], v[184:199]
  ds_read_b64_tr_b16 v[228:229], v2 offset:1024
  ds_read_b64_tr_b16 v[230:231], v2 offset:1280
  v_rcp_f32 v201, v201
  s_waitcnt vmcnt(4) lgkmcnt(4)
  v_mfma_f32_32x32x16_bf16 v[168:183], v[216:219], v[132:135], v[168:183]
  ds_read_b64_tr_b16 v[232:233], v2 offset:2048
  ds_read_b64_tr_b16 v[234:235], v2 offset:2304
  v_rcp_f32 v202, v202
  v_rcp_f32 v203, v203
  v_mfma_f32_32x32x16_bf16 v[184:199], v[220:223], v[132:135], v[184:199]
  ds_read_b64_tr_b16 v[236:237], v2 offset:3072
  ds_read_b64_tr_b16 v[238:239], v2 offset:3328
  v_mul_f32 v208, v208, v200
  v_mul_f32 v209, v209, v201
  v_mul_f32 v210, v210, v202
  v_mul_f32 v211, v211, v203
  v_cvt_pk_bf16_f32 v200, v208, v209
  v_cvt_pk_bf16_f32 v201, v210, v211
  v_mul_f32 v204, v244, v204
  v_mul_f32 v205, v244, v205
  v_mul_f32 v206, v244, v206
  v_mul_f32 v207, v244, v207
  v_exp_f32 v204, v204
  v_exp_f32 v205, v205
  v_exp_f32 v206, v206
  v_exp_f32 v207, v207
  v_fma_f32 v204, v204, v245, v245
  v_fma_f32 v205, v205, v245, v245
  v_fma_f32 v206, v206, v245, v245
  v_fma_f32 v207, v207, v245, v245
  v_rcp_f32 v204, v204
  v_rcp_f32 v205, v205
  v_rcp_f32 v206, v206
  v_rcp_f32 v207, v207
  v_mul_f32 v212, v212, v204
  v_mul_f32 v213, v213, v205
  v_mul_f32 v214, v214, v206
  v_mul_f32 v215, v215, v207
  v_cvt_pk_bf16_f32 v202, v212, v213
  v_cvt_pk_bf16_f32 v203, v214, v215
  buffer_store_dwordx4 v[200:203], v1, s[36:39], s96 offen offset:0 sc1
  s_cmp_lg_u32 s71, 120
  s_cbranch_scc1 Lwb_65
  buffer_wbl2 sc1
Lwb_65:
  s_waitcnt lgkmcnt(4)
  v_mfma_f32_32x32x16_bf16 v[136:151], v[224:227], v[24:27], 0
  ds_read_b64_tr_b16 v[216:217], v2 offset:4096
  ds_read_b64_tr_b16 v[218:219], v2 offset:4352
  s_mul_i32 s79, s3, 28672
  s_add_u32 s79, s79, 9437184
  s_xor_b32 s78, s76, 0
  s_mul_i32 s78, s78, 114688
  v_mfma_f32_32x32x16_bf16 v[136:151], v[228:231], v[28:31], v[136:151]
  ds_read_b64_tr_b16 v[220:221], v2 offset:5120
  ds_read_b64_tr_b16 v[222:223], v2 offset:5376
  s_add_u32 s78, s78, s79
  v_add_u32 v246, s78, v1
  s_xor_b32 s78, s76, 1
  s_waitcnt lgkmcnt(4)
  v_mfma_f32_32x32x16_bf16 v[136:151], v[232:235], v[32:35], v[136:151]
  ds_read_b64_tr_b16 v[224:225], v2 offset:6144
  ds_read_b64_tr_b16 v[226:227], v2 offset:6400
  s_mul_i32 s78, s78, 114688
  s_add_u32 s78, s78, s79
  v_add_u32 v247, s78, v1
  v_mul_f32 v168, v251, v168
  v_mfma_f32_32x32x16_bf16 v[136:151], v[236:239], v[36:39], v[136:151]
  ds_read_b64_tr_b16 v[228:229], v2 offset:7168
  ds_read_b64_tr_b16 v[230:231], v2 offset:7424
  v_mul_f32 v169, v251, v169
  v_mul_f32 v170, v251, v170
  v_mul_f32 v171, v251, v171
  s_waitcnt lgkmcnt(4)
  v_mfma_f32_32x32x16_bf16 v[136:151], v[216:219], v[40:43], v[136:151]
  ds_read_b64_tr_b16 v[232:233], v2 offset:8192
  ds_read_b64_tr_b16 v[234:235], v2 offset:8448
  v_exp_f32 v168, v168
  v_exp_f32 v169, v169
  v_mfma_f32_32x32x16_bf16 v[136:151], v[220:223], v[44:47], v[136:151]
  ds_read_b64_tr_b16 v[236:237], v2 offset:9216
  ds_read_b64_tr_b16 v[238:239], v2 offset:9472
  v_exp_f32 v170, v170
  s_waitcnt lgkmcnt(4)
  v_mfma_f32_32x32x16_bf16 v[136:151], v[224:227], v[48:51], v[136:151]
  ds_read_b64_tr_b16 v[216:217], v2 offset:10240
  ds_read_b64_tr_b16 v[218:219], v2 offset:10496
  v_exp_f32 v171, v171
  v_fma_f32 v168, v168, v252, v252
  v_fma_f32 v169, v169, v252, v252
  v_mfma_f32_32x32x16_bf16 v[136:151], v[228:231], v[52:55], v[136:151]
  ds_read_b64_tr_b16 v[220:221], v2 offset:11264
  ds_read_b64_tr_b16 v[222:223], v2 offset:11520
  v_fma_f32 v170, v170, v252, v252
  v_fma_f32 v171, v171, v252, v252
  s_waitcnt lgkmcnt(4)
  v_mfma_f32_32x32x16_bf16 v[136:151], v[232:235], v[56:59], v[136:151]
  ds_read_b64_tr_b16 v[224:225], v2 offset:12288
  ds_read_b64_tr_b16 v[226:227], v2 offset:12544
  v_rcp_f32 v168, v168
  v_rcp_f32 v169, v169
  v_mfma_f32_32x32x16_bf16 v[136:151], v[236:239], v[60:63], v[136:151]
  ds_read_b64_tr_b16 v[228:229], v2 offset:13312
  ds_read_b64_tr_b16 v[230:231], v2 offset:13568
  v_rcp_f32 v170, v170
  s_waitcnt lgkmcnt(4)
  v_mfma_f32_32x32x16_bf16 v[136:151], v[216:219], v[64:67], v[136:151]
  ds_read_b64_tr_b16 v[232:233], v2 offset:14336
  ds_read_b64_tr_b16 v[234:235], v2 offset:14592
  v_rcp_f32 v171, v171
  v_mul_f32 v184, v184, v168
  v_mul_f32 v185, v185, v169
  v_mfma_f32_32x32x16_bf16 v[136:151], v[220:223], v[68:71], v[136:151]
  ds_read_b64_tr_b16 v[236:237], v2 offset:15360
  ds_read_b64_tr_b16 v[238:239], v2 offset:15616
  v_mul_f32 v186, v186, v170
  v_mul_f32 v187, v187, v171
  v_cvt_pk_bf16_f32 v168, v184, v185
  s_waitcnt lgkmcnt(4)
  v_mfma_f32_32x32x16_bf16 v[136:151], v[224:227], v[72:75], v[136:151]
  ds_read_b64_tr_b16 v[216:217], v2 offset:16384
  ds_read_b64_tr_b16 v[218:219], v2 offset:16640
  v_cvt_pk_bf16_f32 v169, v186, v187
  v_mul_f32 v172, v251, v172
  v_mul_f32 v173, v251, v173
  v_mul_f32 v174, v251, v174
  v_mfma_f32_32x32x16_bf16 v[136:151], v[228:231], v[76:79], v[136:151]
  ds_read_b64_tr_b16 v[220:221], v2 offset:17408
  ds_read_b64_tr_b16 v[222:223], v2 offset:17664
  v_mul_f32 v175, v251, v175
  v_exp_f32 v172, v172
  s_waitcnt lgkmcnt(4)
  v_mfma_f32_32x32x16_bf16 v[136:151], v[232:235], v[80:83], v[136:151]
  ds_read_b64_tr_b16 v[224:225], v2 offset:18432
  ds_read_b64_tr_b16 v[226:227], v2 offset:18688
  v_exp_f32 v173, v173
  v_exp_f32 v174, v174
  v_mfma_f32_32x32x16_bf16 v[136:151], v[236:239], v[84:87], v[136:151]
  ds_read_b64_tr_b16 v[228:229], v2 offset:19456
  ds_read_b64_tr_b16 v[230:231], v2 offset:19712
  v_exp_f32 v175, v175
  v_fma_f32 v172, v172, v252, v252
  s_waitcnt lgkmcnt(4)
  v_mfma_f32_32x32x16_bf16 v[136:151], v[216:219], v[88:91], v[136:151]
  ds_read_b64_tr_b16 v[232:233], v2 offset:20480
  ds_read_b64_tr_b16 v[234:235], v2 offset:20736
  v_fma_f32 v173, v173, v252, v252
  v_fma_f32 v174, v174, v252, v252
  v_fma_f32 v175, v175, v252, v252
  v_mfma_f32_32x32x16_bf16 v[136:151], v[220:223], v[92:95], v[136:151]
  ds_read_b64_tr_b16 v[236:237], v2 offset:21504
  ds_read_b64_tr_b16 v[238:239], v2 offset:21760
  v_rcp_f32 v172, v172
  s_waitcnt lgkmcnt(4)
  v_mfma_f32_32x32x16_bf16 v[136:151], v[224:227], v[96:99], v[136:151]
  ds_read_b64_tr_b16 v[216:217], v2 offset:22528
  ds_read_b64_tr_b16 v[218:219], v2 offset:22784
  v_rcp_f32 v173, v173
  v_rcp_f32 v174, v174
  v_mfma_f32_32x32x16_bf16 v[136:151], v[228:231], v[100:103], v[136:151]
  ds_read_b64_tr_b16 v[220:221], v2 offset:23552
  ds_read_b64_tr_b16 v[222:223], v2 offset:23808
  v_rcp_f32 v175, v175
  v_mul_f32 v188, v188, v172
  s_waitcnt lgkmcnt(4)
  v_mfma_f32_32x32x16_bf16 v[136:151], v[232:235], v[104:107], v[136:151]
  ds_read_b64_tr_b16 v[224:225], v2 offset:24576
  ds_read_b64_tr_b16 v[226:227], v2 offset:24832
  v_mul_f32 v189, v189, v173
  v_mul_f32 v190, v190, v174
  v_mul_f32 v191, v191, v175
  v_cvt_pk_bf16_f32 v170, v188, v189
  v_mfma_f32_32x32x16_bf16 v[136:151], v[236:239], v[108:111], v[136:151]
  ds_read_b64_tr_b16 v[228:229], v2 offset:25600
  ds_read_b64_tr_b16 v[230:231], v2 offset:25856
  v_cvt_pk_bf16_f32 v171, v190, v191
  buffer_store_dwordx4 v[168:171], v1, s[36:39], s91 offen offset:0 sc1
  s_waitcnt vmcnt(1)
  s_waitcnt lgkmcnt(4)
  v_mfma_f32_32x32x16_bf16 v[136:151], v[216:219], v[112:115], v[136:151]
  ds_read_b64_tr_b16 v[232:233], v2 offset:26624
  ds_read_b64_tr_b16 v[234:235], v2 offset:26880
  s_add_u32 s83, s52, 5
  v_mov_b32 v255, s83
  buffer_store_dword v255, v4, s[36:39], s92 offen sc1
  buffer_load_dword v15, v12, s[36:39], s94 offen sc1
  v_mfma_f32_32x32x16_bf16 v[136:151], v[220:223], v[116:119], v[136:151]
  ds_read_b64_tr_b16 v[236:237], v2 offset:27648
  ds_read_b64_tr_b16 v[238:239], v2 offset:27904
  v_mul_f32 v176, v251, v176
  v_mul_f32 v177, v251, v177
  v_mul_f32 v178, v251, v178
  s_waitcnt lgkmcnt(4)
  v_mfma_f32_32x32x16_bf16 v[136:151], v[224:227], v[120:123], v[136:151]
  s_barrier
  ds_read_b128 v[216:219], v10 offset:0
  v_mul_f32 v179, v251, v179
  v_exp_f32 v176, v176
  v_mfma_f32_32x32x16_bf16 v[136:151], v[228:231], v[124:127], v[136:151]
  ds_read_b128 v[220:223], v10 offset:1024
  v_exp_f32 v177, v177
  v_exp_f32 v178, v178
  v_mfma_f32_32x32x16_bf16 v[136:151], a[228:231], v[240:243], v[136:151]
  v_exp_f32 v179, v179
  v_fma_f32 v176, v176, v252, v252
  v_fma_f32 v177, v177, v252, v252
  v_fma_f32 v178, v178, v252, v252
  s_waitcnt lgkmcnt(2)
  v_mfma_f32_32x32x16_bf16 v[136:151], v[232:235], v[128:131], v[136:151]
  ds_read_b128 v[224:227], v10 offset:2048
  v_fma_f32 v179, v179, v252, v252
  v_rcp_f32 v176, v176
  v_rcp_f32 v177, v177
  v_mfma_f32_32x32x16_bf16 v[136:151], v[236:239], v[132:135], v[136:151]
  ds_read_b128 v[228:231], v10 offset:3072
  v_rcp_f32 v178, v178
  v_rcp_f32 v179, v179
  s_waitcnt lgkmcnt(2)
  v_mfma_f32_32x32x16_bf16 v[152:167], v[216:219], v[24:27], 0
  ds_read_b128 v[232:235], v10 offset:4096
  v_mul_f32 v192, v192, v176
  v_mul_f32 v193, v193, v177
  v_mul_f32 v194, v194, v178
  v_mul_f32 v195, v195, v179
  v_cvt_pk_bf16_f32 v172, v192, v193
  v_mfma_f32_32x32x16_bf16 v[152:167], v[220:223], v[28:31], v[152:167]
  ds_read_b128 v[236:239], v10 offset:5120
  v_cvt_pk_bf16_f32 v173, v194, v195
  v_mul_f32 v180, v251, v180
  v_mul_f32 v181, v251, v181
  v_mul_f32 v182, v251, v182
  s_waitcnt lgkmcnt(2)
  v_mfma_f32_32x32x16_bf16 v[152:167], v[224:227], v[32:35], v[152:167]
  ds_read_b128 v[216:219], v10 offset:6144
  v_mul_f32 v183, v251, v183
  v_exp_f32 v180, v180
  v_exp_f32 v181, v181
  v_mfma_f32_32x32x16_bf16 v[152:167], v[228:231], v[36:39], v[152:167]
  ds_read_b128 v[220:223], v10 offset:7168
  v_exp_f32 v182, v182
  v_exp_f32 v183, v183
  s_waitcnt lgkmcnt(2)
  v_mfma_f32_32x32x16_bf16 v[152:167], v[232:235], v[40:43], v[152:167]
  ds_read_b128 v[224:227], v10 offset:8192
  v_fma_f32 v180, v180, v252, v252
  v_fma_f32 v181, v181, v252, v252
  v_fma_f32 v182, v182, v252, v252
  v_fma_f32 v183, v183, v252, v252
  v_mfma_f32_32x32x16_bf16 v[152:167], v[236:239], v[44:47], v[152:167]
  ds_read_b128 v[228:231], v10 offset:9216
  v_rcp_f32 v180, v180
  v_rcp_f32 v181, v181
  s_waitcnt lgkmcnt(2)
  v_mfma_f32_32x32x16_bf16 v[152:167], v[216:219], v[48:51], v[152:167]
  ds_read_b128 v[232:235], v10 offset:10240
  v_rcp_f32 v182, v182
  v_rcp_f32 v183, v183
  v_mul_f32 v196, v196, v180
  v_mfma_f32_32x32x16_bf16 v[152:167], v[220:223], v[52:55], v[152:167]
  ds_read_b128 v[236:239], v10 offset:11264
  s_add_u32 s84, s52, 5
  s_waitcnt vmcnt(0)
  v_subrev_u32 v15, s84, v15
  v_cmp_le_u32 vcc, 16, v15
  s_cbranch_vccnz Lslow_66
Lback_67:
  s_waitcnt lgkmcnt(2)
  v_mfma_f32_32x32x16_bf16 v[152:167], v[224:227], v[56:59], v[152:167]
  ds_read_b128 v[216:219], v10 offset:12288
  buffer_load_dwordx4 v[24:27], v246, s[40:43], 0 offen offset:0 sc1
  v_mul_f32 v197, v197, v181
  v_mul_f32 v198, v198, v182
  v_mul_f32 v199, v199, v183
  v_cvt_pk_bf16_f32 v174, v196, v197
  v_mfma_f32_32x32x16_bf16 v[152:167], v[228:231], v[60:63], v[152:167]
  ds_read_b128 v[220:223], v10 offset:13312
  v_cvt_pk_bf16_f32 v175, v198, v199
  buffer_store_dwordx4 v[172:175], v1, s[36:39], s91 offen offset:1024 sc1
  v_lshlrev_b32 v168, 16, v16
  v_and_b32 v169, 0xffff0000, v16
  s_waitcnt lgkmcnt(2)
  v_mfma_f32_32x32x16_bf16 v[152:167], v[232:235], v[64:67], v[152:167]
  ds_read_b128 v[224:227], v10 offset:14336
  buffer_load_dwordx4 v[28:31], v247, s[40:43], 0 offen offset:0 sc1
  v_lshlrev_b32 v170, 16, v17
  v_and_b32 v171, 0xffff0000, v17
  v_lshlrev_b32 v172, 16, v18
  v_and_b32 v173, 0xffff0000, v18
  v_mfma_f32_32x32x16_bf16 v[152:167], v[236:239], v[68:71], v[152:167]
  ds_read_b128 v[228:231], v10 offset:15360
  v_lshlrev_b32 v174, 16, v19
  v_and_b32 v175, 0xffff0000, v19
  v_lshlrev_b32 v176, 16, v20
  v_and_b32 v177, 0xffff0000, v20
  s_waitcnt lgkmcnt(2)
  v_mfma_f32_32x32x16_bf16 v[152:167], v[216:219], v[72:75], v[152:167]
  ds_read_b128 v[232:235], v10 offset:16384
  buffer_load_dwordx4 v[32:35], v246, s[40:43], 0 offen offset:1024 sc1
  v_lshlrev_b32 v178, 16, v21
  v_and_b32 v179, 0xffff0000, v21
  v_lshlrev_b32 v180, 16, v22
  v_and_b32 v181, 0xffff0000, v22
  v_mfma_f32_32x32x16_bf16 v[152:167], v[220:223], v[76:79], v[152:167]
  ds_read_b128 v[236:239], v10 offset:17408
  v_lshlrev_b32 v182, 16, v23
  v_and_b32 v183, 0xffff0000, v23
  s_add_u32 s91, s91, 8192
  v_lshrrev_b32 v249, 2, v1
  s_waitcnt lgkmcnt(2)
  v_mfma_f32_32x32x16_bf16 v[152:167], v[224:227], v[80:83], v[152:167]
  ds_read_b128 v[216:219], v10 offset:18432
  buffer_load_dwordx4 v[36:39], v247, s[40:43], 0 offen offset:1024 sc1
  v_and_b32 v249, 0x3c, v249
  v_mul_f32 v136, v251, v136
  v_mul_f32 v137, v251, v137
  v_mul_f32 v138, v251, v138
  v_mfma_f32_32x32x16_bf16 v[152:167], v[228:231], v[84:87], v[152:167]
  ds_read_b128 v[220:223], v10 offset:19456
  v_mul_f32 v139, v251, v139
  v_exp_f32 v136, v136
  s_waitcnt lgkmcnt(2)
  v_mfma_f32_32x32x16_bf16 v[152:167], v[232:235], v[88:91], v[152:167]
  ds_read_b128 v[224:227], v10 offset:20480
  buffer_load_dwordx4 v[40:43], v246, s[40:43], 0 offen offset:2048 sc1
  v_exp_f32 v137, v137
  v_exp_f32 v138, v138
  v_mfma_f32_32x32x16_bf16 v[152:167], v[236:239], v[92:95], v[152:167]
  ds_read_b128 v[228:231], v10 offset:21504
  v_exp_f32 v139, v139
  v_fma_f32 v136, v136, v252, v252
  v_fma_f32 v137, v137, v252, v252
  s_waitcnt lgkmcnt(2)
  v_mfma_f32_32x32x16_bf16 v[152:167], v[216:219], v[96:99], v[152:167]
  ds_read_b128 v[232:235], v10 offset:22528
  buffer_load_dwordx4 v[44:47], v247, s[40:43], 0 offen offset:2048 sc1
  v_fma_f32 v138, v138, v252, v252
  v_fma_f32 v139, v139, v252, v252
  v_rcp_f32 v136, v136
  v_mfma_f32_32x32x16_bf16 v[152:167], v[220:223], v[100:103], v[152:167]
  ds_read_b128 v[236:239], v10 offset:23552
  v_rcp_f32 v137, v137
  v_rcp_f32 v138, v138
  s_waitcnt lgkmcnt(2)
  v_mfma_f32_32x32x16_bf16 v[152:167], v[224:227], v[104:107], v[152:167]
  ds_read_b128 v[216:219], v10 offset:24576
  buffer_load_dwordx4 v[48:51], v246, s[40:43], 0 offen offset:3072 sc1
  v_rcp_f32 v139, v139
  v_mul_f32 v144, v144, v136
  v_mul_f32 v145, v145, v137
  v_mfma_f32_32x32x16_bf16 v[152:167], v[228:231], v[108:111], v[152:167]
  ds_read_b128 v[220:223], v10 offset:25600
  v_mul_f32 v146, v146, v138
  v_mul_f32 v147, v147, v139
  v_cvt_pk_bf16_f32 v136, v144, v145
  v_cvt_pk_bf16_f32 v137, v146, v147
  s_waitcnt lgkmcnt(2)
  v_mfma_f32_32x32x16_bf16 v[152:167], v[232:235], v[112:115], v[152:167]
  ds_read_b128 v[224:227], v10 offset:26624
  buffer_load_dwordx4 v[52:55], v247, s[40:43], 0 offen offset:3072 sc1
  v_mul_f32 v140, v251, v140
  v_mul_f32 v141, v251, v141
  v_mul_f32 v142, v251, v142
  v_mul_f32 v143, v251, v143
  v_mfma_f32_32x32x16_bf16 v[152:167], v[236:239], v[116:119], v[152:167]
  ds_read_b128 v[228:231], v10 offset:27648
  v_exp_f32 v140, v140
  v_exp_f32 v141, v141
  s_waitcnt lgkmcnt(2)
  v_mfma_f32_32x32x16_bf16 v[152:167], v[216:219], v[120:123], v[152:167]
  buffer_load_dwordx4 v[56:59], v246, s[40:43], s57 offen offset:0 sc1
  v_exp_f32 v142, v142
  v_exp_f32 v143, v143
  v_fma_f32 v140, v140, v252, v252
  v_mfma_f32_32x32x16_bf16 v[152:167], v[220:223], v[124:127], v[152:167]
  v_fma_f32 v141, v141, v252, v252
  v_fma_f32 v142, v142, v252, v252
  v_fma_f32 v143, v143, v252, v252
  v_rcp_f32 v140, v140
  v_mfma_f32_32x32x16_bf16 v[152:167], a[230:233], v[240:243], v[152:167]
  v_rcp_f32 v141, v141
  v_rcp_f32 v142, v142
  s_waitcnt lgkmcnt(0)
  v_mfma_f32_32x32x16_bf16 v[152:167], v[224:227], v[128:131], v[152:167]
  buffer_load_dwordx4 v[60:63], v247, s[40:43], s57 offen offset:0 sc1
  v_rcp_f32 v143, v143
  v_mul_f32 v148, v148, v140
  v_mul_f32 v149, v149, v141
  v_mul_f32 v150, v150, v142
  v_mfma_f32_32x32x16_bf16 v[152:167], v[228:231], v[132:135], v[152:167]
  v_mul_f32 v151, v151, v143
  v_cvt_pk_bf16_f32 v138, v148, v149
  v_cvt_pk_bf16_f32 v139, v150, v151
  buffer_store_dwordx4 v[136:139], v1, s[36:39], s91 offen offset:0 sc1
  s_waitcnt vmcnt(10)
  v_mfma_f32_32x32x16_bf16 v[168:183], a[0:3], v[24:27], v[168:183]
  s_add_u32 s83, s52, 5
  v_mov_b32 v255, s83
  buffer_store_dword v255, v4, s[36:39], s93 offen sc1
  v_mfma_f32_32x32x16_bf16 v[184:199], a[4:7], v[24:27], 0
  buffer_load_dwordx4 v[64:67], v246, s[40:43], s57 offen offset:1024 sc1
  v_mul_f32 v152, v251, v152
  v_mul_f32 v153, v251, v153
  v_mul_f32 v154, v251, v154
  v_mul_f32 v155, v251, v155
  s_waitcnt vmcnt(11)
  v_mfma_f32_32x32x16_bf16 v[200:215], a[0:3], v[28:31], 0
  v_exp_f32 v152, v152
  v_exp_f32 v153, v153
  v_exp_f32 v154, v154
  v_mfma_f32_32x32x16_bf16 v[216:231], a[4:7], v[28:31], 0
  buffer_load_dwordx4 v[68:71], v247, s[40:43], s57 offen offset:1024 sc1
  v_exp_f32 v155, v155
  v_fma_f32 v152, v152, v252, v252
  v_fma_f32 v153, v153, v252, v252
  s_waitcnt vmcnt(11)
  v_mfma_f32_32x32x16_bf16 v[168:183], a[8:11], v[32:35], v[168:183]
  v_fma_f32 v154, v154, v252, v252
  v_fma_f32 v155, v155, v252, v252
  v_rcp_f32 v152, v152
  v_rcp_f32 v153, v153
  v_mfma_f32_32x32x16_bf16 v[184:199], a[12:15], v[32:35], v[184:199]
  buffer_load_dwordx4 v[72:75], v246, s[40:43], s57 offen offset:2048 sc1
  v_rcp_f32 v154, v154
  v_rcp_f32 v155, v155
  s_waitcnt vmcnt(11)
  v_mfma_f32_32x32x16_bf16 v[200:215], a[8:11], v[36:39], v[200:215]
  v_mul_f32 v160, v160, v152
  v_mul_f32 v161, v161, v153
  v_mul_f32 v162, v162, v154
  v_mul_f32 v163, v163, v155
  v_cvt_pk_bf16_f32 v152, v160, v161
  v_cvt_pk_bf16_f32 v153, v162, v163
  v_mfma_f32_32x32x16_bf16 v[216:231], a[12:15], v[36:39], v[216:231]
  buffer_load_dwordx4 v[76:79], v247, s[40:43], s57 offen offset:2048 sc1
  v_mul_f32 v156, v251, v156
  v_mul_f32 v157, v251, v157
  v_mul_f32 v158, v251, v158
  v_mul_f32 v159, v251, v159
  s_waitcnt vmcnt(11)
  v_mfma_f32_32x32x16_bf16 v[168:183], a[16:19], v[40:43], v[168:183]
  v_exp_f32 v156, v156
  v_exp_f32 v157, v157
  v_exp_f32 v158, v158
  v_mfma_f32_32x32x16_bf16 v[184:199], a[20:23], v[40:43], v[184:199]
  buffer_load_dwordx4 v[80:83], v246, s[40:43], s57 offen offset:3072 sc1
  v_exp_f32 v159, v159
  v_fma_f32 v156, v156, v252, v252
  v_fma_f32 v157, v157, v252, v252
  s_waitcnt vmcnt(11)
  v_mfma_f32_32x32x16_bf16 v[200:215], a[16:19], v[44:47], v[200:215]
  v_fma_f32 v158, v158, v252, v252
  v_fma_f32 v159, v159, v252, v252
  v_rcp_f32 v156, v156
  v_rcp_f32 v157, v157
  v_mfma_f32_32x32x16_bf16 v[216:231], a[20:23], v[44:47], v[216:231]
  buffer_load_dwordx4 v[84:87], v247, s[40:43], s57 offen offset:3072 sc1
  v_rcp_f32 v158, v158
  v_rcp_f32 v159, v159
  s_waitcnt vmcnt(11)
  v_mfma_f32_32x32x16_bf16 v[168:183], a[24:27], v[48:51], v[168:183]
  v_mul_f32 v164, v164, v156
  v_mul_f32 v165, v165, v157
  v_mul_f32 v166, v166, v158
  v_mul_f32 v167, v167, v159
  v_cvt_pk_bf16_f32 v154, v164, v165
  v_cvt_pk_bf16_f32 v155, v166, v167
  v_mfma_f32_32x32x16_bf16 v[184:199], a[28:31], v[48:51], v[184:199]
  buffer_load_dword v15, v12, s[36:39], s95 offen sc1
  buffer_load_dwordx4 v[88:91], v246, s[40:43], s58 offen offset:0 sc1
  buffer_store_dwordx4 v[152:155], v1, s[36:39], s91 offen offset:1024 sc1
  s_waitcnt vmcnt(13)
  v_mfma_f32_32x32x16_bf16 v[200:215], a[24:27], v[52:55], v[200:215]
  v_mfma_f32_32x32x16_bf16 v[216:231], a[28:31], v[52:55], v[216:231]
  buffer_load_dwordx4 v[92:95], v247, s[40:43], s58 offen offset:0 sc1
  s_waitcnt vmcnt(13)
  v_mfma_f32_32x32x16_bf16 v[168:183], a[32:35], v[56:59], v[168:183]
  v_mfma_f32_32x32x16_bf16 v[184:199], a[36:39], v[56:59], v[184:199]
  buffer_load_dwordx4 v[96:99], v246, s[40:43], s58 offen offset:1024 sc1
  s_waitcnt vmcnt(13)
  v_mfma_f32_32x32x16_bf16 v[200:215], a[32:35], v[60:63], v[200:215]
  v_mfma_f32_32x32x16_bf16 v[216:231], a[36:39], v[60:63], v[216:231]
  buffer_load_dwordx4 v[100:103], v247, s[40:43], s58 offen offset:1024 sc1
  s_waitcnt vmcnt(11)
  v_mfma_f32_32x32x16_bf16 v[168:183], a[40:43], v[64:67], v[168:183]
  v_mfma_f32_32x32x16_bf16 v[184:199], a[44:47], v[64:67], v[184:199]
  buffer_load_dwordx4 v[104:107], v246, s[40:43], s58 offen offset:2048 sc1
  s_waitcnt vmcnt(11)
  v_mfma_f32_32x32x16_bf16 v[200:215], a[40:43], v[68:71], v[200:215]
  v_mfma_f32_32x32x16_bf16 v[216:231], a[44:47], v[68:71], v[216:231]
  buffer_load_dwordx4 v[108:111], v247, s[40:43], s58 offen offset:2048 sc1
  s_waitcnt vmcnt(11)
  v_mfma_f32_32x32x16_bf16 v[168:183], a[48:51], v[72:75], v[168:183]
  v_mfma_f32_32x32x16_bf16 v[184:199], a[52:55], v[72:75], v[184:199]
  buffer_load_dwordx4 v[112:115], v246, s[40:43], s58 offen offset:3072 sc1
  s_waitcnt vmcnt(11)
  v_mfma_f32_32x32x16_bf16 v[200:215], a[48:51], v[76:79], v[200:215]
  v_mfma_f32_32x32x16_bf16 v[216:231], a[52:55], v[76:79], v[216:231]
  buffer_load_dwordx4 v[116:119], v247, s[40:43], s58 offen offset:3072 sc1
  s_waitcnt vmcnt(11)
  v_mfma_f32_32x32x16_bf16 v[168:183], a[56:59], v[80:83], v[168:183]
  v_mfma_f32_32x32x16_bf16 v[184:199], a[60:63], v[80:83], v[184:199]
  s_add_u32 s84, s52, 5
  s_waitcnt vmcnt(9)
  v_subrev_u32 v15, s84, v15
  v_cmp_le_u32 vcc, 16, v15
  s_cbranch_vccnz Lslow_68
Lback_69:
  buffer_load_dwordx4 v[120:123], v246, s[40:43], s59 offen offset:0 sc1
  v_mfma_f32_32x32x16_bf16 v[200:215], a[56:59], v[84:87], v[200:215]
  v_mfma_f32_32x32x16_bf16 v[216:231], a[60:63], v[84:87], v[216:231]
  buffer_load_dwordx4 v[124:127], v247, s[40:43], s59 offen offset:0 sc1
  s_waitcnt vmcnt(10)
  v_mfma_f32_32x32x16_bf16 v[168:183], a[64:67], v[88:91], v[168:183]
  v_mfma_f32_32x32x16_bf16 v[184:199], a[68:71], v[88:91], v[184:199]
  buffer_load_dwordx4 v[128:131], v246, s[40:43], s59 offen offset:1024 sc1
  s_waitcnt vmcnt(9)
  v_mfma_f32_32x32x16_bf16 v[200:215], a[64:67], v[92:95], v[200:215]
  v_mfma_f32_32x32x16_bf16 v[216:231], a[68:71], v[92:95], v[216:231]
  buffer_load_dwordx4 v[132:135], v247, s[40:43], s59 offen offset:1024 sc1
  s_waitcnt vmcnt(9)
  v_mfma_f32_32x32x16_bf16 v[168:183], a[72:75], v[96:99], v[168:183]
  v_mfma_f32_32x32x16_bf16 v[184:199], a[76:79], v[96:99], v[184:199]
  buffer_load_dwordx4 v[24:27], v246, s[40:43], s59 offen offset:2048 sc1
  s_waitcnt vmcnt(9)
  v_mfma_f32_32x32x16_bf16 v[200:215], a[72:75], v[100:103], v[200:215]
  v_mfma_f32_32x32x16_bf16 v[216:231], a[76:79], v[100:103], v[216:231]
  buffer_load_dwordx4 v[28:31], v247, s[40:43], s59 offen offset:2048 sc1
  s_waitcnt vmcnt(9)
  v_mfma_f32_32x32x16_bf16 v[168:183], a[80:83], v[104:107], v[168:183]
  v_mfma_f32_32x32x16_bf16 v[184:199], a[84:87], v[104:107], v[184:199]
  buffer_load_dwordx4 v[32:35], v246, s[40:43], s59 offen offset:3072 sc1
  s_add_u32 s83, s52, 6
  v_mov_b32 v255, s83
  buffer_store_dword v255, v4, s[36:39], s93 offen sc1
  s_waitcnt vmcnt(10)
  v_mfma_f32_32x32x16_bf16 v[200:215], a[80:83], v[108:111], v[200:215]
  v_add_u32 v250, s64, v1
  s_xor_b32 s82, s3, 1
  s_mul_i32 s82, s82, 12288
  s_add_u32 s82, s82, 114688
  v_add_u32 v251, s82, v1
  s_xor_b32 s82, s3, 2
  v_mfma_f32_32x32x16_bf16 v[216:231], a[84:87], v[108:111], v[216:231]
  buffer_load_dwordx4 v[36:39], v247, s[40:43], s59 offen offset:3072 sc1
  s_mul_i32 s82, s82, 12288
  s_add_u32 s82, s82, 118784
  v_add_u32 v252, s82, v1
  s_xor_b32 s82, s3, 3
  s_waitcnt vmcnt(10)
  v_mfma_f32_32x32x16_bf16 v[168:183], a[88:91], v[112:115], v[168:183]
  s_mul_i32 s82, s82, 12288
  s_add_u32 s82, s82, 122880
  v_add_u32 v253, s82, v1
  s_lshl_b32 s80, s76, 15
  s_add_u32 s80, s80, 5242880
  s_lshl_b32 s79, s77, 11
  v_mfma_f32_32x32x16_bf16 v[184:199], a[92:95], v[112:115], v[184:199]
  buffer_load_dwordx4 v[40:43], v246, s[40:43], s60 offen offset:0 sc1
  s_add_u32 s78, s80, s79
  s_lshl_b32 s79, s55, 9
  s_add_u32 s79, s79, s80
  s_and_b32 s80, s3, 1
  s_waitcnt vmcnt(10)
  v_mfma_f32_32x32x16_bf16 v[200:215], a[88:91], v[116:119], v[200:215]
  s_lshl_b32 s80, s80, 3
  s_add_u32 s79, s79, s80
  s_add_u32 s79, s79, 28672
  s_lshl_b32 s80, s76, 7
  s_lshl_b32 s82, s77, 2
  s_add_u32 s80, s80, s82
  v_mfma_f32_32x32x16_bf16 v[216:231], a[92:95], v[116:119], v[216:231]
  buffer_load_dwordx4 v[44:47], v247, s[40:43], s60 offen offset:0 sc1
  s_add_u32 s80, s80, 24576
  s_waitcnt vmcnt(10)
  v_mfma_f32_32x32x16_bf16 v[168:183], a[96:99], v[120:123], v[168:183]
  v_mfma_f32_32x32x16_bf16 v[184:199], a[100:103], v[120:123], v[184:199]
  buffer_load_dwordx4 v[48:51], v246, s[40:43], s60 offen offset:1024 sc1
  s_waitcnt vmcnt(10)
  v_mfma_f32_32x32x16_bf16 v[200:215], a[96:99], v[124:127], v[200:215]
  v_mfma_f32_32x32x16_bf16 v[216:231], a[100:103], v[124:127], v[216:231]
  buffer_load_dword v15, v12, s[36:39], s95 offen sc1
  buffer_load_dwordx4 v[52:55], v247, s[40:43], s60 offen offset:1024 sc1
  s_waitcnt vmcnt(11)
  v_mfma_f32_32x32x16_bf16 v[168:183], a[104:107], v[128:131], v[168:183]
  v_mfma_f32_32x32x16_bf16 v[184:199], a[108:111], v[128:131], v[184:199]
  buffer_load_dwordx4 v[56:59], v246, s[40:43], s60 offen offset:2048 sc1
  s_waitcnt vmcnt(11)
  v_mfma_f32_32x32x16_bf16 v[200:215], a[104:107], v[132:135], v[200:215]
  v_mfma_f32_32x32x16_bf16 v[216:231], a[108:111], v[132:135], v[216:231]
  buffer_load_dwordx4 v[60:63], v247, s[40:43], s60 offen offset:2048 sc1
  s_waitcnt vmcnt(11)
  v_mfma_f32_32x32x16_bf16 v[168:183], a[112:115], v[24:27], v[168:183]
  v_mfma_f32_32x32x16_bf16 v[184:199], a[116:119], v[24:27], v[184:199]
  buffer_load_dwordx4 v[64:67], v246, s[40:43], s60 offen offset:3072 sc1
  s_waitcnt vmcnt(11)
  v_mfma_f32_32x32x16_bf16 v[200:215], a[112:115], v[28:31], v[200:215]
  v_mfma_f32_32x32x16_bf16 v[216:231], a[116:119], v[28:31], v[216:231]
  buffer_load_dwordx4 v[68:71], v247, s[40:43], s60 offen offset:3072 sc1
  s_waitcnt vmcnt(11)
  v_mfma_f32_32x32x16_bf16 v[168:183], a[120:123], v[32:35], v[168:183]
  v_mfma_f32_32x32x16_bf16 v[184:199], a[124:127], v[32:35], v[184:199]
  s_waitcnt vmcnt(9)
  v_mfma_f32_32x32x16_bf16 v[200:215], a[120:123], v[36:39], v[200:215]
  v_mfma_f32_32x32x16_bf16 v[216:231], a[124:127], v[36:39], v[216:231]
  s_waitcnt vmcnt(8)
  v_mfma_f32_32x32x16_bf16 v[168:183], a[128:131], v[40:43], v[168:183]
  v_mfma_f32_32x32x16_bf16 v[184:199], a[132:135], v[40:43], v[184:199]
  s_waitcnt vmcnt(7)
  v_mfma_f32_32x32x16_bf16 v[200:215], a[128:131], v[44:47], v[200:215]
  v_mfma_f32_32x32x16_bf16 v[216:231], a[132:135], v[44:47], v[216:231]
  s_add_u32 s84, s52, 6
  s_waitcnt vmcnt(5)
  v_subrev_u32 v15, s84, v15
  v_cmp_le_u32 vcc, 16, v15
  s_cbranch_vccnz Lslow_70
Lback_71:
  buffer_load_dwordx4 v[72:75], v246, s[40:43], s61 offen offset:0 sc1
  buffer_load_dwordx4 v[76:79], v247, s[40:43], s61 offen offset:0 sc1
  v_mfma_f32_32x32x16_bf16 v[168:183], a[136:139], v[48:51], v[168:183]
  v_mfma_f32_32x32x16_bf16 v[184:199], a[140:143], v[48:51], v[184:199]
  buffer_load_dwordx4 v[80:83], v246, s[40:43], s61 offen offset:1024 sc1
  buffer_load_dwordx4 v[84:87], v247, s[40:43], s61 offen offset:1024 sc1
  s_waitcnt vmcnt(8)
  v_mfma_f32_32x32x16_bf16 v[200:215], a[136:139], v[52:55], v[200:215]
  v_mfma_f32_32x32x16_bf16 v[216:231], a[140:143], v[52:55], v[216:231]
  buffer_load_dwordx4 v[92:95], v247, s[40:43], s61 offen offset:2048 sc1
  buffer_load_dwordx4 v[100:103], v247, s[40:43], s61 offen offset:3072 sc1
  s_waitcnt vmcnt(9)
  v_mfma_f32_32x32x16_bf16 v[168:183], a[144:147], v[56:59], v[168:183]
  v_mfma_f32_32x32x16_bf16 v[184:199], a[148:151], v[56:59], v[184:199]
  buffer_load_dwordx4 v[108:111], v247, s[40:43], s62 offen offset:0 sc1
  buffer_load_dwordx4 v[116:119], v247, s[40:43], s62 offen offset:1024 sc1
  s_waitcnt vmcnt(10)
  v_mfma_f32_32x32x16_bf16 v[200:215], a[144:147], v[60:63], v[200:215]
  v_mfma_f32_32x32x16_bf16 v[216:231], a[148:151], v[60:63], v[216:231]
  buffer_load_dwordx4 v[124:127], v247, s[40:43], s62 offen offset:2048 sc1
  buffer_load_dwordx4 v[132:135], v247, s[40:43], s62 offen offset:3072 sc1
  s_waitcnt vmcnt(11)
  v_mfma_f32_32x32x16_bf16 v[168:183], a[152:155], v[64:67], v[168:183]
  v_mfma_f32_32x32x16_bf16 v[184:199], a[156:159], v[64:67], v[184:199]
  buffer_load_dwordx4 v[88:91], v246, s[40:43], s61 offen offset:2048 sc1
  buffer_load_dwordx4 v[96:99], v246, s[40:43], s61 offen offset:3072 sc1
  s_waitcnt vmcnt(12)
  v_mfma_f32_32x32x16_bf16 v[200:215], a[152:155], v[68:71], v[200:215]
  v_mfma_f32_32x32x16_bf16 v[216:231], a[156:159], v[68:71], v[216:231]
  buffer_load_dwordx4 v[104:107], v246, s[40:43], s62 offen offset:0 sc1
  buffer_load_dwordx4 v[112:115], v246, s[40:43], s62 offen offset:1024 sc1
  s_waitcnt vmcnt(13)
  v_mfma_f32_32x32x16_bf16 v[168:183], a[160:163], v[72:75], v[168:183]
  v_mfma_f32_32x32x16_bf16 v[184:199], a[164:167], v[72:75], v[184:199]
  buffer_load_dwordx4 v[120:123], v246, s[40:43], s62 offen offset:2048 sc1
  s_waitcnt vmcnt(13)
  v_mfma_f32_32x32x16_bf16 v[200:215], a[160:163], v[76:79], v[200:215]
  v_mfma_f32_32x32x16_bf16 v[216:231], a[164:167], v[76:79], v[216:231]
  buffer_load_dwordx4 v[128:131], v246, s[40:43], s62 offen offset:3072 sc1
  s_waitcnt vmcnt(13)
  v_mfma_f32_32x32x16_bf16 v[168:183], a[168:171], v[80:83], v[168:183]
  v_mfma_f32_32x32x16_bf16 v[184:199], a[172:175], v[80:83], v[184:199]
  s_waitcnt vmcnt(12)
  v_mfma_f32_32x32x16_bf16 v[200:215], a[168:171], v[84:87], v[200:215]
  v_mfma_f32_32x32x16_bf16 v[216:231], a[172:175], v[84:87], v[216:231]
  s_waitcnt vmcnt(11)
  v_mfma_f32_32x32x16_bf16 v[216:231], a[180:183], v[92:95], v[216:231]
  s_waitcnt vmcnt(10)
  v_mfma_f32_32x32x16_bf16 v[216:231], a[188:191], v[100:103], v[216:231]
  s_waitcnt vmcnt(9)
  v_mfma_f32_32x32x16_bf16 v[216:231], a[196:199], v[108:111], v[216:231]
  s_waitcnt vmcnt(8)
  v_mfma_f32_32x32x16_bf16 v[216:231], a[204:207], v[116:119], v[216:231]
  s_waitcnt vmcnt(7)
  v_mfma_f32_32x32x16_bf16 v[216:231], a[212:215], v[124:127], v[216:231]
  s_waitcnt vmcnt(6)
  v_mfma_f32_32x32x16_bf16 v[216:231], a[220:223], v[132:135], v[216:231]
  v_mfma_f32_32x32x16_bf16 v[200:215], a[176:179], v[92:95], v[200:215]
  v_mfma_f32_32x32x16_bf16 v[200:215], a[184:187], v[100:103], v[200:215]
  ds_write_b128 v250, v[216:219] offset:8192
  v_mfma_f32_32x32x16_bf16 v[200:215], a[192:195], v[108:111], v[200:215]
  ds_write_b128 v250, v[220:223] offset:9216
  v_mfma_f32_32x32x16_bf16 v[200:215], a[200:203], v[116:119], v[200:215]
  ds_write_b128 v250, v[224:227] offset:10240
  v_mfma_f32_32x32x16_bf16 v[200:215], a[208:211], v[124:127], v[200:215]
  ds_write_b128 v250, v[228:231] offset:11264
  v_mfma_f32_32x32x16_bf16 v[200:215], a[216:219], v[132:135], v[200:215]
  s_waitcnt vmcnt(5)
  v_mfma_f32_32x32x16_bf16 v[184:199], a[180:183], v[88:91], v[184:199]
  s_waitcnt vmcnt(4)
  v_mfma_f32_32x32x16_bf16 v[184:199], a[188:191], v[96:99], v[184:199]
  s_cmp_lg_u32 s71, 124
  s_cbranch_scc1 Lwb_72
  buffer_wbl2 sc0 sc1
Lwb_72:
  ds_write_b128 v250, v[200:203] offset:4096
  s_waitcnt vmcnt(3)
  v_mfma_f32_32x32x16_bf16 v[184:199], a[196:199], v[104:107], v[184:199]
  ds_write_b128 v250, v[204:207] offset:5120
  s_waitcnt vmcnt(2)
  v_mfma_f32_32x32x16_bf16 v[184:199], a[204:207], v[112:115], v[184:199]
  ds_write_b128 v250, v[208:211] offset:6144
  s_waitcnt vmcnt(1)
  v_mfma_f32_32x32x16_bf16 v[184:199], a[212:215], v[120:123], v[184:199]
  ds_write_b128 v250, v[212:215] offset:7168
  s_waitcnt vmcnt(0)
  v_mfma_f32_32x32x16_bf16 v[184:199], a[220:223], v[128:131], v[184:199]
  v_mfma_f32_32x32x16_bf16 v[168:183], a[176:179], v[88:91], v[168:183]
  v_mfma_f32_32x32x16_bf16 v[168:183], a[184:187], v[96:99], v[168:183]
  ds_write_b128 v250, v[184:187] offset:0
  v_mfma_f32_32x32x16_bf16 v[168:183], a[192:195], v[104:107], v[168:183]
  ds_write_b128 v250, v[188:191] offset:1024
  v_mfma_f32_32x32x16_bf16 v[168:183], a[200:203], v[112:115], v[168:183]
  ds_write_b128 v250, v[192:195] offset:2048
  v_mfma_f32_32x32x16_bf16 v[168:183], a[208:211], v[120:123], v[168:183]
  ds_write_b128 v250, v[196:199] offset:3072
  v_mfma_f32_32x32x16_bf16 v[168:183], a[216:219], v[128:131], v[168:183]
  s_waitcnt lgkmcnt(0)
  s_barrier
  ds_read_b128 v[184:187], v251 offset:0
  ds_read_b128 v[200:203], v252 offset:0
  ds_read_b128 v[216:219], v253 offset:0
  ds_read_b128 v[188:191], v251 offset:1024
  ds_read_b128 v[204:207], v252 offset:1024
  ds_read_b128 v[220:223], v253 offset:1024
  ds_read_b128 v[192:195], v251 offset:2048
  ds_read_b128 v[208:211], v252 offset:2048
  ds_read_b128 v[224:227], v253 offset:2048
  ds_read_b128 v[196:199], v251 offset:3072
  ds_read_b128 v[212:215], v252 offset:3072
  ds_read_b128 v[228:231], v253 offset:3072
  v_mov_b32 v254, 0
  v_mov_b32 v255, 0
  s_waitcnt lgkmcnt(9)
  v_pk_add_f32 v[168:169], v[168:169], v[184:185]
  v_pk_add_f32 v[200:201], v[200:201], v[216:217]
  v_pk_add_f32 v[170:171], v[170:171], v[186:187]
  v_pk_add_f32 v[202:203], v[202:203], v[218:219]
  v_pk_add_f32 v[168:169], v[168:169], v[200:201]
  v_pk_add_f32 v[170:171], v[170:171], v[202:203]
  v_cvt_pk_bf16_f32 v16, v168, v169
  v_cvt_pk_bf16_f32 v17, v170, v171
  s_waitcnt lgkmcnt(6)
  v_pk_add_f32 v[172:173], v[172:173], v[188:189]
  v_pk_add_f32 v[204:205], v[204:205], v[220:221]
  v_pk_add_f32 v[174:175], v[174:175], v[190:191]
  v_pk_add_f32 v[206:207], v[206:207], v[222:223]
  v_pk_add_f32 v[172:173], v[172:173], v[204:205]
  v_pk_add_f32 v[174:175], v[174:175], v[206:207]
  v_cvt_pk_bf16_f32 v18, v172, v173
  v_cvt_pk_bf16_f32 v19, v174, v175
  buffer_store_dwordx4 v[16:19], v9, s[32:35], 0 offen offset:0
  s_waitcnt lgkmcnt(3)
  v_pk_add_f32 v[176:177], v[176:177], v[192:193]
  v_pk_add_f32 v[208:209], v[208:209], v[224:225]
  v_pk_add_f32 v[178:179], v[178:179], v[194:195]
  v_pk_add_f32 v[210:211], v[210:211], v[226:227]
  v_pk_add_f32 v[176:177], v[176:177], v[208:209]
  v_pk_add_f32 v[178:179], v[178:179], v[210:211]
  v_cvt_pk_bf16_f32 v20, v176, v177
  v_cvt_pk_bf16_f32 v21, v178, v179
  s_waitcnt lgkmcnt(0)
  v_pk_add_f32 v[180:181], v[180:181], v[196:197]
  v_pk_add_f32 v[212:213], v[212:213], v[228:229]
  v_pk_add_f32 v[182:183], v[182:183], v[198:199]
  v_pk_add_f32 v[214:215], v[214:215], v[230:231]
  v_pk_add_f32 v[180:181], v[180:181], v[212:213]
  v_pk_add_f32 v[182:183], v[182:183], v[214:215]
  v_cvt_pk_bf16_f32 v22, v180, v181
  v_cvt_pk_bf16_f32 v23, v182, v183
  buffer_store_dwordx4 v[20:23], v9, s[32:35], 0 offen offset:32
  s_add_u32 s78, s101, 1
  v_mov_b32 v250, s78
  s_lshl_b32 s79, s2, 2
  s_add_u32 s79, s79, s3
  s_cmp_lg_u32 s79, 0
  s_cselect_b32 s80, 0x40000000, 0
  buffer_store_dword v250, v4, s[36:39], s80 offen sc1
  s_endpgm
Lre_44:
  s_add_u32 s53, s53, 1
  s_cmp_gt_u32 s53, 0x20000
  s_cbranch_scc1 Lgd_45
  buffer_load_dwordx4 v[184:187], v246, s[36:39], 0 offen offset:0 sc1
  buffer_load_dwordx4 v[188:191], v246, s[36:39], 0 offen offset:1024 sc1
  buffer_load_dwordx4 v[192:195], v246, s[36:39], 0 offen offset:2048 sc1
  buffer_load_dwordx4 v[196:199], v246, s[36:39], 0 offen offset:3072 sc1
  buffer_load_dwordx4 v[200:203], v246, s[36:39], s57 offen offset:0 sc1
  buffer_load_dwordx4 v[204:207], v246, s[36:39], s57 offen offset:1024 sc1
  buffer_load_dwordx4 v[208:211], v246, s[36:39], s57 offen offset:2048 sc1
  buffer_load_dwordx4 v[212:215], v246, s[36:39], s57 offen offset:3072 sc1
  s_waitcnt vmcnt(0)
  v_xor_b32 v252, v187, v253
  v_bitop3_b32 v252, v252, v191, v253 bitop3:0xf6
  v_bitop3_b32 v252, v252, v195, v253 bitop3:0xf6
  v_bitop3_b32 v252, v252, v199, v253 bitop3:0xf6
  v_bitop3_b32 v252, v252, v203, v253 bitop3:0xf6
  v_bitop3_b32 v252, v252, v207, v253 bitop3:0xf6
  v_bitop3_b32 v252, v252, v211, v253 bitop3:0xf6
  v_bitop3_b32 v252, v252, v215, v253 bitop3:0xf6
  v_cmp_ne_u32 vcc, 0, v252
  s_nop 1
  s_and_b64 vcc, vcc, s[80:81]
  s_cbranch_scc1 Lre_44
  s_branch Lchk_43
Lslow_50:
  buffer_load_dword v15, v12, s[36:39], s94 offen sc1
  s_add_u32 s53, s53, 1
  s_cmp_gt_u32 s53, 0x20000
  s_cbranch_scc1 Lback_51
  s_waitcnt vmcnt(0)
  v_subrev_u32 v15, s84, v15
  v_cmp_le_u32 vcc, 16, v15
  s_cbranch_vccnz Lslow_50
  s_branch Lback_51
Lslow_52:
  buffer_load_dword v15, v12, s[36:39], s95 offen sc1
  s_add_u32 s53, s53, 1
  s_cmp_gt_u32 s53, 0x20000
  s_cbranch_scc1 Lback_53
  s_waitcnt vmcnt(0)
  v_subrev_u32 v15, s84, v15
  v_cmp_le_u32 vcc, 16, v15
  s_cbranch_vccnz Lslow_52
  s_branch Lback_53
Lslow_54:
  buffer_load_dword v15, v12, s[36:39], s95 offen sc1
  s_add_u32 s53, s53, 1
  s_cmp_gt_u32 s53, 0x20000
  s_cbranch_scc1 Lback_55
  s_waitcnt vmcnt(0)
  v_subrev_u32 v15, s84, v15
  v_cmp_le_u32 vcc, 16, v15
  s_cbranch_vccnz Lslow_54
  s_branch Lback_55
Lre_59:
  s_add_u32 s53, s53, 1
  s_cmp_gt_u32 s53, 0x20000
  s_cbranch_scc1 Lgd_60
  buffer_load_dwordx4 v[184:187], v246, s[36:39], 0 offen offset:0 sc1
  buffer_load_dwordx4 v[188:191], v246, s[36:39], 0 offen offset:1024 sc1
  buffer_load_dwordx4 v[192:195], v246, s[36:39], 0 offen offset:2048 sc1
  buffer_load_dwordx4 v[196:199], v246, s[36:39], 0 offen offset:3072 sc1
  buffer_load_dwordx4 v[200:203], v246, s[36:39], s57 offen offset:0 sc1
  buffer_load_dwordx4 v[204:207], v246, s[36:39], s57 offen offset:1024 sc1
  buffer_load_dwordx4 v[208:211], v246, s[36:39], s57 offen offset:2048 sc1
  buffer_load_dwordx4 v[212:215], v246, s[36:39], s57 offen offset:3072 sc1
  s_waitcnt vmcnt(0)
  v_xor_b32 v252, v187, v253
  v_bitop3_b32 v252, v252, v191, v253 bitop3:0xf6
  v_bitop3_b32 v252, v252, v195, v253 bitop3:0xf6
  v_bitop3_b32 v252, v252, v199, v253 bitop3:0xf6
  v_bitop3_b32 v252, v252, v203, v253 bitop3:0xf6
  v_bitop3_b32 v252, v252, v207, v253 bitop3:0xf6
  v_bitop3_b32 v252, v252, v211, v253 bitop3:0xf6
  v_bitop3_b32 v252, v252, v215, v253 bitop3:0xf6
  v_cmp_ne_u32 vcc, 0, v252
  s_nop 1
  s_and_b64 vcc, vcc, s[80:81]
  s_cbranch_scc1 Lre_59
  s_branch Lchk_58
Lslow_66:
  buffer_load_dword v15, v12, s[36:39], s94 offen sc1
  s_add_u32 s53, s53, 1
  s_cmp_gt_u32 s53, 0x20000
  s_cbranch_scc1 Lback_67
  s_waitcnt vmcnt(0)
  v_subrev_u32 v15, s84, v15
  v_cmp_le_u32 vcc, 16, v15
  s_cbranch_vccnz Lslow_66
  s_branch Lback_67
Lslow_68:
  buffer_load_dword v15, v12, s[36:39], s95 offen sc1
  s_add_u32 s53, s53, 1
  s_cmp_gt_u32 s53, 0x20000
  s_cbranch_scc1 Lback_69
  s_waitcnt vmcnt(0)
  v_subrev_u32 v15, s84, v15
  v_cmp_le_u32 vcc, 16, v15
  s_cbranch_vccnz Lslow_68
  s_branch Lback_69
Lslow_70:
  buffer_load_dword v15, v12, s[36:39], s95 offen sc1
  s_add_u32 s53, s53, 1
  s_cmp_gt_u32 s53, 0x20000
  s_cbranch_scc1 Lback_71
  s_waitcnt vmcnt(0)
  v_subrev_u32 v15, s84, v15
  v_cmp_le_u32 vcc, 16, v15
  s_cbranch_vccnz Lslow_70
  s_branch Lback_71
L_end:
  s_endpgm
.section .rodata,"a"
.p2align 6
.amdhsa_kernel interleave_layers__linear_attn_block__glu_gated_glu__prompt_kernel
  .amdhsa_next_free_vgpr 512
  .amdhsa_next_free_sgpr 102
  .amdhsa_accum_offset 256
  .amdhsa_group_segment_fixed_size 0
  .amdhsa_kernarg_size 80
  .amdhsa_user_sgpr_count 2
  .amdhsa_user_sgpr_kernarg_segment_ptr 1
  .amdhsa_system_sgpr_workgroup_id_x 1
.end_amdhsa_kernel
```
